```python
import torch

def _softmax(x, axis=-1):
    return torch.softmax(x, dim=axis)
def _gelu(x):
    return torch.nn.functional.gelu(x, approximate="tanh")
def _silu(x):
    return torch.nn.functional.silu(x)
def _sigmoid(x):
    return torch.sigmoid(x)
def _layernorm(x, axis=-1, eps=1e-5):
    m = x.mean(dim=axis, keepdim=True)
    v = x.var(dim=axis, keepdim=True, unbiased=False)
    return (x - m) / torch.sqrt(v + eps)
def _scatter_add(tgt, idx, src, axis=0):
    return tgt.clone().index_add_(axis, idx, src)
def _segment_sum(src, seg, n):
    out = torch.zeros((n,) + src.shape[1:], dtype=src.dtype)
    return out.index_add_(0, seg, src)
def _pad(x, pw):
    flat = tuple(v for pair in reversed(pw) for v in pair)
    return torch.nn.functional.pad(x, flat)

kernel_name = 'parallel_sum__ssm_conv_s5__dense_activation_silu__prompt'

def setup_inputs():

    _w = (lambda a: (lambda t: t.to(torch.bfloat16) if t.is_floating_point() else t)(torch.as_tensor(a)))
    def _A_setup():
        B, S, D = 1, 2048, 576
        P = D
        Lambda_re = -0.5 * (lambda _x: torch.exp(torch.as_tensor(_x)))((lambda *s: torch.randn(*s, dtype=torch.bfloat16) * 0.2)(P))
        Lambda_im = (lambda *s: torch.randn(*s, dtype=torch.bfloat16) * 0.8)(P) * 1.0
        B_re = (lambda *s: torch.randn(*s, dtype=torch.bfloat16) * 0.2)(P, D) * (D ** -0.5)
        B_im = (lambda *s: torch.randn(*s, dtype=torch.bfloat16) * 0.2)(P, D) * (D ** -0.5)
        C_re = (lambda *s: torch.randn(*s, dtype=torch.bfloat16) * 0.2)(D, P) * (P ** -0.5)
        C_im = (lambda *s: torch.randn(*s, dtype=torch.bfloat16) * 0.2)(D, P) * (P ** -0.5)
        log_dt = (lambda *s: torch.randn(*s, dtype=torch.bfloat16) * 0.2)(P) * 0.3 - 2.0
        Dskip = (lambda *s: torch.randn(*s, dtype=torch.bfloat16) * 0.05)(D)
        return {
            "x": _w((lambda *s: torch.randn(*s, dtype=torch.bfloat16) * 0.05)(B, S, D)),
            "Lambda_re": _w(Lambda_re),
            "Lambda_im": _w(Lambda_im),
            "B_re": _w(B_re),
            "B_im": _w(B_im),
            "C_re": _w(C_re),
            "C_im": _w(C_im),
            "log_dt": _w(log_dt),
            "Dskip": _w(Dskip),
        }
    _A_in = _A_setup()

    def _B_setup():
        B, S, D, F = 1, 2048, 576, 4608
        return {
            "x": _w((lambda *s: torch.randn(*s, dtype=torch.bfloat16) * 0.05)(B, S, D)),
            "w1": _w((lambda *s: torch.randn(*s, dtype=torch.bfloat16) * 0.8)(D, F) * (D ** -0.5)),
            "w2": _w((lambda *s: torch.randn(*s, dtype=torch.bfloat16) * 0.2)(F, D) * (F ** -0.5)),
        }
    _B_in = _B_setup()

    return {
        "A_x": _A_in["x"],
        "A_Lambda_re": _A_in["Lambda_re"],
        "A_Lambda_im": _A_in["Lambda_im"],
        "A_B_re": _A_in["B_re"],
        "A_B_im": _A_in["B_im"],
        "A_C_re": _A_in["C_re"],
        "A_C_im": _A_in["C_im"],
        "A_log_dt": _A_in["log_dt"],
        "A_Dskip": _A_in["Dskip"],
        "B_x": _B_in["x"],
        "B_w1": _B_in["w1"],
        "B_w2": _B_in["w2"],
    }

def reference(A_x, A_Lambda_re, A_Lambda_im, A_B_re, A_B_im, A_C_re, A_C_im, A_log_dt, A_Dskip, B_x, B_w1, B_w2):
    def _A_ref(x, Lambda_re, Lambda_im, B_re, B_im, C_re, C_im, log_dt, Dskip):
        Bsz, L, H = x.shape
        Lam = Lambda_re + 1j * Lambda_im
        Bmat = B_re + 1j * B_im
        Cmat = C_re + 1j * C_im
        dt = torch.exp(log_dt)
        Lam_bar = torch.exp(dt * Lam)
        B_bar = ((Lam_bar - 1.0) / Lam)[:, None] * Bmat
        Bu = torch.einsum("bld,pd->blp", x + 0j, B_bar)
        h = torch.zeros_like(Bu[:, 0, :])
        hs = []
        for t in range(L):
            h = Lam_bar[None, :] * h + Bu[:, t, :]
            hs.append(h)
        hseq = torch.stack(hs, 1)
        y = 2.0 * torch.einsum("blp,dp->bld", hseq, Cmat).real + x * Dskip[None, None, :]
        return y

    def _B_ref(x, w1, w2):
        h = torch.einsum("bsd,df->bsf", x, w1)
        h = _silu(h)
        out = torch.einsum("bsf,fd->bsd", h, w2)
        return out

    x = A_x
    xn = _layernorm(x, axis=-1)
    return x + _A_ref(xn, A_Lambda_re, A_Lambda_im, A_B_re, A_B_im, A_C_re, A_C_im, A_log_dt, A_Dskip) + _B_ref(xn, B_w1, B_w2)
```

```asm
; @launch grid=(256,1,1) block=(256,1,1) lds=163840
.amdgcn_target "amdgcn-amd-amdhsa--gfx950"
.text
.globl parallel_sum__ssm_conv_s5__dense_activation_silu__prompt_kernel
.p2align 8
.type parallel_sum__ssm_conv_s5__dense_activation_silu__prompt_kernel,@function
parallel_sum__ssm_conv_s5__dense_activation_silu__prompt_kernel:
    s_cmp_ge_u32 s2, 256
    s_cbranch_scc0 L_go
    s_endpgm
L_go:
    s_load_dwordx16 s[16:31], s[0:1], 0
    s_load_dwordx8 s[32:39], s[0:1], 64
    s_load_dwordx4 s[40:43], s[0:1], 96
    s_load_dwordx2 s[44:45], s[0:1], 112
    s_getpc_b64 s[12:13]
L_pc:
    v_lshrrev_b32 v1, 6, v0
    v_and_b32 v0, 63, v0
    v_readfirstlane_b32 s3, v1
    s_lshr_b32 s11, s2, 3
    s_and_b32 s5, s11, 3
    s_bfe_u32 s6, s2, 0x20001
    s_and_b32 s14, s2, 1
    s_lshl_b32 s14, s14, 3
    s_lshr_b32 s4, s11, 2
    s_add_u32 s4, s4, s14
    s_lshl_b32 s14, s11, 2
    s_add_u32 s14, s14, s3
    s_mul_i32 s14, s14, 6
    v_min_u32 v1, 5, v0
    v_add_u32 v1, s14, v1
    v_lshlrev_b32 v1, 7, v1
    v_min_u32 v1, L_code_end-L_pc-4, v1
    v_mov_b32 v3, s13
    v_add_co_u32 v2, vcc, s12, v1
    s_nop 1
    v_addc_co_u32 v3, vcc, 0, v3, vcc
    global_load_dword v4, v[2:3], off
    s_lshl_b32 s46, s4, 2
    s_add_u32 s46, s46, s3
    s_lshl_b32 s15, s46, 5
    v_lshrrev_b32 v6, 5, v0
    v_bfe_u32 v1, v0, 3, 2
    v_lshl_add_u32 v1, v6, 3, v1
    v_add_u32 v1, s15, v1
    v_mul_u32_u24 v1, 1152, v1
    v_and_b32 v2, 7, v0
    v_lshrrev_b32 v3, 4, v0
    v_xor_b32 v2, v2, v3
    v_lshl_add_u32 v40, v2, 4, v1
    v_xor_b32 v2, 4, v2
    v_lshl_add_u32 v41, v2, 4, v1
    v_add_u32 v42, 2560, v40
    v_add_u32 v43, 19968, v41
    v_add_u32 v41, 17408, v41
    s_mul_i32 s47, s3, 36864
    v_bfe_u32 v5, v0, 2, 2
    v_lshlrev_b32 v5, 3, v5
    v_bfe_u32 v1, v0, 4, 1
    v_lshl_add_u32 v5, v1, 2, v5
    v_and_b32 v1, 3, v0
    v_add_u32 v5, v5, v1
    v_and_b32 v1, 15, v0
    v_bfe_u32 v2, v0, 1, 3
    v_lshrrev_b32 v3, 4, v0
    v_xor_b32 v2, v2, v3
    v_lshlrev_b32 v2, 4, v2
    v_lshl_add_u32 v32, v1, 7, v2
    v_xor_b32 v33, 64, v32
    v_add_u32 v36, s47, v32
    v_add_u32 v37, s47, v33
    s_mul_i32 s7, s6, 3
    s_add_u32 s7, s7, s5
    s_add_u32 s14, s6, 12
    s_cmp_eq_u32 s5, 3
    s_cselect_b32 s7, s14, s7
    s_lshl_b32 s14, s46, 4
    s_add_u32 s14, s14, s7
    s_mul_i32 s14, s14, 1152
    s_add_u32 s14, s14, 0x2900000
    v_lshlrev_b32 v7, 30, v6
    v_lshl_add_u32 v7, v0, 2, v7
    v_add_u32 v7, s14, v7
    s_mov_b32 s69, 0
    v_lshl_add_u32 v44, v0, 4, s14
    v_mov_b32 v46, 0
    v_mov_b32 v47, 0
    v_mov_b32 v48, 0
    v_mov_b32 v49, 0
    v_mov_b32 v9, 0
    v_mov_b32 v10, 0
    v_mov_b32 v11, 0
    v_mov_b32 v12, 0
    s_mul_i32 s9, s5, 384
    s_movk_i32 s68, 128
    s_cmp_eq_u32 s5, 3
    s_cselect_b32 s9, 0x100, s9
    s_cselect_b32 s68, 0x180, s68
    s_waitcnt lgkmcnt(0)
    s_mov_b32 s48, s16
    s_mov_b32 s49, s17
    s_mov_b32 s50, 0x240000
    s_mov_b32 s51, 0x20000
    s_add_u32 m0, s47, 0
    s_nop 0
    buffer_load_dwordx4 v40, s[48:51], s9 offen offset:0 lds
    buffer_load_dwordx4 v41, s[48:51], s9 offen offset:1024 lds
    buffer_load_dwordx4 v42, s[48:51], s9 offen offset:2048 lds
    buffer_load_dwordx4 v43, s[48:51], s9 offen offset:3072 lds
    s_add_u32 m0, s47, 4096
    s_add_u32 s9, s9, s68
    buffer_load_dwordx4 v40, s[48:51], s9 offen offset:0 lds
    buffer_load_dwordx4 v41, s[48:51], s9 offen offset:1024 lds
    buffer_load_dwordx4 v42, s[48:51], s9 offen offset:2048 lds
    buffer_load_dwordx4 v43, s[48:51], s9 offen offset:3072 lds
    s_add_u32 m0, s47, 8192
    s_add_u32 s9, s9, s68
    buffer_load_dwordx4 v40, s[48:51], s9 offen offset:0 lds
    buffer_load_dwordx4 v41, s[48:51], s9 offen offset:1024 lds
    buffer_load_dwordx4 v42, s[48:51], s9 offen offset:2048 lds
    buffer_load_dwordx4 v43, s[48:51], s9 offen offset:3072 lds
    s_cmp_eq_u32 s5, 3
    s_cbranch_scc1 L_ssm
    s_mov_b32 s60, s44
    s_mov_b32 s61, s45
    s_mov_b32 s62, 0x10000000
    s_mov_b32 s63, 0x20000
    s_mov_b32 s52, s36
    s_mov_b32 s53, s37
    s_mov_b32 s54, 0x510000
    s_mov_b32 s55, 0x20000
    s_mov_b32 s56, s38
    s_mov_b32 s57, s39
    s_mov_b32 s58, 0x510000
    s_mov_b32 s59, 0x20000
    s_mov_b32 s64, s40
    s_mov_b32 s65, s41
    s_mov_b32 s66, 0x480000
    s_mov_b32 s67, 0x20000
    s_mul_i32 s12, s6, 3
    s_add_u32 s14, s5, 0
    s_cmp_ge_u32 s14, 3
    s_cselect_b32 s13, 3, 0
    s_sub_u32 s14, s14, s13
    s_mul_i32 s24, s14, 1769472
    s_add_u32 s14, s14, s12
    s_mul_i32 s18, s14, 442368
    s_mul_i32 s28, s14, 24576
    s_add_u32 s14, s5, 1
    s_cmp_ge_u32 s14, 3
    s_cselect_b32 s13, 3, 0
    s_sub_u32 s14, s14, s13
    s_mul_i32 s25, s14, 1769472
    s_add_u32 s14, s14, s12
    s_mul_i32 s19, s14, 442368
    s_mul_i32 s29, s14, 24576
    s_mul_i32 s97, s14, 1152
    s_add_u32 s14, s5, 2
    s_cmp_ge_u32 s14, 3
    s_cselect_b32 s13, 3, 0
    s_sub_u32 s14, s14, s13
    s_mul_i32 s26, s14, 1769472
    s_add_u32 s14, s14, s12
    s_mul_i32 s20, s14, 442368
    s_mul_i32 s30, s14, 24576
    s_mul_i32 s98, s14, 1152
    s_mul_i32 s12, s5, 3
    s_lshr_b32 s13, s6, 1
    s_add_u32 s21, s12, 2
    s_add_u32 s23, s12, s13
    s_xor_b32 s13, s13, 1
    s_add_u32 s22, s12, s13
    s_lshl_b32 s94, s21, 7
    s_lshl_b32 s95, s22, 7
    s_lshl_b32 s96, s23, 7
    v_lshrrev_b32 v1, 3, v0
    v_and_b32 v2, 7, v0
    v_and_b32 v3, 6, v1
    v_xor_b32 v25, v2, v3
    v_and_b32 v3, 2, v1
    v_xor_b32 v2, v2, v3
    s_mul_i32 s14, s3, 48
    v_add_u32 v1, s14, v1
    v_mul_u32_u24 v3, 1152, v1
    v_lshl_add_u32 v25, v25, 4, v3
    v_mul_u32_u24 v3, 9216, v1
    s_mul_i32 s14, s7, 768
    v_add_u32 v3, s14, v3
    v_lshl_add_u32 v13, v2, 4, v3
    v_xor_b32 v2, 4, v2
    v_lshl_add_u32 v2, v2, 4, v3
    v_add_u32 v14, 72704, v2
    v_add_u32 v26, 8192, v25
    v_add_u32 v15, 145408, v13
    v_add_u32 v27, 16384, v25
    v_add_u32 v16, 221184, v2
    v_add_u32 v28, 27648, v25
    v_add_u32 v17, 293888, v13
    v_add_u32 v29, 35840, v25
    v_add_u32 v18, 366592, v2
    v_add_u32 v30, 44032, v25
    s_mul_i32 s8, s3, 6144
    s_mul_i32 s13, s46, 27
    s_mul_i32 s14, s7, 3456
    s_add_u32 s13, s13, s14
    v_min_u32 v1, 26, v0
    v_add_u32 v1, s13, v1
    v_lshlrev_b32 v31, 7, v1
    s_mul_i32 s13, s46, 9
    v_min_u32 v1, 17, v0
    v_lshrrev_b32 v2, 1, v1
    v_and_b32 v3, 1, v1
    v_add_u32 v1, s13, v2
    v_mul_u32_u24 v1, 9216, v1
    v_lshl_add_u32 v1, v3, 7, v1
    s_mul_i32 s14, s7, 768
    v_add_u32 v3, s14, v1
    s_mul_i32 s14, s46, 294912
    s_add_u32 s14, s14, 0x1400000
    v_lshl_add_u32 v8, v0, 4, s14
    v_bfe_u32 v1, v0, 2, 2
    v_lshrrev_b32 v2, 4, v0
    v_lshl_add_u32 v1, v2, 3, v1
    v_lshlrev_b32 v1, 7, v1
    v_and_b32 v2, 3, v0
    v_lshl_add_u32 v1, v2, 3, v1
    v_bfe_u32 v2, v0, 3, 2
    v_lshl_add_u32 v19, v2, 5, v1
    v_xor_b32 v20, 32, v19
    v_xor_b32 v21, 64, v19
    v_xor_b32 v22, 96, v19
    s_and_b32 s27, s6, 1
    s_lshl_b32 s68, s4, 3
    s_mul_i32 s99, s46, 18432
    s_add_u32 s99, s99, 0x2900000
    s_lshl_b32 s31, s3, 8
    s_add_u32 s31, s31, 0x24000
    v_and_b32 v1, 31, v5
    v_lshl_add_u32 v45, v1, 3, s31
    s_lshl_b32 s12, s27, 6
    s_add_u32 s12, s12, s96
    s_lshl_b32 s13, s46, 5
    v_lshrrev_b32 v1, 2, v0
    v_add_u32 v1, s13, v1
    v_mul_u32_u24 v1, 1152, v1
    v_and_b32 v2, 3, v0
    v_lshl_add_u32 v1, v2, 4, v1
    v_add_u32 v105, s12, v1
    v_and_b32 v2, 15, v0
    v_lshl_add_u32 v104, v2, 2, s12
    s_mov_b64 exec, 0
    s_cmp_eq_u32 s3, 1
    s_cbranch_scc1 L_wf4
    s_cmp_eq_u32 s3, 2
    s_cbranch_scc1 L_wf8
    s_cmp_eq_u32 s3, 3
    s_cbranch_scc1 L_wf12
L_wf0:
    s_branch L_pf0
L_rf0:
L_wf1:
    s_branch L_pf1
L_rf1:
L_wf2:
    s_branch L_pf2
L_rf2:
L_wf3:
    s_branch L_wfe
L_wf4:
    s_branch L_pf4
L_rf4:
L_wf5:
    s_branch L_pf5
L_rf5:
L_wf6:
    s_branch L_pf6
L_rf6:
L_wf7:
    s_branch L_wfe
L_wf8:
    s_branch L_pf8
L_rf8:
L_wf9:
    s_branch L_pf9
L_rf9:
L_wf10:
    s_branch L_pf10
L_rf10:
L_wf11:
    s_branch L_wfe
L_wf12:
    s_branch L_pf12
L_rf12:
L_wf13:
    s_branch L_pf13
L_rf13:
L_wf14:
L_wf15:
L_wfe:
    s_mov_b64 exec, -1
    s_branch L_warmed_f
.p2align 12
L_warmed_f:
    s_mov_b32 s14, 0x3f803f80
    s_mov_b32 s15, 0xffff0000
    s_waitcnt vmcnt(8)
    ds_read_b128 v[112:115], v36 offset:0
    ds_read_b128 v[116:119], v36 offset:2048
    ds_read_b128 v[120:123], v37 offset:0
    ds_read_b128 v[124:127], v37 offset:2048
    s_add_u32 m0, s47, 12288
    s_add_u32 s9, s9, 128
    s_cmp_eq_u32 s9, 1152
    s_cselect_b32 s9, 0, s9
    buffer_load_dwordx4 v40, s[48:51], s9 offen offset:0 lds
    buffer_load_dwordx4 v41, s[48:51], s9 offen offset:1024 lds
    buffer_load_dwordx4 v42, s[48:51], s9 offen offset:2048 lds
    buffer_load_dwordx4 v43, s[48:51], s9 offen offset:3072 lds
    s_waitcnt lgkmcnt(0)
    v_dot2c_f32_bf16 v9, s14, v112
    v_dot2c_f32_bf16 v11, v112, v112
    v_dot2c_f32_bf16 v10, s14, v116
    v_dot2c_f32_bf16 v12, v116, v116
    v_dot2c_f32_bf16 v9, s14, v113
    v_dot2c_f32_bf16 v11, v113, v113
    v_dot2c_f32_bf16 v10, s14, v117
    v_dot2c_f32_bf16 v12, v117, v117
    v_dot2c_f32_bf16 v9, s14, v114
    v_dot2c_f32_bf16 v11, v114, v114
    v_dot2c_f32_bf16 v10, s14, v118
    v_dot2c_f32_bf16 v12, v118, v118
    v_dot2c_f32_bf16 v9, s14, v115
    v_dot2c_f32_bf16 v11, v115, v115
    v_dot2c_f32_bf16 v10, s14, v119
    v_dot2c_f32_bf16 v12, v119, v119
    v_dot2c_f32_bf16 v9, s14, v120
    v_dot2c_f32_bf16 v11, v120, v120
    v_dot2c_f32_bf16 v10, s14, v124
    v_dot2c_f32_bf16 v12, v124, v124
    v_dot2c_f32_bf16 v9, s14, v121
    v_dot2c_f32_bf16 v11, v121, v121
    v_dot2c_f32_bf16 v10, s14, v125
    v_dot2c_f32_bf16 v12, v125, v125
    v_dot2c_f32_bf16 v9, s14, v122
    v_dot2c_f32_bf16 v11, v122, v122
    v_dot2c_f32_bf16 v10, s14, v126
    v_dot2c_f32_bf16 v12, v126, v126
    v_dot2c_f32_bf16 v9, s14, v123
    v_dot2c_f32_bf16 v11, v123, v123
    v_dot2c_f32_bf16 v10, s14, v127
    v_dot2c_f32_bf16 v12, v127, v127
    s_waitcnt vmcnt(8)
    ds_read_b128 v[128:131], v36 offset:4096
    ds_read_b128 v[132:135], v36 offset:6144
    ds_read_b128 v[136:139], v37 offset:4096
    ds_read_b128 v[140:143], v37 offset:6144
    s_add_u32 m0, s47, 16384
    s_add_u32 s9, s9, 128
    buffer_load_dwordx4 v40, s[48:51], s9 offen offset:0 lds
    buffer_load_dwordx4 v41, s[48:51], s9 offen offset:1024 lds
    buffer_load_dwordx4 v42, s[48:51], s9 offen offset:2048 lds
    buffer_load_dwordx4 v43, s[48:51], s9 offen offset:3072 lds
    s_waitcnt lgkmcnt(0)
    v_dot2c_f32_bf16 v9, s14, v128
    v_dot2c_f32_bf16 v11, v128, v128
    v_dot2c_f32_bf16 v10, s14, v132
    v_dot2c_f32_bf16 v12, v132, v132
    v_dot2c_f32_bf16 v9, s14, v129
    v_dot2c_f32_bf16 v11, v129, v129
    v_dot2c_f32_bf16 v10, s14, v133
    v_dot2c_f32_bf16 v12, v133, v133
    v_dot2c_f32_bf16 v9, s14, v130
    v_dot2c_f32_bf16 v11, v130, v130
    v_dot2c_f32_bf16 v10, s14, v134
    v_dot2c_f32_bf16 v12, v134, v134
    v_dot2c_f32_bf16 v9, s14, v131
    v_dot2c_f32_bf16 v11, v131, v131
    v_dot2c_f32_bf16 v10, s14, v135
    v_dot2c_f32_bf16 v12, v135, v135
    v_dot2c_f32_bf16 v9, s14, v136
    v_dot2c_f32_bf16 v11, v136, v136
    v_dot2c_f32_bf16 v10, s14, v140
    v_dot2c_f32_bf16 v12, v140, v140
    v_dot2c_f32_bf16 v9, s14, v137
    v_dot2c_f32_bf16 v11, v137, v137
    v_dot2c_f32_bf16 v10, s14, v141
    v_dot2c_f32_bf16 v12, v141, v141
    v_dot2c_f32_bf16 v9, s14, v138
    v_dot2c_f32_bf16 v11, v138, v138
    v_dot2c_f32_bf16 v10, s14, v142
    v_dot2c_f32_bf16 v12, v142, v142
    v_dot2c_f32_bf16 v9, s14, v139
    v_dot2c_f32_bf16 v11, v139, v139
    v_dot2c_f32_bf16 v10, s14, v143
    v_dot2c_f32_bf16 v12, v143, v143
    s_waitcnt vmcnt(8)
    ds_read_b128 v[144:147], v36 offset:8192
    ds_read_b128 v[148:151], v36 offset:10240
    ds_read_b128 v[152:155], v37 offset:8192
    ds_read_b128 v[156:159], v37 offset:10240
    s_add_u32 m0, s47, 20480
    s_add_u32 s9, s9, 128
    buffer_load_dwordx4 v40, s[48:51], s9 offen offset:0 lds
    buffer_load_dwordx4 v41, s[48:51], s9 offen offset:1024 lds
    buffer_load_dwordx4 v42, s[48:51], s9 offen offset:2048 lds
    buffer_load_dwordx4 v43, s[48:51], s9 offen offset:3072 lds
    s_waitcnt lgkmcnt(0)
    v_dot2c_f32_bf16 v9, s14, v144
    v_dot2c_f32_bf16 v11, v144, v144
    v_dot2c_f32_bf16 v10, s14, v148
    v_dot2c_f32_bf16 v12, v148, v148
    v_dot2c_f32_bf16 v9, s14, v145
    v_dot2c_f32_bf16 v11, v145, v145
    v_dot2c_f32_bf16 v10, s14, v149
    v_dot2c_f32_bf16 v12, v149, v149
    v_dot2c_f32_bf16 v9, s14, v146
    v_dot2c_f32_bf16 v11, v146, v146
    v_dot2c_f32_bf16 v10, s14, v150
    v_dot2c_f32_bf16 v12, v150, v150
    v_dot2c_f32_bf16 v9, s14, v147
    v_dot2c_f32_bf16 v11, v147, v147
    v_dot2c_f32_bf16 v10, s14, v151
    v_dot2c_f32_bf16 v12, v151, v151
    v_dot2c_f32_bf16 v9, s14, v152
    v_dot2c_f32_bf16 v11, v152, v152
    v_dot2c_f32_bf16 v10, s14, v156
    v_dot2c_f32_bf16 v12, v156, v156
    v_dot2c_f32_bf16 v9, s14, v153
    v_dot2c_f32_bf16 v11, v153, v153
    v_dot2c_f32_bf16 v10, s14, v157
    v_dot2c_f32_bf16 v12, v157, v157
    v_dot2c_f32_bf16 v9, s14, v154
    v_dot2c_f32_bf16 v11, v154, v154
    v_dot2c_f32_bf16 v10, s14, v158
    v_dot2c_f32_bf16 v12, v158, v158
    v_dot2c_f32_bf16 v9, s14, v155
    v_dot2c_f32_bf16 v11, v155, v155
    v_dot2c_f32_bf16 v10, s14, v159
    v_dot2c_f32_bf16 v12, v159, v159
    s_waitcnt vmcnt(8)
    ds_read_b128 v[160:163], v36 offset:12288
    ds_read_b128 v[164:167], v36 offset:14336
    ds_read_b128 v[168:171], v37 offset:12288
    ds_read_b128 v[172:175], v37 offset:14336
    s_add_u32 m0, s47, 24576
    s_add_u32 s9, s9, 128
    s_cmp_eq_u32 s9, 1152
    s_cselect_b32 s9, 0, s9
    buffer_load_dwordx4 v40, s[48:51], s9 offen offset:0 lds
    buffer_load_dwordx4 v41, s[48:51], s9 offen offset:1024 lds
    buffer_load_dwordx4 v42, s[48:51], s9 offen offset:2048 lds
    buffer_load_dwordx4 v43, s[48:51], s9 offen offset:3072 lds
    s_waitcnt lgkmcnt(0)
    v_dot2c_f32_bf16 v9, s14, v160
    v_dot2c_f32_bf16 v11, v160, v160
    v_dot2c_f32_bf16 v10, s14, v164
    v_dot2c_f32_bf16 v12, v164, v164
    v_dot2c_f32_bf16 v9, s14, v161
    v_dot2c_f32_bf16 v11, v161, v161
    v_dot2c_f32_bf16 v10, s14, v165
    v_dot2c_f32_bf16 v12, v165, v165
    v_dot2c_f32_bf16 v9, s14, v162
    v_dot2c_f32_bf16 v11, v162, v162
    v_dot2c_f32_bf16 v10, s14, v166
    v_dot2c_f32_bf16 v12, v166, v166
    v_dot2c_f32_bf16 v9, s14, v163
    v_dot2c_f32_bf16 v11, v163, v163
    v_dot2c_f32_bf16 v10, s14, v167
    v_dot2c_f32_bf16 v12, v167, v167
    v_dot2c_f32_bf16 v9, s14, v168
    v_dot2c_f32_bf16 v11, v168, v168
    v_dot2c_f32_bf16 v10, s14, v172
    v_dot2c_f32_bf16 v12, v172, v172
    v_dot2c_f32_bf16 v9, s14, v169
    v_dot2c_f32_bf16 v11, v169, v169
    v_dot2c_f32_bf16 v10, s14, v173
    v_dot2c_f32_bf16 v12, v173, v173
    v_dot2c_f32_bf16 v9, s14, v170
    v_dot2c_f32_bf16 v11, v170, v170
    v_dot2c_f32_bf16 v10, s14, v174
    v_dot2c_f32_bf16 v12, v174, v174
    v_dot2c_f32_bf16 v9, s14, v171
    v_dot2c_f32_bf16 v11, v171, v171
    v_dot2c_f32_bf16 v10, s14, v175
    v_dot2c_f32_bf16 v12, v175, v175
    s_waitcnt vmcnt(8)
    ds_read_b128 v[176:179], v36 offset:16384
    ds_read_b128 v[180:183], v36 offset:18432
    ds_read_b128 v[184:187], v37 offset:16384
    ds_read_b128 v[188:191], v37 offset:18432
    s_add_u32 m0, s47, 28672
    s_add_u32 s9, s9, 128
    buffer_load_dwordx4 v40, s[48:51], s9 offen offset:0 lds
    buffer_load_dwordx4 v41, s[48:51], s9 offen offset:1024 lds
    buffer_load_dwordx4 v42, s[48:51], s9 offen offset:2048 lds
    buffer_load_dwordx4 v43, s[48:51], s9 offen offset:3072 lds
    s_waitcnt lgkmcnt(0)
    v_dot2c_f32_bf16 v9, s14, v176
    v_dot2c_f32_bf16 v11, v176, v176
    v_dot2c_f32_bf16 v10, s14, v180
    v_dot2c_f32_bf16 v12, v180, v180
    v_dot2c_f32_bf16 v9, s14, v177
    v_dot2c_f32_bf16 v11, v177, v177
    v_dot2c_f32_bf16 v10, s14, v181
    v_dot2c_f32_bf16 v12, v181, v181
    v_dot2c_f32_bf16 v9, s14, v178
    v_dot2c_f32_bf16 v11, v178, v178
    v_dot2c_f32_bf16 v10, s14, v182
    v_dot2c_f32_bf16 v12, v182, v182
    v_dot2c_f32_bf16 v9, s14, v179
    v_dot2c_f32_bf16 v11, v179, v179
    v_dot2c_f32_bf16 v10, s14, v183
    v_dot2c_f32_bf16 v12, v183, v183
    v_dot2c_f32_bf16 v9, s14, v184
    v_dot2c_f32_bf16 v11, v184, v184
    v_dot2c_f32_bf16 v10, s14, v188
    v_dot2c_f32_bf16 v12, v188, v188
    v_dot2c_f32_bf16 v9, s14, v185
    v_dot2c_f32_bf16 v11, v185, v185
    v_dot2c_f32_bf16 v10, s14, v189
    v_dot2c_f32_bf16 v12, v189, v189
    v_dot2c_f32_bf16 v9, s14, v186
    v_dot2c_f32_bf16 v11, v186, v186
    v_dot2c_f32_bf16 v10, s14, v190
    v_dot2c_f32_bf16 v12, v190, v190
    v_dot2c_f32_bf16 v9, s14, v187
    v_dot2c_f32_bf16 v11, v187, v187
    v_dot2c_f32_bf16 v10, s14, v191
    v_dot2c_f32_bf16 v12, v191, v191
    s_waitcnt vmcnt(8)
    ds_read_b128 v[192:195], v36 offset:20480
    ds_read_b128 v[196:199], v36 offset:22528
    ds_read_b128 v[200:203], v37 offset:20480
    ds_read_b128 v[204:207], v37 offset:22528
    s_add_u32 m0, s47, 32768
    s_add_u32 s9, s9, 128
    buffer_load_dwordx4 v40, s[48:51], s9 offen offset:0 lds
    buffer_load_dwordx4 v41, s[48:51], s9 offen offset:1024 lds
    buffer_load_dwordx4 v42, s[48:51], s9 offen offset:2048 lds
    buffer_load_dwordx4 v43, s[48:51], s9 offen offset:3072 lds
    s_waitcnt lgkmcnt(0)
    v_dot2c_f32_bf16 v9, s14, v192
    v_dot2c_f32_bf16 v11, v192, v192
    v_dot2c_f32_bf16 v10, s14, v196
    v_dot2c_f32_bf16 v12, v196, v196
    v_dot2c_f32_bf16 v9, s14, v193
    v_dot2c_f32_bf16 v11, v193, v193
    v_dot2c_f32_bf16 v10, s14, v197
    v_dot2c_f32_bf16 v12, v197, v197
    v_dot2c_f32_bf16 v9, s14, v194
    v_dot2c_f32_bf16 v11, v194, v194
    v_dot2c_f32_bf16 v10, s14, v198
    v_dot2c_f32_bf16 v12, v198, v198
    v_dot2c_f32_bf16 v9, s14, v195
    v_dot2c_f32_bf16 v11, v195, v195
    v_dot2c_f32_bf16 v10, s14, v199
    v_dot2c_f32_bf16 v12, v199, v199
    v_dot2c_f32_bf16 v9, s14, v200
    v_dot2c_f32_bf16 v11, v200, v200
    v_dot2c_f32_bf16 v10, s14, v204
    v_dot2c_f32_bf16 v12, v204, v204
    v_dot2c_f32_bf16 v9, s14, v201
    v_dot2c_f32_bf16 v11, v201, v201
    v_dot2c_f32_bf16 v10, s14, v205
    v_dot2c_f32_bf16 v12, v205, v205
    v_dot2c_f32_bf16 v9, s14, v202
    v_dot2c_f32_bf16 v11, v202, v202
    v_dot2c_f32_bf16 v10, s14, v206
    v_dot2c_f32_bf16 v12, v206, v206
    v_dot2c_f32_bf16 v9, s14, v203
    v_dot2c_f32_bf16 v11, v203, v203
    v_dot2c_f32_bf16 v10, s14, v207
    v_dot2c_f32_bf16 v12, v207, v207
    s_waitcnt vmcnt(8)
    ds_read_b128 v[208:211], v36 offset:24576
    ds_read_b128 v[212:215], v36 offset:26624
    ds_read_b128 v[216:219], v37 offset:24576
    ds_read_b128 v[220:223], v37 offset:26624
    s_waitcnt lgkmcnt(0)
    v_dot2c_f32_bf16 v9, s14, v208
    v_dot2c_f32_bf16 v11, v208, v208
    v_dot2c_f32_bf16 v10, s14, v212
    v_dot2c_f32_bf16 v12, v212, v212
    v_dot2c_f32_bf16 v9, s14, v209
    v_dot2c_f32_bf16 v11, v209, v209
    v_dot2c_f32_bf16 v10, s14, v213
    v_dot2c_f32_bf16 v12, v213, v213
    v_dot2c_f32_bf16 v9, s14, v210
    v_dot2c_f32_bf16 v11, v210, v210
    v_dot2c_f32_bf16 v10, s14, v214
    v_dot2c_f32_bf16 v12, v214, v214
    v_dot2c_f32_bf16 v9, s14, v211
    v_dot2c_f32_bf16 v11, v211, v211
    v_dot2c_f32_bf16 v10, s14, v215
    v_dot2c_f32_bf16 v12, v215, v215
    v_dot2c_f32_bf16 v9, s14, v216
    v_dot2c_f32_bf16 v11, v216, v216
    v_dot2c_f32_bf16 v10, s14, v220
    v_dot2c_f32_bf16 v12, v220, v220
    v_dot2c_f32_bf16 v9, s14, v217
    v_dot2c_f32_bf16 v11, v217, v217
    v_dot2c_f32_bf16 v10, s14, v221
    v_dot2c_f32_bf16 v12, v221, v221
    v_dot2c_f32_bf16 v9, s14, v218
    v_dot2c_f32_bf16 v11, v218, v218
    v_dot2c_f32_bf16 v10, s14, v222
    v_dot2c_f32_bf16 v12, v222, v222
    v_dot2c_f32_bf16 v9, s14, v219
    v_dot2c_f32_bf16 v11, v219, v219
    v_dot2c_f32_bf16 v10, s14, v223
    v_dot2c_f32_bf16 v12, v223, v223
    s_waitcnt vmcnt(4)
    ds_read_b128 v[224:227], v36 offset:28672
    ds_read_b128 v[228:231], v36 offset:30720
    ds_read_b128 v[232:235], v37 offset:28672
    ds_read_b128 v[236:239], v37 offset:30720
    buffer_load_dword v4, v3, s[52:55], 0 offen offset:0
    s_waitcnt lgkmcnt(0)
    v_dot2c_f32_bf16 v9, s14, v224
    v_dot2c_f32_bf16 v11, v224, v224
    v_dot2c_f32_bf16 v10, s14, v228
    v_dot2c_f32_bf16 v12, v228, v228
    v_dot2c_f32_bf16 v9, s14, v225
    v_dot2c_f32_bf16 v11, v225, v225
    v_dot2c_f32_bf16 v10, s14, v229
    v_dot2c_f32_bf16 v12, v229, v229
    v_dot2c_f32_bf16 v9, s14, v226
    v_dot2c_f32_bf16 v11, v226, v226
    v_dot2c_f32_bf16 v10, s14, v230
    v_dot2c_f32_bf16 v12, v230, v230
    v_dot2c_f32_bf16 v9, s14, v227
    v_dot2c_f32_bf16 v11, v227, v227
    v_dot2c_f32_bf16 v10, s14, v231
    v_dot2c_f32_bf16 v12, v231, v231
    v_dot2c_f32_bf16 v9, s14, v232
    v_dot2c_f32_bf16 v11, v232, v232
    v_dot2c_f32_bf16 v10, s14, v236
    v_dot2c_f32_bf16 v12, v236, v236
    v_dot2c_f32_bf16 v9, s14, v233
    v_dot2c_f32_bf16 v11, v233, v233
    v_dot2c_f32_bf16 v10, s14, v237
    v_dot2c_f32_bf16 v12, v237, v237
    v_dot2c_f32_bf16 v9, s14, v234
    v_dot2c_f32_bf16 v11, v234, v234
    v_dot2c_f32_bf16 v10, s14, v238
    v_dot2c_f32_bf16 v12, v238, v238
    v_dot2c_f32_bf16 v9, s14, v235
    v_dot2c_f32_bf16 v11, v235, v235
    v_dot2c_f32_bf16 v10, s14, v239
    v_dot2c_f32_bf16 v12, v239, v239
    s_waitcnt vmcnt(1)
    ds_read_b128 v[240:243], v36 offset:32768
    ds_read_b128 v[244:247], v36 offset:34816
    ds_read_b128 v[248:251], v37 offset:32768
    ds_read_b128 v[252:255], v37 offset:34816
    s_waitcnt lgkmcnt(0)
    s_barrier
    s_add_u32 s9, s24, 0
    s_add_u32 m0, s8, 0x0
    s_nop 0
    buffer_load_dwordx4 v13, s[52:55], s9 offen offset:0 nt lds
    buffer_load_dwordx4 v14, s[52:55], s9 offen offset:1024 nt lds
    buffer_load_dwordx4 v15, s[52:55], s9 offen offset:2048 nt lds
    s_add_u32 m0, s8, 0xc00
    s_nop 0
    buffer_load_dwordx4 v16, s[52:55], s9 offen offset:0 nt lds
    buffer_load_dwordx4 v17, s[52:55], s9 offen offset:1024 nt lds
    buffer_load_dwordx4 v18, s[52:55], s9 offen offset:2048 nt lds
    v_dot2c_f32_bf16 v9, s14, v240
    v_dot2c_f32_bf16 v11, v240, v240
    v_dot2c_f32_bf16 v10, s14, v244
    v_dot2c_f32_bf16 v12, v244, v244
    v_dot2c_f32_bf16 v9, s14, v241
    v_dot2c_f32_bf16 v11, v241, v241
    v_dot2c_f32_bf16 v10, s14, v245
    v_dot2c_f32_bf16 v12, v245, v245
    v_dot2c_f32_bf16 v9, s14, v242
    v_dot2c_f32_bf16 v11, v242, v242
    v_dot2c_f32_bf16 v10, s14, v246
    v_dot2c_f32_bf16 v12, v246, v246
    v_dot2c_f32_bf16 v9, s14, v243
    v_dot2c_f32_bf16 v11, v243, v243
    v_dot2c_f32_bf16 v10, s14, v247
    v_dot2c_f32_bf16 v12, v247, v247
    v_dot2c_f32_bf16 v9, s14, v248
    v_dot2c_f32_bf16 v11, v248, v248
    v_dot2c_f32_bf16 v10, s14, v252
    v_dot2c_f32_bf16 v12, v252, v252
    v_dot2c_f32_bf16 v9, s14, v249
    v_dot2c_f32_bf16 v11, v249, v249
    v_dot2c_f32_bf16 v10, s14, v253
    v_dot2c_f32_bf16 v12, v253, v253
    v_dot2c_f32_bf16 v9, s14, v250
    v_dot2c_f32_bf16 v11, v250, v250
    v_dot2c_f32_bf16 v10, s14, v254
    v_dot2c_f32_bf16 v12, v254, v254
    v_dot2c_f32_bf16 v9, s14, v251
    v_dot2c_f32_bf16 v11, v251, v251
    v_dot2c_f32_bf16 v10, s14, v255
    v_dot2c_f32_bf16 v12, v255, v255
    s_nop 1
    v_permlane16_swap_b32 v9, v10
    v_permlane16_swap_b32 v11, v12
    v_add_f32 v9, v9, v10
    v_add_f32 v11, v11, v12
    v_mov_b32 v10, v9
    v_mov_b32 v12, v11
    s_nop 0
    v_permlane32_swap_b32 v9, v10
    v_permlane32_swap_b32 v11, v12
    v_add_f32 v9, v9, v10
    v_add_f32 v11, v11, v12
    v_mul_f32 v9, 0x3ae38e39, v9
    v_mul_f32 v11, 0x3ae38e39, v11
    v_fma_f32 v12, -v9, v9, v11
    v_max_f32 v12, 0, v12
    v_cvt_pk_bf16_f32 v10, v9, v12
    v_lshlrev_b32 v9, 16, v10
    v_and_b32 v12, 0xffff0000, v10
    v_add_f32 v12, 0x3727c5ac, v12
    v_cvt_pk_bf16_f32 v12, v12, v12
    v_and_b32 v12, 0xffff0000, v12
    v_sqrt_f32 v12, v12
    s_nop 0
    v_cvt_pk_bf16_f32 v12, v12, v12
    v_and_b32 v12, 0xffff0000, v12
    v_rcp_f32 v12, v12
    s_nop 0
    v_mul_f32 v10, 0xbfb8aa3b, v12
    v_mul_f32 v11, v10, v9
    v_xor_b32 v11, 0x80000000, v11
    s_mov_b32 s15, 0xffff0000
    v_mov_b32 v108, v10
    v_mov_b32 v109, v11
    s_nop 0
    v_permlane16_swap_b32 v10, v108
    v_permlane16_swap_b32 v11, v109
    s_and_b32 s34, s4, 7
    v_mul_f32_e64 v50, -v9, v12
    v_mov_b32 v51, v12
    ds_write_b64 v45, v[50:51]
    v_and_b32 v1, 1, v0
    s_sub_u32 s12, s98, s97
    v_mul_i32_i24 v1, s12, v1
    s_add_u32 s12, s97, s99
    v_add_u32 v9, s12, v1
    v_lshlrev_b32 v32, 16, v112
    v_and_b32 v33, s15, v112
    v_lshlrev_b32 v34, 16, v113
    v_and_b32 v35, s15, v113
    v_pk_fma_f32 v[32:33], v[32:33], v[10:11], v[10:11] op_sel:[0,0,1] op_sel_hi:[1,0,1]
    v_pk_fma_f32 v[34:35], v[34:35], v[10:11], v[10:11] op_sel:[0,0,1] op_sel_hi:[1,0,1]
    v_cvt_pk_bf16_f32 v112, v32, v33
    v_cvt_pk_bf16_f32 v113, v34, v35
    v_lshlrev_b32 v32, 16, v114
    v_and_b32 v33, s15, v114
    v_lshlrev_b32 v34, 16, v115
    v_and_b32 v35, s15, v115
    v_pk_fma_f32 v[32:33], v[32:33], v[10:11], v[10:11] op_sel:[0,0,1] op_sel_hi:[1,0,1]
    v_pk_fma_f32 v[34:35], v[34:35], v[10:11], v[10:11] op_sel:[0,0,1] op_sel_hi:[1,0,1]
    v_cvt_pk_bf16_f32 v114, v32, v33
    v_cvt_pk_bf16_f32 v115, v34, v35
    v_lshlrev_b32 v36, 16, v116
    v_and_b32 v37, s15, v116
    v_lshlrev_b32 v38, 16, v117
    v_and_b32 v39, s15, v117
    v_pk_fma_f32 v[36:37], v[36:37], v[108:109], v[108:109] op_sel:[0,0,1] op_sel_hi:[1,0,1]
    v_pk_fma_f32 v[38:39], v[38:39], v[108:109], v[108:109] op_sel:[0,0,1] op_sel_hi:[1,0,1]
    v_cvt_pk_bf16_f32 v116, v36, v37
    v_cvt_pk_bf16_f32 v117, v38, v39
    v_lshlrev_b32 v36, 16, v118
    v_and_b32 v37, s15, v118
    v_lshlrev_b32 v38, 16, v119
    v_and_b32 v39, s15, v119
    v_pk_fma_f32 v[36:37], v[36:37], v[108:109], v[108:109] op_sel:[0,0,1] op_sel_hi:[1,0,1]
    v_pk_fma_f32 v[38:39], v[38:39], v[108:109], v[108:109] op_sel:[0,0,1] op_sel_hi:[1,0,1]
    v_cvt_pk_bf16_f32 v118, v36, v37
    v_cvt_pk_bf16_f32 v119, v38, v39
    v_lshlrev_b32 v32, 16, v120
    v_and_b32 v33, s15, v120
    v_lshlrev_b32 v34, 16, v121
    v_and_b32 v35, s15, v121
    v_pk_fma_f32 v[32:33], v[32:33], v[10:11], v[10:11] op_sel:[0,0,1] op_sel_hi:[1,0,1]
    v_pk_fma_f32 v[34:35], v[34:35], v[10:11], v[10:11] op_sel:[0,0,1] op_sel_hi:[1,0,1]
    v_cvt_pk_bf16_f32 v120, v32, v33
    v_cvt_pk_bf16_f32 v121, v34, v35
    v_lshlrev_b32 v32, 16, v122
    v_and_b32 v33, s15, v122
    v_lshlrev_b32 v34, 16, v123
    v_and_b32 v35, s15, v123
    v_pk_fma_f32 v[32:33], v[32:33], v[10:11], v[10:11] op_sel:[0,0,1] op_sel_hi:[1,0,1]
    v_pk_fma_f32 v[34:35], v[34:35], v[10:11], v[10:11] op_sel:[0,0,1] op_sel_hi:[1,0,1]
    v_cvt_pk_bf16_f32 v122, v32, v33
    v_cvt_pk_bf16_f32 v123, v34, v35
    v_lshlrev_b32 v36, 16, v124
    v_and_b32 v37, s15, v124
    v_lshlrev_b32 v38, 16, v125
    v_and_b32 v39, s15, v125
    v_pk_fma_f32 v[36:37], v[36:37], v[108:109], v[108:109] op_sel:[0,0,1] op_sel_hi:[1,0,1]
    v_pk_fma_f32 v[38:39], v[38:39], v[108:109], v[108:109] op_sel:[0,0,1] op_sel_hi:[1,0,1]
    v_cvt_pk_bf16_f32 v124, v36, v37
    v_cvt_pk_bf16_f32 v125, v38, v39
    v_lshlrev_b32 v36, 16, v126
    v_and_b32 v37, s15, v126
    v_lshlrev_b32 v38, 16, v127
    v_and_b32 v39, s15, v127
    v_pk_fma_f32 v[36:37], v[36:37], v[108:109], v[108:109] op_sel:[0,0,1] op_sel_hi:[1,0,1]
    v_pk_fma_f32 v[38:39], v[38:39], v[108:109], v[108:109] op_sel:[0,0,1] op_sel_hi:[1,0,1]
    v_cvt_pk_bf16_f32 v126, v36, v37
    v_cvt_pk_bf16_f32 v127, v38, v39
    v_lshlrev_b32 v32, 16, v128
    v_and_b32 v33, s15, v128
    v_lshlrev_b32 v34, 16, v129
    v_and_b32 v35, s15, v129
    v_pk_fma_f32 v[32:33], v[32:33], v[10:11], v[10:11] op_sel:[0,0,1] op_sel_hi:[1,0,1]
    v_pk_fma_f32 v[34:35], v[34:35], v[10:11], v[10:11] op_sel:[0,0,1] op_sel_hi:[1,0,1]
    v_cvt_pk_bf16_f32 v128, v32, v33
    v_cvt_pk_bf16_f32 v129, v34, v35
    v_lshlrev_b32 v32, 16, v130
    v_and_b32 v33, s15, v130
    v_lshlrev_b32 v34, 16, v131
    v_and_b32 v35, s15, v131
    v_pk_fma_f32 v[32:33], v[32:33], v[10:11], v[10:11] op_sel:[0,0,1] op_sel_hi:[1,0,1]
    v_pk_fma_f32 v[34:35], v[34:35], v[10:11], v[10:11] op_sel:[0,0,1] op_sel_hi:[1,0,1]
    v_cvt_pk_bf16_f32 v130, v32, v33
    v_cvt_pk_bf16_f32 v131, v34, v35
    v_lshlrev_b32 v36, 16, v132
    v_and_b32 v37, s15, v132
    v_lshlrev_b32 v38, 16, v133
    v_and_b32 v39, s15, v133
    v_pk_fma_f32 v[36:37], v[36:37], v[108:109], v[108:109] op_sel:[0,0,1] op_sel_hi:[1,0,1]
    v_pk_fma_f32 v[38:39], v[38:39], v[108:109], v[108:109] op_sel:[0,0,1] op_sel_hi:[1,0,1]
    v_cvt_pk_bf16_f32 v132, v36, v37
    v_cvt_pk_bf16_f32 v133, v38, v39
    v_lshlrev_b32 v36, 16, v134
    v_and_b32 v37, s15, v134
    v_lshlrev_b32 v38, 16, v135
    v_and_b32 v39, s15, v135
    v_pk_fma_f32 v[36:37], v[36:37], v[108:109], v[108:109] op_sel:[0,0,1] op_sel_hi:[1,0,1]
    v_pk_fma_f32 v[38:39], v[38:39], v[108:109], v[108:109] op_sel:[0,0,1] op_sel_hi:[1,0,1]
    v_cvt_pk_bf16_f32 v134, v36, v37
    v_cvt_pk_bf16_f32 v135, v38, v39
    v_lshlrev_b32 v32, 16, v136
    v_and_b32 v33, s15, v136
    v_lshlrev_b32 v34, 16, v137
    v_and_b32 v35, s15, v137
    v_pk_fma_f32 v[32:33], v[32:33], v[10:11], v[10:11] op_sel:[0,0,1] op_sel_hi:[1,0,1]
    v_pk_fma_f32 v[34:35], v[34:35], v[10:11], v[10:11] op_sel:[0,0,1] op_sel_hi:[1,0,1]
    v_cvt_pk_bf16_f32 v136, v32, v33
    v_cvt_pk_bf16_f32 v137, v34, v35
    v_lshlrev_b32 v32, 16, v138
    v_and_b32 v33, s15, v138
    v_lshlrev_b32 v34, 16, v139
    v_and_b32 v35, s15, v139
    v_pk_fma_f32 v[32:33], v[32:33], v[10:11], v[10:11] op_sel:[0,0,1] op_sel_hi:[1,0,1]
    v_pk_fma_f32 v[34:35], v[34:35], v[10:11], v[10:11] op_sel:[0,0,1] op_sel_hi:[1,0,1]
    v_cvt_pk_bf16_f32 v138, v32, v33
    v_cvt_pk_bf16_f32 v139, v34, v35
    v_lshlrev_b32 v36, 16, v140
    v_and_b32 v37, s15, v140
    v_lshlrev_b32 v38, 16, v141
    v_and_b32 v39, s15, v141
    v_pk_fma_f32 v[36:37], v[36:37], v[108:109], v[108:109] op_sel:[0,0,1] op_sel_hi:[1,0,1]
    v_pk_fma_f32 v[38:39], v[38:39], v[108:109], v[108:109] op_sel:[0,0,1] op_sel_hi:[1,0,1]
    v_cvt_pk_bf16_f32 v140, v36, v37
    v_cvt_pk_bf16_f32 v141, v38, v39
    v_lshlrev_b32 v36, 16, v142
    v_and_b32 v37, s15, v142
    v_lshlrev_b32 v38, 16, v143
    v_and_b32 v39, s15, v143
    v_pk_fma_f32 v[36:37], v[36:37], v[108:109], v[108:109] op_sel:[0,0,1] op_sel_hi:[1,0,1]
    v_pk_fma_f32 v[38:39], v[38:39], v[108:109], v[108:109] op_sel:[0,0,1] op_sel_hi:[1,0,1]
    v_cvt_pk_bf16_f32 v142, v36, v37
    v_cvt_pk_bf16_f32 v143, v38, v39
    v_lshlrev_b32 v32, 16, v144
    v_and_b32 v33, s15, v144
    v_lshlrev_b32 v34, 16, v145
    v_and_b32 v35, s15, v145
    v_pk_fma_f32 v[32:33], v[32:33], v[10:11], v[10:11] op_sel:[0,0,1] op_sel_hi:[1,0,1]
    v_pk_fma_f32 v[34:35], v[34:35], v[10:11], v[10:11] op_sel:[0,0,1] op_sel_hi:[1,0,1]
    v_cvt_pk_bf16_f32 v144, v32, v33
    v_cvt_pk_bf16_f32 v145, v34, v35
    v_lshlrev_b32 v32, 16, v146
    v_and_b32 v33, s15, v146
    v_lshlrev_b32 v34, 16, v147
    v_and_b32 v35, s15, v147
    v_pk_fma_f32 v[32:33], v[32:33], v[10:11], v[10:11] op_sel:[0,0,1] op_sel_hi:[1,0,1]
    v_pk_fma_f32 v[34:35], v[34:35], v[10:11], v[10:11] op_sel:[0,0,1] op_sel_hi:[1,0,1]
    v_cvt_pk_bf16_f32 v146, v32, v33
    v_cvt_pk_bf16_f32 v147, v34, v35
    v_lshlrev_b32 v36, 16, v148
    v_and_b32 v37, s15, v148
    v_lshlrev_b32 v38, 16, v149
    v_and_b32 v39, s15, v149
    v_pk_fma_f32 v[36:37], v[36:37], v[108:109], v[108:109] op_sel:[0,0,1] op_sel_hi:[1,0,1]
    v_pk_fma_f32 v[38:39], v[38:39], v[108:109], v[108:109] op_sel:[0,0,1] op_sel_hi:[1,0,1]
    v_cvt_pk_bf16_f32 v148, v36, v37
    v_cvt_pk_bf16_f32 v149, v38, v39
    v_lshlrev_b32 v36, 16, v150
    v_and_b32 v37, s15, v150
    v_lshlrev_b32 v38, 16, v151
    v_and_b32 v39, s15, v151
    v_pk_fma_f32 v[36:37], v[36:37], v[108:109], v[108:109] op_sel:[0,0,1] op_sel_hi:[1,0,1]
    v_pk_fma_f32 v[38:39], v[38:39], v[108:109], v[108:109] op_sel:[0,0,1] op_sel_hi:[1,0,1]
    v_cvt_pk_bf16_f32 v150, v36, v37
    v_cvt_pk_bf16_f32 v151, v38, v39
    v_lshlrev_b32 v32, 16, v152
    v_and_b32 v33, s15, v152
    v_lshlrev_b32 v34, 16, v153
    v_and_b32 v35, s15, v153
    v_pk_fma_f32 v[32:33], v[32:33], v[10:11], v[10:11] op_sel:[0,0,1] op_sel_hi:[1,0,1]
    v_pk_fma_f32 v[34:35], v[34:35], v[10:11], v[10:11] op_sel:[0,0,1] op_sel_hi:[1,0,1]
    v_cvt_pk_bf16_f32 v152, v32, v33
    v_cvt_pk_bf16_f32 v153, v34, v35
    v_lshlrev_b32 v32, 16, v154
    v_and_b32 v33, s15, v154
    v_lshlrev_b32 v34, 16, v155
    v_and_b32 v35, s15, v155
    v_pk_fma_f32 v[32:33], v[32:33], v[10:11], v[10:11] op_sel:[0,0,1] op_sel_hi:[1,0,1]
    v_pk_fma_f32 v[34:35], v[34:35], v[10:11], v[10:11] op_sel:[0,0,1] op_sel_hi:[1,0,1]
    v_cvt_pk_bf16_f32 v154, v32, v33
    v_cvt_pk_bf16_f32 v155, v34, v35
    v_lshlrev_b32 v36, 16, v156
    v_and_b32 v37, s15, v156
    v_lshlrev_b32 v38, 16, v157
    v_and_b32 v39, s15, v157
    v_pk_fma_f32 v[36:37], v[36:37], v[108:109], v[108:109] op_sel:[0,0,1] op_sel_hi:[1,0,1]
    v_pk_fma_f32 v[38:39], v[38:39], v[108:109], v[108:109] op_sel:[0,0,1] op_sel_hi:[1,0,1]
    v_cvt_pk_bf16_f32 v156, v36, v37
    v_cvt_pk_bf16_f32 v157, v38, v39
    v_lshlrev_b32 v36, 16, v158
    v_and_b32 v37, s15, v158
    v_lshlrev_b32 v38, 16, v159
    v_and_b32 v39, s15, v159
    v_pk_fma_f32 v[36:37], v[36:37], v[108:109], v[108:109] op_sel:[0,0,1] op_sel_hi:[1,0,1]
    v_pk_fma_f32 v[38:39], v[38:39], v[108:109], v[108:109] op_sel:[0,0,1] op_sel_hi:[1,0,1]
    v_cvt_pk_bf16_f32 v158, v36, v37
    v_cvt_pk_bf16_f32 v159, v38, v39
    v_lshlrev_b32 v32, 16, v160
    v_and_b32 v33, s15, v160
    v_lshlrev_b32 v34, 16, v161
    v_and_b32 v35, s15, v161
    v_pk_fma_f32 v[32:33], v[32:33], v[10:11], v[10:11] op_sel:[0,0,1] op_sel_hi:[1,0,1]
    v_pk_fma_f32 v[34:35], v[34:35], v[10:11], v[10:11] op_sel:[0,0,1] op_sel_hi:[1,0,1]
    v_cvt_pk_bf16_f32 v160, v32, v33
    v_cvt_pk_bf16_f32 v161, v34, v35
    v_lshlrev_b32 v32, 16, v162
    v_and_b32 v33, s15, v162
    v_lshlrev_b32 v34, 16, v163
    v_and_b32 v35, s15, v163
    v_pk_fma_f32 v[32:33], v[32:33], v[10:11], v[10:11] op_sel:[0,0,1] op_sel_hi:[1,0,1]
    v_pk_fma_f32 v[34:35], v[34:35], v[10:11], v[10:11] op_sel:[0,0,1] op_sel_hi:[1,0,1]
    v_cvt_pk_bf16_f32 v162, v32, v33
    v_cvt_pk_bf16_f32 v163, v34, v35
    v_lshlrev_b32 v36, 16, v164
    v_and_b32 v37, s15, v164
    v_lshlrev_b32 v38, 16, v165
    v_and_b32 v39, s15, v165
    v_pk_fma_f32 v[36:37], v[36:37], v[108:109], v[108:109] op_sel:[0,0,1] op_sel_hi:[1,0,1]
    v_pk_fma_f32 v[38:39], v[38:39], v[108:109], v[108:109] op_sel:[0,0,1] op_sel_hi:[1,0,1]
    v_cvt_pk_bf16_f32 v164, v36, v37
    v_cvt_pk_bf16_f32 v165, v38, v39
    v_lshlrev_b32 v36, 16, v166
    v_and_b32 v37, s15, v166
    v_lshlrev_b32 v38, 16, v167
    v_and_b32 v39, s15, v167
    v_pk_fma_f32 v[36:37], v[36:37], v[108:109], v[108:109] op_sel:[0,0,1] op_sel_hi:[1,0,1]
    v_pk_fma_f32 v[38:39], v[38:39], v[108:109], v[108:109] op_sel:[0,0,1] op_sel_hi:[1,0,1]
    v_cvt_pk_bf16_f32 v166, v36, v37
    v_cvt_pk_bf16_f32 v167, v38, v39
    v_lshlrev_b32 v32, 16, v168
    v_and_b32 v33, s15, v168
    v_lshlrev_b32 v34, 16, v169
    v_and_b32 v35, s15, v169
    v_pk_fma_f32 v[32:33], v[32:33], v[10:11], v[10:11] op_sel:[0,0,1] op_sel_hi:[1,0,1]
    v_pk_fma_f32 v[34:35], v[34:35], v[10:11], v[10:11] op_sel:[0,0,1] op_sel_hi:[1,0,1]
    v_cvt_pk_bf16_f32 v168, v32, v33
    v_cvt_pk_bf16_f32 v169, v34, v35
    v_lshlrev_b32 v32, 16, v170
    v_and_b32 v33, s15, v170
    v_lshlrev_b32 v34, 16, v171
    v_and_b32 v35, s15, v171
    v_pk_fma_f32 v[32:33], v[32:33], v[10:11], v[10:11] op_sel:[0,0,1] op_sel_hi:[1,0,1]
    v_pk_fma_f32 v[34:35], v[34:35], v[10:11], v[10:11] op_sel:[0,0,1] op_sel_hi:[1,0,1]
    v_cvt_pk_bf16_f32 v170, v32, v33
    v_cvt_pk_bf16_f32 v171, v34, v35
    v_lshlrev_b32 v36, 16, v172
    v_and_b32 v37, s15, v172
    v_lshlrev_b32 v38, 16, v173
    v_and_b32 v39, s15, v173
    v_pk_fma_f32 v[36:37], v[36:37], v[108:109], v[108:109] op_sel:[0,0,1] op_sel_hi:[1,0,1]
    v_pk_fma_f32 v[38:39], v[38:39], v[108:109], v[108:109] op_sel:[0,0,1] op_sel_hi:[1,0,1]
    v_cvt_pk_bf16_f32 v172, v36, v37
    v_cvt_pk_bf16_f32 v173, v38, v39
    v_lshlrev_b32 v36, 16, v174
    v_and_b32 v37, s15, v174
    v_lshlrev_b32 v38, 16, v175
    v_and_b32 v39, s15, v175
    v_pk_fma_f32 v[36:37], v[36:37], v[108:109], v[108:109] op_sel:[0,0,1] op_sel_hi:[1,0,1]
    v_pk_fma_f32 v[38:39], v[38:39], v[108:109], v[108:109] op_sel:[0,0,1] op_sel_hi:[1,0,1]
    v_cvt_pk_bf16_f32 v174, v36, v37
    v_cvt_pk_bf16_f32 v175, v38, v39
    v_lshlrev_b32 v32, 16, v176
    v_and_b32 v33, s15, v176
    v_lshlrev_b32 v34, 16, v177
    v_and_b32 v35, s15, v177
    v_pk_fma_f32 v[32:33], v[32:33], v[10:11], v[10:11] op_sel:[0,0,1] op_sel_hi:[1,0,1]
    v_pk_fma_f32 v[34:35], v[34:35], v[10:11], v[10:11] op_sel:[0,0,1] op_sel_hi:[1,0,1]
    v_cvt_pk_bf16_f32 v176, v32, v33
    v_cvt_pk_bf16_f32 v177, v34, v35
    v_lshlrev_b32 v32, 16, v178
    v_and_b32 v33, s15, v178
    v_lshlrev_b32 v34, 16, v179
    v_and_b32 v35, s15, v179
    v_pk_fma_f32 v[32:33], v[32:33], v[10:11], v[10:11] op_sel:[0,0,1] op_sel_hi:[1,0,1]
    v_pk_fma_f32 v[34:35], v[34:35], v[10:11], v[10:11] op_sel:[0,0,1] op_sel_hi:[1,0,1]
    v_cvt_pk_bf16_f32 v178, v32, v33
    v_cvt_pk_bf16_f32 v179, v34, v35
    v_lshlrev_b32 v36, 16, v180
    v_and_b32 v37, s15, v180
    v_lshlrev_b32 v38, 16, v181
    v_and_b32 v39, s15, v181
    v_pk_fma_f32 v[36:37], v[36:37], v[108:109], v[108:109] op_sel:[0,0,1] op_sel_hi:[1,0,1]
    v_pk_fma_f32 v[38:39], v[38:39], v[108:109], v[108:109] op_sel:[0,0,1] op_sel_hi:[1,0,1]
    v_cvt_pk_bf16_f32 v180, v36, v37
    v_cvt_pk_bf16_f32 v181, v38, v39
    v_lshlrev_b32 v36, 16, v182
    v_and_b32 v37, s15, v182
    v_lshlrev_b32 v38, 16, v183
    v_and_b32 v39, s15, v183
    v_pk_fma_f32 v[36:37], v[36:37], v[108:109], v[108:109] op_sel:[0,0,1] op_sel_hi:[1,0,1]
    v_pk_fma_f32 v[38:39], v[38:39], v[108:109], v[108:109] op_sel:[0,0,1] op_sel_hi:[1,0,1]
    v_cvt_pk_bf16_f32 v182, v36, v37
    v_cvt_pk_bf16_f32 v183, v38, v39
    s_add_u32 s9, s25, 0
    s_add_u32 m0, s8, 0x6000
    s_nop 0
    buffer_load_dwordx4 v13, s[52:55], s9 offen offset:0 lds
    v_lshlrev_b32 v32, 16, v184
    v_and_b32 v33, s15, v184
    v_lshlrev_b32 v34, 16, v185
    v_and_b32 v35, s15, v185
    v_pk_fma_f32 v[32:33], v[32:33], v[10:11], v[10:11] op_sel:[0,0,1] op_sel_hi:[1,0,1]
    v_pk_fma_f32 v[34:35], v[34:35], v[10:11], v[10:11] op_sel:[0,0,1] op_sel_hi:[1,0,1]
    v_cvt_pk_bf16_f32 v184, v32, v33
    v_cvt_pk_bf16_f32 v185, v34, v35
    v_lshlrev_b32 v32, 16, v186
    v_and_b32 v33, s15, v186
    v_lshlrev_b32 v34, 16, v187
    v_and_b32 v35, s15, v187
    v_pk_fma_f32 v[32:33], v[32:33], v[10:11], v[10:11] op_sel:[0,0,1] op_sel_hi:[1,0,1]
    v_pk_fma_f32 v[34:35], v[34:35], v[10:11], v[10:11] op_sel:[0,0,1] op_sel_hi:[1,0,1]
    v_cvt_pk_bf16_f32 v186, v32, v33
    v_cvt_pk_bf16_f32 v187, v34, v35
    buffer_load_dwordx4 v14, s[52:55], s9 offen offset:1024 lds
    v_lshlrev_b32 v36, 16, v188
    v_and_b32 v37, s15, v188
    v_lshlrev_b32 v38, 16, v189
    v_and_b32 v39, s15, v189
    v_pk_fma_f32 v[36:37], v[36:37], v[108:109], v[108:109] op_sel:[0,0,1] op_sel_hi:[1,0,1]
    v_pk_fma_f32 v[38:39], v[38:39], v[108:109], v[108:109] op_sel:[0,0,1] op_sel_hi:[1,0,1]
    v_cvt_pk_bf16_f32 v188, v36, v37
    v_cvt_pk_bf16_f32 v189, v38, v39
    v_lshlrev_b32 v36, 16, v190
    v_and_b32 v37, s15, v190
    v_lshlrev_b32 v38, 16, v191
    v_and_b32 v39, s15, v191
    v_pk_fma_f32 v[36:37], v[36:37], v[108:109], v[108:109] op_sel:[0,0,1] op_sel_hi:[1,0,1]
    v_pk_fma_f32 v[38:39], v[38:39], v[108:109], v[108:109] op_sel:[0,0,1] op_sel_hi:[1,0,1]
    v_cvt_pk_bf16_f32 v190, v36, v37
    v_cvt_pk_bf16_f32 v191, v38, v39
    buffer_load_dwordx4 v15, s[52:55], s9 offen offset:2048 lds
    v_lshlrev_b32 v32, 16, v192
    v_and_b32 v33, s15, v192
L_pf0:
    s_cbranch_execz L_rf0
    v_lshlrev_b32 v34, 16, v193
    v_and_b32 v35, s15, v193
    v_pk_fma_f32 v[32:33], v[32:33], v[10:11], v[10:11] op_sel:[0,0,1] op_sel_hi:[1,0,1]
    v_pk_fma_f32 v[34:35], v[34:35], v[10:11], v[10:11] op_sel:[0,0,1] op_sel_hi:[1,0,1]
    v_cvt_pk_bf16_f32 v192, v32, v33
    v_cvt_pk_bf16_f32 v193, v34, v35
    v_lshlrev_b32 v32, 16, v194
    v_and_b32 v33, s15, v194
    v_lshlrev_b32 v34, 16, v195
    v_and_b32 v35, s15, v195
    v_pk_fma_f32 v[32:33], v[32:33], v[10:11], v[10:11] op_sel:[0,0,1] op_sel_hi:[1,0,1]
    v_pk_fma_f32 v[34:35], v[34:35], v[10:11], v[10:11] op_sel:[0,0,1] op_sel_hi:[1,0,1]
    v_cvt_pk_bf16_f32 v194, v32, v33
    v_cvt_pk_bf16_f32 v195, v34, v35
    s_add_u32 m0, s8, 0x6c00
    s_nop 0
    buffer_load_dwordx4 v16, s[52:55], s9 offen offset:0 lds
    v_lshlrev_b32 v36, 16, v196
    v_and_b32 v37, s15, v196
    v_lshlrev_b32 v38, 16, v197
    v_and_b32 v39, s15, v197
    v_pk_fma_f32 v[36:37], v[36:37], v[108:109], v[108:109] op_sel:[0,0,1] op_sel_hi:[1,0,1]
    v_pk_fma_f32 v[38:39], v[38:39], v[108:109], v[108:109] op_sel:[0,0,1] op_sel_hi:[1,0,1]
    v_cvt_pk_bf16_f32 v196, v36, v37
    v_cvt_pk_bf16_f32 v197, v38, v39
    v_lshlrev_b32 v36, 16, v198
    v_and_b32 v37, s15, v198
    v_lshlrev_b32 v38, 16, v199
    v_and_b32 v39, s15, v199
    v_pk_fma_f32 v[36:37], v[36:37], v[108:109], v[108:109] op_sel:[0,0,1] op_sel_hi:[1,0,1]
    v_pk_fma_f32 v[38:39], v[38:39], v[108:109], v[108:109] op_sel:[0,0,1] op_sel_hi:[1,0,1]
    v_cvt_pk_bf16_f32 v198, v36, v37
    v_cvt_pk_bf16_f32 v199, v38, v39
    buffer_load_dwordx4 v17, s[52:55], s9 offen offset:1024 lds
    v_lshlrev_b32 v32, 16, v200
    v_and_b32 v33, s15, v200
    v_lshlrev_b32 v34, 16, v201
    v_and_b32 v35, s15, v201
    v_pk_fma_f32 v[32:33], v[32:33], v[10:11], v[10:11] op_sel:[0,0,1] op_sel_hi:[1,0,1]
    v_pk_fma_f32 v[34:35], v[34:35], v[10:11], v[10:11] op_sel:[0,0,1] op_sel_hi:[1,0,1]
    v_cvt_pk_bf16_f32 v200, v32, v33
    v_cvt_pk_bf16_f32 v201, v34, v35
    v_lshlrev_b32 v32, 16, v202
    v_and_b32 v33, s15, v202
    v_lshlrev_b32 v34, 16, v203
    v_and_b32 v35, s15, v203
    v_pk_fma_f32 v[32:33], v[32:33], v[10:11], v[10:11] op_sel:[0,0,1] op_sel_hi:[1,0,1]
    v_pk_fma_f32 v[34:35], v[34:35], v[10:11], v[10:11] op_sel:[0,0,1] op_sel_hi:[1,0,1]
    v_cvt_pk_bf16_f32 v202, v32, v33
    v_cvt_pk_bf16_f32 v203, v34, v35
    buffer_load_dwordx4 v18, s[52:55], s9 offen offset:2048 lds
    v_lshlrev_b32 v36, 16, v204
    v_and_b32 v37, s15, v204
    v_lshlrev_b32 v38, 16, v205
    v_and_b32 v39, s15, v205
    v_pk_fma_f32 v[36:37], v[36:37], v[108:109], v[108:109] op_sel:[0,0,1] op_sel_hi:[1,0,1]
    v_pk_fma_f32 v[38:39], v[38:39], v[108:109], v[108:109] op_sel:[0,0,1] op_sel_hi:[1,0,1]
    v_cvt_pk_bf16_f32 v204, v36, v37
    v_cvt_pk_bf16_f32 v205, v38, v39
    v_lshlrev_b32 v36, 16, v206
    v_and_b32 v37, s15, v206
    v_lshlrev_b32 v38, 16, v207
    v_and_b32 v39, s15, v207
    v_pk_fma_f32 v[36:37], v[36:37], v[108:109], v[108:109] op_sel:[0,0,1] op_sel_hi:[1,0,1]
    v_pk_fma_f32 v[38:39], v[38:39], v[108:109], v[108:109] op_sel:[0,0,1] op_sel_hi:[1,0,1]
    v_cvt_pk_bf16_f32 v206, v36, v37
    v_cvt_pk_bf16_f32 v207, v38, v39
    v_lshlrev_b32 v32, 16, v208
    v_and_b32 v33, s15, v208
    v_lshlrev_b32 v34, 16, v209
    v_and_b32 v35, s15, v209
    v_pk_fma_f32 v[32:33], v[32:33], v[10:11], v[10:11] op_sel:[0,0,1] op_sel_hi:[1,0,1]
    v_pk_fma_f32 v[34:35], v[34:35], v[10:11], v[10:11] op_sel:[0,0,1] op_sel_hi:[1,0,1]
    v_cvt_pk_bf16_f32 v208, v32, v33
    v_cvt_pk_bf16_f32 v209, v34, v35
    v_lshlrev_b32 v32, 16, v210
    v_and_b32 v33, s15, v210
    v_lshlrev_b32 v34, 16, v211
    v_and_b32 v35, s15, v211
    v_pk_fma_f32 v[32:33], v[32:33], v[10:11], v[10:11] op_sel:[0,0,1] op_sel_hi:[1,0,1]
    v_pk_fma_f32 v[34:35], v[34:35], v[10:11], v[10:11] op_sel:[0,0,1] op_sel_hi:[1,0,1]
    v_cvt_pk_bf16_f32 v210, v32, v33
    v_cvt_pk_bf16_f32 v211, v34, v35
    s_add_u32 s9, s26, 0
    s_add_u32 m0, s8, 0xc000
    s_nop 0
    buffer_load_dwordx4 v13, s[52:55], s9 offen offset:0 lds
    v_lshlrev_b32 v36, 16, v212
    v_and_b32 v37, s15, v212
    v_lshlrev_b32 v38, 16, v213
    v_and_b32 v39, s15, v213
    v_pk_fma_f32 v[36:37], v[36:37], v[108:109], v[108:109] op_sel:[0,0,1] op_sel_hi:[1,0,1]
    v_pk_fma_f32 v[38:39], v[38:39], v[108:109], v[108:109] op_sel:[0,0,1] op_sel_hi:[1,0,1]
    v_cvt_pk_bf16_f32 v212, v36, v37
    v_cvt_pk_bf16_f32 v213, v38, v39
    v_lshlrev_b32 v36, 16, v214
    v_and_b32 v37, s15, v214
    v_lshlrev_b32 v38, 16, v215
    v_and_b32 v39, s15, v215
    v_pk_fma_f32 v[36:37], v[36:37], v[108:109], v[108:109] op_sel:[0,0,1] op_sel_hi:[1,0,1]
    v_pk_fma_f32 v[38:39], v[38:39], v[108:109], v[108:109] op_sel:[0,0,1] op_sel_hi:[1,0,1]
    v_cvt_pk_bf16_f32 v214, v36, v37
    v_cvt_pk_bf16_f32 v215, v38, v39
    buffer_load_dwordx4 v14, s[52:55], s9 offen offset:1024 lds
    v_lshlrev_b32 v32, 16, v216
    v_and_b32 v33, s15, v216
    v_lshlrev_b32 v34, 16, v217
    v_and_b32 v35, s15, v217
    v_pk_fma_f32 v[32:33], v[32:33], v[10:11], v[10:11] op_sel:[0,0,1] op_sel_hi:[1,0,1]
    v_pk_fma_f32 v[34:35], v[34:35], v[10:11], v[10:11] op_sel:[0,0,1] op_sel_hi:[1,0,1]
    v_cvt_pk_bf16_f32 v216, v32, v33
    v_cvt_pk_bf16_f32 v217, v34, v35
    v_lshlrev_b32 v32, 16, v218
    v_and_b32 v33, s15, v218
    v_lshlrev_b32 v34, 16, v219
    v_and_b32 v35, s15, v219
    v_pk_fma_f32 v[32:33], v[32:33], v[10:11], v[10:11] op_sel:[0,0,1] op_sel_hi:[1,0,1]
    v_pk_fma_f32 v[34:35], v[34:35], v[10:11], v[10:11] op_sel:[0,0,1] op_sel_hi:[1,0,1]
    v_cvt_pk_bf16_f32 v218, v32, v33
    v_cvt_pk_bf16_f32 v219, v34, v35
    buffer_load_dwordx4 v15, s[52:55], s9 offen offset:2048 lds
    v_lshlrev_b32 v36, 16, v220
    v_and_b32 v37, s15, v220
    v_lshlrev_b32 v38, 16, v221
    v_and_b32 v39, s15, v221
    v_pk_fma_f32 v[36:37], v[36:37], v[108:109], v[108:109] op_sel:[0,0,1] op_sel_hi:[1,0,1]
    v_pk_fma_f32 v[38:39], v[38:39], v[108:109], v[108:109] op_sel:[0,0,1] op_sel_hi:[1,0,1]
    v_cvt_pk_bf16_f32 v220, v36, v37
    v_cvt_pk_bf16_f32 v221, v38, v39
    v_lshlrev_b32 v36, 16, v222
    v_and_b32 v37, s15, v222
    v_lshlrev_b32 v38, 16, v223
    v_and_b32 v39, s15, v223
    v_pk_fma_f32 v[36:37], v[36:37], v[108:109], v[108:109] op_sel:[0,0,1] op_sel_hi:[1,0,1]
    v_pk_fma_f32 v[38:39], v[38:39], v[108:109], v[108:109] op_sel:[0,0,1] op_sel_hi:[1,0,1]
    v_cvt_pk_bf16_f32 v222, v36, v37
    v_cvt_pk_bf16_f32 v223, v38, v39
    s_add_u32 m0, s8, 0xcc00
    s_nop 0
    buffer_load_dwordx4 v16, s[52:55], s9 offen offset:0 lds
    v_lshlrev_b32 v32, 16, v224
    v_and_b32 v33, s15, v224
    v_lshlrev_b32 v34, 16, v225
    v_and_b32 v35, s15, v225
    v_pk_fma_f32 v[32:33], v[32:33], v[10:11], v[10:11] op_sel:[0,0,1] op_sel_hi:[1,0,1]
    v_pk_fma_f32 v[34:35], v[34:35], v[10:11], v[10:11] op_sel:[0,0,1] op_sel_hi:[1,0,1]
    v_cvt_pk_bf16_f32 v224, v32, v33
    v_cvt_pk_bf16_f32 v225, v34, v35
    v_lshlrev_b32 v32, 16, v226
    v_and_b32 v33, s15, v226
    v_lshlrev_b32 v34, 16, v227
    v_and_b32 v35, s15, v227
    v_pk_fma_f32 v[32:33], v[32:33], v[10:11], v[10:11] op_sel:[0,0,1] op_sel_hi:[1,0,1]
    v_pk_fma_f32 v[34:35], v[34:35], v[10:11], v[10:11] op_sel:[0,0,1] op_sel_hi:[1,0,1]
    v_cvt_pk_bf16_f32 v226, v32, v33
    v_cvt_pk_bf16_f32 v227, v34, v35
    buffer_load_dwordx4 v17, s[52:55], s9 offen offset:1024 lds
    v_lshlrev_b32 v36, 16, v228
    v_and_b32 v37, s15, v228
    v_lshlrev_b32 v38, 16, v229
    v_and_b32 v39, s15, v229
    v_pk_fma_f32 v[36:37], v[36:37], v[108:109], v[108:109] op_sel:[0,0,1] op_sel_hi:[1,0,1]
    v_pk_fma_f32 v[38:39], v[38:39], v[108:109], v[108:109] op_sel:[0,0,1] op_sel_hi:[1,0,1]
    v_cvt_pk_bf16_f32 v228, v36, v37
    v_cvt_pk_bf16_f32 v229, v38, v39
    v_lshlrev_b32 v36, 16, v230
    v_and_b32 v37, s15, v230
    v_lshlrev_b32 v38, 16, v231
    v_and_b32 v39, s15, v231
    v_pk_fma_f32 v[36:37], v[36:37], v[108:109], v[108:109] op_sel:[0,0,1] op_sel_hi:[1,0,1]
    v_pk_fma_f32 v[38:39], v[38:39], v[108:109], v[108:109] op_sel:[0,0,1] op_sel_hi:[1,0,1]
    v_cvt_pk_bf16_f32 v230, v36, v37
    v_cvt_pk_bf16_f32 v231, v38, v39
    buffer_load_dwordx4 v18, s[52:55], s9 offen offset:2048 lds
    buffer_store_dwordx4 v[46:49], v44, s[60:63], 0 offen offset:0 sc1
    s_waitcnt vmcnt(13)
    s_barrier
    ds_read_b64_tr_b16 a[200:201], v19 offset:0
    ds_read_b64_tr_b16 a[202:203], v19 offset:512
    ds_read_b64_tr_b16 a[204:205], v19 offset:4096
    ds_read_b64_tr_b16 a[206:207], v19 offset:4608
    ds_read_b64_tr_b16 a[208:209], v19 offset:8192
    ds_read_b64_tr_b16 a[210:211], v19 offset:8704
    ds_read_b64_tr_b16 a[212:213], v20 offset:0
    ds_read_b64_tr_b16 a[214:215], v20 offset:512
    ds_read_b64_tr_b16 a[216:217], v20 offset:4096
    ds_read_b64_tr_b16 a[218:219], v20 offset:4608
    ds_read_b64_tr_b16 a[220:221], v20 offset:8192
    ds_read_b64_tr_b16 a[222:223], v20 offset:8704
    ds_read_b64_tr_b16 a[224:225], v21 offset:0
    ds_read_b64_tr_b16 a[226:227], v21 offset:512
    ds_read_b64_tr_b16 a[228:229], v21 offset:4096
    ds_read_b64_tr_b16 a[230:231], v21 offset:4608
    s_waitcnt lgkmcnt(6)
    v_mfma_f32_16x16x32_bf16 v[40:43], a[200:203], v[112:115], 0
    ds_read_b64_tr_b16 a[232:233], v21 offset:8192
    v_lshlrev_b32 v32, 16, v232
    v_mfma_f32_16x16x32_bf16 v[40:43], a[204:207], v[120:123], v[40:43]
    ds_read_b64_tr_b16 a[234:235], v21 offset:8704
    v_and_b32 v33, s15, v232
    v_lshlrev_b32 v34, 16, v233
    v_mfma_f32_16x16x32_bf16 v[40:43], a[208:211], v[128:131], v[40:43]
    s_add_u32 s9, s24, 128
    ds_read_b64_tr_b16 a[236:237], v22 offset:0
    v_and_b32 v35, s15, v233
    v_mfma_f32_16x16x32_bf16 v[48:51], a[208:211], v[132:135], 0
    s_add_u32 m0, s8, 0x12000
    ds_read_b64_tr_b16 a[238:239], v22 offset:512
    buffer_load_dwordx4 v13, s[52:55], s9 offen offset:0 lds
    v_mfma_f32_16x16x32_bf16 v[48:51], a[204:207], v[124:127], v[48:51]
    ds_read_b64_tr_b16 a[240:241], v22 offset:4096
    v_fma_f32 v32, v32, v10, v11
    v_mfma_f32_16x16x32_bf16 v[48:51], a[200:203], v[116:119], v[48:51]
    ds_read_b64_tr_b16 a[242:243], v22 offset:4608
    v_fma_f32 v33, v33, v10, v11
    v_fma_f32 v34, v34, v10, v11
    v_mfma_f32_16x16x32_bf16 v[44:47], a[212:215], v[112:115], 0
    s_waitcnt lgkmcnt(4)
    ds_read_b64_tr_b16 a[244:245], v22 offset:8192
    v_fma_f32 v35, v35, v10, v11
    v_mfma_f32_16x16x32_bf16 v[44:47], a[216:219], v[120:123], v[44:47]
    ds_read_b64_tr_b16 a[246:247], v22 offset:8704
    buffer_load_dwordx4 v14, s[52:55], s9 offen offset:1024 lds
    v_mfma_f32_16x16x32_bf16 v[44:47], a[220:223], v[128:131], v[44:47]
    ds_read_b64_tr_b16 a[248:249], v19 offset:12288
    v_cvt_pk_bf16_f32 v232, v32, v33
    v_mfma_f32_16x16x32_bf16 v[52:55], a[220:223], v[132:135], 0
    ds_read_b64_tr_b16 a[250:251], v19 offset:12800
    v_cvt_pk_bf16_f32 v233, v34, v35
    v_lshlrev_b32 v32, 16, v234
    v_mfma_f32_16x16x32_bf16 v[52:55], a[216:219], v[124:127], v[52:55]
    ds_read_b64_tr_b16 a[252:253], v19 offset:16384
    v_and_b32 v33, s15, v234
    v_mfma_f32_16x16x32_bf16 v[52:55], a[212:215], v[116:119], v[52:55]
    ds_read_b64_tr_b16 a[254:255], v19 offset:16896
    buffer_load_dwordx4 v15, s[52:55], s9 offen offset:2048 lds
    v_mfma_f32_16x16x32_bf16 v[56:59], a[224:227], v[112:115], 0
    ds_read_b64_tr_b16 a[200:201], v19 offset:20480
    v_lshlrev_b32 v34, 16, v235
    v_mfma_f32_16x16x32_bf16 v[56:59], a[228:231], v[120:123], v[56:59]
    ds_read_b64_tr_b16 a[202:203], v19 offset:20992
    v_and_b32 v35, s15, v235
    v_fma_f32 v32, v32, v10, v11
    v_mfma_f32_16x16x32_bf16 v[56:59], a[232:235], v[128:131], v[56:59]
    s_add_u32 m0, s8, 0x12c00
    s_waitcnt lgkmcnt(4)
    ds_read_b64_tr_b16 a[204:205], v20 offset:12288
    v_fma_f32 v33, v33, v10, v11
    v_mfma_f32_16x16x32_bf16 v[64:67], a[232:235], v[132:135], 0
    ds_read_b64_tr_b16 a[206:207], v20 offset:12800
    buffer_load_dwordx4 v16, s[52:55], s9 offen offset:0 lds
    v_mfma_f32_16x16x32_bf16 v[64:67], a[228:231], v[124:127], v[64:67]
    ds_read_b64_tr_b16 a[208:209], v20 offset:16384
    v_fma_f32 v34, v34, v10, v11
    v_mfma_f32_16x16x32_bf16 v[64:67], a[224:227], v[116:119], v[64:67]
    ds_read_b64_tr_b16 a[210:211], v20 offset:16896
    v_fma_f32 v35, v35, v10, v11
    v_cvt_pk_bf16_f32 v234, v32, v33
    v_mfma_f32_16x16x32_bf16 v[60:63], a[236:239], v[112:115], 0
    ds_read_b64_tr_b16 a[212:213], v20 offset:20480
    v_cvt_pk_bf16_f32 v235, v34, v35
    v_mfma_f32_16x16x32_bf16 v[60:63], a[240:243], v[120:123], v[60:63]
    ds_read_b64_tr_b16 a[214:215], v20 offset:20992
    buffer_load_dwordx4 v17, s[52:55], s9 offen offset:1024 lds
    v_mfma_f32_16x16x32_bf16 v[60:63], a[244:247], v[128:131], v[60:63]
    ds_read_b64_tr_b16 a[216:217], v21 offset:12288
    v_lshlrev_b32 v36, 16, v236
    v_mfma_f32_16x16x32_bf16 v[68:71], a[244:247], v[132:135], 0
    ds_read_b64_tr_b16 a[218:219], v21 offset:12800
    v_and_b32 v37, s15, v236
    v_lshlrev_b32 v38, 16, v237
    v_mfma_f32_16x16x32_bf16 v[68:71], a[240:243], v[124:127], v[68:71]
    s_waitcnt vmcnt(12) lgkmcnt(4)
    ds_read_b64_tr_b16 a[220:221], v21 offset:16384
    v_and_b32 v39, s15, v237
    v_mfma_f32_16x16x32_bf16 v[68:71], a[236:239], v[116:119], v[68:71]
    ds_read_b64_tr_b16 a[222:223], v21 offset:16896
    buffer_load_dwordx4 v18, s[52:55], s9 offen offset:2048 lds
    v_mfma_f32_16x16x32_bf16 v[40:43], a[248:251], v[136:139], v[40:43]
    s_barrier
    ds_read_b64_tr_b16 a[224:225], v21 offset:20480
    v_mfma_f32_16x16x32_bf16 v[40:43], a[252:255], v[144:147], v[40:43]
    ds_read_b64_tr_b16 a[226:227], v21 offset:20992
    v_fma_f32 v36, v36, v108, v109
    v_mfma_f32_16x16x32_bf16 v[40:43], a[200:203], v[152:155], v[40:43]
    s_add_u32 s9, s25, 128
    ds_read_b64_tr_b16 a[228:229], v22 offset:12288
    v_fma_f32 v37, v37, v108, v109
    v_mfma_f32_16x16x32_bf16 v[48:51], a[200:203], v[156:159], v[48:51]
    s_add_u32 m0, s8, 0x18000
    ds_read_b64_tr_b16 a[230:231], v22 offset:12800
    buffer_load_dwordx4 v13, s[52:55], s9 offen offset:0 lds
    v_mfma_f32_16x16x32_bf16 v[48:51], a[252:255], v[148:151], v[48:51]
    ds_read_b64_tr_b16 a[232:233], v22 offset:16384
    v_fma_f32 v38, v38, v108, v109
    v_mfma_f32_16x16x32_bf16 v[48:51], a[248:251], v[140:143], v[48:51]
    ds_read_b64_tr_b16 a[234:235], v22 offset:16896
    v_fma_f32 v39, v39, v108, v109
    v_cvt_pk_bf16_f32 v236, v36, v37
    v_mfma_f32_16x16x32_bf16 v[44:47], a[204:207], v[136:139], v[44:47]
    s_waitcnt lgkmcnt(4)
    ds_read_b64_tr_b16 a[236:237], v22 offset:20480
    v_cvt_pk_bf16_f32 v237, v38, v39
    v_mfma_f32_16x16x32_bf16 v[44:47], a[208:211], v[144:147], v[44:47]
    ds_read_b64_tr_b16 a[238:239], v22 offset:20992
    buffer_load_dwordx4 v14, s[52:55], s9 offen offset:1024 lds
    v_mfma_f32_16x16x32_bf16 v[44:47], a[212:215], v[152:155], v[44:47]
    ds_read_b64_tr_b16 a[240:241], v19 offset:24576
    v_lshlrev_b32 v36, 16, v238
    v_mfma_f32_16x16x32_bf16 v[52:55], a[212:215], v[156:159], v[52:55]
    ds_read_b64_tr_b16 a[242:243], v19 offset:25088
    v_and_b32 v37, s15, v238
    v_lshlrev_b32 v38, 16, v239
    v_mfma_f32_16x16x32_bf16 v[52:55], a[208:211], v[148:151], v[52:55]
    ds_read_b64_tr_b16 a[244:245], v19 offset:28672
    v_and_b32 v39, s15, v239
    v_mfma_f32_16x16x32_bf16 v[52:55], a[204:207], v[140:143], v[52:55]
    ds_read_b64_tr_b16 a[246:247], v19 offset:29184
    buffer_load_dwordx4 v15, s[52:55], s9 offen offset:2048 lds
    v_mfma_f32_16x16x32_bf16 v[56:59], a[216:219], v[136:139], v[56:59]
    ds_read_b64_tr_b16 a[248:249], v19 offset:32768
    v_fma_f32 v36, v36, v108, v109
    v_mfma_f32_16x16x32_bf16 v[56:59], a[220:223], v[144:147], v[56:59]
    ds_read_b64_tr_b16 a[250:251], v19 offset:33280
    v_fma_f32 v37, v37, v108, v109
    v_fma_f32 v38, v38, v108, v109
    v_mfma_f32_16x16x32_bf16 v[56:59], a[224:227], v[152:155], v[56:59]
    s_add_u32 m0, s8, 0x18c00
    s_waitcnt lgkmcnt(4)
    ds_read_b64_tr_b16 a[252:253], v20 offset:24576
    v_fma_f32 v39, v39, v108, v109
    v_mfma_f32_16x16x32_bf16 v[64:67], a[224:227], v[156:159], v[64:67]
    ds_read_b64_tr_b16 a[254:255], v20 offset:25088
    buffer_load_dwordx4 v16, s[52:55], s9 offen offset:0 lds
    v_mfma_f32_16x16x32_bf16 v[64:67], a[220:223], v[148:151], v[64:67]
    ds_read_b64_tr_b16 a[200:201], v20 offset:28672
    v_cvt_pk_bf16_f32 v238, v36, v37
    v_mfma_f32_16x16x32_bf16 v[64:67], a[216:219], v[140:143], v[64:67]
    ds_read_b64_tr_b16 a[202:203], v20 offset:29184
    v_cvt_pk_bf16_f32 v239, v38, v39
    v_lshlrev_b32 v32, 16, v240
    v_mfma_f32_16x16x32_bf16 v[60:63], a[228:231], v[136:139], v[60:63]
    ds_read_b64_tr_b16 a[204:205], v20 offset:32768
    v_and_b32 v33, s15, v240
    v_mfma_f32_16x16x32_bf16 v[60:63], a[232:235], v[144:147], v[60:63]
    ds_read_b64_tr_b16 a[206:207], v20 offset:33280
    buffer_load_dwordx4 v17, s[52:55], s9 offen offset:1024 lds
    v_mfma_f32_16x16x32_bf16 v[60:63], a[236:239], v[152:155], v[60:63]
    ds_read_b64_tr_b16 a[208:209], v21 offset:24576
    v_lshlrev_b32 v34, 16, v241
    v_mfma_f32_16x16x32_bf16 v[68:71], a[236:239], v[156:159], v[68:71]
    ds_read_b64_tr_b16 a[210:211], v21 offset:25088
    v_and_b32 v35, s15, v241
    v_fma_f32 v32, v32, v10, v11
    v_mfma_f32_16x16x32_bf16 v[68:71], a[232:235], v[148:151], v[68:71]
    s_waitcnt vmcnt(12) lgkmcnt(4)
    ds_read_b64_tr_b16 a[212:213], v21 offset:28672
    v_fma_f32 v33, v33, v10, v11
    v_mfma_f32_16x16x32_bf16 v[68:71], a[228:231], v[140:143], v[68:71]
    ds_read_b64_tr_b16 a[214:215], v21 offset:29184
    buffer_load_dwordx4 v18, s[52:55], s9 offen offset:2048 lds
    v_mfma_f32_16x16x32_bf16 v[40:43], a[240:243], v[160:163], v[40:43]
    s_barrier
    ds_read_b64_tr_b16 a[216:217], v21 offset:32768
    v_mfma_f32_16x16x32_bf16 v[40:43], a[244:247], v[168:171], v[40:43]
    ds_read_b64_tr_b16 a[218:219], v21 offset:33280
    v_fma_f32 v34, v34, v10, v11
    v_mfma_f32_16x16x32_bf16 v[40:43], a[248:251], v[176:179], v[40:43]
    s_add_u32 s9, s26, 128
    ds_read_b64_tr_b16 a[220:221], v22 offset:24576
    v_fma_f32 v35, v35, v10, v11
    v_mfma_f32_16x16x32_bf16 v[48:51], a[248:251], v[180:183], v[48:51]
    s_add_u32 m0, s8, 0x1e000
    ds_read_b64_tr_b16 a[222:223], v22 offset:25088
    buffer_load_dwordx4 v13, s[52:55], s9 offen offset:0 lds
    v_mfma_f32_16x16x32_bf16 v[48:51], a[244:247], v[172:175], v[48:51]
    ds_read_b64_tr_b16 a[224:225], v22 offset:28672
    v_cvt_pk_bf16_f32 v240, v32, v33
    v_mfma_f32_16x16x32_bf16 v[48:51], a[240:243], v[164:167], v[48:51]
    ds_read_b64_tr_b16 a[226:227], v22 offset:29184
    v_cvt_pk_bf16_f32 v241, v34, v35
    v_lshlrev_b32 v32, 16, v242
    v_mfma_f32_16x16x32_bf16 v[44:47], a[252:255], v[160:163], v[44:47]
    s_waitcnt lgkmcnt(4)
    ds_read_b64_tr_b16 a[228:229], v22 offset:32768
    v_and_b32 v33, s15, v242
    v_mfma_f32_16x16x32_bf16 v[44:47], a[200:203], v[168:171], v[44:47]
    ds_read_b64_tr_b16 a[230:231], v22 offset:33280
    buffer_load_dwordx4 v14, s[52:55], s9 offen offset:1024 lds
    v_mfma_f32_16x16x32_bf16 v[44:47], a[204:207], v[176:179], v[44:47]
    ds_read_b64_tr_b16 a[232:233], v19 offset:36864
    v_lshlrev_b32 v34, 16, v243
    v_mfma_f32_16x16x32_bf16 v[52:55], a[204:207], v[180:183], v[52:55]
    ds_read_b64_tr_b16 a[234:235], v19 offset:37376
    v_and_b32 v35, s15, v243
    v_fma_f32 v32, v32, v10, v11
    v_mfma_f32_16x16x32_bf16 v[52:55], a[200:203], v[172:175], v[52:55]
    ds_read_b64_tr_b16 a[236:237], v19 offset:40960
    v_fma_f32 v33, v33, v10, v11
    v_mfma_f32_16x16x32_bf16 v[52:55], a[252:255], v[164:167], v[52:55]
    ds_read_b64_tr_b16 a[238:239], v19 offset:41472
    buffer_load_dwordx4 v15, s[52:55], s9 offen offset:2048 lds
    v_mfma_f32_16x16x32_bf16 v[56:59], a[208:211], v[160:163], v[56:59]
    ds_read_b64_tr_b16 a[240:241], v19 offset:45056
    ds_read_b64_tr_b16 a[242:243], v19 offset:45568
    v_mfma_f32_16x16x32_bf16 v[56:59], a[212:215], v[168:171], v[56:59]
    v_add_u32 v19, 0xc000, v19
    v_fma_f32 v34, v34, v10, v11
    v_fma_f32 v35, v35, v10, v11
    v_mfma_f32_16x16x32_bf16 v[56:59], a[216:219], v[176:179], v[56:59]
    s_add_u32 m0, s8, 0x1ec00
    s_waitcnt lgkmcnt(4)
    ds_read_b64_tr_b16 a[244:245], v20 offset:36864
    v_cvt_pk_bf16_f32 v242, v32, v33
    v_mfma_f32_16x16x32_bf16 v[64:67], a[216:219], v[180:183], v[64:67]
    ds_read_b64_tr_b16 a[246:247], v20 offset:37376
    buffer_load_dwordx4 v16, s[52:55], s9 offen offset:0 lds
    v_mfma_f32_16x16x32_bf16 v[64:67], a[212:215], v[172:175], v[64:67]
    ds_read_b64_tr_b16 a[248:249], v20 offset:40960
    v_cvt_pk_bf16_f32 v243, v34, v35
    v_mfma_f32_16x16x32_bf16 v[64:67], a[208:211], v[164:167], v[64:67]
    ds_read_b64_tr_b16 a[250:251], v20 offset:41472
    v_lshlrev_b32 v36, 16, v244
    v_and_b32 v37, s15, v244
    v_mfma_f32_16x16x32_bf16 v[60:63], a[220:223], v[160:163], v[60:63]
    ds_read_b64_tr_b16 a[252:253], v20 offset:45056
    ds_read_b64_tr_b16 a[254:255], v20 offset:45568
    v_mfma_f32_16x16x32_bf16 v[60:63], a[224:227], v[168:171], v[60:63]
    buffer_load_dwordx4 v17, s[52:55], s9 offen offset:1024 lds
    v_add_u32 v20, 0xc000, v20
    v_mfma_f32_16x16x32_bf16 v[60:63], a[228:231], v[176:179], v[60:63]
    ds_read_b64_tr_b16 a[200:201], v21 offset:36864
    v_lshlrev_b32 v38, 16, v245
    v_mfma_f32_16x16x32_bf16 v[68:71], a[228:231], v[180:183], v[68:71]
    ds_read_b64_tr_b16 a[202:203], v21 offset:37376
    v_and_b32 v39, s15, v245
    v_fma_f32 v36, v36, v108, v109
    v_mfma_f32_16x16x32_bf16 v[68:71], a[224:227], v[172:175], v[68:71]
    s_waitcnt lgkmcnt(4)
    ds_read_b64_tr_b16 a[204:205], v21 offset:40960
    v_fma_f32 v37, v37, v108, v109
    v_mfma_f32_16x16x32_bf16 v[68:71], a[220:223], v[164:167], v[68:71]
    ds_read_b64_tr_b16 a[206:207], v21 offset:41472
    buffer_load_dwordx4 v18, s[52:55], s9 offen offset:2048 lds
    v_mfma_f32_16x16x32_bf16 v[40:43], a[232:235], v[184:187], v[40:43]
    ds_read_b64_tr_b16 a[208:209], v21 offset:45056
    ds_read_b64_tr_b16 a[210:211], v21 offset:45568
    v_mfma_f32_16x16x32_bf16 v[40:43], a[236:239], v[192:195], v[40:43]
    v_add_u32 v21, 0xc000, v21
    v_fma_f32 v38, v38, v108, v109
    v_fma_f32 v39, v39, v108, v109
    v_mfma_f32_16x16x32_bf16 v[40:43], a[240:243], v[200:203], v[40:43]
    ds_read_b64_tr_b16 a[212:213], v22 offset:36864
    v_cvt_pk_bf16_f32 v244, v36, v37
    v_mfma_f32_16x16x32_bf16 v[48:51], a[240:243], v[204:207], v[48:51]
    ds_read_b64_tr_b16 a[214:215], v22 offset:37376
    v_cvt_pk_bf16_f32 v245, v38, v39
    v_lshlrev_b32 v36, 16, v246
    v_mfma_f32_16x16x32_bf16 v[48:51], a[236:239], v[196:199], v[48:51]
    ds_read_b64_tr_b16 a[216:217], v22 offset:40960
    v_and_b32 v37, s15, v246
    v_mfma_f32_16x16x32_bf16 v[48:51], a[232:235], v[188:191], v[48:51]
    ds_read_b64_tr_b16 a[218:219], v22 offset:41472
    buffer_load_dword v4, v3, s[52:55], 0 offen offset:256
    v_mfma_f32_16x16x32_bf16 v[44:47], a[244:247], v[184:187], v[44:47]
    s_waitcnt lgkmcnt(4)
    ds_read_b64_tr_b16 a[220:221], v22 offset:45056
    ds_read_b64_tr_b16 a[222:223], v22 offset:45568
    v_mfma_f32_16x16x32_bf16 v[44:47], a[248:251], v[192:195], v[44:47]
    v_add_u32 v22, 0xc000, v22
    v_lshlrev_b32 v38, 16, v247
    v_and_b32 v39, s15, v247
    v_mfma_f32_16x16x32_bf16 v[44:47], a[252:255], v[200:203], v[44:47]
    s_lshl_b32 s11, s3, 11
    ds_read_b64_tr_b16 a[224:225], v19 offset:0
    v_fma_f32 v36, v36, v108, v109
    v_mfma_f32_16x16x32_bf16 v[52:55], a[252:255], v[204:207], v[52:55]
    s_add_u32 m0, s11, 0x24400
    ds_read_b64_tr_b16 a[226:227], v19 offset:512
    buffer_load_dwordx4 v105, s[48:51], 0 offen lds
    v_mfma_f32_16x16x32_bf16 v[52:55], a[248:251], v[196:199], v[52:55]
    ds_read_b64_tr_b16 a[228:229], v19 offset:4096
    v_fma_f32 v37, v37, v108, v109
    v_mfma_f32_16x16x32_bf16 v[52:55], a[244:247], v[188:191], v[52:55]
    s_movk_i32 s11, 17408
    ds_read_b64_tr_b16 a[230:231], v19 offset:4608
    buffer_load_dwordx4 v105, s[48:51], s11 offen offset:1024 lds
    v_mfma_f32_16x16x32_bf16 v[56:59], a[200:203], v[184:187], v[56:59]
    s_lshl_b32 s11, s3, 8
    ds_read_b64_tr_b16 a[232:233], v19 offset:8192
    v_fma_f32 v38, v38, v108, v109
    v_mfma_f32_16x16x32_bf16 v[56:59], a[204:207], v[192:195], v[56:59]
    s_add_u32 m0, s11, 0x26400
    ds_read_b64_tr_b16 a[234:235], v19 offset:8704
    global_load_lds_dword v104, s[32:33]
    v_mfma_f32_16x16x32_bf16 v[56:59], a[208:211], v[200:203], v[56:59]
    s_waitcnt lgkmcnt(4)
    ds_read_b64_tr_b16 a[236:237], v20 offset:0
    v_fma_f32 v39, v39, v108, v109
    v_mfma_f32_16x16x32_bf16 v[64:67], a[208:211], v[204:207], v[64:67]
    ds_read_b64_tr_b16 a[238:239], v20 offset:512
    v_cvt_pk_bf16_f32 v246, v36, v37
    v_cvt_pk_bf16_f32 v247, v38, v39
    v_mfma_f32_16x16x32_bf16 v[64:67], a[204:207], v[196:199], v[64:67]
    ds_read_b64_tr_b16 a[240:241], v20 offset:4096
    v_lshlrev_b32 v32, 16, v248
    v_mfma_f32_16x16x32_bf16 v[64:67], a[200:203], v[188:191], v[64:67]
    ds_read_b64_tr_b16 a[242:243], v20 offset:4608
    v_and_b32 v33, s15, v248
    v_lshlrev_b32 v34, 16, v249
    v_mfma_f32_16x16x32_bf16 v[60:63], a[212:215], v[184:187], v[60:63]
    ds_read_b64_tr_b16 a[244:245], v20 offset:8192
    v_and_b32 v35, s15, v249
    v_mfma_f32_16x16x32_bf16 v[60:63], a[216:219], v[192:195], v[60:63]
    ds_read_b64_tr_b16 a[246:247], v20 offset:8704
    v_fma_f32 v32, v32, v10, v11
    v_fma_f32 v33, v33, v10, v11
    v_mfma_f32_16x16x32_bf16 v[60:63], a[220:223], v[200:203], v[60:63]
    ds_read_b64_tr_b16 a[248:249], v21 offset:0
    v_fma_f32 v34, v34, v10, v11
    v_mfma_f32_16x16x32_bf16 v[68:71], a[220:223], v[204:207], v[68:71]
    ds_read_b64_tr_b16 a[250:251], v21 offset:512
    v_fma_f32 v35, v35, v10, v11
    v_cvt_pk_bf16_f32 v248, v32, v33
    v_mfma_f32_16x16x32_bf16 v[68:71], a[216:219], v[196:199], v[68:71]
    s_waitcnt vmcnt(16) lgkmcnt(4)
    ds_read_b64_tr_b16 a[252:253], v21 offset:4096
    v_cvt_pk_bf16_f32 v249, v34, v35
    v_mfma_f32_16x16x32_bf16 v[68:71], a[212:215], v[188:191], v[68:71]
    ds_read_b64_tr_b16 a[254:255], v21 offset:4608
    v_lshlrev_b32 v32, 16, v250
    v_and_b32 v33, s15, v250
    v_mfma_f32_16x16x32_bf16 v[40:43], a[224:227], v[208:211], v[40:43]
    s_barrier
    ds_read_b64_tr_b16 a[200:201], v21 offset:8192
    ds_read_b64_tr_b16 a[202:203], v21 offset:8704
    v_lshlrev_b32 v34, 16, v251
    s_cmp_lg_u32 s3, 0
    s_cbranch_scc1 L_ffn_an
    s_mov_b64 exec, 1
    v_mov_b32 v2, 1
    v_mov_b32 v1, s68
    global_atomic_add v1, v2, s[42:43]
    s_mov_b64 exec, -1
L_ffn_an:
    v_mfma_f32_16x16x32_bf16 v[40:43], a[228:231], v[216:219], v[40:43]
    v_mfma_f32_16x16x32_bf16 v[40:43], a[232:235], v[224:227], v[40:43]
    ds_read_b64_tr_b16 a[204:205], v22 offset:0
    v_and_b32 v35, s15, v251
    v_mfma_f32_16x16x32_bf16 v[48:51], a[232:235], v[228:231], v[48:51]
    ds_read_b64_tr_b16 a[206:207], v22 offset:512
    v_fma_f32 v32, v32, v10, v11
    v_fma_f32 v33, v33, v10, v11
    v_mfma_f32_16x16x32_bf16 v[48:51], a[228:231], v[220:223], v[48:51]
    ds_read_b64_tr_b16 a[208:209], v22 offset:4096
    v_fma_f32 v34, v34, v10, v11
    v_mfma_f32_16x16x32_bf16 v[48:51], a[224:227], v[212:215], v[48:51]
    ds_read_b64_tr_b16 a[210:211], v22 offset:4608
    v_fma_f32 v35, v35, v10, v11
    v_cvt_pk_bf16_f32 v250, v32, v33
    v_mfma_f32_16x16x32_bf16 v[44:47], a[236:239], v[208:211], v[44:47]
    s_waitcnt lgkmcnt(4)
    ds_read_b64_tr_b16 a[212:213], v22 offset:8192
    v_cvt_pk_bf16_f32 v251, v34, v35
    v_mfma_f32_16x16x32_bf16 v[44:47], a[240:243], v[216:219], v[44:47]
    ds_read_b64_tr_b16 a[214:215], v22 offset:8704
    v_lshlrev_b32 v36, 16, v252
    v_and_b32 v37, s15, v252
    v_mfma_f32_16x16x32_bf16 v[44:47], a[244:247], v[224:227], v[44:47]
    ds_read_b64_tr_b16 a[216:217], v19 offset:12288
    v_lshlrev_b32 v38, 16, v253
    v_mfma_f32_16x16x32_bf16 v[52:55], a[244:247], v[228:231], v[52:55]
    ds_read_b64_tr_b16 a[218:219], v19 offset:12800
    v_and_b32 v39, s15, v253
    v_fma_f32 v36, v36, v108, v109
    v_mfma_f32_16x16x32_bf16 v[52:55], a[240:243], v[220:223], v[52:55]
    ds_read_b64_tr_b16 a[220:221], v19 offset:16384
    v_fma_f32 v37, v37, v108, v109
    v_mfma_f32_16x16x32_bf16 v[52:55], a[236:239], v[212:215], v[52:55]
    ds_read_b64_tr_b16 a[222:223], v19 offset:16896
    v_fma_f32 v38, v38, v108, v109
    v_fma_f32 v39, v39, v108, v109
    v_mfma_f32_16x16x32_bf16 v[56:59], a[248:251], v[208:211], v[56:59]
    ds_read_b64_tr_b16 a[224:225], v19 offset:20480
    v_cvt_pk_bf16_f32 v252, v36, v37
    v_mfma_f32_16x16x32_bf16 v[56:59], a[252:255], v[216:219], v[56:59]
L_pf4:
    s_cbranch_execz L_rf4
    ds_read_b64_tr_b16 a[226:227], v19 offset:20992
    v_cvt_pk_bf16_f32 v253, v38, v39
    v_lshlrev_b32 v36, 16, v254
    v_mfma_f32_16x16x32_bf16 v[56:59], a[200:203], v[224:227], v[56:59]
    s_waitcnt lgkmcnt(4)
    ds_read_b64_tr_b16 a[228:229], v20 offset:12288
    v_and_b32 v37, s15, v254
    v_mfma_f32_16x16x32_bf16 v[64:67], a[200:203], v[228:231], v[64:67]
    ds_read_b64_tr_b16 a[230:231], v20 offset:12800
    v_lshlrev_b32 v38, 16, v255
    v_and_b32 v39, s15, v255
    v_mfma_f32_16x16x32_bf16 v[64:67], a[252:255], v[220:223], v[64:67]
    ds_read_b64_tr_b16 a[232:233], v20 offset:16384
    v_fma_f32 v36, v36, v108, v109
    v_mfma_f32_16x16x32_bf16 v[64:67], a[248:251], v[212:215], v[64:67]
    ds_read_b64_tr_b16 a[234:235], v20 offset:16896
    v_fma_f32 v37, v37, v108, v109
    v_fma_f32 v38, v38, v108, v109
    v_mfma_f32_16x16x32_bf16 v[60:63], a[204:207], v[208:211], v[60:63]
    ds_read_b64_tr_b16 a[236:237], v20 offset:20480
    v_fma_f32 v39, v39, v108, v109
    v_mfma_f32_16x16x32_bf16 v[60:63], a[208:211], v[216:219], v[60:63]
    ds_read_b64_tr_b16 a[238:239], v20 offset:20992
    v_cvt_pk_bf16_f32 v254, v36, v37
    v_cvt_pk_bf16_f32 v255, v38, v39
    v_mfma_f32_16x16x32_bf16 v[60:63], a[212:215], v[224:227], v[60:63]
    ds_read_b64_tr_b16 a[240:241], v21 offset:12288
    v_mfma_f32_16x16x32_bf16 v[68:71], a[212:215], v[228:231], v[68:71]
    ds_read_b64_tr_b16 a[242:243], v21 offset:12800
    v_mfma_f32_16x16x32_bf16 v[68:71], a[208:211], v[220:223], v[68:71]
    s_waitcnt lgkmcnt(4)
    ds_read_b64_tr_b16 a[244:245], v21 offset:16384
    v_mfma_f32_16x16x32_bf16 v[68:71], a[204:207], v[212:215], v[68:71]
    ds_read_b64_tr_b16 a[246:247], v21 offset:16896
    v_mfma_f32_16x16x32_bf16 v[40:43], a[216:219], v[232:235], v[40:43]
    ds_read_b64_tr_b16 a[248:249], v21 offset:20480
    v_mfma_f32_16x16x32_bf16 v[40:43], a[220:223], v[240:243], v[40:43]
    ds_read_b64_tr_b16 a[250:251], v21 offset:20992
    v_mfma_f32_16x16x32_bf16 v[40:43], a[224:227], v[248:251], v[40:43]
    ds_read_b64_tr_b16 a[252:253], v22 offset:12288
    v_mfma_f32_16x16x32_bf16 v[48:51], a[224:227], v[252:255], v[48:51]
    ds_read_b64_tr_b16 a[254:255], v22 offset:12800
    v_mfma_f32_16x16x32_bf16 v[48:51], a[220:223], v[244:247], v[48:51]
    ds_read_b64_tr_b16 a[200:201], v22 offset:16384
    v_mfma_f32_16x16x32_bf16 v[48:51], a[216:219], v[236:239], v[48:51]
    ds_read_b64_tr_b16 a[202:203], v22 offset:16896
    v_mfma_f32_16x16x32_bf16 v[44:47], a[228:231], v[232:235], v[44:47]
    s_waitcnt lgkmcnt(4)
    ds_read_b64_tr_b16 a[204:205], v22 offset:20480
    v_mfma_f32_16x16x32_bf16 v[44:47], a[232:235], v[240:243], v[44:47]
    ds_read_b64_tr_b16 a[206:207], v22 offset:20992
    v_mfma_f32_16x16x32_bf16 v[44:47], a[236:239], v[248:251], v[44:47]
    ds_read_b64_tr_b16 a[208:209], v19 offset:24576
    v_mfma_f32_16x16x32_bf16 v[52:55], a[236:239], v[252:255], v[52:55]
    ds_read_b64_tr_b16 a[210:211], v19 offset:25088
    v_mfma_f32_16x16x32_bf16 v[52:55], a[232:235], v[244:247], v[52:55]
    ds_read_b64_tr_b16 a[212:213], v19 offset:28672
    v_mfma_f32_16x16x32_bf16 v[52:55], a[228:231], v[236:239], v[52:55]
    ds_read_b64_tr_b16 a[214:215], v19 offset:29184
    v_mfma_f32_16x16x32_bf16 v[56:59], a[240:243], v[232:235], v[56:59]
    ds_read_b64_tr_b16 a[216:217], v19 offset:32768
    v_mfma_f32_16x16x32_bf16 v[56:59], a[244:247], v[240:243], v[56:59]
    ds_read_b64_tr_b16 a[218:219], v19 offset:33280
    v_mfma_f32_16x16x32_bf16 v[56:59], a[248:251], v[248:251], v[56:59]
    s_waitcnt lgkmcnt(4)
    ds_read_b64_tr_b16 a[220:221], v20 offset:24576
    v_mfma_f32_16x16x32_bf16 v[64:67], a[248:251], v[252:255], v[64:67]
    ds_read_b64_tr_b16 a[222:223], v20 offset:25088
    v_mfma_f32_16x16x32_bf16 v[64:67], a[244:247], v[244:247], v[64:67]
    ds_read_b64_tr_b16 a[224:225], v20 offset:28672
    v_mfma_f32_16x16x32_bf16 v[64:67], a[240:243], v[236:239], v[64:67]
    ds_read_b64_tr_b16 a[226:227], v20 offset:29184
    v_mfma_f32_16x16x32_bf16 v[60:63], a[252:255], v[232:235], v[60:63]
    ds_read_b64_tr_b16 a[228:229], v20 offset:32768
    v_mfma_f32_16x16x32_bf16 v[60:63], a[200:203], v[240:243], v[60:63]
    ds_read_b64_tr_b16 a[230:231], v20 offset:33280
    v_mfma_f32_16x16x32_bf16 v[60:63], a[204:207], v[248:251], v[60:63]
    ds_read_b64_tr_b16 a[232:233], v21 offset:24576
    v_mfma_f32_16x16x32_bf16 v[68:71], a[204:207], v[252:255], v[68:71]
    ds_read_b64_tr_b16 a[234:235], v21 offset:25088
    v_mfma_f32_16x16x32_bf16 v[68:71], a[200:203], v[244:247], v[68:71]
    s_waitcnt vmcnt(10) lgkmcnt(4)
    ds_read_b64_tr_b16 a[236:237], v21 offset:28672
    v_mfma_f32_16x16x32_bf16 v[68:71], a[252:255], v[236:239], v[68:71]
    ds_read_b64_tr_b16 a[238:239], v21 offset:29184
    v_mfma_f32_16x16x32_bf16 v[72:75], a[208:211], v[112:115], 0
    s_barrier
    v_mfma_f32_16x16x32_bf16 v[72:75], a[212:215], v[120:123], v[72:75]
    ds_read_b64_tr_b16 a[240:241], v21 offset:32768
    ds_read_b64_tr_b16 a[242:243], v21 offset:33280
    v_mfma_f32_16x16x32_bf16 v[72:75], a[216:219], v[128:131], v[72:75]
    s_add_u32 s9, s24, 256
    ds_read_b64_tr_b16 a[244:245], v22 offset:24576
    v_mfma_f32_16x16x32_bf16 v[80:83], a[216:219], v[132:135], 0
    s_add_u32 m0, s8, 0x0
    ds_read_b64_tr_b16 a[246:247], v22 offset:25088
    buffer_load_dwordx4 v13, s[52:55], s9 offen offset:0 lds
    v_mfma_f32_16x16x32_bf16 v[80:83], a[212:215], v[124:127], v[80:83]
    ds_read_b64_tr_b16 a[248:249], v22 offset:28672
    v_mfma_f32_16x16x32_bf16 v[80:83], a[208:211], v[116:119], v[80:83]
    ds_read_b64_tr_b16 a[250:251], v22 offset:29184
    v_mfma_f32_16x16x32_bf16 v[76:79], a[220:223], v[112:115], 0
    s_waitcnt lgkmcnt(4)
    ds_read_b64_tr_b16 a[252:253], v22 offset:32768
    v_exp_f32 v32, v40
    v_mfma_f32_16x16x32_bf16 v[76:79], a[224:227], v[120:123], v[76:79]
    ds_read_b64_tr_b16 a[254:255], v22 offset:33280
    buffer_load_dwordx4 v14, s[52:55], s9 offen offset:1024 lds
    v_mfma_f32_16x16x32_bf16 v[76:79], a[228:231], v[128:131], v[76:79]
    ds_read_b64_tr_b16 a[200:201], v19 offset:36864
    v_exp_f32 v33, v41
    v_mfma_f32_16x16x32_bf16 v[84:87], a[228:231], v[132:135], 0
    s_lshl_b32 s12, s5, 1
    ds_read_b64_tr_b16 a[202:203], v19 offset:37376
    v_add_f32 v32, 1.0, v32
    v_mfma_f32_16x16x32_bf16 v[84:87], a[224:227], v[124:127], v[84:87]
    ds_read_b64_tr_b16 a[204:205], v19 offset:40960
    v_exp_f32 v34, v42
    v_add_f32 v33, 1.0, v33
    v_mfma_f32_16x16x32_bf16 v[84:87], a[220:223], v[116:119], v[84:87]
    ds_read_b64_tr_b16 a[206:207], v19 offset:41472
    buffer_load_dwordx4 v15, s[52:55], s9 offen offset:2048 lds
    v_mfma_f32_16x16x32_bf16 v[88:91], a[232:235], v[112:115], 0
    ds_read_b64_tr_b16 a[208:209], v19 offset:45056
    ds_read_b64_tr_b16 a[210:211], v19 offset:45568
    v_mfma_f32_16x16x32_bf16 v[88:91], a[236:239], v[120:123], v[88:91]
    s_lshr_b32 s13, s6, 1
    v_add_u32 v19, 0xc000, v19
    v_exp_f32 v35, v43
    v_add_f32 v34, 1.0, v34
    v_mfma_f32_16x16x32_bf16 v[88:91], a[240:243], v[128:131], v[88:91]
    s_add_u32 m0, s8, 0xc00
    s_waitcnt lgkmcnt(4)
    ds_read_b64_tr_b16 a[212:213], v20 offset:36864
    v_rcp_f32 v32, v32
    v_mfma_f32_16x16x32_bf16 v[96:99], a[240:243], v[132:135], 0
    ds_read_b64_tr_b16 a[214:215], v20 offset:37376
    buffer_load_dwordx4 v16, s[52:55], s9 offen offset:0 lds
    v_mfma_f32_16x16x32_bf16 v[96:99], a[236:239], v[124:127], v[96:99]
    ds_read_b64_tr_b16 a[216:217], v20 offset:40960
    v_add_f32 v35, 1.0, v35
    v_mfma_f32_16x16x32_bf16 v[96:99], a[232:235], v[116:119], v[96:99]
    s_add_u32 s12, s12, s13
    ds_read_b64_tr_b16 a[218:219], v20 offset:41472
    v_rcp_f32 v33, v33
    v_mfma_f32_16x16x32_bf16 v[92:95], a[244:247], v[112:115], 0
    ds_read_b64_tr_b16 a[220:221], v20 offset:45056
    ds_read_b64_tr_b16 a[222:223], v20 offset:45568
    v_add_u32 v20, 0xc000, v20
    v_rcp_f32 v34, v34
    v_mfma_f32_16x16x32_bf16 v[92:95], a[248:251], v[120:123], v[92:95]
    buffer_load_dwordx4 v17, s[52:55], s9 offen offset:1024 lds
    v_mfma_f32_16x16x32_bf16 v[92:95], a[252:255], v[128:131], v[92:95]
    s_cmp_ge_u32 s12, 3
    ds_read_b64_tr_b16 a[224:225], v21 offset:36864
    v_rcp_f32 v35, v35
    v_mfma_f32_16x16x32_bf16 v[100:103], a[252:255], v[132:135], 0
    s_cselect_b32 s35, 2, 0
    s_cselect_b32 s36, 3, 0
    ds_read_b64_tr_b16 a[226:227], v21 offset:37376
    v_mfma_f32_16x16x32_bf16 v[100:103], a[248:251], v[124:127], v[100:103]
    s_waitcnt lgkmcnt(4)
    ds_read_b64_tr_b16 a[228:229], v21 offset:40960
    v_exp_f32 v36, v44
    v_mul_f32 v32, v40, v32
    v_mfma_f32_16x16x32_bf16 v[100:103], a[244:247], v[116:119], v[100:103]
    ds_read_b64_tr_b16 a[230:231], v21 offset:41472
    buffer_load_dwordx4 v18, s[52:55], s9 offen offset:2048 lds
    v_mfma_f32_16x16x32_bf16 v[72:75], a[200:203], v[136:139], v[72:75]
    ds_read_b64_tr_b16 a[232:233], v21 offset:45056
    ds_read_b64_tr_b16 a[234:235], v21 offset:45568
    v_mfma_f32_16x16x32_bf16 v[72:75], a[204:207], v[144:147], v[72:75]
    s_sub_u32 s12, s12, s36
    v_add_u32 v21, 0xc000, v21
    v_mul_f32 v33, v41, v33
    v_exp_f32 v37, v45
    v_mfma_f32_16x16x32_bf16 v[72:75], a[208:211], v[152:155], v[72:75]
    s_add_u32 s9, s25, 256
    ds_read_b64_tr_b16 a[236:237], v22 offset:36864
    v_add_f32 v36, 1.0, v36
    v_cvt_pk_bf16_f32 v104, v32, v33
    v_mfma_f32_16x16x32_bf16 v[80:83], a[208:211], v[156:159], v[80:83]
    s_add_u32 m0, s8, 0x6000
    ds_read_b64_tr_b16 a[238:239], v22 offset:37376
    buffer_load_dwordx4 v13, s[52:55], s9 offen offset:0 lds
    v_mfma_f32_16x16x32_bf16 v[80:83], a[204:207], v[148:151], v[80:83]
    ds_read_b64_tr_b16 a[240:241], v22 offset:40960
    v_mul_f32 v34, v42, v34
    v_mfma_f32_16x16x32_bf16 v[80:83], a[200:203], v[140:143], v[80:83]
    s_xor_b32 s36, s35, 2
    ds_read_b64_tr_b16 a[242:243], v22 offset:41472
    v_exp_f32 v38, v46
    v_mfma_f32_16x16x32_bf16 v[76:79], a[212:215], v[136:139], v[76:79]
    s_waitcnt lgkmcnt(4)
    ds_read_b64_tr_b16 a[244:245], v22 offset:45056
    ds_read_b64_tr_b16 a[246:247], v22 offset:45568
    v_add_u32 v22, 0xc000, v22
    v_mfma_f32_16x16x32_bf16 v[76:79], a[216:219], v[144:147], v[76:79]
    buffer_load_dwordx4 v14, s[52:55], s9 offen offset:1024 lds
    v_add_f32 v37, 1.0, v37
    v_mfma_f32_16x16x32_bf16 v[76:79], a[220:223], v[152:155], v[76:79]
    ds_read_b64_tr_b16 a[248:249], v19 offset:0
    v_mul_f32 v35, v43, v35
    v_mfma_f32_16x16x32_bf16 v[84:87], a[220:223], v[156:159], v[84:87]
    s_lshl_b32 s12, s12, 7
    ds_read_b64_tr_b16 a[250:251], v19 offset:512
    v_cvt_pk_bf16_f32 v105, v34, v35
    v_exp_f32 v39, v47
    v_mfma_f32_16x16x32_bf16 v[84:87], a[216:219], v[148:151], v[84:87]
    ds_read_b64_tr_b16 a[252:253], v19 offset:4096
    v_add_f32 v38, 1.0, v38
    v_rcp_f32 v36, v36
    v_mfma_f32_16x16x32_bf16 v[84:87], a[212:215], v[140:143], v[84:87]
    ds_read_b64_tr_b16 a[254:255], v19 offset:4608
    buffer_load_dwordx4 v15, s[52:55], s9 offen offset:2048 lds
    v_mfma_f32_16x16x32_bf16 v[88:91], a[224:227], v[136:139], v[88:91]
    ds_read_b64_tr_b16 a[200:201], v19 offset:8192
    v_add_f32 v39, 1.0, v39
    v_mfma_f32_16x16x32_bf16 v[88:91], a[228:231], v[144:147], v[88:91]
    s_add_u32 s12, s12, s99
    ds_read_b64_tr_b16 a[202:203], v19 offset:8704
    v_rcp_f32 v37, v37
    v_mfma_f32_16x16x32_bf16 v[88:91], a[232:235], v[152:155], v[88:91]
    s_add_u32 m0, s8, 0x6c00
    s_waitcnt lgkmcnt(4)
    ds_read_b64_tr_b16 a[204:205], v20 offset:0
    v_rcp_f32 v38, v38
    v_mfma_f32_16x16x32_bf16 v[96:99], a[232:235], v[156:159], v[96:99]
    ds_read_b64_tr_b16 a[206:207], v20 offset:512
    buffer_load_dwordx4 v16, s[52:55], s9 offen offset:0 lds
    v_mfma_f32_16x16x32_bf16 v[96:99], a[228:231], v[148:151], v[96:99]
    ds_read_b64_tr_b16 a[208:209], v20 offset:4096
    v_rcp_f32 v39, v39
    v_mfma_f32_16x16x32_bf16 v[96:99], a[224:227], v[140:143], v[96:99]
    s_add_u32 s12, s12, 13952
    ds_read_b64_tr_b16 a[210:211], v20 offset:4608
    v_exp_f32 v32, v48
    v_mfma_f32_16x16x32_bf16 v[92:95], a[236:239], v[136:139], v[92:95]
    ds_read_b64_tr_b16 a[212:213], v20 offset:8192
    v_mul_f32 v36, v44, v36
    v_mul_f32 v37, v45, v37
    v_mfma_f32_16x16x32_bf16 v[92:95], a[240:243], v[144:147], v[92:95]
    ds_read_b64_tr_b16 a[214:215], v20 offset:8704
    buffer_load_dwordx4 v17, s[52:55], s9 offen offset:1024 lds
    v_mfma_f32_16x16x32_bf16 v[92:95], a[244:247], v[152:155], v[92:95]
    ds_read_b64_tr_b16 a[216:217], v21 offset:0
    v_exp_f32 v33, v49
    v_mfma_f32_16x16x32_bf16 v[100:103], a[244:247], v[156:159], v[100:103]
    s_mul_i32 s38, s35, 1152
    ds_read_b64_tr_b16 a[218:219], v21 offset:512
    v_add_f32 v32, 1.0, v32
    v_cvt_pk_bf16_f32 v106, v36, v37
    v_mfma_f32_16x16x32_bf16 v[100:103], a[240:243], v[148:151], v[100:103]
    s_waitcnt vmcnt(15) lgkmcnt(4)
    ds_read_b64_tr_b16 a[220:221], v21 offset:4096
    v_mul_f32 v38, v46, v38
    v_exp_f32 v34, v50
    v_mfma_f32_16x16x32_bf16 v[100:103], a[236:239], v[140:143], v[100:103]
    ds_read_b64_tr_b16 a[222:223], v21 offset:4608
    buffer_load_dwordx4 v18, s[52:55], s9 offen offset:2048 lds
    v_mfma_f32_16x16x32_bf16 v[72:75], a[248:251], v[160:163], v[72:75]
    s_barrier
    ds_read_b64_tr_b16 a[224:225], v21 offset:8192
    v_mfma_f32_16x16x32_bf16 v[72:75], a[252:255], v[168:171], v[72:75]
    ds_read_b64_tr_b16 a[226:227], v21 offset:8704
    v_add_f32 v33, 1.0, v33
    v_mfma_f32_16x16x32_bf16 v[72:75], a[200:203], v[176:179], v[72:75]
    s_add_u32 s9, s26, 256
    ds_read_b64_tr_b16 a[228:229], v22 offset:0
    v_mul_f32 v39, v47, v39
    v_cvt_pk_bf16_f32 v107, v38, v39
    v_mfma_f32_16x16x32_bf16 v[80:83], a[200:203], v[180:183], v[80:83]
    s_add_u32 m0, s8, 0xc000
    ds_read_b64_tr_b16 a[230:231], v22 offset:512
    buffer_load_dwordx4 v13, s[52:55], s9 offen offset:0 lds
    v_mfma_f32_16x16x32_bf16 v[80:83], a[252:255], v[172:175], v[80:83]
    ds_read_b64_tr_b16 a[232:233], v22 offset:4096
    v_exp_f32 v35, v51
    v_mfma_f32_16x16x32_bf16 v[80:83], a[248:251], v[164:167], v[80:83]
    s_add_u32 s38, s38, s12
    ds_read_b64_tr_b16 a[234:235], v22 offset:4608
    v_add_f32 v34, 1.0, v34
    v_mfma_f32_16x16x32_bf16 v[76:79], a[204:207], v[160:163], v[76:79]
    s_waitcnt lgkmcnt(4)
    ds_read_b64_tr_b16 a[236:237], v22 offset:8192
    v_rcp_f32 v32, v32
    v_add_f32 v35, 1.0, v35
    v_mfma_f32_16x16x32_bf16 v[76:79], a[208:211], v[168:171], v[76:79]
    ds_read_b64_tr_b16 a[238:239], v22 offset:8704
    buffer_load_dwordx4 v14, s[52:55], s9 offen offset:1024 lds
    v_mfma_f32_16x16x32_bf16 v[76:79], a[212:215], v[176:179], v[76:79]
    ds_read_b64_tr_b16 a[240:241], v19 offset:12288
    v_rcp_f32 v33, v33
    v_mfma_f32_16x16x32_bf16 v[84:87], a[212:215], v[180:183], v[84:87]
    s_mul_i32 s39, s36, 1152
    ds_read_b64_tr_b16 a[242:243], v19 offset:12800
    v_rcp_f32 v34, v34
    v_mfma_f32_16x16x32_bf16 v[84:87], a[208:211], v[172:175], v[84:87]
    ds_read_b64_tr_b16 a[244:245], v19 offset:16384
    v_rcp_f32 v35, v35
    v_mfma_f32_16x16x32_bf16 v[84:87], a[204:207], v[164:167], v[84:87]
    s_add_u32 s31, s28, 0
    ds_read_b64_tr_b16 a[246:247], v19 offset:16896
    buffer_load_dwordx4 v15, s[52:55], s9 offen offset:2048 lds
    v_mfma_f32_16x16x32_bf16 v[88:91], a[216:219], v[160:163], v[88:91]
    v_exp_f32 v36, v52
    v_mfma_f32_16x16x32_bf16 v[88:91], a[220:223], v[168:171], v[88:91]
    buffer_store_dwordx4 v[104:107], v8, s[60:63], s31 offen offset:0 sc1
    ds_read_b64_tr_b16 a[248:249], v19 offset:20480
    ds_read_b64_tr_b16 a[250:251], v19 offset:20992
    v_mfma_f32_16x16x32_bf16 v[88:91], a[224:227], v[176:179], v[88:91]
    s_add_u32 m0, s8, 0xcc00
    s_waitcnt lgkmcnt(4)
    ds_read_b64_tr_b16 a[252:253], v20 offset:12288
    v_mul_f32 v32, v48, v32
    v_mul_f32 v33, v49, v33
    v_mfma_f32_16x16x32_bf16 v[96:99], a[224:227], v[180:183], v[96:99]
    ds_read_b64_tr_b16 a[254:255], v20 offset:12800
    buffer_load_dwordx4 v16, s[52:55], s9 offen offset:0 lds
    v_mfma_f32_16x16x32_bf16 v[96:99], a[220:223], v[172:175], v[96:99]
    ds_read_b64_tr_b16 a[200:201], v20 offset:16384
    v_exp_f32 v37, v53
    v_mfma_f32_16x16x32_bf16 v[96:99], a[216:219], v[164:167], v[96:99]
    s_add_u32 s39, s39, s12
    ds_read_b64_tr_b16 a[202:203], v20 offset:16896
    v_add_f32 v36, 1.0, v36
    v_cvt_pk_bf16_f32 v108, v32, v33
    v_mfma_f32_16x16x32_bf16 v[92:95], a[228:231], v[160:163], v[92:95]
    ds_read_b64_tr_b16 a[204:205], v20 offset:20480
    v_mul_f32 v34, v50, v34
    v_exp_f32 v38, v54
    v_mfma_f32_16x16x32_bf16 v[92:95], a[232:235], v[168:171], v[92:95]
    ds_read_b64_tr_b16 a[206:207], v20 offset:20992
    buffer_load_dwordx4 v17, s[52:55], s9 offen offset:1024 lds
    v_mfma_f32_16x16x32_bf16 v[92:95], a[236:239], v[176:179], v[92:95]
    ds_read_b64_tr_b16 a[208:209], v21 offset:12288
    v_add_f32 v37, 1.0, v37
    v_mfma_f32_16x16x32_bf16 v[100:103], a[236:239], v[180:183], v[100:103]
    s_add_u32 s39, s39, 384
    ds_read_b64_tr_b16 a[210:211], v21 offset:12800
    v_mul_f32 v35, v51, v35
    v_cvt_pk_bf16_f32 v109, v34, v35
    v_mfma_f32_16x16x32_bf16 v[100:103], a[232:235], v[172:175], v[100:103]
    s_waitcnt lgkmcnt(4)
    ds_read_b64_tr_b16 a[212:213], v21 offset:16384
    v_exp_f32 v39, v55
    v_mfma_f32_16x16x32_bf16 v[100:103], a[228:231], v[164:167], v[100:103]
    ds_read_b64_tr_b16 a[214:215], v21 offset:16896
    buffer_load_dwordx4 v18, s[52:55], s9 offen offset:2048 lds
    v_mfma_f32_16x16x32_bf16 v[72:75], a[240:243], v[184:187], v[72:75]
    ds_read_b64_tr_b16 a[216:217], v21 offset:20480
    v_add_f32 v38, 1.0, v38
    v_mfma_f32_16x16x32_bf16 v[72:75], a[244:247], v[192:195], v[72:75]
    s_add_u32 s35, s35, 4
    ds_read_b64_tr_b16 a[218:219], v21 offset:20992
    v_rcp_f32 v36, v36
    v_add_f32 v39, 1.0, v39
    v_mfma_f32_16x16x32_bf16 v[72:75], a[248:251], v[200:203], v[72:75]
    ds_read_b64_tr_b16 a[220:221], v22 offset:12288
    v_rcp_f32 v37, v37
    v_mfma_f32_16x16x32_bf16 v[80:83], a[248:251], v[204:207], v[80:83]
    s_lshl_b32 s35, s35, 12
    ds_read_b64_tr_b16 a[222:223], v22 offset:12800
    v_rcp_f32 v38, v38
    v_mfma_f32_16x16x32_bf16 v[80:83], a[244:247], v[196:199], v[80:83]
    ds_read_b64_tr_b16 a[224:225], v22 offset:16384
    v_rcp_f32 v39, v39
    v_mfma_f32_16x16x32_bf16 v[80:83], a[240:243], v[188:191], v[80:83]
    ds_read_b64_tr_b16 a[226:227], v22 offset:16896
    buffer_load_dword v4, v3, s[52:55], 0 offen offset:512
    v_mfma_f32_16x16x32_bf16 v[76:79], a[252:255], v[184:187], v[76:79]
    s_waitcnt lgkmcnt(4)
    ds_read_b64_tr_b16 a[228:229], v22 offset:20480
    v_exp_f32 v32, v56
    v_mfma_f32_16x16x32_bf16 v[76:79], a[200:203], v[192:195], v[76:79]
    ds_read_b64_tr_b16 a[230:231], v22 offset:20992
    v_mul_f32 v36, v52, v36
    v_mul_f32 v37, v53, v37
    v_mfma_f32_16x16x32_bf16 v[76:79], a[204:207], v[200:203], v[76:79]
    ds_read_b64_tr_b16 a[232:233], v19 offset:24576
    v_exp_f32 v33, v57
    v_mfma_f32_16x16x32_bf16 v[84:87], a[204:207], v[204:207], v[84:87]
    s_add_u32 s36, s36, 4
    ds_read_b64_tr_b16 a[234:235], v19 offset:25088
    v_add_f32 v32, 1.0, v32
    v_cvt_pk_bf16_f32 v110, v36, v37
    v_mfma_f32_16x16x32_bf16 v[84:87], a[200:203], v[196:199], v[84:87]
    ds_read_b64_tr_b16 a[236:237], v19 offset:28672
    v_mul_f32 v38, v54, v38
    v_mfma_f32_16x16x32_bf16 v[84:87], a[252:255], v[188:191], v[84:87]
    s_lshl_b32 s36, s36, 12
    ds_read_b64_tr_b16 a[238:239], v19 offset:29184
    v_exp_f32 v34, v58
    v_add_f32 v33, 1.0, v33
    v_mfma_f32_16x16x32_bf16 v[88:91], a[208:211], v[184:187], v[88:91]
    ds_read_b64_tr_b16 a[240:241], v19 offset:32768
    v_mul_f32 v39, v55, v39
    v_mfma_f32_16x16x32_bf16 v[88:91], a[212:215], v[192:195], v[88:91]
    s_xor_b32 s13, s13, 1
    ds_read_b64_tr_b16 a[242:243], v19 offset:33280
    v_cvt_pk_bf16_f32 v111, v38, v39
    v_exp_f32 v35, v59
    v_mfma_f32_16x16x32_bf16 v[88:91], a[216:219], v[200:203], v[88:91]
    s_waitcnt lgkmcnt(4)
    ds_read_b64_tr_b16 a[244:245], v20 offset:24576
    v_add_f32 v34, 1.0, v34
    v_mfma_f32_16x16x32_bf16 v[96:99], a[216:219], v[204:207], v[96:99]
    ds_read_b64_tr_b16 a[246:247], v20 offset:25088
    v_rcp_f32 v32, v32
    v_add_f32 v35, 1.0, v35
    v_mfma_f32_16x16x32_bf16 v[96:99], a[212:215], v[196:199], v[96:99]
    ds_read_b64_tr_b16 a[248:249], v20 offset:28672
    v_rcp_f32 v33, v33
    v_mfma_f32_16x16x32_bf16 v[96:99], a[208:211], v[188:191], v[96:99]
    s_lshl_b32 s37, s13, 13
    ds_read_b64_tr_b16 a[250:251], v20 offset:29184
    v_rcp_f32 v34, v34
    v_mfma_f32_16x16x32_bf16 v[92:95], a[220:223], v[184:187], v[92:95]
    ds_read_b64_tr_b16 a[252:253], v20 offset:32768
    v_rcp_f32 v35, v35
    v_mfma_f32_16x16x32_bf16 v[92:95], a[224:227], v[192:195], v[92:95]
    s_mul_i32 s13, s5, 1152
    ds_read_b64_tr_b16 a[254:255], v20 offset:33280
    v_exp_f32 v36, v60
    v_mfma_f32_16x16x32_bf16 v[92:95], a[228:231], v[200:203], v[92:95]
    ds_read_b64_tr_b16 a[200:201], v21 offset:24576
    v_mul_f32 v32, v56, v32
    v_mfma_f32_16x16x32_bf16 v[100:103], a[228:231], v[204:207], v[100:103]
    s_add_u32 s13, s13, s99
    ds_read_b64_tr_b16 a[202:203], v21 offset:25088
    v_mul_f32 v33, v57, v33
    v_exp_f32 v37, v61
    v_mfma_f32_16x16x32_bf16 v[100:103], a[224:227], v[196:199], v[100:103]
    s_waitcnt vmcnt(14) lgkmcnt(4)
    ds_read_b64_tr_b16 a[204:205], v21 offset:28672
    v_add_f32 v36, 1.0, v36
    v_mfma_f32_16x16x32_bf16 v[100:103], a[220:223], v[188:191], v[100:103]
    ds_read_b64_tr_b16 a[206:207], v21 offset:29184
    v_cvt_pk_bf16_f32 v32, v32, v33
    v_mul_f32 v34, v58, v34
    v_mfma_f32_16x16x32_bf16 v[72:75], a[232:235], v[208:211], v[72:75]
    s_barrier
    ds_read_b64_tr_b16 a[208:209], v21 offset:32768
    v_mfma_f32_16x16x32_bf16 v[72:75], a[236:239], v[216:219], v[72:75]
    ds_read_b64_tr_b16 a[210:211], v21 offset:33280
    v_exp_f32 v38, v62
    v_mfma_f32_16x16x32_bf16 v[72:75], a[240:243], v[224:227], v[72:75]
    buffer_store_dwordx4 v[108:111], v8, s[60:63], s31 offen offset:1024 sc1
    ds_read_b64_tr_b16 a[212:213], v22 offset:24576
    v_add_f32 v37, 1.0, v37
    v_mul_f32 v35, v59, v35
    v_mfma_f32_16x16x32_bf16 v[80:83], a[240:243], v[228:231], v[80:83]
    ds_read_b64_tr_b16 a[214:215], v22 offset:25088
    v_cvt_pk_bf16_f32 v34, v34, v35
    v_mfma_f32_16x16x32_bf16 v[80:83], a[236:239], v[220:223], v[80:83]
    ds_read_b64_tr_b16 a[216:217], v22 offset:28672
    v_exp_f32 v39, v63
    v_mfma_f32_16x16x32_bf16 v[80:83], a[232:235], v[212:215], v[80:83]
    s_add_u32 s47, s13, 896
    ds_read_b64_tr_b16 a[218:219], v22 offset:29184
    v_add_f32 v38, 1.0, v38
    v_accvgpr_write_b32 a0, v32
    v_mfma_f32_16x16x32_bf16 v[76:79], a[244:247], v[208:211], v[76:79]
    s_waitcnt lgkmcnt(4)
    ds_read_b64_tr_b16 a[220:221], v22 offset:32768
    v_rcp_f32 v36, v36
    v_mfma_f32_16x16x32_bf16 v[76:79], a[248:251], v[216:219], v[76:79]
    ds_read_b64_tr_b16 a[222:223], v22 offset:33280
    v_add_f32 v39, 1.0, v39
    v_accvgpr_write_b32 a1, v34
    v_mfma_f32_16x16x32_bf16 v[76:79], a[252:255], v[224:227], v[76:79]
    ds_read_b64_tr_b16 a[224:225], v19 offset:36864
    v_rcp_f32 v37, v37
    v_mfma_f32_16x16x32_bf16 v[84:87], a[252:255], v[228:231], v[84:87]
    ds_read_b64_tr_b16 a[226:227], v19 offset:37376
    v_rcp_f32 v38, v38
    v_mfma_f32_16x16x32_bf16 v[84:87], a[248:251], v[220:223], v[84:87]
    ds_read_b64_tr_b16 a[228:229], v19 offset:40960
    v_rcp_f32 v39, v39
    v_mfma_f32_16x16x32_bf16 v[84:87], a[244:247], v[212:215], v[84:87]
    ds_read_b64_tr_b16 a[230:231], v19 offset:41472
    v_exp_f32 v32, v64
    v_mfma_f32_16x16x32_bf16 v[88:91], a[200:203], v[208:211], v[88:91]
    ds_read_b64_tr_b16 a[232:233], v19 offset:45056
    ds_read_b64_tr_b16 a[234:235], v19 offset:45568
    v_mfma_f32_16x16x32_bf16 v[88:91], a[204:207], v[216:219], v[88:91]
    v_add_u32 v19, 0xfffe8000, v19
    v_mul_f32 v36, v60, v36
    v_mul_f32 v37, v61, v37
    v_mfma_f32_16x16x32_bf16 v[88:91], a[208:211], v[224:227], v[88:91]
    s_waitcnt lgkmcnt(4)
    ds_read_b64_tr_b16 a[236:237], v20 offset:36864
    v_exp_f32 v33, v65
    v_mfma_f32_16x16x32_bf16 v[96:99], a[208:211], v[228:231], v[96:99]
    ds_read_b64_tr_b16 a[238:239], v20 offset:37376
    v_add_f32 v32, 1.0, v32
    v_cvt_pk_bf16_f32 v36, v36, v37
    v_mul_f32 v38, v62, v38
    v_mfma_f32_16x16x32_bf16 v[96:99], a[204:207], v[220:223], v[96:99]
    ds_read_b64_tr_b16 a[240:241], v20 offset:40960
    v_exp_f32 v34, v66
    v_mfma_f32_16x16x32_bf16 v[96:99], a[200:203], v[212:215], v[96:99]
    ds_read_b64_tr_b16 a[242:243], v20 offset:41472
    v_add_f32 v33, 1.0, v33
    v_mul_f32 v39, v63, v39
    v_mfma_f32_16x16x32_bf16 v[92:95], a[212:215], v[208:211], v[92:95]
    ds_read_b64_tr_b16 a[244:245], v20 offset:45056
    ds_read_b64_tr_b16 a[246:247], v20 offset:45568
    v_mfma_f32_16x16x32_bf16 v[92:95], a[216:219], v[216:219], v[92:95]
    v_add_u32 v20, 0xfffe8000, v20
    v_cvt_pk_bf16_f32 v38, v38, v39
    v_exp_f32 v35, v67
    v_mfma_f32_16x16x32_bf16 v[92:95], a[220:223], v[224:227], v[92:95]
    ds_read_b64_tr_b16 a[248:249], v21 offset:36864
    v_add_f32 v34, 1.0, v34
    v_mfma_f32_16x16x32_bf16 v[100:103], a[220:223], v[228:231], v[100:103]
    ds_read_b64_tr_b16 a[250:251], v21 offset:37376
    v_accvgpr_write_b32 a2, v36
    v_rcp_f32 v32, v32
    v_mfma_f32_16x16x32_bf16 v[100:103], a[216:219], v[220:223], v[100:103]
    s_waitcnt lgkmcnt(4)
    ds_read_b64_tr_b16 a[252:253], v21 offset:40960
    v_add_f32 v35, 1.0, v35
    v_mfma_f32_16x16x32_bf16 v[100:103], a[212:215], v[212:215], v[100:103]
    ds_read_b64_tr_b16 a[254:255], v21 offset:41472
    v_accvgpr_write_b32 a3, v38
    v_rcp_f32 v33, v33
    v_mfma_f32_16x16x32_bf16 v[72:75], a[224:227], v[232:235], v[72:75]
    ds_read_b64_tr_b16 a[200:201], v21 offset:45056
    ds_read_b64_tr_b16 a[202:203], v21 offset:45568
    v_mfma_f32_16x16x32_bf16 v[72:75], a[228:231], v[240:243], v[72:75]
    v_add_u32 v21, 0xfffe8000, v21
    v_rcp_f32 v34, v34
    v_mfma_f32_16x16x32_bf16 v[72:75], a[232:235], v[248:251], v[72:75]
    ds_read_b64_tr_b16 a[204:205], v22 offset:36864
    v_rcp_f32 v35, v35
    v_mfma_f32_16x16x32_bf16 v[80:83], a[232:235], v[252:255], v[80:83]
    ds_read_b64_tr_b16 a[206:207], v22 offset:37376
    v_exp_f32 v36, v68
    v_mul_f32 v32, v64, v32
    v_mfma_f32_16x16x32_bf16 v[80:83], a[228:231], v[244:247], v[80:83]
    ds_read_b64_tr_b16 a[208:209], v22 offset:40960
    v_mul_f32 v33, v65, v33
    v_mfma_f32_16x16x32_bf16 v[80:83], a[224:227], v[236:239], v[80:83]
    ds_read_b64_tr_b16 a[210:211], v22 offset:41472
    v_exp_f32 v37, v69
    v_add_f32 v36, 1.0, v36
    v_mfma_f32_16x16x32_bf16 v[76:79], a[236:239], v[232:235], v[76:79]
    s_waitcnt lgkmcnt(4)
    ds_read_b64_tr_b16 a[212:213], v22 offset:45056
    ds_read_b64_tr_b16 a[214:215], v22 offset:45568
    v_mfma_f32_16x16x32_bf16 v[76:79], a[240:243], v[240:243], v[76:79]
    v_add_u32 v22, 0xfffe8000, v22
    v_cvt_pk_bf16_f32 v32, v32, v33
    v_mul_f32 v34, v66, v34
    v_mfma_f32_16x16x32_bf16 v[76:79], a[244:247], v[248:251], v[76:79]
    ds_read_b64_tr_b16 a[216:217], v19 offset:0
    v_exp_f32 v38, v70
    v_mfma_f32_16x16x32_bf16 v[84:87], a[244:247], v[252:255], v[84:87]
    ds_read_b64_tr_b16 a[218:219], v19 offset:512
    v_add_f32 v37, 1.0, v37
    v_mul_f32 v35, v67, v35
    v_mfma_f32_16x16x32_bf16 v[84:87], a[240:243], v[244:247], v[84:87]
    ds_read_b64_tr_b16 a[220:221], v19 offset:4096
    v_cvt_pk_bf16_f32 v34, v34, v35
    v_mfma_f32_16x16x32_bf16 v[84:87], a[236:239], v[236:239], v[84:87]
    ds_read_b64_tr_b16 a[222:223], v19 offset:4608
    v_exp_f32 v39, v71
    v_add_f32 v38, 1.0, v38
    v_mfma_f32_16x16x32_bf16 v[88:91], a[248:251], v[232:235], v[88:91]
    buffer_store_dwordx4 a[0:3], v8, s[60:63], s31 offen offset:2048 sc1
    ds_read_b64_tr_b16 a[224:225], v19 offset:8192
    ds_read_b64_tr_b16 a[226:227], v19 offset:8704
    v_accvgpr_write_b32 a4, v32
    v_mfma_f32_16x16x32_bf16 v[88:91], a[252:255], v[240:243], v[88:91]
    v_rcp_f32 v36, v36
    v_mfma_f32_16x16x32_bf16 v[88:91], a[200:203], v[248:251], v[88:91]
    s_waitcnt lgkmcnt(4)
    ds_read_b64_tr_b16 a[228:229], v20 offset:0
    v_add_f32 v39, 1.0, v39
    v_mfma_f32_16x16x32_bf16 v[96:99], a[200:203], v[252:255], v[96:99]
    ds_read_b64_tr_b16 a[230:231], v20 offset:512
    v_accvgpr_write_b32 a5, v34
    v_rcp_f32 v37, v37
    v_mfma_f32_16x16x32_bf16 v[96:99], a[252:255], v[244:247], v[96:99]
    ds_read_b64_tr_b16 a[232:233], v20 offset:4096
    v_rcp_f32 v38, v38
    v_mfma_f32_16x16x32_bf16 v[96:99], a[248:251], v[236:239], v[96:99]
    ds_read_b64_tr_b16 a[234:235], v20 offset:4608
    v_rcp_f32 v39, v39
    v_mfma_f32_16x16x32_bf16 v[92:95], a[204:207], v[232:235], v[92:95]
    ds_read_b64_tr_b16 a[236:237], v20 offset:8192
    v_mul_f32 v36, v68, v36
    v_mfma_f32_16x16x32_bf16 v[92:95], a[208:211], v[240:243], v[92:95]
    ds_read_b64_tr_b16 a[238:239], v20 offset:8704
    v_mul_f32 v37, v69, v37
    v_cvt_pk_bf16_f32 v36, v36, v37
    v_mul_f32 v38, v70, v38
    v_mfma_f32_16x16x32_bf16 v[92:95], a[212:215], v[248:251], v[92:95]
L_pf8:
    s_cbranch_execz L_rf8
    ds_read_b64_tr_b16 a[240:241], v21 offset:0
    v_mul_f32 v39, v71, v39
    v_mfma_f32_16x16x32_bf16 v[100:103], a[212:215], v[252:255], v[100:103]
    ds_read_b64_tr_b16 a[242:243], v21 offset:512
    v_cvt_pk_bf16_f32 v38, v38, v39
    v_accvgpr_write_b32 a6, v36
    v_accvgpr_write_b32 a7, v38
    v_mfma_f32_16x16x32_bf16 v[100:103], a[208:211], v[244:247], v[100:103]
    s_waitcnt vmcnt(10) lgkmcnt(4)
    ds_read_b64_tr_b16 a[244:245], v21 offset:4096
    v_mfma_f32_16x16x32_bf16 v[100:103], a[204:207], v[236:239], v[100:103]
    ds_read_b64_tr_b16 a[246:247], v21 offset:4608
    v_mfma_f32_16x16x32_bf16 v[40:43], a[216:219], v[112:115], 0
    s_barrier
    v_mfma_f32_16x16x32_bf16 v[40:43], a[220:223], v[120:123], v[40:43]
    ds_read_b64_tr_b16 a[248:249], v21 offset:8192
    ds_read_b64_tr_b16 a[250:251], v21 offset:8704
    v_mfma_f32_16x16x32_bf16 v[40:43], a[224:227], v[128:131], v[40:43]
    s_add_u32 s9, s24, 384
    ds_read_b64_tr_b16 a[252:253], v22 offset:0
    v_mfma_f32_16x16x32_bf16 v[48:51], a[224:227], v[132:135], 0
    s_add_u32 m0, s8, 0x12000
    ds_read_b64_tr_b16 a[254:255], v22 offset:512
    buffer_load_dwordx4 v13, s[52:55], s9 offen offset:0 lds
    v_mfma_f32_16x16x32_bf16 v[48:51], a[220:223], v[124:127], v[48:51]
    v_mfma_f32_16x16x32_bf16 v[48:51], a[216:219], v[116:119], v[48:51]
    buffer_store_dwordx4 a[4:7], v8, s[60:63], s31 offen offset:3072 sc1
    ds_read_b64_tr_b16 a[200:201], v22 offset:4096
    ds_read_b64_tr_b16 a[202:203], v22 offset:4608
    v_mfma_f32_16x16x32_bf16 v[44:47], a[228:231], v[112:115], 0
    s_waitcnt lgkmcnt(4)
    ds_read_b64_tr_b16 a[204:205], v22 offset:8192
    v_exp_f32 v32, v72
    v_mfma_f32_16x16x32_bf16 v[44:47], a[232:235], v[120:123], v[44:47]
    ds_read_b64_tr_b16 a[206:207], v22 offset:8704
    buffer_load_dwordx4 v14, s[52:55], s9 offen offset:1024 lds
    v_mfma_f32_16x16x32_bf16 v[44:47], a[236:239], v[128:131], v[44:47]
    ds_read_b64_tr_b16 a[208:209], v19 offset:12288
    v_exp_f32 v33, v73
    v_mfma_f32_16x16x32_bf16 v[52:55], a[236:239], v[132:135], 0
    ds_read_b64_tr_b16 a[210:211], v19 offset:12800
    v_add_f32 v32, 1.0, v32
    v_exp_f32 v34, v74
    v_mfma_f32_16x16x32_bf16 v[52:55], a[232:235], v[124:127], v[52:55]
    ds_read_b64_tr_b16 a[212:213], v19 offset:16384
    v_add_f32 v33, 1.0, v33
    v_mfma_f32_16x16x32_bf16 v[52:55], a[228:231], v[116:119], v[52:55]
    ds_read_b64_tr_b16 a[214:215], v19 offset:16896
    buffer_load_dwordx4 v15, s[52:55], s9 offen offset:2048 lds
    v_mfma_f32_16x16x32_bf16 v[56:59], a[240:243], v[112:115], 0
    ds_read_b64_tr_b16 a[216:217], v19 offset:20480
    v_exp_f32 v35, v75
    v_mfma_f32_16x16x32_bf16 v[56:59], a[244:247], v[120:123], v[56:59]
    ds_read_b64_tr_b16 a[218:219], v19 offset:20992
    v_add_f32 v34, 1.0, v34
    v_rcp_f32 v32, v32
    v_mfma_f32_16x16x32_bf16 v[56:59], a[248:251], v[128:131], v[56:59]
    s_add_u32 m0, s8, 0x12c00
    s_waitcnt lgkmcnt(4)
    ds_read_b64_tr_b16 a[220:221], v20 offset:12288
    v_add_f32 v35, 1.0, v35
    v_mfma_f32_16x16x32_bf16 v[64:67], a[248:251], v[132:135], 0
    ds_read_b64_tr_b16 a[222:223], v20 offset:12800
    buffer_load_dwordx4 v16, s[52:55], s9 offen offset:0 lds
    v_mfma_f32_16x16x32_bf16 v[64:67], a[244:247], v[124:127], v[64:67]
    ds_read_b64_tr_b16 a[224:225], v20 offset:16384
    v_rcp_f32 v33, v33
    v_mfma_f32_16x16x32_bf16 v[64:67], a[240:243], v[116:119], v[64:67]
    ds_read_b64_tr_b16 a[226:227], v20 offset:16896
    v_rcp_f32 v34, v34
    v_mfma_f32_16x16x32_bf16 v[60:63], a[252:255], v[112:115], 0
    ds_read_b64_tr_b16 a[228:229], v20 offset:20480
    v_rcp_f32 v35, v35
    v_mfma_f32_16x16x32_bf16 v[60:63], a[200:203], v[120:123], v[60:63]
    ds_read_b64_tr_b16 a[230:231], v20 offset:20992
    buffer_load_dwordx4 v17, s[52:55], s9 offen offset:1024 lds
    v_mfma_f32_16x16x32_bf16 v[60:63], a[204:207], v[128:131], v[60:63]
    ds_read_b64_tr_b16 a[232:233], v21 offset:12288
    v_exp_f32 v36, v76
    v_mfma_f32_16x16x32_bf16 v[68:71], a[204:207], v[132:135], 0
    ds_read_b64_tr_b16 a[234:235], v21 offset:12800
    v_mul_f32 v32, v72, v32
    v_mul_f32 v33, v73, v33
    v_mfma_f32_16x16x32_bf16 v[68:71], a[200:203], v[124:127], v[68:71]
    s_waitcnt lgkmcnt(4)
    ds_read_b64_tr_b16 a[236:237], v21 offset:16384
    v_exp_f32 v37, v77
    v_mfma_f32_16x16x32_bf16 v[68:71], a[252:255], v[116:119], v[68:71]
    ds_read_b64_tr_b16 a[238:239], v21 offset:16896
    buffer_load_dwordx4 v18, s[52:55], s9 offen offset:2048 lds
    v_mfma_f32_16x16x32_bf16 v[40:43], a[208:211], v[136:139], v[40:43]
    ds_read_b64_tr_b16 a[240:241], v21 offset:20480
    v_add_f32 v36, 1.0, v36
    v_mfma_f32_16x16x32_bf16 v[40:43], a[212:215], v[144:147], v[40:43]
    ds_read_b64_tr_b16 a[242:243], v21 offset:20992
    v_cvt_pk_bf16_f32 v32, v32, v33
    v_mul_f32 v34, v74, v34
    v_exp_f32 v38, v78
    v_mfma_f32_16x16x32_bf16 v[40:43], a[216:219], v[152:155], v[40:43]
    s_add_u32 s9, s25, 384
    ds_read_b64_tr_b16 a[244:245], v22 offset:12288
    v_add_f32 v37, 1.0, v37
    v_mfma_f32_16x16x32_bf16 v[48:51], a[216:219], v[156:159], v[48:51]
    s_add_u32 m0, s8, 0x18000
    ds_read_b64_tr_b16 a[246:247], v22 offset:12800
    buffer_load_dwordx4 v13, s[52:55], s9 offen offset:0 lds
    v_mfma_f32_16x16x32_bf16 v[48:51], a[212:215], v[148:151], v[48:51]
    ds_read_b64_tr_b16 a[248:249], v22 offset:16384
    v_mul_f32 v35, v75, v35
    v_mfma_f32_16x16x32_bf16 v[48:51], a[208:211], v[140:143], v[48:51]
    ds_read_b64_tr_b16 a[250:251], v22 offset:16896
    v_cvt_pk_bf16_f32 v34, v34, v35
    v_exp_f32 v39, v79
    v_mfma_f32_16x16x32_bf16 v[44:47], a[220:223], v[136:139], v[44:47]
    s_waitcnt lgkmcnt(4)
    ds_read_b64_tr_b16 a[252:253], v22 offset:20480
    v_add_f32 v38, 1.0, v38
    v_accvgpr_write_b32 a8, v32
    v_mfma_f32_16x16x32_bf16 v[44:47], a[224:227], v[144:147], v[44:47]
    ds_read_b64_tr_b16 a[254:255], v22 offset:20992
    buffer_load_dwordx4 v14, s[52:55], s9 offen offset:1024 lds
    v_mfma_f32_16x16x32_bf16 v[44:47], a[228:231], v[152:155], v[44:47]
    ds_read_b64_tr_b16 a[200:201], v19 offset:24576
    v_rcp_f32 v36, v36
    v_mfma_f32_16x16x32_bf16 v[52:55], a[228:231], v[156:159], v[52:55]
    ds_read_b64_tr_b16 a[202:203], v19 offset:25088
    v_add_f32 v39, 1.0, v39
    v_accvgpr_write_b32 a9, v34
    v_mfma_f32_16x16x32_bf16 v[52:55], a[224:227], v[148:151], v[52:55]
    ds_read_b64_tr_b16 a[204:205], v19 offset:28672
    v_rcp_f32 v37, v37
    v_mfma_f32_16x16x32_bf16 v[52:55], a[220:223], v[140:143], v[52:55]
    ds_read_b64_tr_b16 a[206:207], v19 offset:29184
    buffer_load_dwordx4 v15, s[52:55], s9 offen offset:2048 lds
    v_mfma_f32_16x16x32_bf16 v[56:59], a[232:235], v[136:139], v[56:59]
    ds_read_b64_tr_b16 a[208:209], v19 offset:32768
    v_rcp_f32 v38, v38
    v_mfma_f32_16x16x32_bf16 v[56:59], a[236:239], v[144:147], v[56:59]
    ds_read_b64_tr_b16 a[210:211], v19 offset:33280
    v_rcp_f32 v39, v39
    v_mfma_f32_16x16x32_bf16 v[56:59], a[240:243], v[152:155], v[56:59]
    s_add_u32 m0, s8, 0x18c00
    s_waitcnt lgkmcnt(4)
    ds_read_b64_tr_b16 a[212:213], v20 offset:24576
    v_exp_f32 v32, v80
    v_mfma_f32_16x16x32_bf16 v[64:67], a[240:243], v[156:159], v[64:67]
    ds_read_b64_tr_b16 a[214:215], v20 offset:25088
    buffer_load_dwordx4 v16, s[52:55], s9 offen offset:0 lds
    v_mfma_f32_16x16x32_bf16 v[64:67], a[236:239], v[148:151], v[64:67]
    ds_read_b64_tr_b16 a[216:217], v20 offset:28672
    v_mul_f32 v36, v76, v36
    v_mfma_f32_16x16x32_bf16 v[64:67], a[232:235], v[140:143], v[64:67]
    ds_read_b64_tr_b16 a[218:219], v20 offset:29184
    v_mul_f32 v37, v77, v37
    v_exp_f32 v33, v81
    v_mfma_f32_16x16x32_bf16 v[60:63], a[244:247], v[136:139], v[60:63]
    ds_read_b64_tr_b16 a[220:221], v20 offset:32768
    v_add_f32 v32, 1.0, v32
    v_cvt_pk_bf16_f32 v36, v36, v37
    v_mfma_f32_16x16x32_bf16 v[60:63], a[248:251], v[144:147], v[60:63]
    ds_read_b64_tr_b16 a[222:223], v20 offset:33280
    buffer_load_dwordx4 v17, s[52:55], s9 offen offset:1024 lds
    v_mfma_f32_16x16x32_bf16 v[60:63], a[252:255], v[152:155], v[60:63]
    ds_read_b64_tr_b16 a[224:225], v21 offset:24576
    v_mul_f32 v38, v78, v38
    v_mfma_f32_16x16x32_bf16 v[68:71], a[252:255], v[156:159], v[68:71]
    ds_read_b64_tr_b16 a[226:227], v21 offset:25088
    v_exp_f32 v34, v82
    v_add_f32 v33, 1.0, v33
    v_mfma_f32_16x16x32_bf16 v[68:71], a[248:251], v[148:151], v[68:71]
    s_waitcnt vmcnt(15) lgkmcnt(4)
    ds_read_b64_tr_b16 a[228:229], v21 offset:28672
    v_mul_f32 v39, v79, v39
    v_cvt_pk_bf16_f32 v38, v38, v39
    v_mfma_f32_16x16x32_bf16 v[68:71], a[244:247], v[140:143], v[68:71]
    ds_read_b64_tr_b16 a[230:231], v21 offset:29184
    buffer_load_dwordx4 v18, s[52:55], s9 offen offset:2048 lds
    v_mfma_f32_16x16x32_bf16 v[40:43], a[200:203], v[160:163], v[40:43]
    s_barrier
    ds_read_b64_tr_b16 a[232:233], v21 offset:32768
    v_mfma_f32_16x16x32_bf16 v[40:43], a[204:207], v[168:171], v[40:43]
    ds_read_b64_tr_b16 a[234:235], v21 offset:33280
    v_exp_f32 v35, v83
    v_mfma_f32_16x16x32_bf16 v[40:43], a[208:211], v[176:179], v[40:43]
    s_add_u32 s9, s26, 384
    ds_read_b64_tr_b16 a[236:237], v22 offset:24576
    v_add_f32 v34, 1.0, v34
    v_accvgpr_write_b32 a10, v36
    v_mfma_f32_16x16x32_bf16 v[48:51], a[208:211], v[180:183], v[48:51]
    s_add_u32 m0, s8, 0x1e000
    ds_read_b64_tr_b16 a[238:239], v22 offset:25088
    buffer_load_dwordx4 v13, s[52:55], s9 offen offset:0 lds
    v_mfma_f32_16x16x32_bf16 v[48:51], a[204:207], v[172:175], v[48:51]
    ds_read_b64_tr_b16 a[240:241], v22 offset:28672
    v_rcp_f32 v32, v32
    v_mfma_f32_16x16x32_bf16 v[48:51], a[200:203], v[164:167], v[48:51]
    ds_read_b64_tr_b16 a[242:243], v22 offset:29184
    v_add_f32 v35, 1.0, v35
    v_accvgpr_write_b32 a11, v38
    v_mfma_f32_16x16x32_bf16 v[44:47], a[212:215], v[160:163], v[44:47]
    s_waitcnt lgkmcnt(4)
    ds_read_b64_tr_b16 a[244:245], v22 offset:32768
    v_rcp_f32 v33, v33
    v_mfma_f32_16x16x32_bf16 v[44:47], a[216:219], v[168:171], v[44:47]
    ds_read_b64_tr_b16 a[246:247], v22 offset:33280
    buffer_load_dwordx4 v14, s[52:55], s9 offen offset:1024 lds
    v_mfma_f32_16x16x32_bf16 v[44:47], a[220:223], v[176:179], v[44:47]
    ds_read_b64_tr_b16 a[248:249], v19 offset:36864
    v_rcp_f32 v34, v34
    v_mfma_f32_16x16x32_bf16 v[52:55], a[220:223], v[180:183], v[52:55]
    ds_read_b64_tr_b16 a[250:251], v19 offset:37376
    v_rcp_f32 v35, v35
    v_mfma_f32_16x16x32_bf16 v[52:55], a[216:219], v[172:175], v[52:55]
    ds_read_b64_tr_b16 a[252:253], v19 offset:40960
    v_exp_f32 v36, v84
    v_mfma_f32_16x16x32_bf16 v[52:55], a[212:215], v[164:167], v[52:55]
    s_add_u32 s31, s28, 4096
    ds_read_b64_tr_b16 a[254:255], v19 offset:41472
    buffer_load_dwordx4 v15, s[52:55], s9 offen offset:2048 lds
    v_mfma_f32_16x16x32_bf16 v[56:59], a[224:227], v[160:163], v[56:59]
    buffer_store_dwordx4 a[8:11], v8, s[60:63], s31 offen offset:0 sc1
    ds_read_b64_tr_b16 a[200:201], v19 offset:45056
    ds_read_b64_tr_b16 a[202:203], v19 offset:45568
    v_add_u32 v19, 0xc000, v19
    v_mfma_f32_16x16x32_bf16 v[56:59], a[228:231], v[168:171], v[56:59]
    v_mul_f32 v32, v80, v32
    v_mul_f32 v33, v81, v33
    v_mfma_f32_16x16x32_bf16 v[56:59], a[232:235], v[176:179], v[56:59]
    s_add_u32 m0, s8, 0x1ec00
    s_waitcnt lgkmcnt(4)
    ds_read_b64_tr_b16 a[204:205], v20 offset:36864
    v_exp_f32 v37, v85
    v_mfma_f32_16x16x32_bf16 v[64:67], a[232:235], v[180:183], v[64:67]
    ds_read_b64_tr_b16 a[206:207], v20 offset:37376
    buffer_load_dwordx4 v16, s[52:55], s9 offen offset:0 lds
    v_mfma_f32_16x16x32_bf16 v[64:67], a[228:231], v[172:175], v[64:67]
    ds_read_b64_tr_b16 a[208:209], v20 offset:40960
    v_add_f32 v36, 1.0, v36
    v_mfma_f32_16x16x32_bf16 v[64:67], a[224:227], v[164:167], v[64:67]
    ds_read_b64_tr_b16 a[210:211], v20 offset:41472
    v_cvt_pk_bf16_f32 v32, v32, v33
    v_mul_f32 v34, v82, v34
    v_mfma_f32_16x16x32_bf16 v[60:63], a[236:239], v[160:163], v[60:63]
    ds_read_b64_tr_b16 a[212:213], v20 offset:45056
    ds_read_b64_tr_b16 a[214:215], v20 offset:45568
    v_add_u32 v20, 0xc000, v20
    v_exp_f32 v38, v86
    v_mfma_f32_16x16x32_bf16 v[60:63], a[240:243], v[168:171], v[60:63]
    buffer_load_dwordx4 v17, s[52:55], s9 offen offset:1024 lds
    v_mfma_f32_16x16x32_bf16 v[60:63], a[244:247], v[176:179], v[60:63]
    ds_read_b64_tr_b16 a[216:217], v21 offset:36864
    v_add_f32 v37, 1.0, v37
    v_mfma_f32_16x16x32_bf16 v[68:71], a[244:247], v[180:183], v[68:71]
    ds_read_b64_tr_b16 a[218:219], v21 offset:37376
    v_mul_f32 v35, v83, v35
    v_cvt_pk_bf16_f32 v34, v34, v35
    v_mfma_f32_16x16x32_bf16 v[68:71], a[240:243], v[172:175], v[68:71]
    s_waitcnt lgkmcnt(4)
    ds_read_b64_tr_b16 a[220:221], v21 offset:40960
    v_exp_f32 v39, v87
    v_add_f32 v38, 1.0, v38
    v_mfma_f32_16x16x32_bf16 v[68:71], a[236:239], v[164:167], v[68:71]
    ds_read_b64_tr_b16 a[222:223], v21 offset:41472
    buffer_load_dwordx4 v18, s[52:55], s9 offen offset:2048 lds
    v_mfma_f32_16x16x32_bf16 v[40:43], a[248:251], v[184:187], v[40:43]
    ds_read_b64_tr_b16 a[224:225], v21 offset:45056
    ds_read_b64_tr_b16 a[226:227], v21 offset:45568
    v_mfma_f32_16x16x32_bf16 v[40:43], a[252:255], v[192:195], v[40:43]
    v_add_u32 v21, 0xc000, v21
    v_accvgpr_write_b32 a12, v32
    v_rcp_f32 v36, v36
    v_mfma_f32_16x16x32_bf16 v[40:43], a[200:203], v[200:203], v[40:43]
    ds_read_b64_tr_b16 a[228:229], v22 offset:36864
    v_add_f32 v39, 1.0, v39
    v_mfma_f32_16x16x32_bf16 v[48:51], a[200:203], v[204:207], v[48:51]
    ds_read_b64_tr_b16 a[230:231], v22 offset:37376
    v_accvgpr_write_b32 a13, v34
    v_rcp_f32 v37, v37
    v_mfma_f32_16x16x32_bf16 v[48:51], a[252:255], v[196:199], v[48:51]
    ds_read_b64_tr_b16 a[232:233], v22 offset:40960
    v_rcp_f32 v38, v38
    v_mfma_f32_16x16x32_bf16 v[48:51], a[248:251], v[188:191], v[48:51]
    s_mov_b32 s11, 0
    ds_read_b64_tr_b16 a[234:235], v22 offset:41472
    buffer_load_dword v4, v31, s[56:59], s11 offen
    v_mfma_f32_16x16x32_bf16 v[44:47], a[204:207], v[184:187], v[44:47]
    s_waitcnt lgkmcnt(4)
    ds_read_b64_tr_b16 a[236:237], v22 offset:45056
    ds_read_b64_tr_b16 a[238:239], v22 offset:45568
    v_mfma_f32_16x16x32_bf16 v[44:47], a[208:211], v[192:195], v[44:47]
    v_add_u32 v22, 0xc000, v22
    v_rcp_f32 v39, v39
    v_mfma_f32_16x16x32_bf16 v[44:47], a[212:215], v[200:203], v[44:47]
    ds_read_b64_tr_b16 a[240:241], v19 offset:0
    v_exp_f32 v32, v88
    v_mfma_f32_16x16x32_bf16 v[52:55], a[212:215], v[204:207], v[52:55]
    ds_read_b64_tr_b16 a[242:243], v19 offset:512
    v_mul_f32 v36, v84, v36
    v_mul_f32 v37, v85, v37
    v_mfma_f32_16x16x32_bf16 v[52:55], a[208:211], v[196:199], v[52:55]
    ds_read_b64_tr_b16 a[244:245], v19 offset:4096
    v_exp_f32 v33, v89
    v_mfma_f32_16x16x32_bf16 v[52:55], a[204:207], v[188:191], v[52:55]
    ds_read_b64_tr_b16 a[246:247], v19 offset:4608
    v_add_f32 v32, 1.0, v32
    v_cvt_pk_bf16_f32 v36, v36, v37
    v_mul_f32 v38, v86, v38
    v_mfma_f32_16x16x32_bf16 v[56:59], a[216:219], v[184:187], v[56:59]
    ds_read_b64_tr_b16 a[248:249], v19 offset:8192
    v_exp_f32 v34, v90
    v_mfma_f32_16x16x32_bf16 v[56:59], a[220:223], v[192:195], v[56:59]
    ds_read_b64_tr_b16 a[250:251], v19 offset:8704
    v_add_f32 v33, 1.0, v33
    v_mul_f32 v39, v87, v39
    v_mfma_f32_16x16x32_bf16 v[56:59], a[224:227], v[200:203], v[56:59]
    s_waitcnt lgkmcnt(4)
    ds_read_b64_tr_b16 a[252:253], v20 offset:0
    v_cvt_pk_bf16_f32 v38, v38, v39
    v_mfma_f32_16x16x32_bf16 v[64:67], a[224:227], v[204:207], v[64:67]
    ds_read_b64_tr_b16 a[254:255], v20 offset:512
    v_exp_f32 v35, v91
    v_add_f32 v34, 1.0, v34
    v_mfma_f32_16x16x32_bf16 v[64:67], a[220:223], v[196:199], v[64:67]
    ds_read_b64_tr_b16 a[200:201], v20 offset:4096
    v_accvgpr_write_b32 a14, v36
    v_mfma_f32_16x16x32_bf16 v[64:67], a[216:219], v[188:191], v[64:67]
    ds_read_b64_tr_b16 a[202:203], v20 offset:4608
    v_rcp_f32 v32, v32
    v_add_f32 v35, 1.0, v35
    v_mfma_f32_16x16x32_bf16 v[60:63], a[228:231], v[184:187], v[60:63]
    ds_read_b64_tr_b16 a[204:205], v20 offset:8192
    v_accvgpr_write_b32 a15, v38
    v_mfma_f32_16x16x32_bf16 v[60:63], a[232:235], v[192:195], v[60:63]
    ds_read_b64_tr_b16 a[206:207], v20 offset:8704
    v_rcp_f32 v33, v33
    v_mfma_f32_16x16x32_bf16 v[60:63], a[236:239], v[200:203], v[60:63]
    ds_read_b64_tr_b16 a[208:209], v21 offset:0
    v_rcp_f32 v34, v34
    v_mfma_f32_16x16x32_bf16 v[68:71], a[236:239], v[204:207], v[68:71]
    ds_read_b64_tr_b16 a[210:211], v21 offset:512
    v_rcp_f32 v35, v35
    v_mfma_f32_16x16x32_bf16 v[68:71], a[232:235], v[196:199], v[68:71]
    s_waitcnt vmcnt(14) lgkmcnt(4)
    ds_read_b64_tr_b16 a[212:213], v21 offset:4096
    v_exp_f32 v36, v92
    v_mfma_f32_16x16x32_bf16 v[68:71], a[228:231], v[188:191], v[68:71]
    ds_read_b64_tr_b16 a[214:215], v21 offset:4608
    v_mul_f32 v32, v88, v32
    v_mul_f32 v33, v89, v33
    v_mfma_f32_16x16x32_bf16 v[40:43], a[240:243], v[208:211], v[40:43]
    s_barrier
    ds_read_b64_tr_b16 a[216:217], v21 offset:8192
    v_mfma_f32_16x16x32_bf16 v[40:43], a[244:247], v[216:219], v[40:43]
    ds_read_b64_tr_b16 a[218:219], v21 offset:8704
    v_exp_f32 v37, v93
    v_mfma_f32_16x16x32_bf16 v[40:43], a[248:251], v[224:227], v[40:43]
    buffer_store_dwordx4 a[12:15], v8, s[60:63], s31 offen offset:1024 sc1
    ds_read_b64_tr_b16 a[220:221], v22 offset:0
    v_add_f32 v36, 1.0, v36
    v_cvt_pk_bf16_f32 v32, v32, v33
    v_mfma_f32_16x16x32_bf16 v[48:51], a[248:251], v[228:231], v[48:51]
    ds_read_b64_tr_b16 a[222:223], v22 offset:512
    v_mul_f32 v34, v90, v34
    v_mfma_f32_16x16x32_bf16 v[48:51], a[244:247], v[220:223], v[48:51]
    ds_read_b64_tr_b16 a[224:225], v22 offset:4096
    v_exp_f32 v38, v94
    v_mfma_f32_16x16x32_bf16 v[48:51], a[240:243], v[212:215], v[48:51]
    ds_read_b64_tr_b16 a[226:227], v22 offset:4608
    v_add_f32 v37, 1.0, v37
    v_mul_f32 v35, v91, v35
    v_mfma_f32_16x16x32_bf16 v[44:47], a[252:255], v[208:211], v[44:47]
    s_waitcnt lgkmcnt(4)
    ds_read_b64_tr_b16 a[228:229], v22 offset:8192
    v_cvt_pk_bf16_f32 v34, v34, v35
    v_mfma_f32_16x16x32_bf16 v[44:47], a[200:203], v[216:219], v[44:47]
    ds_read_b64_tr_b16 a[230:231], v22 offset:8704
    v_exp_f32 v39, v95
    v_add_f32 v38, 1.0, v38
    v_mfma_f32_16x16x32_bf16 v[44:47], a[204:207], v[224:227], v[44:47]
    ds_read_b64_tr_b16 a[232:233], v19 offset:12288
    v_accvgpr_write_b32 a16, v32
    v_mfma_f32_16x16x32_bf16 v[52:55], a[204:207], v[228:231], v[52:55]
    ds_read_b64_tr_b16 a[234:235], v19 offset:12800
    v_rcp_f32 v36, v36
    v_add_f32 v39, 1.0, v39
    v_mfma_f32_16x16x32_bf16 v[52:55], a[200:203], v[220:223], v[52:55]
    ds_read_b64_tr_b16 a[236:237], v19 offset:16384
    v_accvgpr_write_b32 a17, v34
    v_mfma_f32_16x16x32_bf16 v[52:55], a[252:255], v[212:215], v[52:55]
    ds_read_b64_tr_b16 a[238:239], v19 offset:16896
    v_rcp_f32 v37, v37
    v_rcp_f32 v38, v38
    v_mfma_f32_16x16x32_bf16 v[56:59], a[208:211], v[208:211], v[56:59]
    ds_read_b64_tr_b16 a[240:241], v19 offset:20480
    v_rcp_f32 v39, v39
    v_mfma_f32_16x16x32_bf16 v[56:59], a[212:215], v[216:219], v[56:59]
    ds_read_b64_tr_b16 a[242:243], v19 offset:20992
    v_exp_f32 v32, v96
    v_mfma_f32_16x16x32_bf16 v[56:59], a[216:219], v[224:227], v[56:59]
    s_waitcnt lgkmcnt(4)
    ds_read_b64_tr_b16 a[244:245], v20 offset:12288
    v_mul_f32 v36, v92, v36
    v_mfma_f32_16x16x32_bf16 v[64:67], a[216:219], v[228:231], v[64:67]
    ds_read_b64_tr_b16 a[246:247], v20 offset:12800
    v_mul_f32 v37, v93, v37
    v_exp_f32 v33, v97
    v_mfma_f32_16x16x32_bf16 v[64:67], a[212:215], v[220:223], v[64:67]
    ds_read_b64_tr_b16 a[248:249], v20 offset:16384
    v_add_f32 v32, 1.0, v32
    v_mfma_f32_16x16x32_bf16 v[64:67], a[208:211], v[212:215], v[64:67]
    ds_read_b64_tr_b16 a[250:251], v20 offset:16896
    v_cvt_pk_bf16_f32 v36, v36, v37
    v_mul_f32 v38, v94, v38
    v_mfma_f32_16x16x32_bf16 v[60:63], a[220:223], v[208:211], v[60:63]
    ds_read_b64_tr_b16 a[252:253], v20 offset:20480
    v_exp_f32 v34, v98
    v_mfma_f32_16x16x32_bf16 v[60:63], a[224:227], v[216:219], v[60:63]
    ds_read_b64_tr_b16 a[254:255], v20 offset:20992
    v_add_f32 v33, 1.0, v33
    v_mul_f32 v39, v95, v39
    v_mfma_f32_16x16x32_bf16 v[60:63], a[228:231], v[224:227], v[60:63]
    ds_read_b64_tr_b16 a[200:201], v21 offset:12288
    v_cvt_pk_bf16_f32 v38, v38, v39
    v_mfma_f32_16x16x32_bf16 v[68:71], a[228:231], v[228:231], v[68:71]
    ds_read_b64_tr_b16 a[202:203], v21 offset:12800
    v_exp_f32 v35, v99
    v_add_f32 v34, 1.0, v34
    v_mfma_f32_16x16x32_bf16 v[68:71], a[224:227], v[220:223], v[68:71]
    s_waitcnt lgkmcnt(4)
    ds_read_b64_tr_b16 a[204:205], v21 offset:16384
    v_accvgpr_write_b32 a18, v36
    v_mfma_f32_16x16x32_bf16 v[68:71], a[220:223], v[212:215], v[68:71]
    ds_read_b64_tr_b16 a[206:207], v21 offset:16896
    v_rcp_f32 v32, v32
    v_add_f32 v35, 1.0, v35
    v_mfma_f32_16x16x32_bf16 v[40:43], a[232:235], v[232:235], v[40:43]
    ds_read_b64_tr_b16 a[208:209], v21 offset:20480
    v_accvgpr_write_b32 a19, v38
    v_mfma_f32_16x16x32_bf16 v[40:43], a[236:239], v[240:243], v[40:43]
    ds_read_b64_tr_b16 a[210:211], v21 offset:20992
    v_rcp_f32 v33, v33
    v_rcp_f32 v34, v34
    v_mfma_f32_16x16x32_bf16 v[40:43], a[240:243], v[248:251], v[40:43]
    ds_read_b64_tr_b16 a[212:213], v22 offset:12288
    v_rcp_f32 v35, v35
    v_mfma_f32_16x16x32_bf16 v[48:51], a[240:243], v[252:255], v[48:51]
    ds_read_b64_tr_b16 a[214:215], v22 offset:12800
    v_exp_f32 v36, v100
    v_mfma_f32_16x16x32_bf16 v[48:51], a[236:239], v[244:247], v[48:51]
    ds_read_b64_tr_b16 a[216:217], v22 offset:16384
    v_mul_f32 v32, v96, v32
    v_mfma_f32_16x16x32_bf16 v[48:51], a[232:235], v[236:239], v[48:51]
    ds_read_b64_tr_b16 a[218:219], v22 offset:16896
    v_mul_f32 v33, v97, v33
    v_exp_f32 v37, v101
    v_mfma_f32_16x16x32_bf16 v[44:47], a[244:247], v[232:235], v[44:47]
    s_waitcnt lgkmcnt(4)
    ds_read_b64_tr_b16 a[220:221], v22 offset:20480
    v_add_f32 v36, 1.0, v36
    v_mfma_f32_16x16x32_bf16 v[44:47], a[248:251], v[240:243], v[44:47]
    ds_read_b64_tr_b16 a[222:223], v22 offset:20992
    v_cvt_pk_bf16_f32 v32, v32, v33
    v_mul_f32 v34, v98, v34
    v_mfma_f32_16x16x32_bf16 v[44:47], a[252:255], v[248:251], v[44:47]
    ds_read_b64_tr_b16 a[224:225], v19 offset:24576
    v_exp_f32 v38, v102
    v_mfma_f32_16x16x32_bf16 v[52:55], a[252:255], v[252:255], v[52:55]
    ds_read_b64_tr_b16 a[226:227], v19 offset:25088
    v_add_f32 v37, 1.0, v37
    v_mul_f32 v35, v99, v35
    v_mfma_f32_16x16x32_bf16 v[52:55], a[248:251], v[244:247], v[52:55]
    ds_read_b64_tr_b16 a[228:229], v19 offset:28672
    v_cvt_pk_bf16_f32 v34, v34, v35
    v_mfma_f32_16x16x32_bf16 v[52:55], a[244:247], v[236:239], v[52:55]
    ds_read_b64_tr_b16 a[230:231], v19 offset:29184
    v_exp_f32 v39, v103
    v_add_f32 v38, 1.0, v38
    v_mfma_f32_16x16x32_bf16 v[56:59], a[200:203], v[232:235], v[56:59]
    buffer_store_dwordx4 a[16:19], v8, s[60:63], s31 offen offset:2048 sc1
    ds_read_b64_tr_b16 a[232:233], v19 offset:32768
    ds_read_b64_tr_b16 a[234:235], v19 offset:33280
    v_accvgpr_write_b32 a20, v32
    v_mfma_f32_16x16x32_bf16 v[56:59], a[204:207], v[240:243], v[56:59]
    v_rcp_f32 v36, v36
    v_mfma_f32_16x16x32_bf16 v[56:59], a[208:211], v[248:251], v[56:59]
    s_waitcnt lgkmcnt(4)
    ds_read_b64_tr_b16 a[236:237], v20 offset:24576
    v_add_f32 v39, 1.0, v39
    v_mfma_f32_16x16x32_bf16 v[64:67], a[208:211], v[252:255], v[64:67]
    ds_read_b64_tr_b16 a[238:239], v20 offset:25088
    v_accvgpr_write_b32 a21, v34
    v_rcp_f32 v37, v37
    v_mfma_f32_16x16x32_bf16 v[64:67], a[204:207], v[244:247], v[64:67]
    ds_read_b64_tr_b16 a[240:241], v20 offset:28672
    v_rcp_f32 v38, v38
    v_mfma_f32_16x16x32_bf16 v[64:67], a[200:203], v[236:239], v[64:67]
    ds_read_b64_tr_b16 a[242:243], v20 offset:29184
    v_rcp_f32 v39, v39
    v_mfma_f32_16x16x32_bf16 v[60:63], a[212:215], v[232:235], v[60:63]
    ds_read_b64_tr_b16 a[244:245], v20 offset:32768
    v_mul_f32 v36, v100, v36
    v_mfma_f32_16x16x32_bf16 v[60:63], a[216:219], v[240:243], v[60:63]
    ds_read_b64_tr_b16 a[246:247], v20 offset:33280
    v_mul_f32 v37, v101, v37
    v_cvt_pk_bf16_f32 v36, v36, v37
    v_mul_f32 v38, v102, v38
    v_mfma_f32_16x16x32_bf16 v[60:63], a[220:223], v[248:251], v[60:63]
    ds_read_b64_tr_b16 a[248:249], v21 offset:24576
    v_mul_f32 v39, v103, v39
    v_mfma_f32_16x16x32_bf16 v[68:71], a[220:223], v[252:255], v[68:71]
    ds_read_b64_tr_b16 a[250:251], v21 offset:25088
    v_cvt_pk_bf16_f32 v38, v38, v39
    v_accvgpr_write_b32 a22, v36
    v_accvgpr_write_b32 a23, v38
    v_mfma_f32_16x16x32_bf16 v[68:71], a[216:219], v[244:247], v[68:71]
    s_waitcnt vmcnt(10) lgkmcnt(4)
    ds_read_b64_tr_b16 a[252:253], v21 offset:28672
    v_mfma_f32_16x16x32_bf16 v[68:71], a[212:215], v[236:239], v[68:71]
    ds_read_b64_tr_b16 a[254:255], v21 offset:29184
    v_mfma_f32_16x16x32_bf16 v[72:75], a[224:227], v[112:115], 0
    s_barrier
    v_mfma_f32_16x16x32_bf16 v[72:75], a[228:231], v[120:123], v[72:75]
    ds_read_b64_tr_b16 a[200:201], v21 offset:32768
    ds_read_b64_tr_b16 a[202:203], v21 offset:33280
    v_mfma_f32_16x16x32_bf16 v[72:75], a[232:235], v[128:131], v[72:75]
    s_add_u32 s9, s24, 512
    ds_read_b64_tr_b16 a[204:205], v22 offset:24576
    v_mfma_f32_16x16x32_bf16 v[80:83], a[232:235], v[132:135], 0
    s_add_u32 m0, s8, 0x0
    ds_read_b64_tr_b16 a[206:207], v22 offset:25088
    buffer_load_dwordx4 v13, s[52:55], s9 offen offset:0 lds
    v_mfma_f32_16x16x32_bf16 v[80:83], a[228:231], v[124:127], v[80:83]
    v_mfma_f32_16x16x32_bf16 v[80:83], a[224:227], v[116:119], v[80:83]
    buffer_store_dwordx4 a[20:23], v8, s[60:63], s31 offen offset:3072 sc1
    ds_read_b64_tr_b16 a[208:209], v22 offset:28672
    ds_read_b64_tr_b16 a[210:211], v22 offset:29184
    v_mfma_f32_16x16x32_bf16 v[76:79], a[236:239], v[112:115], 0
    s_waitcnt lgkmcnt(4)
    ds_read_b64_tr_b16 a[212:213], v22 offset:32768
    v_exp_f32 v32, v40
    v_mfma_f32_16x16x32_bf16 v[76:79], a[240:243], v[120:123], v[76:79]
    ds_read_b64_tr_b16 a[214:215], v22 offset:33280
    buffer_load_dwordx4 v14, s[52:55], s9 offen offset:1024 lds
    v_mfma_f32_16x16x32_bf16 v[76:79], a[244:247], v[128:131], v[76:79]
    ds_read_b64_tr_b16 a[216:217], v19 offset:36864
    v_exp_f32 v33, v41
    v_mfma_f32_16x16x32_bf16 v[84:87], a[244:247], v[132:135], 0
    ds_read_b64_tr_b16 a[218:219], v19 offset:37376
    v_add_f32 v32, 1.0, v32
    v_exp_f32 v34, v42
    v_mfma_f32_16x16x32_bf16 v[84:87], a[240:243], v[124:127], v[84:87]
    ds_read_b64_tr_b16 a[220:221], v19 offset:40960
    v_add_f32 v33, 1.0, v33
    v_mfma_f32_16x16x32_bf16 v[84:87], a[236:239], v[116:119], v[84:87]
    ds_read_b64_tr_b16 a[222:223], v19 offset:41472
    buffer_load_dwordx4 v15, s[52:55], s9 offen offset:2048 lds
    v_mfma_f32_16x16x32_bf16 v[88:91], a[248:251], v[112:115], 0
    ds_read_b64_tr_b16 a[224:225], v19 offset:45056
    ds_read_b64_tr_b16 a[226:227], v19 offset:45568
    v_mfma_f32_16x16x32_bf16 v[88:91], a[252:255], v[120:123], v[88:91]
    v_add_u32 v19, 0xc000, v19
    v_exp_f32 v35, v43
    v_add_f32 v34, 1.0, v34
    v_mfma_f32_16x16x32_bf16 v[88:91], a[200:203], v[128:131], v[88:91]
    s_add_u32 m0, s8, 0xc00
    s_waitcnt lgkmcnt(4)
    ds_read_b64_tr_b16 a[228:229], v20 offset:36864
    v_rcp_f32 v32, v32
    v_add_f32 v35, 1.0, v35
    v_mfma_f32_16x16x32_bf16 v[96:99], a[200:203], v[132:135], 0
    ds_read_b64_tr_b16 a[230:231], v20 offset:37376
    buffer_load_dwordx4 v16, s[52:55], s9 offen offset:0 lds
    v_mfma_f32_16x16x32_bf16 v[96:99], a[252:255], v[124:127], v[96:99]
    ds_read_b64_tr_b16 a[232:233], v20 offset:40960
    v_rcp_f32 v33, v33
    v_mfma_f32_16x16x32_bf16 v[96:99], a[248:251], v[116:119], v[96:99]
    ds_read_b64_tr_b16 a[234:235], v20 offset:41472
    v_rcp_f32 v34, v34
    v_mfma_f32_16x16x32_bf16 v[92:95], a[204:207], v[112:115], 0
    ds_read_b64_tr_b16 a[236:237], v20 offset:45056
    ds_read_b64_tr_b16 a[238:239], v20 offset:45568
    v_mfma_f32_16x16x32_bf16 v[92:95], a[208:211], v[120:123], v[92:95]
    buffer_load_dwordx4 v17, s[52:55], s9 offen offset:1024 lds
    v_add_u32 v20, 0xc000, v20
    v_mfma_f32_16x16x32_bf16 v[92:95], a[212:215], v[128:131], v[92:95]
    ds_read_b64_tr_b16 a[240:241], v21 offset:36864
    v_rcp_f32 v35, v35
    v_mfma_f32_16x16x32_bf16 v[100:103], a[212:215], v[132:135], 0
    ds_read_b64_tr_b16 a[242:243], v21 offset:37376
    v_exp_f32 v36, v44
    v_mul_f32 v32, v40, v32
    v_mfma_f32_16x16x32_bf16 v[100:103], a[208:211], v[124:127], v[100:103]
    s_waitcnt lgkmcnt(4)
    ds_read_b64_tr_b16 a[244:245], v21 offset:40960
    v_mul_f32 v33, v41, v33
    v_mfma_f32_16x16x32_bf16 v[100:103], a[204:207], v[116:119], v[100:103]
    ds_read_b64_tr_b16 a[246:247], v21 offset:41472
    buffer_load_dwordx4 v18, s[52:55], s9 offen offset:2048 lds
    v_mfma_f32_16x16x32_bf16 v[72:75], a[216:219], v[136:139], v[72:75]
L_pf12:
    s_cbranch_execz L_rf12
    ds_read_b64_tr_b16 a[248:249], v21 offset:45056
    ds_read_b64_tr_b16 a[250:251], v21 offset:45568
    v_mfma_f32_16x16x32_bf16 v[72:75], a[220:223], v[144:147], v[72:75]
    v_add_u32 v21, 0xc000, v21
    v_exp_f32 v37, v45
    v_add_f32 v36, 1.0, v36
    v_cvt_pk_bf16_f32 v32, v32, v33
    v_mfma_f32_16x16x32_bf16 v[72:75], a[224:227], v[152:155], v[72:75]
    s_add_u32 s9, s25, 512
    ds_read_b64_tr_b16 a[252:253], v22 offset:36864
    v_mul_f32 v34, v42, v34
    v_exp_f32 v38, v46
    v_mfma_f32_16x16x32_bf16 v[80:83], a[224:227], v[156:159], v[80:83]
    s_add_u32 m0, s8, 0x6000
    ds_read_b64_tr_b16 a[254:255], v22 offset:37376
    buffer_load_dwordx4 v13, s[52:55], s9 offen offset:0 lds
    v_mfma_f32_16x16x32_bf16 v[80:83], a[220:223], v[148:151], v[80:83]
    ds_read_b64_tr_b16 a[200:201], v22 offset:40960
    v_add_f32 v37, 1.0, v37
    v_mfma_f32_16x16x32_bf16 v[80:83], a[216:219], v[140:143], v[80:83]
    ds_read_b64_tr_b16 a[202:203], v22 offset:41472
    v_mul_f32 v35, v43, v35
    v_cvt_pk_bf16_f32 v34, v34, v35
    v_mfma_f32_16x16x32_bf16 v[76:79], a[228:231], v[136:139], v[76:79]
    s_waitcnt lgkmcnt(4)
    ds_read_b64_tr_b16 a[204:205], v22 offset:45056
    ds_read_b64_tr_b16 a[206:207], v22 offset:45568
    v_add_u32 v22, 0xc000, v22
    v_exp_f32 v39, v47
    v_mfma_f32_16x16x32_bf16 v[76:79], a[232:235], v[144:147], v[76:79]
    buffer_load_dwordx4 v14, s[52:55], s9 offen offset:1024 lds
    v_mfma_f32_16x16x32_bf16 v[76:79], a[236:239], v[152:155], v[76:79]
    ds_read_b64_tr_b16 a[208:209], v19 offset:0
    v_add_f32 v38, 1.0, v38
    v_mfma_f32_16x16x32_bf16 v[84:87], a[236:239], v[156:159], v[84:87]
    ds_read_b64_tr_b16 a[210:211], v19 offset:512
    v_accvgpr_write_b32 a24, v32
    v_rcp_f32 v36, v36
    v_mfma_f32_16x16x32_bf16 v[84:87], a[232:235], v[148:151], v[84:87]
    ds_read_b64_tr_b16 a[212:213], v19 offset:4096
    v_add_f32 v39, 1.0, v39
    v_accvgpr_write_b32 a25, v34
    v_mfma_f32_16x16x32_bf16 v[84:87], a[228:231], v[140:143], v[84:87]
    ds_read_b64_tr_b16 a[214:215], v19 offset:4608
    buffer_load_dwordx4 v15, s[52:55], s9 offen offset:2048 lds
    v_mfma_f32_16x16x32_bf16 v[88:91], a[240:243], v[136:139], v[88:91]
    ds_read_b64_tr_b16 a[216:217], v19 offset:8192
    v_rcp_f32 v37, v37
    v_mfma_f32_16x16x32_bf16 v[88:91], a[244:247], v[144:147], v[88:91]
    ds_read_b64_tr_b16 a[218:219], v19 offset:8704
    v_rcp_f32 v38, v38
    v_mfma_f32_16x16x32_bf16 v[88:91], a[248:251], v[152:155], v[88:91]
    s_add_u32 m0, s8, 0x6c00
    s_waitcnt lgkmcnt(4)
    ds_read_b64_tr_b16 a[220:221], v20 offset:0
    v_rcp_f32 v39, v39
    v_mfma_f32_16x16x32_bf16 v[96:99], a[248:251], v[156:159], v[96:99]
    ds_read_b64_tr_b16 a[222:223], v20 offset:512
    buffer_load_dwordx4 v16, s[52:55], s9 offen offset:0 lds
    v_mfma_f32_16x16x32_bf16 v[96:99], a[244:247], v[148:151], v[96:99]
    ds_read_b64_tr_b16 a[224:225], v20 offset:4096
    v_exp_f32 v32, v48
    v_mfma_f32_16x16x32_bf16 v[96:99], a[240:243], v[140:143], v[96:99]
    ds_read_b64_tr_b16 a[226:227], v20 offset:4608
    v_mul_f32 v36, v44, v36
    v_mul_f32 v37, v45, v37
    v_mfma_f32_16x16x32_bf16 v[92:95], a[252:255], v[136:139], v[92:95]
    ds_read_b64_tr_b16 a[228:229], v20 offset:8192
    v_exp_f32 v33, v49
    v_mfma_f32_16x16x32_bf16 v[92:95], a[200:203], v[144:147], v[92:95]
    ds_read_b64_tr_b16 a[230:231], v20 offset:8704
    buffer_load_dwordx4 v17, s[52:55], s9 offen offset:1024 lds
    v_mfma_f32_16x16x32_bf16 v[92:95], a[204:207], v[152:155], v[92:95]
    ds_read_b64_tr_b16 a[232:233], v21 offset:0
    v_add_f32 v32, 1.0, v32
    v_mfma_f32_16x16x32_bf16 v[100:103], a[204:207], v[156:159], v[100:103]
    ds_read_b64_tr_b16 a[234:235], v21 offset:512
    v_cvt_pk_bf16_f32 v36, v36, v37
    v_mul_f32 v38, v46, v38
    v_exp_f32 v34, v50
    v_mfma_f32_16x16x32_bf16 v[100:103], a[200:203], v[148:151], v[100:103]
    s_waitcnt vmcnt(15) lgkmcnt(4)
    ds_read_b64_tr_b16 a[236:237], v21 offset:4096
    v_add_f32 v33, 1.0, v33
    v_mfma_f32_16x16x32_bf16 v[100:103], a[252:255], v[140:143], v[100:103]
    ds_read_b64_tr_b16 a[238:239], v21 offset:4608
    buffer_load_dwordx4 v18, s[52:55], s9 offen offset:2048 lds
    v_mfma_f32_16x16x32_bf16 v[72:75], a[208:211], v[160:163], v[72:75]
    s_barrier
    ds_read_b64_tr_b16 a[240:241], v21 offset:8192
    v_mfma_f32_16x16x32_bf16 v[72:75], a[212:215], v[168:171], v[72:75]
    ds_read_b64_tr_b16 a[242:243], v21 offset:8704
    v_mul_f32 v39, v47, v39
    v_cvt_pk_bf16_f32 v38, v38, v39
    v_mfma_f32_16x16x32_bf16 v[72:75], a[216:219], v[176:179], v[72:75]
    s_add_u32 s9, s26, 512
    ds_read_b64_tr_b16 a[244:245], v22 offset:0
    v_exp_f32 v35, v51
    v_mfma_f32_16x16x32_bf16 v[80:83], a[216:219], v[180:183], v[80:83]
    s_add_u32 m0, s8, 0xc000
    ds_read_b64_tr_b16 a[246:247], v22 offset:512
    buffer_load_dwordx4 v13, s[52:55], s9 offen offset:0 lds
    v_mfma_f32_16x16x32_bf16 v[80:83], a[212:215], v[172:175], v[80:83]
    ds_read_b64_tr_b16 a[248:249], v22 offset:4096
    v_add_f32 v34, 1.0, v34
    v_mfma_f32_16x16x32_bf16 v[80:83], a[208:211], v[164:167], v[80:83]
    ds_read_b64_tr_b16 a[250:251], v22 offset:4608
    v_accvgpr_write_b32 a26, v36
    v_rcp_f32 v32, v32
    v_mfma_f32_16x16x32_bf16 v[76:79], a[220:223], v[160:163], v[76:79]
    s_waitcnt lgkmcnt(4)
    ds_read_b64_tr_b16 a[252:253], v22 offset:8192
    v_add_f32 v35, 1.0, v35
    v_accvgpr_write_b32 a27, v38
    v_mfma_f32_16x16x32_bf16 v[76:79], a[224:227], v[168:171], v[76:79]
    ds_read_b64_tr_b16 a[254:255], v22 offset:8704
    buffer_load_dwordx4 v14, s[52:55], s9 offen offset:1024 lds
    v_mfma_f32_16x16x32_bf16 v[76:79], a[228:231], v[176:179], v[76:79]
    ds_read_b64_tr_b16 a[200:201], v19 offset:12288
    v_rcp_f32 v33, v33
    v_mfma_f32_16x16x32_bf16 v[84:87], a[228:231], v[180:183], v[84:87]
    ds_read_b64_tr_b16 a[202:203], v19 offset:12800
    v_rcp_f32 v34, v34
    v_mfma_f32_16x16x32_bf16 v[84:87], a[224:227], v[172:175], v[84:87]
    ds_read_b64_tr_b16 a[204:205], v19 offset:16384
    v_rcp_f32 v35, v35
    v_mfma_f32_16x16x32_bf16 v[84:87], a[220:223], v[164:167], v[84:87]
    s_add_u32 s31, s28, 8192
    ds_read_b64_tr_b16 a[206:207], v19 offset:16896
    buffer_load_dwordx4 v15, s[52:55], s9 offen offset:2048 lds
    v_mfma_f32_16x16x32_bf16 v[88:91], a[232:235], v[160:163], v[88:91]
    buffer_store_dwordx4 a[24:27], v8, s[60:63], s31 offen offset:0 sc1
    ds_read_b64_tr_b16 a[208:209], v19 offset:20480
    v_exp_f32 v36, v52
    v_mfma_f32_16x16x32_bf16 v[88:91], a[236:239], v[168:171], v[88:91]
    ds_read_b64_tr_b16 a[210:211], v19 offset:20992
    v_mul_f32 v32, v48, v32
    v_mfma_f32_16x16x32_bf16 v[88:91], a[240:243], v[176:179], v[88:91]
    s_add_u32 m0, s8, 0xcc00
    s_waitcnt lgkmcnt(4)
    ds_read_b64_tr_b16 a[212:213], v20 offset:12288
    v_mul_f32 v33, v49, v33
    v_exp_f32 v37, v53
    v_mfma_f32_16x16x32_bf16 v[96:99], a[240:243], v[180:183], v[96:99]
    ds_read_b64_tr_b16 a[214:215], v20 offset:12800
    buffer_load_dwordx4 v16, s[52:55], s9 offen offset:0 lds
    v_mfma_f32_16x16x32_bf16 v[96:99], a[236:239], v[172:175], v[96:99]
    ds_read_b64_tr_b16 a[216:217], v20 offset:16384
    v_mov_b32 v2, s68
    v_mfma_f32_16x16x32_bf16 v[96:99], a[232:235], v[164:167], v[96:99]
    ds_read_b64_tr_b16 a[218:219], v20 offset:16896
    v_add_f32 v36, 1.0, v36
    v_cvt_pk_bf16_f32 v32, v32, v33
    v_mul_f32 v34, v50, v34
    v_mfma_f32_16x16x32_bf16 v[92:95], a[244:247], v[160:163], v[92:95]
    ds_read_b64_tr_b16 a[220:221], v20 offset:20480
    v_exp_f32 v38, v54
    v_mfma_f32_16x16x32_bf16 v[92:95], a[248:251], v[168:171], v[92:95]
    ds_read_b64_tr_b16 a[222:223], v20 offset:20992
    buffer_load_dwordx4 v17, s[52:55], s9 offen offset:1024 lds
    v_mfma_f32_16x16x32_bf16 v[92:95], a[252:255], v[176:179], v[92:95]
    ds_read_b64_tr_b16 a[224:225], v21 offset:12288
    v_add_f32 v37, 1.0, v37
    v_mul_f32 v35, v51, v35
    v_mfma_f32_16x16x32_bf16 v[100:103], a[252:255], v[180:183], v[100:103]
    ds_read_b64_tr_b16 a[226:227], v21 offset:12800
    global_load_dword v12, v2, s[42:43] sc1
    v_mfma_f32_16x16x32_bf16 v[100:103], a[248:251], v[172:175], v[100:103]
    s_waitcnt lgkmcnt(4)
    ds_read_b64_tr_b16 a[228:229], v21 offset:16384
    v_cvt_pk_bf16_f32 v34, v34, v35
    v_mfma_f32_16x16x32_bf16 v[100:103], a[244:247], v[164:167], v[100:103]
    ds_read_b64_tr_b16 a[230:231], v21 offset:16896
    buffer_load_dwordx4 v18, s[52:55], s9 offen offset:2048 lds
    v_mfma_f32_16x16x32_bf16 v[72:75], a[200:203], v[184:187], v[72:75]
    ds_read_b64_tr_b16 a[232:233], v21 offset:20480
    v_exp_f32 v39, v55
    v_mfma_f32_16x16x32_bf16 v[72:75], a[204:207], v[192:195], v[72:75]
    ds_read_b64_tr_b16 a[234:235], v21 offset:20992
    v_add_f32 v38, 1.0, v38
    v_accvgpr_write_b32 a28, v32
    v_rcp_f32 v36, v36
    v_mfma_f32_16x16x32_bf16 v[72:75], a[208:211], v[200:203], v[72:75]
    ds_read_b64_tr_b16 a[236:237], v22 offset:12288
    v_add_f32 v39, 1.0, v39
    v_mfma_f32_16x16x32_bf16 v[80:83], a[208:211], v[204:207], v[80:83]
    ds_read_b64_tr_b16 a[238:239], v22 offset:12800
    v_accvgpr_write_b32 a29, v34
    v_rcp_f32 v37, v37
    v_mfma_f32_16x16x32_bf16 v[80:83], a[204:207], v[196:199], v[80:83]
    ds_read_b64_tr_b16 a[240:241], v22 offset:16384
    v_rcp_f32 v38, v38
    v_mfma_f32_16x16x32_bf16 v[80:83], a[200:203], v[188:191], v[80:83]
    s_mov_b32 s11, 221184
    ds_read_b64_tr_b16 a[242:243], v22 offset:16896
    buffer_load_dword v4, v31, s[56:59], s11 offen
    v_mfma_f32_16x16x32_bf16 v[76:79], a[212:215], v[184:187], v[76:79]
    s_waitcnt lgkmcnt(4)
    ds_read_b64_tr_b16 a[244:245], v22 offset:20480
    v_rcp_f32 v39, v39
    v_mfma_f32_16x16x32_bf16 v[76:79], a[216:219], v[192:195], v[76:79]
    ds_read_b64_tr_b16 a[246:247], v22 offset:20992
    v_exp_f32 v32, v56
    v_mfma_f32_16x16x32_bf16 v[76:79], a[220:223], v[200:203], v[76:79]
    ds_read_b64_tr_b16 a[248:249], v19 offset:24576
    v_mul_f32 v36, v52, v36
    v_mfma_f32_16x16x32_bf16 v[84:87], a[220:223], v[204:207], v[84:87]
    ds_read_b64_tr_b16 a[250:251], v19 offset:25088
    v_mul_f32 v37, v53, v37
    v_exp_f32 v33, v57
    v_mfma_f32_16x16x32_bf16 v[84:87], a[216:219], v[196:199], v[84:87]
    ds_read_b64_tr_b16 a[252:253], v19 offset:28672
    v_add_f32 v32, 1.0, v32
    v_mfma_f32_16x16x32_bf16 v[84:87], a[212:215], v[188:191], v[84:87]
    ds_read_b64_tr_b16 a[254:255], v19 offset:29184
    v_cvt_pk_bf16_f32 v36, v36, v37
    v_mul_f32 v38, v54, v38
    v_mfma_f32_16x16x32_bf16 v[88:91], a[224:227], v[184:187], v[88:91]
    ds_read_b64_tr_b16 a[200:201], v19 offset:32768
    v_exp_f32 v34, v58
    v_mfma_f32_16x16x32_bf16 v[88:91], a[228:231], v[192:195], v[88:91]
    ds_read_b64_tr_b16 a[202:203], v19 offset:33280
    v_add_f32 v33, 1.0, v33
    v_mul_f32 v39, v55, v39
    v_cvt_pk_bf16_f32 v38, v38, v39
    v_mfma_f32_16x16x32_bf16 v[88:91], a[232:235], v[200:203], v[88:91]
    s_waitcnt lgkmcnt(4)
    ds_read_b64_tr_b16 a[204:205], v20 offset:24576
    v_exp_f32 v35, v59
    v_mfma_f32_16x16x32_bf16 v[96:99], a[232:235], v[204:207], v[96:99]
    ds_read_b64_tr_b16 a[206:207], v20 offset:25088
    v_add_f32 v34, 1.0, v34
    v_accvgpr_write_b32 a30, v36
    v_mfma_f32_16x16x32_bf16 v[96:99], a[228:231], v[196:199], v[96:99]
    ds_read_b64_tr_b16 a[208:209], v20 offset:28672
    v_rcp_f32 v32, v32
    v_mfma_f32_16x16x32_bf16 v[96:99], a[224:227], v[188:191], v[96:99]
    ds_read_b64_tr_b16 a[210:211], v20 offset:29184
    v_add_f32 v35, 1.0, v35
    v_accvgpr_write_b32 a31, v38
    v_mfma_f32_16x16x32_bf16 v[92:95], a[236:239], v[184:187], v[92:95]
    ds_read_b64_tr_b16 a[212:213], v20 offset:32768
    v_rcp_f32 v33, v33
    v_mfma_f32_16x16x32_bf16 v[92:95], a[240:243], v[192:195], v[92:95]
    ds_read_b64_tr_b16 a[214:215], v20 offset:33280
    v_rcp_f32 v34, v34
    v_mfma_f32_16x16x32_bf16 v[92:95], a[244:247], v[200:203], v[92:95]
    ds_read_b64_tr_b16 a[216:217], v21 offset:24576
    v_rcp_f32 v35, v35
    v_mfma_f32_16x16x32_bf16 v[100:103], a[244:247], v[204:207], v[100:103]
    ds_read_b64_tr_b16 a[218:219], v21 offset:25088
    v_exp_f32 v36, v60
    v_mfma_f32_16x16x32_bf16 v[100:103], a[240:243], v[196:199], v[100:103]
    s_waitcnt vmcnt(15) lgkmcnt(4)
    ds_read_b64_tr_b16 a[220:221], v21 offset:28672
    v_mul_f32 v32, v56, v32
    v_mfma_f32_16x16x32_bf16 v[100:103], a[236:239], v[188:191], v[100:103]
    ds_read_b64_tr_b16 a[222:223], v21 offset:29184
    v_mul_f32 v33, v57, v33
    v_exp_f32 v37, v61
    v_mfma_f32_16x16x32_bf16 v[72:75], a[248:251], v[208:211], v[72:75]
    s_barrier
    ds_read_b64_tr_b16 a[224:225], v21 offset:32768
    v_mfma_f32_16x16x32_bf16 v[72:75], a[252:255], v[216:219], v[72:75]
    ds_read_b64_tr_b16 a[226:227], v21 offset:33280
    v_add_f32 v36, 1.0, v36
    v_cvt_pk_bf16_f32 v32, v32, v33
    v_mfma_f32_16x16x32_bf16 v[72:75], a[200:203], v[224:227], v[72:75]
    buffer_store_dwordx4 a[28:31], v8, s[60:63], s31 offen offset:1024 sc1
    ds_read_b64_tr_b16 a[228:229], v22 offset:24576
    ds_read_b64_tr_b16 a[230:231], v22 offset:25088
    v_mul_f32 v34, v58, v34
    v_mfma_f32_16x16x32_bf16 v[80:83], a[200:203], v[228:231], v[80:83]
    v_exp_f32 v38, v62
    v_mfma_f32_16x16x32_bf16 v[80:83], a[252:255], v[220:223], v[80:83]
    ds_read_b64_tr_b16 a[232:233], v22 offset:28672
    v_add_f32 v37, 1.0, v37
    v_mfma_f32_16x16x32_bf16 v[80:83], a[248:251], v[212:215], v[80:83]
    ds_read_b64_tr_b16 a[234:235], v22 offset:29184
    v_mul_f32 v35, v59, v35
    v_cvt_pk_bf16_f32 v34, v34, v35
    v_exp_f32 v39, v63
    v_mfma_f32_16x16x32_bf16 v[76:79], a[204:207], v[208:211], v[76:79]
    s_waitcnt lgkmcnt(4)
    ds_read_b64_tr_b16 a[236:237], v22 offset:32768
    v_add_f32 v38, 1.0, v38
    v_mfma_f32_16x16x32_bf16 v[76:79], a[208:211], v[216:219], v[76:79]
    ds_read_b64_tr_b16 a[238:239], v22 offset:33280
    v_accvgpr_write_b32 a32, v32
    v_rcp_f32 v36, v36
    v_mfma_f32_16x16x32_bf16 v[76:79], a[212:215], v[224:227], v[76:79]
    ds_read_b64_tr_b16 a[240:241], v19 offset:36864
    v_add_f32 v39, 1.0, v39
    v_mfma_f32_16x16x32_bf16 v[84:87], a[212:215], v[228:231], v[84:87]
    ds_read_b64_tr_b16 a[242:243], v19 offset:37376
    v_accvgpr_write_b32 a33, v34
    v_rcp_f32 v37, v37
    v_mfma_f32_16x16x32_bf16 v[84:87], a[208:211], v[220:223], v[84:87]
    ds_read_b64_tr_b16 a[244:245], v19 offset:40960
    v_rcp_f32 v38, v38
    v_mfma_f32_16x16x32_bf16 v[84:87], a[204:207], v[212:215], v[84:87]
    ds_read_b64_tr_b16 a[246:247], v19 offset:41472
    v_rcp_f32 v39, v39
    v_mfma_f32_16x16x32_bf16 v[88:91], a[216:219], v[208:211], v[88:91]
    ds_read_b64_tr_b16 a[248:249], v19 offset:45056
    ds_read_b64_tr_b16 a[250:251], v19 offset:45568
    v_mfma_f32_16x16x32_bf16 v[88:91], a[220:223], v[216:219], v[88:91]
    v_add_u32 v19, 0xfffe8000, v19
    v_exp_f32 v32, v64
    v_mul_f32 v36, v60, v36
    v_mfma_f32_16x16x32_bf16 v[88:91], a[224:227], v[224:227], v[88:91]
    s_waitcnt lgkmcnt(4)
    ds_read_b64_tr_b16 a[252:253], v20 offset:36864
    v_mul_f32 v37, v61, v37
    v_mfma_f32_16x16x32_bf16 v[96:99], a[224:227], v[228:231], v[96:99]
    ds_read_b64_tr_b16 a[254:255], v20 offset:37376
    v_exp_f32 v33, v65
    v_add_f32 v32, 1.0, v32
    v_mfma_f32_16x16x32_bf16 v[96:99], a[220:223], v[220:223], v[96:99]
    ds_read_b64_tr_b16 a[200:201], v20 offset:40960
    v_cvt_pk_bf16_f32 v36, v36, v37
    v_mfma_f32_16x16x32_bf16 v[96:99], a[216:219], v[212:215], v[96:99]
    ds_read_b64_tr_b16 a[202:203], v20 offset:41472
    v_mul_f32 v38, v62, v38
    v_exp_f32 v34, v66
    v_mfma_f32_16x16x32_bf16 v[92:95], a[228:231], v[208:211], v[92:95]
    ds_read_b64_tr_b16 a[204:205], v20 offset:45056
    ds_read_b64_tr_b16 a[206:207], v20 offset:45568
    v_mfma_f32_16x16x32_bf16 v[92:95], a[232:235], v[216:219], v[92:95]
    v_add_u32 v20, 0xfffe8000, v20
    v_add_f32 v33, 1.0, v33
    v_mul_f32 v39, v63, v39
    v_cvt_pk_bf16_f32 v38, v38, v39
    v_mfma_f32_16x16x32_bf16 v[92:95], a[236:239], v[224:227], v[92:95]
    ds_read_b64_tr_b16 a[208:209], v21 offset:36864
    v_exp_f32 v35, v67
    v_mfma_f32_16x16x32_bf16 v[100:103], a[236:239], v[228:231], v[100:103]
    ds_read_b64_tr_b16 a[210:211], v21 offset:37376
    v_add_f32 v34, 1.0, v34
    v_accvgpr_write_b32 a34, v36
    v_mfma_f32_16x16x32_bf16 v[100:103], a[232:235], v[220:223], v[100:103]
    s_waitcnt lgkmcnt(4)
    ds_read_b64_tr_b16 a[212:213], v21 offset:40960
    v_rcp_f32 v32, v32
    v_mfma_f32_16x16x32_bf16 v[100:103], a[228:231], v[212:215], v[100:103]
    ds_read_b64_tr_b16 a[214:215], v21 offset:41472
    v_add_f32 v35, 1.0, v35
    v_accvgpr_write_b32 a35, v38
    v_mfma_f32_16x16x32_bf16 v[72:75], a[240:243], v[232:235], v[72:75]
    ds_read_b64_tr_b16 a[216:217], v21 offset:45056
    ds_read_b64_tr_b16 a[218:219], v21 offset:45568
    v_mfma_f32_16x16x32_bf16 v[72:75], a[244:247], v[240:243], v[72:75]
    v_add_u32 v21, 0xfffe8000, v21
    v_rcp_f32 v33, v33
    v_rcp_f32 v34, v34
    v_mfma_f32_16x16x32_bf16 v[72:75], a[248:251], v[248:251], v[72:75]
    ds_read_b64_tr_b16 a[220:221], v22 offset:36864
    v_rcp_f32 v35, v35
    v_mfma_f32_16x16x32_bf16 v[80:83], a[248:251], v[252:255], v[80:83]
    ds_read_b64_tr_b16 a[222:223], v22 offset:37376
    v_exp_f32 v36, v68
    v_mfma_f32_16x16x32_bf16 v[80:83], a[244:247], v[244:247], v[80:83]
    ds_read_b64_tr_b16 a[224:225], v22 offset:40960
    v_mul_f32 v32, v64, v32
    v_mfma_f32_16x16x32_bf16 v[80:83], a[240:243], v[236:239], v[80:83]
    ds_read_b64_tr_b16 a[226:227], v22 offset:41472
    v_mul_f32 v33, v65, v33
    v_exp_f32 v37, v69
    v_mfma_f32_16x16x32_bf16 v[76:79], a[252:255], v[232:235], v[76:79]
    s_waitcnt lgkmcnt(4)
    ds_read_b64_tr_b16 a[228:229], v22 offset:45056
    ds_read_b64_tr_b16 a[230:231], v22 offset:45568
    v_mfma_f32_16x16x32_bf16 v[76:79], a[200:203], v[240:243], v[76:79]
    v_add_u32 v22, 0xfffe8000, v22
    v_add_f32 v36, 1.0, v36
    v_cvt_pk_bf16_f32 v32, v32, v33
    v_mfma_f32_16x16x32_bf16 v[76:79], a[204:207], v[248:251], v[76:79]
    ds_read_b64_tr_b16 a[232:233], v19 offset:0
    v_mul_f32 v34, v66, v34
    v_mfma_f32_16x16x32_bf16 v[84:87], a[204:207], v[252:255], v[84:87]
    ds_read_b64_tr_b16 a[234:235], v19 offset:512
    v_exp_f32 v38, v70
    v_add_f32 v37, 1.0, v37
    v_mul_f32 v35, v67, v35
    v_mfma_f32_16x16x32_bf16 v[84:87], a[200:203], v[244:247], v[84:87]
    ds_read_b64_tr_b16 a[236:237], v19 offset:4096
    v_cvt_pk_bf16_f32 v34, v34, v35
    v_mfma_f32_16x16x32_bf16 v[84:87], a[252:255], v[236:239], v[84:87]
    ds_read_b64_tr_b16 a[238:239], v19 offset:4608
    v_exp_f32 v39, v71
    v_add_f32 v38, 1.0, v38
    v_mfma_f32_16x16x32_bf16 v[88:91], a[208:211], v[232:235], v[88:91]
    buffer_store_dwordx4 a[32:35], v8, s[60:63], s31 offen offset:2048 sc1
    ds_read_b64_tr_b16 a[240:241], v19 offset:8192
    ds_read_b64_tr_b16 a[242:243], v19 offset:8704
    v_accvgpr_write_b32 a36, v32
    v_mfma_f32_16x16x32_bf16 v[88:91], a[212:215], v[240:243], v[88:91]
    v_rcp_f32 v36, v36
    v_mfma_f32_16x16x32_bf16 v[88:91], a[216:219], v[248:251], v[88:91]
    s_waitcnt lgkmcnt(4)
    ds_read_b64_tr_b16 a[244:245], v20 offset:0
    v_add_f32 v39, 1.0, v39
    v_mfma_f32_16x16x32_bf16 v[96:99], a[216:219], v[252:255], v[96:99]
    ds_read_b64_tr_b16 a[246:247], v20 offset:512
    v_accvgpr_write_b32 a37, v34
    v_rcp_f32 v37, v37
    v_mfma_f32_16x16x32_bf16 v[96:99], a[212:215], v[244:247], v[96:99]
    ds_read_b64_tr_b16 a[248:249], v20 offset:4096
    v_rcp_f32 v38, v38
    v_mfma_f32_16x16x32_bf16 v[96:99], a[208:211], v[236:239], v[96:99]
    ds_read_b64_tr_b16 a[250:251], v20 offset:4608
    v_rcp_f32 v39, v39
    v_mfma_f32_16x16x32_bf16 v[92:95], a[220:223], v[232:235], v[92:95]
    ds_read_b64_tr_b16 a[252:253], v20 offset:8192
    v_mul_f32 v36, v68, v36
    v_mfma_f32_16x16x32_bf16 v[92:95], a[224:227], v[240:243], v[92:95]
    ds_read_b64_tr_b16 a[254:255], v20 offset:8704
    v_mul_f32 v37, v69, v37
    v_cvt_pk_bf16_f32 v36, v36, v37
    v_mul_f32 v38, v70, v38
    v_mfma_f32_16x16x32_bf16 v[92:95], a[228:231], v[248:251], v[92:95]
    ds_read_b64_tr_b16 a[200:201], v21 offset:0
    v_mul_f32 v39, v71, v39
    v_mfma_f32_16x16x32_bf16 v[100:103], a[228:231], v[252:255], v[100:103]
    ds_read_b64_tr_b16 a[202:203], v21 offset:512
    v_cvt_pk_bf16_f32 v38, v38, v39
    v_accvgpr_write_b32 a38, v36
    v_accvgpr_write_b32 a39, v38
    v_mfma_f32_16x16x32_bf16 v[100:103], a[224:227], v[244:247], v[100:103]
    s_waitcnt vmcnt(11) lgkmcnt(4)
    ds_read_b64_tr_b16 a[204:205], v21 offset:4096
    v_mfma_f32_16x16x32_bf16 v[100:103], a[220:223], v[236:239], v[100:103]
    ds_read_b64_tr_b16 a[206:207], v21 offset:4608
    v_mfma_f32_16x16x32_bf16 v[40:43], a[232:235], v[112:115], 0
    s_barrier
    v_mfma_f32_16x16x32_bf16 v[40:43], a[236:239], v[120:123], v[40:43]
    ds_read_b64_tr_b16 a[208:209], v21 offset:8192
    ds_read_b64_tr_b16 a[210:211], v21 offset:8704
    v_mfma_f32_16x16x32_bf16 v[40:43], a[240:243], v[128:131], v[40:43]
    s_add_u32 s9, s24, 640
    ds_read_b64_tr_b16 a[212:213], v22 offset:0
    v_mfma_f32_16x16x32_bf16 v[48:51], a[240:243], v[132:135], 0
    s_add_u32 m0, s8, 0x12000
    ds_read_b64_tr_b16 a[214:215], v22 offset:512
    buffer_load_dwordx4 v13, s[52:55], s9 offen offset:0 lds
    v_mfma_f32_16x16x32_bf16 v[48:51], a[236:239], v[124:127], v[48:51]
    s_waitcnt vmcnt(5)
    ds_read_b64_tr_b16 a[216:217], v22 offset:4096
    v_mfma_f32_16x16x32_bf16 v[48:51], a[232:235], v[116:119], v[48:51]
    ds_read_b64_tr_b16 a[218:219], v22 offset:4608
    v_cmp_gt_u32 vcc, 16, v12
    v_mfma_f32_16x16x32_bf16 v[44:47], a[244:247], v[112:115], 0
    s_cbranch_vccnz L_fc_spin
L_fc_ret:
    s_waitcnt lgkmcnt(4)
    ds_read_b64_tr_b16 a[220:221], v22 offset:8192
    v_exp_f32 v32, v72
    v_mfma_f32_16x16x32_bf16 v[44:47], a[248:251], v[120:123], v[44:47]
    ds_read_b64_tr_b16 a[222:223], v22 offset:8704
    buffer_load_dwordx4 v14, s[52:55], s9 offen offset:1024 lds
    v_mfma_f32_16x16x32_bf16 v[44:47], a[252:255], v[128:131], v[44:47]
    buffer_store_dwordx4 a[36:39], v8, s[60:63], s31 offen offset:3072 sc1
    ds_read_b64_tr_b16 a[224:225], v19 offset:12288
    v_exp_f32 v33, v73
    v_mfma_f32_16x16x32_bf16 v[52:55], a[252:255], v[132:135], 0
    ds_read_b64_tr_b16 a[226:227], v19 offset:12800
    v_add_f32 v32, 1.0, v32
    v_mfma_f32_16x16x32_bf16 v[52:55], a[248:251], v[124:127], v[52:55]
    ds_read_b64_tr_b16 a[228:229], v19 offset:16384
    v_exp_f32 v34, v74
    v_add_f32 v33, 1.0, v33
    v_mfma_f32_16x16x32_bf16 v[52:55], a[244:247], v[116:119], v[52:55]
    ds_read_b64_tr_b16 a[230:231], v19 offset:16896
    buffer_load_dwordx4 v15, s[52:55], s9 offen offset:2048 lds
    v_mfma_f32_16x16x32_bf16 v[56:59], a[200:203], v[112:115], 0
    ds_read_b64_tr_b16 a[232:233], v19 offset:20480
    v_exp_f32 v35, v75
    v_mfma_f32_16x16x32_bf16 v[56:59], a[204:207], v[120:123], v[56:59]
    ds_read_b64_tr_b16 a[234:235], v19 offset:20992
    v_add_f32 v34, 1.0, v34
    v_rcp_f32 v32, v32
    v_mfma_f32_16x16x32_bf16 v[56:59], a[208:211], v[128:131], v[56:59]
    s_add_u32 m0, s8, 0x12c00
    s_waitcnt lgkmcnt(4)
    ds_read_b64_tr_b16 a[236:237], v20 offset:12288
    v_add_f32 v35, 1.0, v35
    v_mfma_f32_16x16x32_bf16 v[64:67], a[208:211], v[132:135], 0
    ds_read_b64_tr_b16 a[238:239], v20 offset:12800
    buffer_load_dwordx4 v16, s[52:55], s9 offen offset:0 lds
    v_mfma_f32_16x16x32_bf16 v[64:67], a[204:207], v[124:127], v[64:67]
    ds_read_b64_tr_b16 a[240:241], v20 offset:16384
    v_rcp_f32 v33, v33
    v_mfma_f32_16x16x32_bf16 v[64:67], a[200:203], v[116:119], v[64:67]
    ds_read_b64_tr_b16 a[242:243], v20 offset:16896
    v_rcp_f32 v34, v34
    v_rcp_f32 v35, v35
    v_mfma_f32_16x16x32_bf16 v[60:63], a[212:215], v[112:115], 0
    ds_read_b64_tr_b16 a[244:245], v20 offset:20480
    v_exp_f32 v36, v76
    v_mfma_f32_16x16x32_bf16 v[60:63], a[216:219], v[120:123], v[60:63]
    ds_read_b64_tr_b16 a[246:247], v20 offset:20992
    buffer_load_dwordx4 v17, s[52:55], s9 offen offset:1024 lds
    v_mfma_f32_16x16x32_bf16 v[60:63], a[220:223], v[128:131], v[60:63]
    ds_read_b64_tr_b16 a[248:249], v21 offset:12288
    v_mul_f32 v32, v72, v32
    v_mfma_f32_16x16x32_bf16 v[68:71], a[220:223], v[132:135], 0
    ds_read_b64_tr_b16 a[250:251], v21 offset:12800
    v_mul_f32 v33, v73, v33
    v_exp_f32 v37, v77
    v_mfma_f32_16x16x32_bf16 v[68:71], a[216:219], v[124:127], v[68:71]
    s_waitcnt lgkmcnt(4)
    ds_read_b64_tr_b16 a[252:253], v21 offset:16384
    v_add_f32 v36, 1.0, v36
    v_cvt_pk_bf16_f32 v32, v32, v33
    v_mfma_f32_16x16x32_bf16 v[68:71], a[212:215], v[116:119], v[68:71]
    ds_read_b64_tr_b16 a[254:255], v21 offset:16896
    buffer_load_dwordx4 v18, s[52:55], s9 offen offset:2048 lds
    v_mfma_f32_16x16x32_bf16 v[40:43], a[224:227], v[136:139], v[40:43]
    ds_read_b64_tr_b16 a[200:201], v21 offset:20480
    v_mul_f32 v34, v74, v34
    v_mfma_f32_16x16x32_bf16 v[40:43], a[228:231], v[144:147], v[40:43]
    ds_read_b64_tr_b16 a[202:203], v21 offset:20992
    v_exp_f32 v38, v78
    v_add_f32 v37, 1.0, v37
    v_mul_f32 v35, v75, v35
    v_mfma_f32_16x16x32_bf16 v[40:43], a[232:235], v[152:155], v[40:43]
    s_add_u32 s9, s25, 640
    ds_read_b64_tr_b16 a[204:205], v22 offset:12288
    v_cvt_pk_bf16_f32 v34, v34, v35
    v_exp_f32 v39, v79
    v_mfma_f32_16x16x32_bf16 v[48:51], a[232:235], v[156:159], v[48:51]
    s_add_u32 m0, s8, 0x18000
    ds_read_b64_tr_b16 a[206:207], v22 offset:12800
    buffer_load_dwordx4 v13, s[52:55], s9 offen offset:0 lds
    v_mfma_f32_16x16x32_bf16 v[48:51], a[228:231], v[148:151], v[48:51]
    ds_read_b64_tr_b16 a[208:209], v22 offset:16384
    v_add_f32 v38, 1.0, v38
    v_mfma_f32_16x16x32_bf16 v[48:51], a[224:227], v[140:143], v[48:51]
    ds_read_b64_tr_b16 a[210:211], v22 offset:16896
    v_accvgpr_write_b32 a40, v32
    v_rcp_f32 v36, v36
    v_mfma_f32_16x16x32_bf16 v[44:47], a[236:239], v[136:139], v[44:47]
    s_waitcnt lgkmcnt(4)
    ds_read_b64_tr_b16 a[212:213], v22 offset:20480
    v_add_f32 v39, 1.0, v39
    v_accvgpr_write_b32 a41, v34
    v_mfma_f32_16x16x32_bf16 v[44:47], a[240:243], v[144:147], v[44:47]
    ds_read_b64_tr_b16 a[214:215], v22 offset:20992
    buffer_load_dwordx4 v14, s[52:55], s9 offen offset:1024 lds
    v_mfma_f32_16x16x32_bf16 v[44:47], a[244:247], v[152:155], v[44:47]
    ds_read_b64_tr_b16 a[216:217], v19 offset:24576
    v_rcp_f32 v37, v37
    v_mfma_f32_16x16x32_bf16 v[52:55], a[244:247], v[156:159], v[52:55]
    ds_read_b64_tr_b16 a[218:219], v19 offset:25088
    v_rcp_f32 v38, v38
    v_mfma_f32_16x16x32_bf16 v[52:55], a[240:243], v[148:151], v[52:55]
    ds_read_b64_tr_b16 a[220:221], v19 offset:28672
    v_rcp_f32 v39, v39
    v_mfma_f32_16x16x32_bf16 v[52:55], a[236:239], v[140:143], v[52:55]
    ds_read_b64_tr_b16 a[222:223], v19 offset:29184
    buffer_load_dwordx4 v15, s[52:55], s9 offen offset:2048 lds
    v_mfma_f32_16x16x32_bf16 v[56:59], a[248:251], v[136:139], v[56:59]
    ds_read_b64_tr_b16 a[224:225], v19 offset:32768
    v_exp_f32 v32, v80
    v_mfma_f32_16x16x32_bf16 v[56:59], a[252:255], v[144:147], v[56:59]
    ds_read_b64_tr_b16 a[226:227], v19 offset:33280
    v_mul_f32 v36, v76, v36
    v_mul_f32 v37, v77, v37
    v_exp_f32 v33, v81
    v_mfma_f32_16x16x32_bf16 v[56:59], a[200:203], v[152:155], v[56:59]
    s_add_u32 m0, s8, 0x18c00
    s_waitcnt lgkmcnt(4)
    ds_read_b64_tr_b16 a[228:229], v20 offset:24576
    v_add_f32 v32, 1.0, v32
    v_mfma_f32_16x16x32_bf16 v[64:67], a[200:203], v[156:159], v[64:67]
    ds_read_b64_tr_b16 a[230:231], v20 offset:25088
    buffer_load_dwordx4 v16, s[52:55], s9 offen offset:0 lds
    v_mfma_f32_16x16x32_bf16 v[64:67], a[252:255], v[148:151], v[64:67]
    ds_read_b64_tr_b16 a[232:233], v20 offset:28672
    v_cvt_pk_bf16_f32 v36, v36, v37
    v_mfma_f32_16x16x32_bf16 v[64:67], a[248:251], v[140:143], v[64:67]
    ds_read_b64_tr_b16 a[234:235], v20 offset:29184
    v_mul_f32 v38, v78, v38
    v_exp_f32 v34, v82
    v_add_f32 v33, 1.0, v33
    v_mfma_f32_16x16x32_bf16 v[60:63], a[204:207], v[136:139], v[60:63]
    ds_read_b64_tr_b16 a[236:237], v20 offset:32768
    v_mul_f32 v39, v79, v39
    v_cvt_pk_bf16_f32 v38, v38, v39
    v_mfma_f32_16x16x32_bf16 v[60:63], a[208:211], v[144:147], v[60:63]
    ds_read_b64_tr_b16 a[238:239], v20 offset:33280
    buffer_load_dwordx4 v17, s[52:55], s9 offen offset:1024 lds
    v_mfma_f32_16x16x32_bf16 v[60:63], a[212:215], v[152:155], v[60:63]
    ds_read_b64_tr_b16 a[240:241], v21 offset:24576
    v_exp_f32 v35, v83
    v_mfma_f32_16x16x32_bf16 v[68:71], a[212:215], v[156:159], v[68:71]
    ds_read_b64_tr_b16 a[242:243], v21 offset:25088
    v_add_f32 v34, 1.0, v34
    v_accvgpr_write_b32 a42, v36
    v_mfma_f32_16x16x32_bf16 v[68:71], a[208:211], v[148:151], v[68:71]
L_pf1:
    s_cbranch_execz L_rf1
    s_waitcnt vmcnt(15) lgkmcnt(4)
    ds_read_b64_tr_b16 a[244:245], v21 offset:28672
    v_rcp_f32 v32, v32
    v_add_f32 v35, 1.0, v35
    v_mfma_f32_16x16x32_bf16 v[68:71], a[204:207], v[140:143], v[68:71]
    ds_read_b64_tr_b16 a[246:247], v21 offset:29184
    buffer_load_dwordx4 v18, s[52:55], s9 offen offset:2048 lds
    v_mfma_f32_16x16x32_bf16 v[40:43], a[216:219], v[160:163], v[40:43]
    s_barrier
    ds_read_b64_tr_b16 a[248:249], v21 offset:32768
    v_mfma_f32_16x16x32_bf16 v[40:43], a[220:223], v[168:171], v[40:43]
    ds_read_b64_tr_b16 a[250:251], v21 offset:33280
    v_accvgpr_write_b32 a43, v38
    v_rcp_f32 v33, v33
    v_mfma_f32_16x16x32_bf16 v[40:43], a[224:227], v[176:179], v[40:43]
    s_add_u32 s9, s26, 640
    ds_read_b64_tr_b16 a[252:253], v22 offset:24576
    v_rcp_f32 v34, v34
    v_mfma_f32_16x16x32_bf16 v[48:51], a[224:227], v[180:183], v[48:51]
    s_add_u32 m0, s8, 0x1e000
    ds_read_b64_tr_b16 a[254:255], v22 offset:25088
    buffer_load_dwordx4 v13, s[52:55], s9 offen offset:0 lds
    v_mfma_f32_16x16x32_bf16 v[48:51], a[220:223], v[172:175], v[48:51]
    ds_read_b64_tr_b16 a[200:201], v22 offset:28672
    v_rcp_f32 v35, v35
    v_mfma_f32_16x16x32_bf16 v[48:51], a[216:219], v[164:167], v[48:51]
    ds_read_b64_tr_b16 a[202:203], v22 offset:29184
    v_exp_f32 v36, v84
    v_mfma_f32_16x16x32_bf16 v[44:47], a[228:231], v[160:163], v[44:47]
    s_waitcnt lgkmcnt(4)
    ds_read_b64_tr_b16 a[204:205], v22 offset:32768
    v_mul_f32 v32, v80, v32
    v_mul_f32 v33, v81, v33
    v_mfma_f32_16x16x32_bf16 v[44:47], a[232:235], v[168:171], v[44:47]
    ds_read_b64_tr_b16 a[206:207], v22 offset:33280
    buffer_load_dwordx4 v14, s[52:55], s9 offen offset:1024 lds
    v_mfma_f32_16x16x32_bf16 v[44:47], a[236:239], v[176:179], v[44:47]
    ds_read_b64_tr_b16 a[208:209], v19 offset:36864
    v_exp_f32 v37, v85
    v_mfma_f32_16x16x32_bf16 v[52:55], a[236:239], v[180:183], v[52:55]
    ds_read_b64_tr_b16 a[210:211], v19 offset:37376
    v_add_f32 v36, 1.0, v36
    v_cvt_pk_bf16_f32 v32, v32, v33
    v_mul_f32 v34, v82, v34
    v_mfma_f32_16x16x32_bf16 v[52:55], a[232:235], v[172:175], v[52:55]
    ds_read_b64_tr_b16 a[212:213], v19 offset:40960
    v_exp_f32 v38, v86
    v_mfma_f32_16x16x32_bf16 v[52:55], a[228:231], v[164:167], v[52:55]
    s_add_u32 s31, s28, 12288
    ds_read_b64_tr_b16 a[214:215], v19 offset:41472
    buffer_load_dwordx4 v15, s[52:55], s9 offen offset:2048 lds
    v_mfma_f32_16x16x32_bf16 v[56:59], a[240:243], v[160:163], v[56:59]
    buffer_store_dwordx4 a[40:43], v8, s[60:63], s31 offen offset:0 sc1
    ds_read_b64_tr_b16 a[216:217], v19 offset:45056
    ds_read_b64_tr_b16 a[218:219], v19 offset:45568
    v_add_u32 v19, 0xc000, v19
    v_mfma_f32_16x16x32_bf16 v[56:59], a[244:247], v[168:171], v[56:59]
    v_add_f32 v37, 1.0, v37
    v_mul_f32 v35, v83, v35
    v_mfma_f32_16x16x32_bf16 v[56:59], a[248:251], v[176:179], v[56:59]
    s_add_u32 m0, s8, 0x1ec00
    s_waitcnt lgkmcnt(4)
    ds_read_b64_tr_b16 a[220:221], v20 offset:36864
    v_cvt_pk_bf16_f32 v34, v34, v35
    v_exp_f32 v39, v87
    v_mfma_f32_16x16x32_bf16 v[64:67], a[248:251], v[180:183], v[64:67]
    ds_read_b64_tr_b16 a[222:223], v20 offset:37376
    buffer_load_dwordx4 v16, s[52:55], s9 offen offset:0 lds
    v_mfma_f32_16x16x32_bf16 v[64:67], a[244:247], v[172:175], v[64:67]
    ds_read_b64_tr_b16 a[224:225], v20 offset:40960
    v_add_f32 v38, 1.0, v38
    v_mfma_f32_16x16x32_bf16 v[64:67], a[240:243], v[164:167], v[64:67]
    ds_read_b64_tr_b16 a[226:227], v20 offset:41472
    v_accvgpr_write_b32 a44, v32
    v_rcp_f32 v36, v36
    v_mfma_f32_16x16x32_bf16 v[60:63], a[252:255], v[160:163], v[60:63]
    ds_read_b64_tr_b16 a[228:229], v20 offset:45056
    ds_read_b64_tr_b16 a[230:231], v20 offset:45568
    v_add_u32 v20, 0xc000, v20
    v_mfma_f32_16x16x32_bf16 v[60:63], a[200:203], v[168:171], v[60:63]
    buffer_load_dwordx4 v17, s[52:55], s9 offen offset:1024 lds
    v_add_f32 v39, 1.0, v39
    v_mfma_f32_16x16x32_bf16 v[60:63], a[204:207], v[176:179], v[60:63]
    s_waitcnt vmcnt(16)
    buffer_store_dword v7, v7, s[60:63], 0 offen offset:0 sc1
    ds_read_b64_tr_b16 a[232:233], v21 offset:36864
    ds_read_b64_tr_b16 a[234:235], v21 offset:37376
    v_accvgpr_write_b32 a45, v34
    v_mfma_f32_16x16x32_bf16 v[68:71], a[204:207], v[180:183], v[68:71]
    v_rcp_f32 v37, v37
    v_mfma_f32_16x16x32_bf16 v[68:71], a[200:203], v[172:175], v[68:71]
    s_waitcnt lgkmcnt(4)
    ds_read_b64_tr_b16 a[236:237], v21 offset:40960
    v_rcp_f32 v38, v38
    v_rcp_f32 v39, v39
    v_mfma_f32_16x16x32_bf16 v[68:71], a[252:255], v[164:167], v[68:71]
    ds_read_b64_tr_b16 a[238:239], v21 offset:41472
    buffer_load_dwordx4 v18, s[52:55], s9 offen offset:2048 lds
    v_mfma_f32_16x16x32_bf16 v[40:43], a[208:211], v[184:187], v[40:43]
    ds_read_b64_tr_b16 a[240:241], v21 offset:45056
    ds_read_b64_tr_b16 a[242:243], v21 offset:45568
    v_mfma_f32_16x16x32_bf16 v[40:43], a[212:215], v[192:195], v[40:43]
    v_add_u32 v21, 0xc000, v21
    v_exp_f32 v32, v88
    v_mfma_f32_16x16x32_bf16 v[40:43], a[216:219], v[200:203], v[40:43]
    s_add_u32 s9, s18, s94
    ds_read_b64_tr_b16 a[244:245], v22 offset:36864
    v_mul_f32 v36, v84, v36
    v_mul_f32 v37, v85, v37
    v_mfma_f32_16x16x32_bf16 v[48:51], a[216:219], v[204:207], v[48:51]
    s_add_u32 m0, s8, 0x0
    ds_read_b64_tr_b16 a[246:247], v22 offset:37376
    buffer_load_dwordx4 v25, s[56:59], s9 offen offset:0 lds
    v_mfma_f32_16x16x32_bf16 v[48:51], a[212:215], v[196:199], v[48:51]
    ds_read_b64_tr_b16 a[248:249], v22 offset:40960
    v_exp_f32 v33, v89
    v_mfma_f32_16x16x32_bf16 v[48:51], a[208:211], v[188:191], v[48:51]
    ds_read_b64_tr_b16 a[250:251], v22 offset:41472
    v_add_f32 v32, 1.0, v32
    v_cvt_pk_bf16_f32 v36, v36, v37
    v_mul_f32 v38, v86, v38
    v_mfma_f32_16x16x32_bf16 v[44:47], a[220:223], v[184:187], v[44:47]
    s_waitcnt lgkmcnt(4)
    ds_read_b64_tr_b16 a[252:253], v22 offset:45056
    ds_read_b64_tr_b16 a[254:255], v22 offset:45568
    v_add_u32 v22, 0xc000, v22
    v_exp_f32 v34, v90
    v_mfma_f32_16x16x32_bf16 v[44:47], a[224:227], v[192:195], v[44:47]
    buffer_load_dwordx4 v26, s[56:59], s9 offen offset:1024 lds
    v_mfma_f32_16x16x32_bf16 v[44:47], a[228:231], v[200:203], v[44:47]
    ds_read_b64_tr_b16 a[200:201], v19 offset:0
    v_add_f32 v33, 1.0, v33
    v_mfma_f32_16x16x32_bf16 v[52:55], a[228:231], v[204:207], v[52:55]
    ds_read_b64_tr_b16 a[202:203], v19 offset:512
    v_mul_f32 v39, v87, v39
    v_cvt_pk_bf16_f32 v38, v38, v39
    v_mfma_f32_16x16x32_bf16 v[52:55], a[224:227], v[196:199], v[52:55]
    ds_read_b64_tr_b16 a[204:205], v19 offset:4096
    v_exp_f32 v35, v91
    v_add_f32 v34, 1.0, v34
    v_mfma_f32_16x16x32_bf16 v[52:55], a[220:223], v[188:191], v[52:55]
    ds_read_b64_tr_b16 a[206:207], v19 offset:4608
    buffer_load_dwordx4 v27, s[56:59], s9 offen offset:2048 lds
    v_mfma_f32_16x16x32_bf16 v[56:59], a[232:235], v[184:187], v[56:59]
    ds_read_b64_tr_b16 a[208:209], v19 offset:8192
    v_accvgpr_write_b32 a46, v36
    v_mfma_f32_16x16x32_bf16 v[56:59], a[236:239], v[192:195], v[56:59]
    ds_read_b64_tr_b16 a[210:211], v19 offset:8704
    v_rcp_f32 v32, v32
    v_add_f32 v35, 1.0, v35
    v_accvgpr_write_b32 a47, v38
    v_mfma_f32_16x16x32_bf16 v[56:59], a[240:243], v[200:203], v[56:59]
    s_add_u32 m0, s8, 0xc00
    s_waitcnt lgkmcnt(4)
    ds_read_b64_tr_b16 a[212:213], v20 offset:0
    v_rcp_f32 v33, v33
    v_mfma_f32_16x16x32_bf16 v[64:67], a[240:243], v[204:207], v[64:67]
    ds_read_b64_tr_b16 a[214:215], v20 offset:512
    buffer_load_dwordx4 v28, s[56:59], s9 offen offset:0 lds
    v_mfma_f32_16x16x32_bf16 v[64:67], a[236:239], v[196:199], v[64:67]
    ds_read_b64_tr_b16 a[216:217], v20 offset:4096
    v_rcp_f32 v34, v34
    v_mfma_f32_16x16x32_bf16 v[64:67], a[232:235], v[188:191], v[64:67]
    ds_read_b64_tr_b16 a[218:219], v20 offset:4608
    v_rcp_f32 v35, v35
    v_mfma_f32_16x16x32_bf16 v[60:63], a[244:247], v[184:187], v[60:63]
    ds_read_b64_tr_b16 a[220:221], v20 offset:8192
    v_exp_f32 v36, v92
    v_mul_f32 v32, v88, v32
    v_mfma_f32_16x16x32_bf16 v[60:63], a[248:251], v[192:195], v[60:63]
    ds_read_b64_tr_b16 a[222:223], v20 offset:8704
    buffer_load_dwordx4 v29, s[56:59], s9 offen offset:1024 lds
    v_mfma_f32_16x16x32_bf16 v[60:63], a[252:255], v[200:203], v[60:63]
    ds_read_b64_tr_b16 a[224:225], v21 offset:0
    v_mul_f32 v33, v89, v33
    v_mfma_f32_16x16x32_bf16 v[68:71], a[252:255], v[204:207], v[68:71]
    ds_read_b64_tr_b16 a[226:227], v21 offset:512
    v_exp_f32 v37, v93
    v_add_f32 v36, 1.0, v36
    v_mfma_f32_16x16x32_bf16 v[68:71], a[248:251], v[196:199], v[68:71]
    s_waitcnt vmcnt(19) lgkmcnt(4)
    ds_read_b64_tr_b16 a[228:229], v21 offset:4096
    v_cvt_pk_bf16_f32 v32, v32, v33
    v_mul_f32 v34, v90, v34
    v_mfma_f32_16x16x32_bf16 v[68:71], a[244:247], v[188:191], v[68:71]
    ds_read_b64_tr_b16 a[230:231], v21 offset:4608
    buffer_load_dwordx4 v30, s[56:59], s9 offen offset:2048 lds
    v_mfma_f32_16x16x32_bf16 v[40:43], a[200:203], v[208:211], v[40:43]
    s_barrier
    ds_read_b64_tr_b16 a[232:233], v21 offset:8192
    v_mfma_f32_16x16x32_bf16 v[40:43], a[204:207], v[216:219], v[40:43]
    ds_read_b64_tr_b16 a[234:235], v21 offset:8704
    v_exp_f32 v38, v94
    v_add_f32 v37, 1.0, v37
    v_mfma_f32_16x16x32_bf16 v[40:43], a[208:211], v[224:227], v[40:43]
    s_add_u32 s9, s18, s95
    ds_read_b64_tr_b16 a[236:237], v22 offset:0
    v_mul_f32 v35, v91, v35
    v_cvt_pk_bf16_f32 v34, v34, v35
    v_mfma_f32_16x16x32_bf16 v[48:51], a[208:211], v[228:231], v[48:51]
    s_add_u32 m0, s8, 0x6000
    ds_read_b64_tr_b16 a[238:239], v22 offset:512
    buffer_load_dwordx4 v25, s[56:59], s9 offen offset:0 lds
    v_mfma_f32_16x16x32_bf16 v[48:51], a[204:207], v[220:223], v[48:51]
    buffer_store_dwordx4 a[44:47], v8, s[60:63], s31 offen offset:1024 sc1
    ds_read_b64_tr_b16 a[240:241], v22 offset:4096
    v_exp_f32 v39, v95
    v_mfma_f32_16x16x32_bf16 v[48:51], a[200:203], v[212:215], v[48:51]
    ds_read_b64_tr_b16 a[242:243], v22 offset:4608
    v_add_f32 v38, 1.0, v38
    v_mfma_f32_16x16x32_bf16 v[44:47], a[212:215], v[208:211], v[44:47]
    s_waitcnt lgkmcnt(4)
    ds_read_b64_tr_b16 a[244:245], v22 offset:8192
    v_accvgpr_write_b32 a48, v32
    v_mfma_f32_16x16x32_bf16 v[44:47], a[216:219], v[216:219], v[44:47]
    ds_read_b64_tr_b16 a[246:247], v22 offset:8704
    v_rcp_f32 v36, v36
    v_add_f32 v39, 1.0, v39
    v_accvgpr_write_b32 a49, v34
    v_mfma_f32_16x16x32_bf16 v[44:47], a[220:223], v[224:227], v[44:47]
    ds_read_b64_tr_b16 a[248:249], v19 offset:12288
    v_rcp_f32 v37, v37
    v_mfma_f32_16x16x32_bf16 v[52:55], a[220:223], v[228:231], v[52:55]
    ds_read_b64_tr_b16 a[250:251], v19 offset:12800
    v_rcp_f32 v38, v38
    v_mfma_f32_16x16x32_bf16 v[52:55], a[216:219], v[220:223], v[52:55]
    ds_read_b64_tr_b16 a[252:253], v19 offset:16384
    v_rcp_f32 v39, v39
    v_mfma_f32_16x16x32_bf16 v[52:55], a[212:215], v[212:215], v[52:55]
    ds_read_b64_tr_b16 a[254:255], v19 offset:16896
    buffer_load_dwordx4 v26, s[56:59], s9 offen offset:1024 lds
    v_mfma_f32_16x16x32_bf16 v[56:59], a[224:227], v[208:211], v[56:59]
    ds_read_b64_tr_b16 a[200:201], v19 offset:20480
    v_exp_f32 v32, v96
    v_mfma_f32_16x16x32_bf16 v[56:59], a[228:231], v[216:219], v[56:59]
    ds_read_b64_tr_b16 a[202:203], v19 offset:20992
    v_mul_f32 v36, v92, v36
    v_mul_f32 v37, v93, v37
    v_mfma_f32_16x16x32_bf16 v[56:59], a[232:235], v[224:227], v[56:59]
    s_waitcnt lgkmcnt(4)
    ds_read_b64_tr_b16 a[204:205], v20 offset:12288
    v_exp_f32 v33, v97
    v_mfma_f32_16x16x32_bf16 v[64:67], a[232:235], v[228:231], v[64:67]
    ds_read_b64_tr_b16 a[206:207], v20 offset:12800
    v_add_f32 v32, 1.0, v32
    v_cvt_pk_bf16_f32 v36, v36, v37
    v_mul_f32 v38, v94, v38
    v_mfma_f32_16x16x32_bf16 v[64:67], a[228:231], v[220:223], v[64:67]
    ds_read_b64_tr_b16 a[208:209], v20 offset:16384
    v_exp_f32 v34, v98
    v_mfma_f32_16x16x32_bf16 v[64:67], a[224:227], v[212:215], v[64:67]
    ds_read_b64_tr_b16 a[210:211], v20 offset:16896
    v_add_f32 v33, 1.0, v33
    v_mul_f32 v39, v95, v39
    v_cvt_pk_bf16_f32 v38, v38, v39
    v_mfma_f32_16x16x32_bf16 v[60:63], a[236:239], v[208:211], v[60:63]
    ds_read_b64_tr_b16 a[212:213], v20 offset:20480
    v_exp_f32 v35, v99
    v_mfma_f32_16x16x32_bf16 v[60:63], a[240:243], v[216:219], v[60:63]
    ds_read_b64_tr_b16 a[214:215], v20 offset:20992
    buffer_load_dwordx4 v27, s[56:59], s9 offen offset:2048 lds
    v_mfma_f32_16x16x32_bf16 v[60:63], a[244:247], v[224:227], v[60:63]
    ds_read_b64_tr_b16 a[216:217], v21 offset:12288
    v_add_f32 v34, 1.0, v34
    v_accvgpr_write_b32 a50, v36
    v_mfma_f32_16x16x32_bf16 v[68:71], a[244:247], v[228:231], v[68:71]
    ds_read_b64_tr_b16 a[218:219], v21 offset:12800
    buffer_load_dword v12, v9, s[60:63], 0 offen offset:0 sc1
    v_mfma_f32_16x16x32_bf16 v[68:71], a[240:243], v[220:223], v[68:71]
    s_waitcnt lgkmcnt(4)
    ds_read_b64_tr_b16 a[220:221], v21 offset:16384
    v_rcp_f32 v32, v32
    v_mfma_f32_16x16x32_bf16 v[68:71], a[236:239], v[212:215], v[68:71]
    ds_read_b64_tr_b16 a[222:223], v21 offset:16896
    v_add_f32 v35, 1.0, v35
    v_accvgpr_write_b32 a51, v38
    v_mfma_f32_16x16x32_bf16 v[40:43], a[248:251], v[232:235], v[40:43]
    ds_read_b64_tr_b16 a[224:225], v21 offset:20480
    v_rcp_f32 v33, v33
    v_mfma_f32_16x16x32_bf16 v[40:43], a[252:255], v[240:243], v[40:43]
    ds_read_b64_tr_b16 a[226:227], v21 offset:20992
    v_rcp_f32 v34, v34
    v_rcp_f32 v35, v35
    v_mfma_f32_16x16x32_bf16 v[40:43], a[200:203], v[248:251], v[40:43]
    ds_read_b64_tr_b16 a[228:229], v22 offset:12288
    v_exp_f32 v36, v100
    v_mfma_f32_16x16x32_bf16 v[48:51], a[200:203], v[252:255], v[48:51]
    s_add_u32 m0, s8, 0x6c00
    ds_read_b64_tr_b16 a[230:231], v22 offset:12800
    buffer_load_dwordx4 v28, s[56:59], s9 offen offset:0 lds
    v_mfma_f32_16x16x32_bf16 v[48:51], a[252:255], v[244:247], v[48:51]
    ds_read_b64_tr_b16 a[232:233], v22 offset:16384
    v_mul_f32 v32, v96, v32
    v_mfma_f32_16x16x32_bf16 v[48:51], a[248:251], v[236:239], v[48:51]
    ds_read_b64_tr_b16 a[234:235], v22 offset:16896
    v_mul_f32 v33, v97, v33
    v_exp_f32 v37, v101
    v_mfma_f32_16x16x32_bf16 v[44:47], a[204:207], v[232:235], v[44:47]
    s_waitcnt lgkmcnt(4)
    ds_read_b64_tr_b16 a[236:237], v22 offset:20480
    v_add_f32 v36, 1.0, v36
    v_mfma_f32_16x16x32_bf16 v[44:47], a[208:211], v[240:243], v[44:47]
    ds_read_b64_tr_b16 a[238:239], v22 offset:20992
    v_cvt_pk_bf16_f32 v32, v32, v33
    v_mul_f32 v34, v98, v34
    v_exp_f32 v38, v102
    v_mfma_f32_16x16x32_bf16 v[44:47], a[212:215], v[248:251], v[44:47]
    ds_read_b64_tr_b16 a[240:241], v19 offset:24576
    v_add_f32 v37, 1.0, v37
    v_mfma_f32_16x16x32_bf16 v[52:55], a[212:215], v[252:255], v[52:55]
    ds_read_b64_tr_b16 a[242:243], v19 offset:25088
    v_mul_f32 v35, v99, v35
    v_cvt_pk_bf16_f32 v34, v34, v35
    v_mfma_f32_16x16x32_bf16 v[52:55], a[208:211], v[244:247], v[52:55]
    ds_read_b64_tr_b16 a[244:245], v19 offset:28672
    v_exp_f32 v39, v103
    v_add_f32 v38, 1.0, v38
    v_mfma_f32_16x16x32_bf16 v[52:55], a[204:207], v[236:239], v[52:55]
    ds_read_b64_tr_b16 a[246:247], v19 offset:29184
    buffer_load_dwordx4 v29, s[56:59], s9 offen offset:1024 lds
    v_mfma_f32_16x16x32_bf16 v[56:59], a[216:219], v[232:235], v[56:59]
    buffer_store_dwordx4 a[48:51], v8, s[60:63], s31 offen offset:2048 sc1
    ds_read_b64_tr_b16 a[248:249], v19 offset:32768
    ds_read_b64_tr_b16 a[250:251], v19 offset:33280
    v_accvgpr_write_b32 a52, v32
    v_mfma_f32_16x16x32_bf16 v[56:59], a[220:223], v[240:243], v[56:59]
    v_rcp_f32 v36, v36
    v_mfma_f32_16x16x32_bf16 v[56:59], a[224:227], v[248:251], v[56:59]
    s_waitcnt lgkmcnt(4)
    ds_read_b64_tr_b16 a[252:253], v20 offset:24576
    v_add_f32 v39, 1.0, v39
    v_mfma_f32_16x16x32_bf16 v[64:67], a[224:227], v[252:255], v[64:67]
    ds_read_b64_tr_b16 a[254:255], v20 offset:25088
    v_accvgpr_write_b32 a53, v34
    v_rcp_f32 v37, v37
    v_mfma_f32_16x16x32_bf16 v[64:67], a[220:223], v[244:247], v[64:67]
    ds_read_b64_tr_b16 a[200:201], v20 offset:28672
    v_rcp_f32 v38, v38
    v_mfma_f32_16x16x32_bf16 v[64:67], a[216:219], v[236:239], v[64:67]
    ds_read_b64_tr_b16 a[202:203], v20 offset:29184
    v_rcp_f32 v39, v39
    v_mul_f32 v36, v100, v36
    v_mfma_f32_16x16x32_bf16 v[60:63], a[228:231], v[232:235], v[60:63]
    ds_read_b64_tr_b16 a[204:205], v20 offset:32768
    v_mul_f32 v37, v101, v37
    v_cvt_pk_bf16_f32 v36, v36, v37
    v_mul_f32 v38, v102, v38
    v_mfma_f32_16x16x32_bf16 v[60:63], a[232:235], v[240:243], v[60:63]
    ds_read_b64_tr_b16 a[206:207], v20 offset:33280
    buffer_load_dwordx4 v30, s[56:59], s9 offen offset:2048 lds
    v_mfma_f32_16x16x32_bf16 v[60:63], a[236:239], v[248:251], v[60:63]
    ds_read_b64_tr_b16 a[208:209], v21 offset:24576
    v_mul_f32 v39, v103, v39
    v_mfma_f32_16x16x32_bf16 v[68:71], a[236:239], v[252:255], v[68:71]
    ds_read_b64_tr_b16 a[210:211], v21 offset:25088
    v_cvt_pk_bf16_f32 v38, v38, v39
    v_accvgpr_write_b32 a54, v36
    v_accvgpr_write_b32 a55, v38
    v_mfma_f32_16x16x32_bf16 v[68:71], a[232:235], v[244:247], v[68:71]
    s_waitcnt vmcnt(23) lgkmcnt(4)
    ds_read_b64_tr_b16 a[212:213], v21 offset:28672
    v_mfma_f32_16x16x32_bf16 v[68:71], a[228:231], v[236:239], v[68:71]
    ds_read_b64_tr_b16 a[214:215], v21 offset:29184
    v_mfma_f32_16x16x32_bf16 v[72:75], a[240:243], v[112:115], 0
    s_barrier
    v_mfma_f32_16x16x32_bf16 v[72:75], a[244:247], v[120:123], v[72:75]
    ds_read_b64_tr_b16 a[216:217], v21 offset:32768
    ds_read_b64_tr_b16 a[218:219], v21 offset:33280
    v_mfma_f32_16x16x32_bf16 v[72:75], a[248:251], v[128:131], v[72:75]
    s_add_u32 s9, s19, s94
    ds_read_b64_tr_b16 a[220:221], v22 offset:24576
    v_mfma_f32_16x16x32_bf16 v[80:83], a[248:251], v[132:135], 0
    s_add_u32 m0, s8, 0xc000
    ds_read_b64_tr_b16 a[222:223], v22 offset:25088
    buffer_load_dwordx4 v25, s[56:59], s9 offen offset:0 lds
    v_mfma_f32_16x16x32_bf16 v[80:83], a[244:247], v[124:127], v[80:83]
    v_mfma_f32_16x16x32_bf16 v[80:83], a[240:243], v[116:119], v[80:83]
    buffer_store_dwordx4 a[52:55], v8, s[60:63], s31 offen offset:3072 sc1
    ds_read_b64_tr_b16 a[224:225], v22 offset:28672
    ds_read_b64_tr_b16 a[226:227], v22 offset:29184
    v_mfma_f32_16x16x32_bf16 v[76:79], a[252:255], v[112:115], 0
    s_waitcnt lgkmcnt(4)
    ds_read_b64_tr_b16 a[228:229], v22 offset:32768
    v_exp_f32 v32, v40
    v_mfma_f32_16x16x32_bf16 v[76:79], a[200:203], v[120:123], v[76:79]
    ds_read_b64_tr_b16 a[230:231], v22 offset:33280
    v_exp_f32 v33, v41
    v_mfma_f32_16x16x32_bf16 v[76:79], a[204:207], v[128:131], v[76:79]
    s_xor_b32 s13, s27, 1
    ds_read_b64_tr_b16 a[232:233], v19 offset:36864
    v_add_f32 v32, 1.0, v32
    v_mfma_f32_16x16x32_bf16 v[84:87], a[204:207], v[132:135], 0
    s_lshl_b32 s12, s13, 6
    ds_read_b64_tr_b16 a[234:235], v19 offset:37376
    v_exp_f32 v34, v42
    v_add_f32 v33, 1.0, v33
    v_mfma_f32_16x16x32_bf16 v[84:87], a[200:203], v[124:127], v[84:87]
    ds_read_b64_tr_b16 a[236:237], v19 offset:40960
    v_exp_f32 v35, v43
    v_add_f32 v34, 1.0, v34
    v_mfma_f32_16x16x32_bf16 v[84:87], a[252:255], v[116:119], v[84:87]
    ds_read_b64_tr_b16 a[238:239], v19 offset:41472
    buffer_load_dwordx4 v26, s[56:59], s9 offen offset:1024 lds
    v_mfma_f32_16x16x32_bf16 v[88:91], a[208:211], v[112:115], 0
    ds_read_b64_tr_b16 a[240:241], v19 offset:45056
    ds_read_b64_tr_b16 a[242:243], v19 offset:45568
    v_mfma_f32_16x16x32_bf16 v[88:91], a[212:215], v[120:123], v[88:91]
    v_add_u32 v19, 0xc000, v19
    v_rcp_f32 v32, v32
    v_add_f32 v35, 1.0, v35
    v_mfma_f32_16x16x32_bf16 v[88:91], a[216:219], v[128:131], v[88:91]
    s_waitcnt lgkmcnt(4)
    ds_read_b64_tr_b16 a[244:245], v20 offset:36864
    v_rcp_f32 v33, v33
    v_mfma_f32_16x16x32_bf16 v[96:99], a[216:219], v[132:135], 0
    ds_read_b64_tr_b16 a[246:247], v20 offset:37376
    v_rcp_f32 v34, v34
    v_rcp_f32 v35, v35
    v_mfma_f32_16x16x32_bf16 v[96:99], a[212:215], v[124:127], v[96:99]
    ds_read_b64_tr_b16 a[248:249], v20 offset:40960
    v_exp_f32 v36, v44
    v_mfma_f32_16x16x32_bf16 v[96:99], a[208:211], v[116:119], v[96:99]
    ds_read_b64_tr_b16 a[250:251], v20 offset:41472
    v_mul_f32 v32, v40, v32
    v_mfma_f32_16x16x32_bf16 v[92:95], a[220:223], v[112:115], 0
    ds_read_b64_tr_b16 a[252:253], v20 offset:45056
    ds_read_b64_tr_b16 a[254:255], v20 offset:45568
    v_add_u32 v20, 0xc000, v20
    v_mfma_f32_16x16x32_bf16 v[92:95], a[224:227], v[120:123], v[92:95]
    buffer_load_dwordx4 v27, s[56:59], s9 offen offset:2048 lds
    v_mul_f32 v33, v41, v33
    v_mfma_f32_16x16x32_bf16 v[92:95], a[228:231], v[128:131], v[92:95]
    ds_read_b64_tr_b16 a[200:201], v21 offset:36864
    v_exp_f32 v37, v45
    v_mfma_f32_16x16x32_bf16 v[100:103], a[228:231], v[132:135], 0
    ds_read_b64_tr_b16 a[202:203], v21 offset:37376
    v_add_f32 v36, 1.0, v36
    v_cvt_pk_bf16_f32 v32, v32, v33
    v_mul_f32 v34, v42, v34
    v_mfma_f32_16x16x32_bf16 v[100:103], a[224:227], v[124:127], v[100:103]
    s_waitcnt lgkmcnt(4)
    ds_read_b64_tr_b16 a[204:205], v21 offset:40960
    v_exp_f32 v38, v46
    v_mfma_f32_16x16x32_bf16 v[100:103], a[220:223], v[116:119], v[100:103]
    ds_read_b64_tr_b16 a[206:207], v21 offset:41472
    v_add_f32 v37, 1.0, v37
    v_mul_f32 v35, v43, v35
    v_cvt_pk_bf16_f32 v34, v34, v35
    v_mfma_f32_16x16x32_bf16 v[72:75], a[232:235], v[136:139], v[72:75]
    ds_read_b64_tr_b16 a[208:209], v21 offset:45056
    ds_read_b64_tr_b16 a[210:211], v21 offset:45568
    v_mfma_f32_16x16x32_bf16 v[72:75], a[236:239], v[144:147], v[72:75]
    v_add_u32 v21, 0xc000, v21
    v_exp_f32 v39, v47
    v_add_f32 v38, 1.0, v38
    v_mfma_f32_16x16x32_bf16 v[72:75], a[240:243], v[152:155], v[72:75]
    ds_read_b64_tr_b16 a[212:213], v22 offset:36864
    v_accvgpr_write_b32 a56, v32
    v_rcp_f32 v36, v36
    v_mfma_f32_16x16x32_bf16 v[80:83], a[240:243], v[156:159], v[80:83]
    s_add_u32 m0, s8, 0xcc00
    ds_read_b64_tr_b16 a[214:215], v22 offset:37376
    buffer_load_dwordx4 v28, s[56:59], s9 offen offset:0 lds
    v_mfma_f32_16x16x32_bf16 v[80:83], a[236:239], v[148:151], v[80:83]
    ds_read_b64_tr_b16 a[216:217], v22 offset:40960
    v_lshrrev_b32 v1, 2, v0
    v_mfma_f32_16x16x32_bf16 v[80:83], a[232:235], v[140:143], v[80:83]
    ds_read_b64_tr_b16 a[218:219], v22 offset:41472
    v_add_f32 v39, 1.0, v39
    v_accvgpr_write_b32 a57, v34
    v_mfma_f32_16x16x32_bf16 v[76:79], a[244:247], v[136:139], v[76:79]
    s_waitcnt lgkmcnt(4)
    ds_read_b64_tr_b16 a[220:221], v22 offset:45056
    ds_read_b64_tr_b16 a[222:223], v22 offset:45568
    v_mfma_f32_16x16x32_bf16 v[76:79], a[248:251], v[144:147], v[76:79]
    v_add_u32 v22, 0xc000, v22
    v_rcp_f32 v37, v37
    v_rcp_f32 v38, v38
    v_mfma_f32_16x16x32_bf16 v[76:79], a[252:255], v[152:155], v[76:79]
    s_waitcnt vmcnt(9)
    ds_read_b64_tr_b16 a[224:225], v19 offset:0
    v_cmp_eq_u32 vcc, 0, v12
    v_mfma_f32_16x16x32_bf16 v[84:87], a[252:255], v[156:159], v[84:87]
    ds_read_b64_tr_b16 a[226:227], v19 offset:512
    v_rcp_f32 v39, v39
    v_exp_f32 v32, v48
    v_mfma_f32_16x16x32_bf16 v[84:87], a[248:251], v[148:151], v[84:87]
    s_cbranch_vccnz L_fh0_spin
L_fh0_ret:
    ds_read_b64_tr_b16 a[228:229], v19 offset:4096
    v_mul_f32 v36, v44, v36
    v_mul_f32 v37, v45, v37
    v_mfma_f32_16x16x32_bf16 v[84:87], a[244:247], v[140:143], v[84:87]
    ds_read_b64_tr_b16 a[230:231], v19 offset:4608
    buffer_load_dwordx4 v29, s[56:59], s9 offen offset:1024 lds
    v_mfma_f32_16x16x32_bf16 v[88:91], a[200:203], v[136:139], v[88:91]
    ds_read_b64_tr_b16 a[232:233], v19 offset:8192
    v_exp_f32 v33, v49
    v_add_f32 v32, 1.0, v32
    v_mfma_f32_16x16x32_bf16 v[88:91], a[204:207], v[144:147], v[88:91]
    s_add_u32 s14, s29, 0
    ds_read_b64_tr_b16 a[234:235], v19 offset:8704
    buffer_load_dwordx4 a[72:75], v8, s[60:63], s14 offen offset:0 sc1
    v_mfma_f32_16x16x32_bf16 v[88:91], a[208:211], v[152:155], v[88:91]
    s_waitcnt lgkmcnt(4)
    ds_read_b64_tr_b16 a[236:237], v20 offset:0
    v_cvt_pk_bf16_f32 v36, v36, v37
    v_mfma_f32_16x16x32_bf16 v[96:99], a[208:211], v[156:159], v[96:99]
    ds_read_b64_tr_b16 a[238:239], v20 offset:512
    v_mul_f32 v38, v46, v38
    v_exp_f32 v34, v50
    v_mfma_f32_16x16x32_bf16 v[96:99], a[204:207], v[148:151], v[96:99]
    ds_read_b64_tr_b16 a[240:241], v20 offset:4096
    v_lshlrev_b32 v1, 7, v1
    v_mfma_f32_16x16x32_bf16 v[96:99], a[200:203], v[140:143], v[96:99]
    ds_read_b64_tr_b16 a[242:243], v20 offset:4608
    v_add_f32 v33, 1.0, v33
    v_mul_f32 v39, v47, v39
    v_cvt_pk_bf16_f32 v38, v38, v39
    v_mfma_f32_16x16x32_bf16 v[92:95], a[212:215], v[136:139], v[92:95]
    ds_read_b64_tr_b16 a[244:245], v20 offset:8192
    v_exp_f32 v35, v51
    v_add_f32 v34, 1.0, v34
    v_mfma_f32_16x16x32_bf16 v[92:95], a[216:219], v[144:147], v[92:95]
    ds_read_b64_tr_b16 a[246:247], v20 offset:8704
    buffer_load_dwordx4 v30, s[56:59], s9 offen offset:2048 lds
    v_mfma_f32_16x16x32_bf16 v[92:95], a[220:223], v[152:155], v[92:95]
    ds_read_b64_tr_b16 a[248:249], v21 offset:0
    v_accvgpr_write_b32 a58, v36
    v_mfma_f32_16x16x32_bf16 v[100:103], a[220:223], v[156:159], v[100:103]
    ds_read_b64_tr_b16 a[250:251], v21 offset:512
    v_rcp_f32 v32, v32
    v_add_f32 v35, 1.0, v35
    v_mfma_f32_16x16x32_bf16 v[100:103], a[216:219], v[148:151], v[100:103]
    s_waitcnt lgkmcnt(4)
    ds_read_b64_tr_b16 a[252:253], v21 offset:4096
    v_and_b32 v2, 3, v0
    v_mfma_f32_16x16x32_bf16 v[100:103], a[212:215], v[140:143], v[100:103]
    ds_read_b64_tr_b16 a[254:255], v21 offset:4608
    v_accvgpr_write_b32 a59, v38
    v_rcp_f32 v33, v33
    v_mfma_f32_16x16x32_bf16 v[72:75], a[224:227], v[160:163], v[72:75]
    s_barrier
    ds_read_b64_tr_b16 a[200:201], v21 offset:8192
    v_mfma_f32_16x16x32_bf16 v[72:75], a[228:231], v[168:171], v[72:75]
    ds_read_b64_tr_b16 a[202:203], v21 offset:8704
    v_rcp_f32 v34, v34
    v_mfma_f32_16x16x32_bf16 v[72:75], a[232:235], v[176:179], v[72:75]
    s_add_u32 s9, s19, s95
    ds_read_b64_tr_b16 a[204:205], v22 offset:0
    v_rcp_f32 v35, v35
    v_exp_f32 v36, v52
    v_mfma_f32_16x16x32_bf16 v[80:83], a[232:235], v[180:183], v[80:83]
    s_add_u32 m0, s8, 0x12000
    ds_read_b64_tr_b16 a[206:207], v22 offset:512
    buffer_load_dwordx4 v25, s[56:59], s9 offen offset:0 lds
    v_mfma_f32_16x16x32_bf16 v[80:83], a[228:231], v[172:175], v[80:83]
    ds_read_b64_tr_b16 a[208:209], v22 offset:4096
    v_mul_f32 v32, v48, v32
    v_mul_f32 v33, v49, v33
    v_mfma_f32_16x16x32_bf16 v[80:83], a[224:227], v[164:167], v[80:83]
    ds_read_b64_tr_b16 a[210:211], v22 offset:4608
    buffer_load_dwordx4 a[76:79], v8, s[60:63], s14 offen offset:1024 sc1
    v_mfma_f32_16x16x32_bf16 v[76:79], a[236:239], v[160:163], v[76:79]
    s_waitcnt lgkmcnt(4)
    ds_read_b64_tr_b16 a[212:213], v22 offset:8192
    v_lshl_add_u32 v1, v2, 3, v1
    v_mfma_f32_16x16x32_bf16 v[76:79], a[240:243], v[168:171], v[76:79]
    ds_read_b64_tr_b16 a[214:215], v22 offset:8704
    v_exp_f32 v37, v53
    v_add_f32 v36, 1.0, v36
    v_mfma_f32_16x16x32_bf16 v[76:79], a[244:247], v[176:179], v[76:79]
    ds_read_b64_tr_b16 a[216:217], v19 offset:12288
    v_cvt_pk_bf16_f32 v32, v32, v33
    v_mfma_f32_16x16x32_bf16 v[84:87], a[244:247], v[180:183], v[84:87]
    ds_read_b64_tr_b16 a[218:219], v19 offset:12800
    v_mul_f32 v34, v50, v34
    v_exp_f32 v38, v54
    v_mfma_f32_16x16x32_bf16 v[84:87], a[240:243], v[172:175], v[84:87]
    ds_read_b64_tr_b16 a[220:221], v19 offset:16384
    v_add_f32 v37, 1.0, v37
    v_mul_f32 v35, v51, v35
    v_cvt_pk_bf16_f32 v34, v34, v35
    v_mfma_f32_16x16x32_bf16 v[84:87], a[236:239], v[164:167], v[84:87]
    s_add_u32 s31, s28, 16384
    ds_read_b64_tr_b16 a[222:223], v19 offset:16896
    buffer_load_dwordx4 v26, s[56:59], s9 offen offset:1024 lds
    v_mfma_f32_16x16x32_bf16 v[88:91], a[248:251], v[160:163], v[88:91]
    buffer_store_dwordx4 a[56:59], v8, s[60:63], s31 offen offset:0 sc1
    ds_read_b64_tr_b16 a[224:225], v19 offset:20480
    v_exp_f32 v39, v55
    v_mfma_f32_16x16x32_bf16 v[88:91], a[252:255], v[168:171], v[88:91]
    ds_read_b64_tr_b16 a[226:227], v19 offset:20992
    v_add_f32 v38, 1.0, v38
    v_mfma_f32_16x16x32_bf16 v[88:91], a[200:203], v[176:179], v[88:91]
    s_waitcnt lgkmcnt(4)
    ds_read_b64_tr_b16 a[228:229], v20 offset:12288
    v_bfe_u32 v2, v0, 3, 2
    v_mfma_f32_16x16x32_bf16 v[96:99], a[200:203], v[180:183], v[96:99]
    ds_read_b64_tr_b16 a[230:231], v20 offset:12800
    v_accvgpr_write_b32 a60, v32
    v_rcp_f32 v36, v36
    v_add_f32 v39, 1.0, v39
    v_mfma_f32_16x16x32_bf16 v[96:99], a[252:255], v[172:175], v[96:99]
    ds_read_b64_tr_b16 a[232:233], v20 offset:16384
    v_accvgpr_write_b32 a61, v34
    v_mfma_f32_16x16x32_bf16 v[96:99], a[248:251], v[164:167], v[96:99]
L_pf5:
    s_cbranch_execz L_rf5
    ds_read_b64_tr_b16 a[234:235], v20 offset:16896
    buffer_load_dwordx4 a[80:83], v8, s[60:63], s14 offen offset:2048 sc1
    v_mfma_f32_16x16x32_bf16 v[92:95], a[204:207], v[160:163], v[92:95]
    ds_read_b64_tr_b16 a[236:237], v20 offset:20480
    v_rcp_f32 v37, v37
    v_rcp_f32 v38, v38
    v_mfma_f32_16x16x32_bf16 v[92:95], a[208:211], v[168:171], v[92:95]
    ds_read_b64_tr_b16 a[238:239], v20 offset:20992
    buffer_load_dwordx4 v27, s[56:59], s9 offen offset:2048 lds
    v_mfma_f32_16x16x32_bf16 v[92:95], a[212:215], v[176:179], v[92:95]
    ds_read_b64_tr_b16 a[240:241], v21 offset:12288
    v_rcp_f32 v39, v39
    v_mfma_f32_16x16x32_bf16 v[100:103], a[212:215], v[180:183], v[100:103]
    ds_read_b64_tr_b16 a[242:243], v21 offset:12800
    v_exp_f32 v32, v56
    v_mfma_f32_16x16x32_bf16 v[100:103], a[208:211], v[172:175], v[100:103]
    s_waitcnt lgkmcnt(4)
    ds_read_b64_tr_b16 a[244:245], v21 offset:16384
    v_lshl_add_u32 v1, v2, 5, v1
    v_mfma_f32_16x16x32_bf16 v[100:103], a[204:207], v[164:167], v[100:103]
    ds_read_b64_tr_b16 a[246:247], v21 offset:16896
    v_mul_f32 v36, v52, v36
    v_mul_f32 v37, v53, v37
    v_exp_f32 v33, v57
    v_mfma_f32_16x16x32_bf16 v[72:75], a[216:219], v[184:187], v[72:75]
    ds_read_b64_tr_b16 a[248:249], v21 offset:20480
    v_add_f32 v32, 1.0, v32
    v_cvt_pk_bf16_f32 v36, v36, v37
    v_mfma_f32_16x16x32_bf16 v[72:75], a[220:223], v[192:195], v[72:75]
    ds_read_b64_tr_b16 a[250:251], v21 offset:20992
    buffer_load_dwordx4 a[84:87], v8, s[60:63], s14 offen offset:3072 sc1
    v_mfma_f32_16x16x32_bf16 v[72:75], a[224:227], v[200:203], v[72:75]
    ds_read_b64_tr_b16 a[252:253], v22 offset:12288
    v_mul_f32 v38, v54, v38
    v_exp_f32 v34, v58
    v_mfma_f32_16x16x32_bf16 v[80:83], a[224:227], v[204:207], v[80:83]
    s_add_u32 m0, s8, 0x12c00
    ds_read_b64_tr_b16 a[254:255], v22 offset:12800
    buffer_load_dwordx4 v28, s[56:59], s9 offen offset:0 lds
    v_mfma_f32_16x16x32_bf16 v[80:83], a[220:223], v[196:199], v[80:83]
    ds_read_b64_tr_b16 a[200:201], v22 offset:16384
    v_add_f32 v33, 1.0, v33
    v_mfma_f32_16x16x32_bf16 v[80:83], a[216:219], v[188:191], v[80:83]
    ds_read_b64_tr_b16 a[202:203], v22 offset:16896
    v_mul_f32 v39, v55, v39
    v_cvt_pk_bf16_f32 v38, v38, v39
    v_mfma_f32_16x16x32_bf16 v[76:79], a[228:231], v[184:187], v[76:79]
    s_waitcnt lgkmcnt(4)
    ds_read_b64_tr_b16 a[204:205], v22 offset:20480
    v_xor_b32 v112, s12, v1
    v_mfma_f32_16x16x32_bf16 v[76:79], a[232:235], v[192:195], v[76:79]
    ds_read_b64_tr_b16 a[206:207], v22 offset:20992
    v_exp_f32 v35, v59
    v_add_f32 v34, 1.0, v34
    v_accvgpr_write_b32 a62, v36
    v_mfma_f32_16x16x32_bf16 v[76:79], a[236:239], v[200:203], v[76:79]
    ds_read_b64_tr_b16 a[208:209], v19 offset:24576
    v_xor_b32 v113, 32, v112
    v_mfma_f32_16x16x32_bf16 v[84:87], a[236:239], v[204:207], v[84:87]
    ds_read_b64_tr_b16 a[210:211], v19 offset:25088
    v_rcp_f32 v32, v32
    v_add_f32 v35, 1.0, v35
    v_mfma_f32_16x16x32_bf16 v[84:87], a[232:235], v[196:199], v[84:87]
    ds_read_b64_tr_b16 a[212:213], v19 offset:28672
    v_accvgpr_write_b32 a63, v38
    v_rcp_f32 v33, v33
    v_mfma_f32_16x16x32_bf16 v[84:87], a[228:231], v[188:191], v[84:87]
    ds_read_b64_tr_b16 a[214:215], v19 offset:29184
    buffer_load_dwordx4 v29, s[56:59], s9 offen offset:1024 lds
    v_mfma_f32_16x16x32_bf16 v[88:91], a[240:243], v[184:187], v[88:91]
    ds_read_b64_tr_b16 a[216:217], v19 offset:32768
    v_rcp_f32 v34, v34
    v_mfma_f32_16x16x32_bf16 v[88:91], a[244:247], v[192:195], v[88:91]
    s_add_u32 s14, s29, 4096
    ds_read_b64_tr_b16 a[218:219], v19 offset:33280
    buffer_load_dwordx4 a[88:91], v8, s[60:63], s14 offen offset:0 sc1
    v_mfma_f32_16x16x32_bf16 v[88:91], a[248:251], v[200:203], v[88:91]
    s_waitcnt lgkmcnt(4)
    ds_read_b64_tr_b16 a[220:221], v20 offset:24576
    v_rcp_f32 v35, v35
    v_mfma_f32_16x16x32_bf16 v[96:99], a[248:251], v[204:207], v[96:99]
    ds_read_b64_tr_b16 a[222:223], v20 offset:25088
    v_exp_f32 v36, v60
    v_mfma_f32_16x16x32_bf16 v[96:99], a[244:247], v[196:199], v[96:99]
    ds_read_b64_tr_b16 a[224:225], v20 offset:28672
    v_xor_b32 v114, 64, v112
    v_mfma_f32_16x16x32_bf16 v[96:99], a[240:243], v[188:191], v[96:99]
    ds_read_b64_tr_b16 a[226:227], v20 offset:29184
    v_mul_f32 v32, v56, v32
    v_mul_f32 v33, v57, v33
    v_exp_f32 v37, v61
    v_mfma_f32_16x16x32_bf16 v[92:95], a[252:255], v[184:187], v[92:95]
    ds_read_b64_tr_b16 a[228:229], v20 offset:32768
    v_add_f32 v36, 1.0, v36
    v_cvt_pk_bf16_f32 v32, v32, v33
    v_mfma_f32_16x16x32_bf16 v[92:95], a[200:203], v[192:195], v[92:95]
    ds_read_b64_tr_b16 a[230:231], v20 offset:33280
    buffer_load_dwordx4 v30, s[56:59], s9 offen offset:2048 lds
    v_mfma_f32_16x16x32_bf16 v[92:95], a[204:207], v[200:203], v[92:95]
    ds_read_b64_tr_b16 a[232:233], v21 offset:24576
    v_mul_f32 v34, v58, v34
    v_mfma_f32_16x16x32_bf16 v[100:103], a[204:207], v[204:207], v[100:103]
    ds_read_b64_tr_b16 a[234:235], v21 offset:25088
    v_exp_f32 v38, v62
    v_add_f32 v37, 1.0, v37
    v_mul_f32 v35, v59, v35
    v_mfma_f32_16x16x32_bf16 v[100:103], a[200:203], v[196:199], v[100:103]
    s_waitcnt lgkmcnt(4)
    ds_read_b64_tr_b16 a[236:237], v21 offset:28672
    v_xor_b32 v115, 96, v112
    v_mfma_f32_16x16x32_bf16 v[100:103], a[252:255], v[188:191], v[100:103]
    ds_read_b64_tr_b16 a[238:239], v21 offset:29184
    v_cvt_pk_bf16_f32 v34, v34, v35
    v_exp_f32 v39, v63
    v_mfma_f32_16x16x32_bf16 v[72:75], a[208:211], v[208:211], v[72:75]
    s_barrier
    ds_read_b64_tr_b16 a[240:241], v21 offset:32768
    v_mfma_f32_16x16x32_bf16 v[72:75], a[212:215], v[216:219], v[72:75]
    ds_read_b64_tr_b16 a[242:243], v21 offset:33280
    v_add_f32 v38, 1.0, v38
    v_accvgpr_write_b32 a64, v32
    v_mfma_f32_16x16x32_bf16 v[72:75], a[216:219], v[224:227], v[72:75]
    s_add_u32 s9, s18, s94
    ds_read_b64_tr_b16 a[244:245], v22 offset:24576
    v_rcp_f32 v36, v36
    v_mfma_f32_16x16x32_bf16 v[80:83], a[216:219], v[228:231], v[80:83]
    s_add_u32 s9, s9, 221184
    s_add_u32 m0, s8, 0x18000
    ds_read_b64_tr_b16 a[246:247], v22 offset:25088
    buffer_load_dwordx4 v25, s[56:59], s9 offen offset:0 lds
    v_mfma_f32_16x16x32_bf16 v[80:83], a[212:215], v[220:223], v[80:83]
    v_add_f32 v39, 1.0, v39
    v_accvgpr_write_b32 a65, v34
    v_mfma_f32_16x16x32_bf16 v[80:83], a[208:211], v[212:215], v[80:83]
    buffer_store_dwordx4 a[60:63], v8, s[60:63], s31 offen offset:1024 sc1
    ds_read_b64_tr_b16 a[248:249], v22 offset:28672
    ds_read_b64_tr_b16 a[250:251], v22 offset:29184
    v_mfma_f32_16x16x32_bf16 v[76:79], a[220:223], v[208:211], v[76:79]
    s_waitcnt lgkmcnt(4)
    ds_read_b64_tr_b16 a[252:253], v22 offset:32768
    v_rcp_f32 v37, v37
    v_mfma_f32_16x16x32_bf16 v[76:79], a[224:227], v[216:219], v[76:79]
    ds_read_b64_tr_b16 a[254:255], v22 offset:33280
    v_rcp_f32 v38, v38
    v_rcp_f32 v39, v39
    v_mfma_f32_16x16x32_bf16 v[76:79], a[228:231], v[224:227], v[76:79]
    ds_read_b64_tr_b16 a[200:201], v19 offset:36864
    v_exp_f32 v32, v64
    v_mfma_f32_16x16x32_bf16 v[84:87], a[228:231], v[228:231], v[84:87]
    ds_read_b64_tr_b16 a[202:203], v19 offset:37376
    buffer_load_dwordx4 a[92:95], v8, s[60:63], s14 offen offset:1024 sc1
    v_mfma_f32_16x16x32_bf16 v[84:87], a[224:227], v[220:223], v[84:87]
    ds_read_b64_tr_b16 a[204:205], v19 offset:40960
    v_mul_f32 v36, v60, v36
    v_mul_f32 v37, v61, v37
    v_mfma_f32_16x16x32_bf16 v[84:87], a[220:223], v[212:215], v[84:87]
    ds_read_b64_tr_b16 a[206:207], v19 offset:41472
    buffer_load_dwordx4 v26, s[56:59], s9 offen offset:1024 lds
    v_mfma_f32_16x16x32_bf16 v[88:91], a[232:235], v[208:211], v[88:91]
    ds_read_b64_tr_b16 a[208:209], v19 offset:45056
    v_exp_f32 v33, v65
    v_add_f32 v32, 1.0, v32
    v_mfma_f32_16x16x32_bf16 v[88:91], a[236:239], v[216:219], v[88:91]
    ds_read_b64_tr_b16 a[210:211], v19 offset:45568
    buffer_load_dwordx4 a[96:99], v8, s[60:63], s14 offen offset:2048 sc1
    v_mfma_f32_16x16x32_bf16 v[88:91], a[240:243], v[224:227], v[88:91]
    s_waitcnt lgkmcnt(4)
    ds_read_b64_tr_b16 a[212:213], v20 offset:36864
    v_cvt_pk_bf16_f32 v36, v36, v37
    v_mfma_f32_16x16x32_bf16 v[96:99], a[240:243], v[228:231], v[96:99]
    ds_read_b64_tr_b16 a[214:215], v20 offset:37376
    v_mul_f32 v38, v62, v38
    v_exp_f32 v34, v66
    v_mfma_f32_16x16x32_bf16 v[96:99], a[236:239], v[220:223], v[96:99]
    ds_read_b64_tr_b16 a[216:217], v20 offset:40960
    v_add_f32 v33, 1.0, v33
    v_mfma_f32_16x16x32_bf16 v[96:99], a[232:235], v[212:215], v[96:99]
    ds_read_b64_tr_b16 a[218:219], v20 offset:41472
    v_mul_f32 v39, v63, v39
    v_cvt_pk_bf16_f32 v38, v38, v39
    v_exp_f32 v35, v67
    v_mfma_f32_16x16x32_bf16 v[92:95], a[244:247], v[208:211], v[92:95]
    ds_read_b64_tr_b16 a[220:221], v20 offset:45056
    v_add_f32 v34, 1.0, v34
    v_accvgpr_write_b32 a66, v36
    v_mfma_f32_16x16x32_bf16 v[92:95], a[248:251], v[216:219], v[92:95]
    ds_read_b64_tr_b16 a[222:223], v20 offset:45568
    buffer_load_dwordx4 v27, s[56:59], s9 offen offset:2048 lds
    v_mfma_f32_16x16x32_bf16 v[92:95], a[252:255], v[224:227], v[92:95]
    ds_read_b64_tr_b16 a[224:225], v21 offset:36864
    v_rcp_f32 v32, v32
    v_mfma_f32_16x16x32_bf16 v[100:103], a[252:255], v[228:231], v[100:103]
    ds_read_b64_tr_b16 a[226:227], v21 offset:37376
    v_add_f32 v35, 1.0, v35
    v_accvgpr_write_b32 a67, v38
    v_mfma_f32_16x16x32_bf16 v[100:103], a[248:251], v[220:223], v[100:103]
    s_waitcnt lgkmcnt(4)
    ds_read_b64_tr_b16 a[228:229], v21 offset:40960
    v_rcp_f32 v33, v33
    v_mfma_f32_16x16x32_bf16 v[100:103], a[244:247], v[212:215], v[100:103]
    ds_read_b64_tr_b16 a[230:231], v21 offset:41472
    v_rcp_f32 v34, v34
    v_mfma_f32_16x16x32_bf16 v[72:75], a[200:203], v[232:235], v[72:75]
    ds_read_b64_tr_b16 a[232:233], v21 offset:45056
    v_rcp_f32 v35, v35
    v_exp_f32 v36, v68
    v_mfma_f32_16x16x32_bf16 v[72:75], a[204:207], v[240:243], v[72:75]
    ds_read_b64_tr_b16 a[234:235], v21 offset:45568
    buffer_load_dwordx4 a[100:103], v8, s[60:63], s14 offen offset:3072 sc1
    v_mfma_f32_16x16x32_bf16 v[72:75], a[208:211], v[248:251], v[72:75]
    ds_read_b64_tr_b16 a[236:237], v22 offset:36864
    v_mul_f32 v32, v64, v32
    v_mfma_f32_16x16x32_bf16 v[80:83], a[208:211], v[252:255], v[80:83]
    s_add_u32 m0, s8, 0x18c00
    ds_read_b64_tr_b16 a[238:239], v22 offset:37376
    buffer_load_dwordx4 v28, s[56:59], s9 offen offset:0 lds
    v_mfma_f32_16x16x32_bf16 v[80:83], a[204:207], v[244:247], v[80:83]
    ds_read_b64_tr_b16 a[240:241], v22 offset:40960
    v_mul_f32 v33, v65, v33
    v_mfma_f32_16x16x32_bf16 v[80:83], a[200:203], v[236:239], v[80:83]
    ds_read_b64_tr_b16 a[242:243], v22 offset:41472
    v_exp_f32 v37, v69
    v_add_f32 v36, 1.0, v36
    v_cvt_pk_bf16_f32 v32, v32, v33
    v_mfma_f32_16x16x32_bf16 v[76:79], a[212:215], v[232:235], v[76:79]
    s_waitcnt lgkmcnt(4)
    ds_read_b64_tr_b16 a[244:245], v22 offset:45056
    v_mul_f32 v34, v66, v34
    v_mfma_f32_16x16x32_bf16 v[76:79], a[216:219], v[240:243], v[76:79]
    ds_read_b64_tr_b16 a[246:247], v22 offset:45568
    v_exp_f32 v38, v70
    v_add_f32 v37, 1.0, v37
    v_mfma_f32_16x16x32_bf16 v[76:79], a[220:223], v[248:251], v[76:79]
    ds_read_b64_tr_b16 a[248:249], v112 offset:0
    v_mul_f32 v35, v67, v35
    v_mfma_f32_16x16x32_bf16 v[84:87], a[220:223], v[252:255], v[84:87]
    ds_read_b64_tr_b16 a[250:251], v112 offset:2048
    v_cvt_pk_bf16_f32 v34, v34, v35
    v_exp_f32 v39, v71
    v_add_f32 v38, 1.0, v38
    v_mfma_f32_16x16x32_bf16 v[84:87], a[216:219], v[244:247], v[84:87]
    ds_read_b64_tr_b16 a[252:253], v112 offset:4096
    v_accvgpr_write_b32 a68, v32
    v_rcp_f32 v36, v36
    v_mfma_f32_16x16x32_bf16 v[84:87], a[212:215], v[236:239], v[84:87]
    ds_read_b64_tr_b16 a[254:255], v112 offset:6144
    buffer_load_dwordx4 v29, s[56:59], s9 offen offset:1024 lds
    v_mfma_f32_16x16x32_bf16 v[88:91], a[224:227], v[232:235], v[88:91]
    v_add_f32 v39, 1.0, v39
    v_accvgpr_write_b32 a69, v34
    v_mfma_f32_16x16x32_bf16 v[88:91], a[228:231], v[240:243], v[88:91]
    buffer_store_dwordx4 a[64:67], v8, s[60:63], s31 offen offset:2048 sc1
    ds_read_b64_tr_b16 a[200:201], v112 offset:8192
    ds_read_b64_tr_b16 a[202:203], v112 offset:10240
    v_mfma_f32_16x16x32_bf16 v[88:91], a[232:235], v[248:251], v[88:91]
    s_waitcnt lgkmcnt(4)
    ds_read_b64_tr_b16 a[204:205], v113 offset:0
    v_rcp_f32 v37, v37
    v_mfma_f32_16x16x32_bf16 v[96:99], a[232:235], v[252:255], v[96:99]
    ds_read_b64_tr_b16 a[206:207], v113 offset:2048
    v_rcp_f32 v38, v38
    v_mfma_f32_16x16x32_bf16 v[96:99], a[228:231], v[244:247], v[96:99]
    ds_read_b64_tr_b16 a[208:209], v113 offset:4096
    v_rcp_f32 v39, v39
    v_mul_f32 v36, v68, v36
    v_mfma_f32_16x16x32_bf16 v[96:99], a[224:227], v[236:239], v[96:99]
    s_add_u32 s14, s29, 8192
    ds_read_b64_tr_b16 a[210:211], v113 offset:6144
    buffer_load_dwordx4 a[104:107], v8, s[60:63], s14 offen offset:0 sc1
    v_mfma_f32_16x16x32_bf16 v[92:95], a[236:239], v[232:235], v[92:95]
    ds_read_b64_tr_b16 a[212:213], v113 offset:8192
    v_mul_f32 v37, v69, v37
    v_cvt_pk_bf16_f32 v36, v36, v37
    v_mul_f32 v38, v70, v38
    v_mfma_f32_16x16x32_bf16 v[92:95], a[240:243], v[240:243], v[92:95]
    ds_read_b64_tr_b16 a[214:215], v113 offset:10240
    buffer_load_dwordx4 v30, s[56:59], s9 offen offset:2048 lds
    v_mfma_f32_16x16x32_bf16 v[92:95], a[244:247], v[248:251], v[92:95]
    ds_read_b64_tr_b16 a[216:217], v114 offset:0
    v_mul_f32 v39, v71, v39
    v_mfma_f32_16x16x32_bf16 v[100:103], a[244:247], v[252:255], v[100:103]
    ds_read_b64_tr_b16 a[218:219], v114 offset:2048
    v_cvt_pk_bf16_f32 v38, v38, v39
    v_accvgpr_write_b32 a70, v36
    v_accvgpr_write_b32 a71, v38
    v_mfma_f32_16x16x32_bf16 v[100:103], a[240:243], v[244:247], v[100:103]
    s_waitcnt vmcnt(31) lgkmcnt(4)
    ds_read_b64_tr_b16 a[220:221], v114 offset:4096
    v_mfma_f32_16x16x32_bf16 v[100:103], a[236:239], v[236:239], v[100:103]
    ds_read_b64_tr_b16 a[222:223], v114 offset:6144
    v_mfma_f32_16x16x32_bf16 v[40:43], a[248:251], v[104:107], 0
    s_barrier
    v_mfma_f32_16x16x32_bf16 v[40:43], a[252:255], a[0:3], v[40:43]
    ds_read_b64_tr_b16 a[224:225], v114 offset:8192
    ds_read_b64_tr_b16 a[226:227], v114 offset:10240
    v_mfma_f32_16x16x32_bf16 v[40:43], a[200:203], a[8:11], v[40:43]
    s_add_u32 s9, s18, s95
    s_add_u32 s9, s9, 221184
    ds_read_b64_tr_b16 a[228:229], v115 offset:0
    v_mfma_f32_16x16x32_bf16 v[48:51], a[200:203], a[12:15], 0
    s_add_u32 m0, s8, 0x1e000
    ds_read_b64_tr_b16 a[230:231], v115 offset:2048
    buffer_load_dwordx4 v25, s[56:59], s9 offen offset:0 lds
    v_mfma_f32_16x16x32_bf16 v[48:51], a[252:255], a[4:7], v[48:51]
    v_mfma_f32_16x16x32_bf16 v[48:51], a[248:251], v[108:111], v[48:51]
    buffer_store_dwordx4 a[68:71], v8, s[60:63], s31 offen offset:3072 sc1
    ds_read_b64_tr_b16 a[232:233], v115 offset:4096
    ds_read_b64_tr_b16 a[234:235], v115 offset:6144
    v_mfma_f32_16x16x32_bf16 v[44:47], a[204:207], v[104:107], 0
    s_waitcnt lgkmcnt(4)
    ds_read_b64_tr_b16 a[236:237], v115 offset:8192
    v_add_u32 v116, 0xc000, v112
    v_mfma_f32_16x16x32_bf16 v[44:47], a[208:211], a[0:3], v[44:47]
    ds_read_b64_tr_b16 a[238:239], v115 offset:10240
    v_exp_f32 v32, v72
    v_mfma_f32_16x16x32_bf16 v[44:47], a[212:215], a[8:11], v[44:47]
    ds_read_b64_tr_b16 a[240:241], v112 offset:12288
    v_exp_f32 v33, v73
    v_mfma_f32_16x16x32_bf16 v[52:55], a[212:215], a[12:15], 0
    ds_read_b64_tr_b16 a[242:243], v112 offset:14336
    buffer_load_dwordx4 a[108:111], v8, s[60:63], s14 offen offset:1024 sc1
    v_mfma_f32_16x16x32_bf16 v[52:55], a[208:211], a[4:7], v[52:55]
    ds_read_b64_tr_b16 a[244:245], v112 offset:16384
    v_add_f32 v32, 1.0, v32
    v_exp_f32 v34, v74
    v_mfma_f32_16x16x32_bf16 v[52:55], a[204:207], v[108:111], v[52:55]
    ds_read_b64_tr_b16 a[246:247], v112 offset:18432
    buffer_load_dwordx4 v26, s[56:59], s9 offen offset:1024 lds
    v_mfma_f32_16x16x32_bf16 v[56:59], a[216:219], v[104:107], 0
    ds_read_b64_tr_b16 a[248:249], v112 offset:20480
    v_add_f32 v33, 1.0, v33
    v_mfma_f32_16x16x32_bf16 v[56:59], a[220:223], a[0:3], v[56:59]
    ds_read_b64_tr_b16 a[250:251], v112 offset:22528
    buffer_load_dwordx4 a[112:115], v8, s[60:63], s14 offen offset:2048 sc1
    v_mfma_f32_16x16x32_bf16 v[56:59], a[224:227], a[8:11], v[56:59]
    s_waitcnt lgkmcnt(4)
    ds_read_b64_tr_b16 a[252:253], v113 offset:12288
    v_exp_f32 v35, v75
    v_mfma_f32_16x16x32_bf16 v[64:67], a[224:227], a[12:15], 0
    ds_read_b64_tr_b16 a[254:255], v113 offset:14336
    v_add_f32 v34, 1.0, v34
    v_mfma_f32_16x16x32_bf16 v[64:67], a[220:223], a[4:7], v[64:67]
    ds_read_b64_tr_b16 a[200:201], v113 offset:16384
    v_add_u32 v117, 0xc000, v113
    v_mfma_f32_16x16x32_bf16 v[64:67], a[216:219], v[108:111], v[64:67]
    ds_read_b64_tr_b16 a[202:203], v113 offset:18432
    v_rcp_f32 v32, v32
    v_add_f32 v35, 1.0, v35
    v_mfma_f32_16x16x32_bf16 v[60:63], a[228:231], v[104:107], 0
    ds_read_b64_tr_b16 a[204:205], v113 offset:20480
    v_rcp_f32 v33, v33
    v_mfma_f32_16x16x32_bf16 v[60:63], a[232:235], a[0:3], v[60:63]
    ds_read_b64_tr_b16 a[206:207], v113 offset:22528
    buffer_load_dwordx4 v27, s[56:59], s9 offen offset:2048 lds
    v_mfma_f32_16x16x32_bf16 v[60:63], a[236:239], a[8:11], v[60:63]
    ds_read_b64_tr_b16 a[208:209], v114 offset:12288
    v_add_u32 v19, 0xc000, v114
    v_mfma_f32_16x16x32_bf16 v[68:71], a[236:239], a[12:15], 0
    ds_read_b64_tr_b16 a[210:211], v114 offset:14336
    v_rcp_f32 v34, v34
    v_mfma_f32_16x16x32_bf16 v[68:71], a[232:235], a[4:7], v[68:71]
    s_waitcnt lgkmcnt(4)
    ds_read_b64_tr_b16 a[212:213], v114 offset:16384
    v_rcp_f32 v35, v35
    v_mfma_f32_16x16x32_bf16 v[68:71], a[228:231], v[108:111], v[68:71]
    ds_read_b64_tr_b16 a[214:215], v114 offset:18432
    v_exp_f32 v36, v76
    v_mul_f32 v32, v72, v32
    v_mfma_f32_16x16x32_bf16 v[40:43], a[240:243], a[16:19], v[40:43]
    ds_read_b64_tr_b16 a[216:217], v114 offset:20480
    v_mul_f32 v33, v73, v33
    v_mfma_f32_16x16x32_bf16 v[40:43], a[244:247], a[24:27], v[40:43]
    ds_read_b64_tr_b16 a[218:219], v114 offset:22528
    buffer_load_dwordx4 a[116:119], v8, s[60:63], s14 offen offset:3072 sc1
    v_mfma_f32_16x16x32_bf16 v[40:43], a[248:251], a[32:35], v[40:43]
    ds_read_b64_tr_b16 a[220:221], v115 offset:12288
    v_exp_f32 v37, v77
    v_mfma_f32_16x16x32_bf16 v[48:51], a[248:251], a[36:39], v[48:51]
    s_add_u32 m0, s8, 0x1ec00
    ds_read_b64_tr_b16 a[222:223], v115 offset:14336
    buffer_load_dwordx4 v28, s[56:59], s9 offen offset:0 lds
    v_mfma_f32_16x16x32_bf16 v[48:51], a[244:247], a[28:31], v[48:51]
    ds_read_b64_tr_b16 a[224:225], v115 offset:16384
    v_add_u32 v20, 0xc000, v115
    v_mfma_f32_16x16x32_bf16 v[48:51], a[240:243], a[20:23], v[48:51]
    ds_read_b64_tr_b16 a[226:227], v115 offset:18432
    v_add_f32 v36, 1.0, v36
    v_cvt_pk_bf16_f32 v120, v32, v33
    v_mul_f32 v34, v74, v34
    v_mfma_f32_16x16x32_bf16 v[44:47], a[252:255], a[16:19], v[44:47]
    s_waitcnt lgkmcnt(4)
    ds_read_b64_tr_b16 a[228:229], v115 offset:20480
    v_add_u32 v21, 0x18000, v112
    v_mfma_f32_16x16x32_bf16 v[44:47], a[200:203], a[24:27], v[44:47]
    ds_read_b64_tr_b16 a[230:231], v115 offset:22528
    v_exp_f32 v38, v78
    v_add_f32 v37, 1.0, v37
    v_mfma_f32_16x16x32_bf16 v[44:47], a[204:207], a[32:35], v[44:47]
    ds_read_b64_tr_b16 a[232:233], v112 offset:24576
    v_mul_f32 v35, v75, v35
    v_mfma_f32_16x16x32_bf16 v[52:55], a[204:207], a[36:39], v[52:55]
    s_add_u32 s24, s30, 0
    ds_read_b64_tr_b16 a[234:235], v112 offset:26624
    buffer_load_dwordx4 a[120:123], v8, s[60:63], s24 offen offset:0 sc1
    v_mfma_f32_16x16x32_bf16 v[52:55], a[200:203], a[28:31], v[52:55]
    ds_read_b64_tr_b16 a[236:237], v112 offset:28672
    v_cvt_pk_bf16_f32 v121, v34, v35
    v_exp_f32 v39, v79
    v_mfma_f32_16x16x32_bf16 v[52:55], a[252:255], a[20:23], v[52:55]
    ds_read_b64_tr_b16 a[238:239], v112 offset:30720
    buffer_load_dwordx4 v29, s[56:59], s9 offen offset:1024 lds
    v_mfma_f32_16x16x32_bf16 v[56:59], a[208:211], a[16:19], v[56:59]
    ds_read_b64_tr_b16 a[240:241], v112 offset:32768
    v_add_f32 v38, 1.0, v38
    v_mfma_f32_16x16x32_bf16 v[56:59], a[212:215], a[24:27], v[56:59]
    ds_read_b64_tr_b16 a[242:243], v112 offset:34816
    v_rcp_f32 v36, v36
    v_mfma_f32_16x16x32_bf16 v[56:59], a[216:219], a[32:35], v[56:59]
    s_waitcnt lgkmcnt(4)
    ds_read_b64_tr_b16 a[244:245], v113 offset:24576
    v_add_u32 v22, 0x18000, v113
    v_mfma_f32_16x16x32_bf16 v[64:67], a[216:219], a[36:39], v[64:67]
    ds_read_b64_tr_b16 a[246:247], v113 offset:26624
    v_add_f32 v39, 1.0, v39
    v_rcp_f32 v37, v37
    v_mfma_f32_16x16x32_bf16 v[64:67], a[212:215], a[28:31], v[64:67]
    ds_read_b64_tr_b16 a[248:249], v113 offset:28672
    v_rcp_f32 v38, v38
    v_mfma_f32_16x16x32_bf16 v[64:67], a[208:211], a[20:23], v[64:67]
    ds_read_b64_tr_b16 a[250:251], v113 offset:30720
    buffer_load_dwordx4 a[124:127], v8, s[60:63], s24 offen offset:1024 sc1
    v_mfma_f32_16x16x32_bf16 v[60:63], a[220:223], a[16:19], v[60:63]
    ds_read_b64_tr_b16 a[252:253], v113 offset:32768
    ds_read_b64_tr_b16 a[254:255], v113 offset:34816
    v_mfma_f32_16x16x32_bf16 v[60:63], a[224:227], a[24:27], v[60:63]
    buffer_load_dwordx4 v30, s[56:59], s9 offen offset:2048 lds
    v_mfma_f32_16x16x32_bf16 v[60:63], a[228:231], a[32:35], v[60:63]
    ds_read_b64_tr_b16 a[200:201], v114 offset:24576
    v_add_u32 v23, 0x18000, v114
    v_mfma_f32_16x16x32_bf16 v[68:71], a[228:231], a[36:39], v[68:71]
    ds_read_b64_tr_b16 a[202:203], v114 offset:26624
    v_rcp_f32 v39, v39
    v_exp_f32 v32, v80
    v_mfma_f32_16x16x32_bf16 v[68:71], a[224:227], a[28:31], v[68:71]
    s_waitcnt vmcnt(35) lgkmcnt(4)
    ds_read_b64_tr_b16 a[204:205], v114 offset:28672
    v_mul_f32 v36, v76, v36
    v_mfma_f32_16x16x32_bf16 v[68:71], a[220:223], a[20:23], v[68:71]
    ds_read_b64_tr_b16 a[206:207], v114 offset:30720
    v_mul_f32 v37, v77, v37
    v_exp_f32 v33, v81
    v_mfma_f32_16x16x32_bf16 v[200:203], a[232:235], v[104:107], 0
    s_barrier
    ds_read_b64_tr_b16 a[208:209], v114 offset:32768
    v_mfma_f32_16x16x32_bf16 v[200:203], a[236:239], a[0:3], v[200:203]
    ds_read_b64_tr_b16 a[210:211], v114 offset:34816
    v_add_f32 v32, 1.0, v32
    v_mfma_f32_16x16x32_bf16 v[200:203], a[240:243], a[8:11], v[200:203]
    s_add_u32 s9, s20, s94
    ds_read_b64_tr_b16 a[212:213], v115 offset:24576
    v_cvt_pk_bf16_f32 v122, v36, v37
    v_mul_f32 v38, v78, v38
    v_mfma_f32_16x16x32_bf16 v[208:211], a[240:243], a[12:15], 0
    s_add_u32 m0, s8, 0x0
    ds_read_b64_tr_b16 a[214:215], v115 offset:26624
    buffer_load_dwordx4 v25, s[56:59], s9 offen offset:0 lds
    v_mfma_f32_16x16x32_bf16 v[208:211], a[236:239], a[4:7], v[208:211]
    ds_read_b64_tr_b16 a[216:217], v115 offset:28672
    v_exp_f32 v34, v82
    v_mfma_f32_16x16x32_bf16 v[208:211], a[232:235], v[108:111], v[208:211]
    ds_read_b64_tr_b16 a[218:219], v115 offset:30720
    buffer_load_dwordx4 a[128:131], v8, s[60:63], s24 offen offset:2048 sc1
    v_mfma_f32_16x16x32_bf16 v[204:207], a[244:247], v[104:107], 0
    s_waitcnt lgkmcnt(4)
    ds_read_b64_tr_b16 a[220:221], v115 offset:32768
    v_add_u32 v24, 0x18000, v115
    v_mfma_f32_16x16x32_bf16 v[204:207], a[248:251], a[0:3], v[204:207]
    ds_read_b64_tr_b16 a[222:223], v115 offset:34816
    v_add_f32 v33, 1.0, v33
    v_mul_f32 v39, v79, v39
    v_mfma_f32_16x16x32_bf16 v[204:207], a[252:255], a[8:11], v[204:207]
    ds_read_b64_tr_b16 a[224:225], v112 offset:36864
    v_cvt_pk_bf16_f32 v123, v38, v39
    v_mfma_f32_16x16x32_bf16 v[212:215], a[252:255], a[12:15], 0
    ds_read_b64_tr_b16 a[226:227], v112 offset:38912
    buffer_load_dwordx4 a[132:135], v8, s[60:63], s24 offen offset:3072 sc1
    v_mfma_f32_16x16x32_bf16 v[212:215], a[248:251], a[4:7], v[212:215]
    ds_read_b64_tr_b16 a[228:229], v112 offset:40960
    v_exp_f32 v35, v83
    v_add_f32 v34, 1.0, v34
    v_mfma_f32_16x16x32_bf16 v[212:215], a[244:247], v[108:111], v[212:215]
    ds_read_b64_tr_b16 a[230:231], v112 offset:43008
    buffer_load_dwordx4 v26, s[56:59], s9 offen offset:1024 lds
    v_mfma_f32_16x16x32_bf16 v[216:219], a[200:203], v[104:107], 0
    ds_read_b64_tr_b16 a[232:233], v112 offset:45056
    v_rcp_f32 v32, v32
    v_mfma_f32_16x16x32_bf16 v[216:219], a[204:207], a[0:3], v[216:219]
    ds_read_b64_tr_b16 a[234:235], v112 offset:47104
    v_add_f32 v35, 1.0, v35
    v_mfma_f32_16x16x32_bf16 v[216:219], a[208:211], a[8:11], v[216:219]
    s_waitcnt lgkmcnt(4)
    ds_read_b64_tr_b16 a[236:237], v113 offset:36864
    v_rcp_f32 v33, v33
    v_mfma_f32_16x16x32_bf16 v[224:227], a[208:211], a[12:15], 0
    ds_read_b64_tr_b16 a[238:239], v113 offset:38912
    v_rcp_f32 v34, v34
    v_mfma_f32_16x16x32_bf16 v[224:227], a[204:207], a[4:7], v[224:227]
    s_waitcnt vmcnt(14)
    v_rcp_f32 v35, v35
    v_mfma_f32_16x16x32_bf16 v[224:227], a[200:203], v[108:111], v[224:227]
    buffer_store_dword v7, v7, s[60:63], 0 offen offset:128 sc1
    ds_read_b64_tr_b16 a[240:241], v113 offset:40960
    ds_read_b64_tr_b16 a[242:243], v113 offset:43008
    v_mfma_f32_16x16x32_bf16 v[220:223], a[212:215], v[104:107], 0
    ds_read_b64_tr_b16 a[244:245], v113 offset:45056
    v_exp_f32 v36, v84
    v_mfma_f32_16x16x32_bf16 v[220:223], a[216:219], a[0:3], v[220:223]
    ds_read_b64_tr_b16 a[246:247], v113 offset:47104
    buffer_load_dwordx4 v27, s[56:59], s9 offen offset:2048 lds
    v_mfma_f32_16x16x32_bf16 v[220:223], a[220:223], a[8:11], v[220:223]
    ds_read_b64_tr_b16 a[248:249], v114 offset:36864
    v_mul_f32 v32, v80, v32
    v_mul_f32 v33, v81, v33
    v_mfma_f32_16x16x32_bf16 v[228:231], a[220:223], a[12:15], 0
    s_add_u32 s24, s30, 4096
    ds_read_b64_tr_b16 a[250:251], v114 offset:38912
    buffer_load_dwordx4 a[136:139], v8, s[60:63], s24 offen offset:0 sc1
    v_mfma_f32_16x16x32_bf16 v[228:231], a[216:219], a[4:7], v[228:231]
    s_add_u32 s31, s28, 20480
    s_waitcnt lgkmcnt(4)
    ds_read_b64_tr_b16 a[252:253], v114 offset:40960
    v_mfma_f32_16x16x32_bf16 v[228:231], a[212:215], v[108:111], v[228:231]
    ds_read_b64_tr_b16 a[254:255], v114 offset:43008
    v_exp_f32 v37, v85
    v_add_f32 v36, 1.0, v36
    v_cvt_pk_bf16_f32 v124, v32, v33
    v_mfma_f32_16x16x32_bf16 v[200:203], a[224:227], a[16:19], v[200:203]
    buffer_store_dwordx4 v[120:123], v8, s[60:63], s31 offen offset:0 sc1
    ds_read_b64_tr_b16 a[200:201], v114 offset:45056
    ds_read_b64_tr_b16 a[202:203], v114 offset:47104
    v_mul_f32 v34, v82, v34
    v_mfma_f32_16x16x32_bf16 v[200:203], a[228:231], a[24:27], v[200:203]
    v_exp_f32 v38, v86
    v_mfma_f32_16x16x32_bf16 v[200:203], a[232:235], a[32:35], v[200:203]
    ds_read_b64_tr_b16 a[204:205], v115 offset:36864
    v_add_f32 v37, 1.0, v37
    v_mfma_f32_16x16x32_bf16 v[208:211], a[232:235], a[36:39], v[208:211]
    s_add_u32 m0, s8, 0xc00
    ds_read_b64_tr_b16 a[206:207], v115 offset:38912
    buffer_load_dwordx4 v28, s[56:59], s9 offen offset:0 lds
    v_mfma_f32_16x16x32_bf16 v[208:211], a[228:231], a[28:31], v[208:211]
    ds_read_b64_tr_b16 a[208:209], v115 offset:40960
    v_mul_f32 v35, v83, v35
    v_cvt_pk_bf16_f32 v125, v34, v35
    v_mfma_f32_16x16x32_bf16 v[208:211], a[224:227], a[20:23], v[208:211]
    ds_read_b64_tr_b16 a[210:211], v115 offset:43008
    buffer_load_dwordx4 a[140:143], v8, s[60:63], s24 offen offset:1024 sc1
    v_mfma_f32_16x16x32_bf16 v[204:207], a[236:239], a[16:19], v[204:207]
    s_waitcnt lgkmcnt(4)
    ds_read_b64_tr_b16 a[212:213], v115 offset:45056
    v_exp_f32 v39, v87
    v_mfma_f32_16x16x32_bf16 v[204:207], a[240:243], a[24:27], v[204:207]
    ds_read_b64_tr_b16 a[214:215], v115 offset:47104
    v_add_f32 v38, 1.0, v38
    v_mfma_f32_16x16x32_bf16 v[204:207], a[244:247], a[32:35], v[204:207]
    ds_read_b64_tr_b16 a[216:217], v116 offset:0
    v_rcp_f32 v36, v36
    v_mfma_f32_16x16x32_bf16 v[212:215], a[244:247], a[36:39], v[212:215]
    ds_read_b64_tr_b16 a[218:219], v116 offset:2048
    buffer_load_dwordx4 a[144:147], v8, s[60:63], s24 offen offset:2048 sc1
    v_mfma_f32_16x16x32_bf16 v[212:215], a[240:243], a[28:31], v[212:215]
    ds_read_b64_tr_b16 a[220:221], v116 offset:4096
    v_add_f32 v39, 1.0, v39
    v_rcp_f32 v37, v37
    v_mfma_f32_16x16x32_bf16 v[212:215], a[236:239], a[20:23], v[212:215]
    ds_read_b64_tr_b16 a[222:223], v116 offset:6144
    buffer_load_dwordx4 v29, s[56:59], s9 offen offset:1024 lds
    v_mfma_f32_16x16x32_bf16 v[216:219], a[248:251], a[16:19], v[216:219]
    v_rcp_f32 v38, v38
    v_mfma_f32_16x16x32_bf16 v[216:219], a[252:255], a[24:27], v[216:219]
    ds_read_b64_tr_b16 a[224:225], v116 offset:8192
    ds_read_b64_tr_b16 a[226:227], v116 offset:10240
    v_mfma_f32_16x16x32_bf16 v[216:219], a[200:203], a[32:35], v[216:219]
    s_waitcnt lgkmcnt(4)
    ds_read_b64_tr_b16 a[228:229], v117 offset:0
    v_rcp_f32 v39, v39
    v_mfma_f32_16x16x32_bf16 v[224:227], a[200:203], a[36:39], v[224:227]
    ds_read_b64_tr_b16 a[230:231], v117 offset:2048
    v_exp_f32 v32, v88
    v_mfma_f32_16x16x32_bf16 v[224:227], a[252:255], a[28:31], v[224:227]
    ds_read_b64_tr_b16 a[232:233], v117 offset:4096
    v_mul_f32 v36, v84, v36
    v_mul_f32 v37, v85, v37
    v_mfma_f32_16x16x32_bf16 v[224:227], a[248:251], a[20:23], v[224:227]
L_pf9:
    s_cbranch_execz L_rf9
    ds_read_b64_tr_b16 a[234:235], v117 offset:6144
    buffer_load_dwordx4 a[148:151], v8, s[60:63], s24 offen offset:3072 sc1
    v_mfma_f32_16x16x32_bf16 v[220:223], a[204:207], a[16:19], v[220:223]
    ds_read_b64_tr_b16 a[236:237], v117 offset:8192
    v_exp_f32 v33, v89
    v_mfma_f32_16x16x32_bf16 v[220:223], a[208:211], a[24:27], v[220:223]
    ds_read_b64_tr_b16 a[238:239], v117 offset:10240
    buffer_load_dwordx4 v30, s[56:59], s9 offen offset:2048 lds
    v_mfma_f32_16x16x32_bf16 v[220:223], a[212:215], a[32:35], v[220:223]
    ds_read_b64_tr_b16 a[240:241], v19 offset:0
    v_add_f32 v32, 1.0, v32
    v_mfma_f32_16x16x32_bf16 v[228:231], a[212:215], a[36:39], v[228:231]
    ds_read_b64_tr_b16 a[242:243], v19 offset:2048
    v_cvt_pk_bf16_f32 v126, v36, v37
    v_mul_f32 v38, v86, v38
    v_mfma_f32_16x16x32_bf16 v[228:231], a[208:211], a[28:31], v[228:231]
    s_waitcnt lgkmcnt(4)
    v_exp_f32 v34, v90
    v_mfma_f32_16x16x32_bf16 v[228:231], a[204:207], a[20:23], v[228:231]
    ds_read_b64_tr_b16 a[244:245], v19 offset:4096
    ds_read_b64_tr_b16 a[246:247], v19 offset:6144
    v_mfma_f32_16x16x32_bf16 v[40:43], a[216:219], a[72:75], v[40:43]
    s_barrier
    ds_read_b64_tr_b16 a[248:249], v19 offset:8192
    v_mfma_f32_16x16x32_bf16 v[40:43], a[220:223], a[80:83], v[40:43]
    ds_read_b64_tr_b16 a[250:251], v19 offset:10240
    v_add_f32 v33, 1.0, v33
    v_mul_f32 v39, v87, v39
    v_mfma_f32_16x16x32_bf16 v[40:43], a[224:227], a[88:91], v[40:43]
    s_add_u32 s9, s20, s95
    ds_read_b64_tr_b16 a[252:253], v20 offset:0
    v_cvt_pk_bf16_f32 v127, v38, v39
    v_mfma_f32_16x16x32_bf16 v[48:51], a[224:227], a[92:95], v[48:51]
    s_add_u32 m0, s8, 0x6000
    ds_read_b64_tr_b16 a[254:255], v20 offset:2048
    buffer_load_dwordx4 v25, s[56:59], s9 offen offset:0 lds
    v_mfma_f32_16x16x32_bf16 v[48:51], a[220:223], a[84:87], v[48:51]
    ds_read_b64_tr_b16 a[200:201], v20 offset:4096
    v_exp_f32 v35, v91
    v_mfma_f32_16x16x32_bf16 v[48:51], a[216:219], a[76:79], v[48:51]
    s_add_u32 s24, s30, 8192
    ds_read_b64_tr_b16 a[202:203], v20 offset:6144
    buffer_load_dwordx4 a[152:155], v8, s[60:63], s24 offen offset:0 sc1
    v_mfma_f32_16x16x32_bf16 v[44:47], a[228:231], a[72:75], v[44:47]
    s_waitcnt lgkmcnt(4)
    ds_read_b64_tr_b16 a[204:205], v20 offset:8192
    v_add_f32 v34, 1.0, v34
    v_mfma_f32_16x16x32_bf16 v[44:47], a[232:235], a[80:83], v[44:47]
    ds_read_b64_tr_b16 a[206:207], v20 offset:10240
    v_rcp_f32 v32, v32
    v_add_f32 v35, 1.0, v35
    v_mfma_f32_16x16x32_bf16 v[44:47], a[236:239], a[88:91], v[44:47]
    ds_read_b64_tr_b16 a[208:209], v116 offset:12288
    v_rcp_f32 v33, v33
    v_mfma_f32_16x16x32_bf16 v[52:55], a[236:239], a[92:95], v[52:55]
    ds_read_b64_tr_b16 a[210:211], v116 offset:14336
    buffer_load_dwordx4 a[156:159], v8, s[60:63], s24 offen offset:1024 sc1
    v_mfma_f32_16x16x32_bf16 v[52:55], a[232:235], a[84:87], v[52:55]
    ds_read_b64_tr_b16 a[212:213], v116 offset:16384
    v_rcp_f32 v34, v34
    v_mfma_f32_16x16x32_bf16 v[52:55], a[228:231], a[76:79], v[52:55]
    ds_read_b64_tr_b16 a[214:215], v116 offset:18432
    buffer_load_dwordx4 v26, s[56:59], s9 offen offset:1024 lds
    v_mfma_f32_16x16x32_bf16 v[56:59], a[240:243], a[72:75], v[56:59]
    ds_read_b64_tr_b16 a[216:217], v116 offset:20480
    v_rcp_f32 v35, v35
    v_mfma_f32_16x16x32_bf16 v[56:59], a[244:247], a[80:83], v[56:59]
    ds_read_b64_tr_b16 a[218:219], v116 offset:22528
    v_exp_f32 v36, v92
    v_mfma_f32_16x16x32_bf16 v[56:59], a[248:251], a[88:91], v[56:59]
    s_waitcnt lgkmcnt(4)
    ds_read_b64_tr_b16 a[220:221], v117 offset:12288
    v_mul_f32 v32, v88, v32
    v_mfma_f32_16x16x32_bf16 v[64:67], a[248:251], a[92:95], v[64:67]
    ds_read_b64_tr_b16 a[222:223], v117 offset:14336
    v_mul_f32 v33, v89, v33
    v_exp_f32 v37, v93
    v_mfma_f32_16x16x32_bf16 v[64:67], a[244:247], a[84:87], v[64:67]
    v_add_f32 v36, 1.0, v36
    v_cvt_pk_bf16_f32 v128, v32, v33
    v_mfma_f32_16x16x32_bf16 v[64:67], a[240:243], a[76:79], v[64:67]
    buffer_store_dwordx4 v[124:127], v8, s[60:63], s31 offen offset:1024 sc1
    ds_read_b64_tr_b16 a[224:225], v117 offset:16384
    ds_read_b64_tr_b16 a[226:227], v117 offset:18432
    v_mfma_f32_16x16x32_bf16 v[60:63], a[252:255], a[72:75], v[60:63]
    ds_read_b64_tr_b16 a[228:229], v117 offset:20480
    v_mul_f32 v34, v90, v34
    v_mfma_f32_16x16x32_bf16 v[60:63], a[200:203], a[80:83], v[60:63]
    ds_read_b64_tr_b16 a[230:231], v117 offset:22528
    buffer_load_dwordx4 v27, s[56:59], s9 offen offset:2048 lds
    v_mfma_f32_16x16x32_bf16 v[60:63], a[204:207], a[88:91], v[60:63]
    ds_read_b64_tr_b16 a[232:233], v19 offset:12288
    v_exp_f32 v38, v94
    v_mfma_f32_16x16x32_bf16 v[68:71], a[204:207], a[92:95], v[68:71]
    ds_read_b64_tr_b16 a[234:235], v19 offset:14336
    buffer_load_dword v12, v9, s[60:63], 0 offen offset:128 sc1
    v_mfma_f32_16x16x32_bf16 v[68:71], a[200:203], a[84:87], v[68:71]
    s_waitcnt vmcnt(26) lgkmcnt(4)
    ds_read_b64_tr_b16 a[236:237], v19 offset:16384
    v_add_f32 v37, 1.0, v37
    v_mfma_f32_16x16x32_bf16 v[68:71], a[252:255], a[76:79], v[68:71]
    s_mul_i32 s12, s46, 294912
    s_xor_b32 s13, s27, 1
    ds_read_b64_tr_b16 a[238:239], v19 offset:18432
    v_mul_f32 v35, v91, v35
    v_cvt_pk_bf16_f32 v129, v34, v35
    v_mfma_f32_16x16x32_bf16 v[40:43], a[208:211], a[96:99], v[40:43]
    ds_read_b64_tr_b16 a[240:241], v19 offset:20480
    v_exp_f32 v39, v95
    v_add_f32 v38, 1.0, v38
    v_mfma_f32_16x16x32_bf16 v[40:43], a[212:215], a[104:107], v[40:43]
    ds_read_b64_tr_b16 a[242:243], v19 offset:22528
    buffer_load_dwordx4 a[160:163], v8, s[60:63], s24 offen offset:2048 sc1
    v_mfma_f32_16x16x32_bf16 v[40:43], a[216:219], a[112:115], v[40:43]
    ds_read_b64_tr_b16 a[244:245], v20 offset:12288
    v_rcp_f32 v36, v36
    v_mfma_f32_16x16x32_bf16 v[48:51], a[216:219], a[116:119], v[48:51]
    s_add_u32 m0, s8, 0x6c00
    ds_read_b64_tr_b16 a[246:247], v20 offset:14336
    buffer_load_dwordx4 v28, s[56:59], s9 offen offset:0 lds
    v_mfma_f32_16x16x32_bf16 v[48:51], a[212:215], a[108:111], v[48:51]
    ds_read_b64_tr_b16 a[248:249], v20 offset:16384
    v_add_f32 v39, 1.0, v39
    v_mfma_f32_16x16x32_bf16 v[48:51], a[208:211], a[100:103], v[48:51]
    ds_read_b64_tr_b16 a[250:251], v20 offset:18432
    buffer_load_dwordx4 a[164:167], v8, s[60:63], s24 offen offset:3072 sc1
    v_mfma_f32_16x16x32_bf16 v[44:47], a[220:223], a[96:99], v[44:47]
    s_waitcnt lgkmcnt(4)
    ds_read_b64_tr_b16 a[252:253], v20 offset:20480
    v_rcp_f32 v37, v37
    v_mfma_f32_16x16x32_bf16 v[44:47], a[224:227], a[104:107], v[44:47]
    s_lshl_b32 s13, s13, 11
    s_add_u32 s12, s12, s13
    ds_read_b64_tr_b16 a[254:255], v20 offset:22528
    v_rcp_f32 v38, v38
    v_mfma_f32_16x16x32_bf16 v[44:47], a[228:231], a[112:115], v[44:47]
    ds_read_b64_tr_b16 a[200:201], v116 offset:24576
    v_rcp_f32 v39, v39
    v_mfma_f32_16x16x32_bf16 v[52:55], a[228:231], a[116:119], v[52:55]
    ds_read_b64_tr_b16 a[202:203], v116 offset:26624
    v_exp_f32 v32, v96
    v_mfma_f32_16x16x32_bf16 v[52:55], a[224:227], a[108:111], v[52:55]
    ds_read_b64_tr_b16 a[204:205], v116 offset:28672
    v_mul_f32 v36, v92, v36
    v_mfma_f32_16x16x32_bf16 v[52:55], a[220:223], a[100:103], v[52:55]
    ds_read_b64_tr_b16 a[206:207], v116 offset:30720
    buffer_load_dwordx4 v29, s[56:59], s9 offen offset:1024 lds
    v_mfma_f32_16x16x32_bf16 v[56:59], a[232:235], a[96:99], v[56:59]
    ds_read_b64_tr_b16 a[208:209], v116 offset:32768
    v_mul_f32 v37, v93, v37
    v_mfma_f32_16x16x32_bf16 v[56:59], a[236:239], a[104:107], v[56:59]
    ds_read_b64_tr_b16 a[210:211], v116 offset:34816
    v_exp_f32 v33, v97
    v_add_f32 v32, 1.0, v32
    v_mfma_f32_16x16x32_bf16 v[56:59], a[240:243], a[112:115], v[56:59]
    s_waitcnt lgkmcnt(4)
    ds_read_b64_tr_b16 a[212:213], v117 offset:24576
    v_cvt_pk_bf16_f32 v130, v36, v37
    v_mfma_f32_16x16x32_bf16 v[64:67], a[240:243], a[116:119], v[64:67]
    s_lshl_b32 s13, s6, 12
    s_mul_i32 s11, s23, 32768
    ds_read_b64_tr_b16 a[214:215], v117 offset:26624
    v_mul_f32 v38, v94, v38
    v_exp_f32 v34, v98
    v_mfma_f32_16x16x32_bf16 v[64:67], a[236:239], a[108:111], v[64:67]
    ds_read_b64_tr_b16 a[216:217], v117 offset:28672
    v_add_f32 v33, 1.0, v33
    v_mfma_f32_16x16x32_bf16 v[64:67], a[232:235], a[100:103], v[64:67]
    ds_read_b64_tr_b16 a[218:219], v117 offset:30720
    v_mul_f32 v39, v95, v39
    v_cvt_pk_bf16_f32 v131, v38, v39
    v_lshl_add_u32 v1, v0, 4, s12
    v_add_u32 v118, s13, v1
    v_mfma_f32_16x16x32_bf16 v[60:63], a[244:247], a[96:99], v[60:63]
    ds_read_b64_tr_b16 a[220:221], v117 offset:32768
    v_exp_f32 v35, v99
    v_mfma_f32_16x16x32_bf16 v[60:63], a[248:251], a[104:107], v[60:63]
    ds_read_b64_tr_b16 a[222:223], v117 offset:34816
    buffer_load_dwordx4 v30, s[56:59], s9 offen offset:2048 lds
    v_mfma_f32_16x16x32_bf16 v[60:63], a[252:255], a[112:115], v[60:63]
    ds_read_b64_tr_b16 a[224:225], v19 offset:24576
    v_add_f32 v34, 1.0, v34
    v_mfma_f32_16x16x32_bf16 v[68:71], a[252:255], a[116:119], v[68:71]
    ds_read_b64_tr_b16 a[226:227], v19 offset:26624
    v_rcp_f32 v32, v32
    v_add_f32 v35, 1.0, v35
    v_xor_b32 v119, 0x800, v118
    v_mfma_f32_16x16x32_bf16 v[68:71], a[248:251], a[108:111], v[68:71]
    s_waitcnt lgkmcnt(4)
    ds_read_b64_tr_b16 a[228:229], v19 offset:28672
    v_rcp_f32 v33, v33
    v_mfma_f32_16x16x32_bf16 v[68:71], a[244:247], a[100:103], v[68:71]
    ds_read_b64_tr_b16 a[230:231], v19 offset:30720
    v_rcp_f32 v34, v34
    v_mfma_f32_16x16x32_bf16 v[200:203], a[200:203], a[72:75], v[200:203]
    s_barrier
    ds_read_b64_tr_b16 a[232:233], v19 offset:32768
    v_mfma_f32_16x16x32_bf16 v[200:203], a[204:207], a[80:83], v[200:203]
    ds_read_b64_tr_b16 a[234:235], v19 offset:34816
    v_rcp_f32 v35, v35
    v_xor_b32 v1, 0x800, v1
    v_mfma_f32_16x16x32_bf16 v[200:203], a[208:211], a[88:91], v[200:203]
    s_add_u32 s9, s19, s94
    ds_read_b64_tr_b16 a[236:237], v20 offset:24576
    v_add_u32 v16, s11, v1
    v_mfma_f32_16x16x32_bf16 v[208:211], a[208:211], a[92:95], v[208:211]
    s_add_u32 s9, s9, 221184
    s_add_u32 m0, s8, 0xc000
    ds_read_b64_tr_b16 a[238:239], v20 offset:26624
    buffer_load_dwordx4 v25, s[56:59], s9 offen offset:0 lds
    v_mfma_f32_16x16x32_bf16 v[208:211], a[204:207], a[84:87], v[208:211]
    ds_read_b64_tr_b16 a[240:241], v20 offset:28672
    v_exp_f32 v36, v100
    v_mfma_f32_16x16x32_bf16 v[208:211], a[200:203], a[76:79], v[208:211]
    ds_read_b64_tr_b16 a[242:243], v20 offset:30720
    v_mul_f32 v32, v96, v32
    v_mul_f32 v33, v97, v33
    v_add_u32 v17, 0x1000, v16
    v_mfma_f32_16x16x32_bf16 v[204:207], a[212:215], a[72:75], v[204:207]
    s_waitcnt lgkmcnt(4)
    ds_read_b64_tr_b16 a[244:245], v20 offset:32768
    v_exp_f32 v37, v101
    v_mfma_f32_16x16x32_bf16 v[204:207], a[216:219], a[80:83], v[204:207]
    s_lshl_b32 s12, s3, 8
    s_add_u32 s12, s12, 0x24000
    ds_read_b64_tr_b16 a[246:247], v20 offset:34816
    v_add_f32 v36, 1.0, v36
    v_mfma_f32_16x16x32_bf16 v[204:207], a[220:223], a[88:91], v[204:207]
    ds_read_b64_tr_b16 a[248:249], v116 offset:36864
    v_cvt_pk_bf16_f32 v132, v32, v33
    v_mfma_f32_16x16x32_bf16 v[212:215], a[220:223], a[92:95], v[212:215]
    ds_read_b64_tr_b16 a[250:251], v116 offset:38912
    v_mul_f32 v34, v98, v34
    v_exp_f32 v38, v102
    v_mfma_f32_16x16x32_bf16 v[212:215], a[216:219], a[84:87], v[212:215]
    ds_read_b64_tr_b16 a[252:253], v116 offset:40960
    v_add_f32 v37, 1.0, v37
    v_mul_f32 v35, v99, v35
    v_mfma_f32_16x16x32_bf16 v[212:215], a[212:215], a[76:79], v[212:215]
    ds_read_b64_tr_b16 a[254:255], v116 offset:43008
    buffer_load_dwordx4 v26, s[56:59], s9 offen offset:1024 lds
    v_mfma_f32_16x16x32_bf16 v[216:219], a[224:227], a[72:75], v[216:219]
    buffer_store_dwordx4 v[128:131], v8, s[60:63], s31 offen offset:2048 sc1
    ds_read_b64_tr_b16 a[200:201], v116 offset:45056
    ds_read_b64_tr_b16 a[202:203], v116 offset:47104
    v_cvt_pk_bf16_f32 v133, v34, v35
    v_mfma_f32_16x16x32_bf16 v[216:219], a[228:231], a[80:83], v[216:219]
    v_exp_f32 v39, v103
    v_mfma_f32_16x16x32_bf16 v[216:219], a[232:235], a[88:91], v[216:219]
    s_waitcnt lgkmcnt(4)
    ds_read_b64_tr_b16 a[204:205], v117 offset:36864
    v_add_f32 v38, 1.0, v38
    v_mfma_f32_16x16x32_bf16 v[224:227], a[232:235], a[92:95], v[224:227]
    s_lshl_b32 s13, s46, 5
    s_lshl_b32 s11, s27, 6
    s_add_u32 s11, s11, s96
    ds_read_b64_tr_b16 a[206:207], v117 offset:38912
    v_rcp_f32 v36, v36
    v_mfma_f32_16x16x32_bf16 v[224:227], a[228:231], a[84:87], v[224:227]
    ds_read_b64_tr_b16 a[208:209], v117 offset:40960
    v_add_f32 v39, 1.0, v39
    v_mfma_f32_16x16x32_bf16 v[224:227], a[224:227], a[76:79], v[224:227]
    ds_read_b64_tr_b16 a[210:211], v117 offset:43008
    v_rcp_f32 v37, v37
    v_mfma_f32_16x16x32_bf16 v[220:223], a[236:239], a[72:75], v[220:223]
    ds_read_b64_tr_b16 a[212:213], v117 offset:45056
    v_rcp_f32 v38, v38
    v_mfma_f32_16x16x32_bf16 v[220:223], a[240:243], a[80:83], v[220:223]
    ds_read_b64_tr_b16 a[214:215], v117 offset:47104
    buffer_load_dwordx4 v27, s[56:59], s9 offen offset:2048 lds
    v_mfma_f32_16x16x32_bf16 v[220:223], a[244:247], a[88:91], v[220:223]
    ds_read_b64_tr_b16 a[216:217], v19 offset:36864
    v_rcp_f32 v39, v39
    v_mfma_f32_16x16x32_bf16 v[228:231], a[244:247], a[92:95], v[228:231]
    ds_read_b64_tr_b16 a[218:219], v19 offset:38912
    v_mul_f32 v36, v100, v36
    v_mul_f32 v37, v101, v37
    v_mfma_f32_16x16x32_bf16 v[228:231], a[240:243], a[84:87], v[228:231]
    s_waitcnt lgkmcnt(4)
    ds_read_b64_tr_b16 a[220:221], v19 offset:40960
    v_cvt_pk_bf16_f32 v134, v36, v37
    v_mfma_f32_16x16x32_bf16 v[228:231], a[236:239], a[76:79], v[228:231]
    ds_read_b64_tr_b16 a[222:223], v19 offset:43008
    v_mul_f32 v38, v102, v38
    v_mul_f32 v39, v103, v39
    v_cvt_pk_bf16_f32 v135, v38, v39
    v_mfma_f32_16x16x32_bf16 v[200:203], a[248:251], a[96:99], v[200:203]
    ds_read_b64_tr_b16 a[224:225], v19 offset:45056
    v_lshrrev_b32 v1, 3, v0
    v_mfma_f32_16x16x32_bf16 v[200:203], a[252:255], a[104:107], v[200:203]
    ds_read_b64_tr_b16 a[226:227], v19 offset:47104
    v_lshl_add_u32 v233, v1, 3, s12
    v_mfma_f32_16x16x32_bf16 v[200:203], a[200:203], a[112:115], v[200:203]
    s_add_u32 m0, s8, 0xcc00
    ds_read_b64_tr_b16 a[228:229], v20 offset:36864
    ds_read_b64_tr_b16 a[230:231], v20 offset:38912
    v_mfma_f32_16x16x32_bf16 v[208:211], a[200:203], a[116:119], v[208:211]
    buffer_load_dwordx4 v28, s[56:59], s9 offen offset:0 lds
    v_mfma_f32_16x16x32_bf16 v[208:211], a[252:255], a[108:111], v[208:211]
    v_mfma_f32_16x16x32_bf16 v[208:211], a[248:251], a[100:103], v[208:211]
    buffer_store_dwordx4 v[132:135], v8, s[60:63], s31 offen offset:3072 sc1
    ds_read_b64_tr_b16 a[232:233], v20 offset:40960
    ds_read_b64_tr_b16 a[234:235], v20 offset:43008
    v_mfma_f32_16x16x32_bf16 v[204:207], a[204:207], a[96:99], v[204:207]
    s_waitcnt lgkmcnt(4)
    ds_read_b64_tr_b16 a[236:237], v20 offset:45056
    v_and_b32 v2, 7, v0
    v_mfma_f32_16x16x32_bf16 v[204:207], a[208:211], a[104:107], v[204:207]
    ds_read_b64_tr_b16 a[238:239], v20 offset:47104
    v_lshl_add_u32 v236, v2, 3, s11
    v_mfma_f32_16x16x32_bf16 v[204:207], a[212:215], a[112:115], v[204:207]
    ds_read_b64_tr_b16 a[240:241], v21 offset:0
    v_mfma_f32_16x16x32_bf16 v[212:215], a[212:215], a[116:119], v[212:215]
    ds_read_b64_tr_b16 a[242:243], v21 offset:2048
    v_add_u32 v1, s13, v1
    v_mfma_f32_16x16x32_bf16 v[212:215], a[208:211], a[108:111], v[212:215]
    ds_read_b64_tr_b16 a[244:245], v21 offset:4096
    ds_read_b64_tr_b16 a[246:247], v21 offset:6144
    v_mfma_f32_16x16x32_bf16 v[212:215], a[204:207], a[100:103], v[212:215]
    buffer_load_dwordx4 v29, s[56:59], s9 offen offset:1024 lds
    v_mfma_f32_16x16x32_bf16 v[216:219], a[216:219], a[96:99], v[216:219]
    ds_read_b64_tr_b16 a[248:249], v21 offset:8192
    v_mul_u32_u24 v1, 1152, v1
    v_mfma_f32_16x16x32_bf16 v[216:219], a[220:223], a[104:107], v[216:219]
    ds_read_b64_tr_b16 a[250:251], v21 offset:10240
    v_add_u32 v235, v1, v236
    v_mfma_f32_16x16x32_bf16 v[216:219], a[224:227], a[112:115], v[216:219]
    s_waitcnt lgkmcnt(4)
    ds_read_b64_tr_b16 a[252:253], v22 offset:0
    v_lshlrev_b32 v234, 1, v235
    v_mfma_f32_16x16x32_bf16 v[224:227], a[224:227], a[116:119], v[224:227]
    ds_read_b64_tr_b16 a[254:255], v22 offset:2048
    v_lshl_add_u32 v236, v2, 3, s12
    v_mfma_f32_16x16x32_bf16 v[224:227], a[220:223], a[108:111], v[224:227]
    ds_read_b64_tr_b16 a[200:201], v22 offset:4096
    v_mfma_f32_16x16x32_bf16 v[224:227], a[216:219], a[100:103], v[224:227]
    ds_read_b64_tr_b16 a[202:203], v22 offset:6144
    v_add_u32 v236, 0x2400, v236
    v_mfma_f32_16x16x32_bf16 v[220:223], a[228:231], a[96:99], v[220:223]
    ds_read_b64_tr_b16 a[204:205], v22 offset:8192
    ds_read_b64_tr_b16 a[206:207], v22 offset:10240
    v_mfma_f32_16x16x32_bf16 v[220:223], a[232:235], a[104:107], v[220:223]
    buffer_load_dwordx4 v30, s[56:59], s9 offen offset:2048 lds
    v_mfma_f32_16x16x32_bf16 v[220:223], a[236:239], a[112:115], v[220:223]
    ds_read_b64_tr_b16 a[208:209], v23 offset:0
    v_mov_b32 v1, s3
    v_mfma_f32_16x16x32_bf16 v[228:231], a[236:239], a[116:119], v[228:231]
    ds_read_b64_tr_b16 a[210:211], v23 offset:2048
    v_lshlrev_b32 v1, 11, v1
    v_mfma_f32_16x16x32_bf16 v[228:231], a[232:235], a[108:111], v[228:231]
    s_waitcnt vmcnt(34) lgkmcnt(4)
    ds_read_b64_tr_b16 a[212:213], v23 offset:4096
    v_mfma_f32_16x16x32_bf16 v[228:231], a[228:231], a[100:103], v[228:231]
    ds_read_b64_tr_b16 a[214:215], v23 offset:6144
    v_lshl_add_u32 v1, v0, 3, v1
    v_mfma_f32_16x16x32_bf16 v[40:43], a[240:243], a[40:43], v[40:43]
    s_barrier
    v_mfma_f32_16x16x32_bf16 v[40:43], a[244:247], a[48:51], v[40:43]
    ds_read_b64_tr_b16 a[216:217], v23 offset:8192
    ds_read_b64_tr_b16 a[218:219], v23 offset:10240
    v_mfma_f32_16x16x32_bf16 v[40:43], a[248:251], a[56:59], v[40:43]
    s_add_u32 s9, s20, s94
    s_add_u32 s9, s9, 221184
    ds_read_b64_tr_b16 a[220:221], v24 offset:0
    v_mfma_f32_16x16x32_bf16 v[48:51], a[248:251], a[60:63], v[48:51]
    s_add_u32 m0, s8, 0x12000
    ds_read_b64_tr_b16 a[222:223], v24 offset:2048
    buffer_load_dwordx4 v25, s[56:59], s9 offen offset:0 lds
    v_mfma_f32_16x16x32_bf16 v[48:51], a[244:247], a[52:55], v[48:51]
    s_waitcnt vmcnt(14)
    ds_read_b64_tr_b16 a[224:225], v24 offset:4096
    v_cmp_eq_u32 vcc, 0, v12
    v_mfma_f32_16x16x32_bf16 v[48:51], a[240:243], a[44:47], v[48:51]
    ds_read_b64_tr_b16 a[226:227], v24 offset:6144
    v_add_u32 v235, 0x24400, v1
    v_mfma_f32_16x16x32_bf16 v[44:47], a[252:255], a[40:43], v[44:47]
    s_cbranch_vccnz L_fh1_spin
L_fh1_ret:
    s_waitcnt lgkmcnt(4)
    ds_read_b64_tr_b16 a[228:229], v24 offset:8192
    v_mfma_f32_16x16x32_bf16 v[44:47], a[200:203], a[48:51], v[44:47]
    ds_read_b64_tr_b16 a[230:231], v24 offset:10240
    v_mfma_f32_16x16x32_bf16 v[44:47], a[204:207], a[56:59], v[44:47]
    ds_read_b64 v[72:73], v233 offset:0
    ds_read_b64_tr_b16 a[232:233], v21 offset:12288
    v_mfma_f32_16x16x32_bf16 v[52:55], a[204:207], a[60:63], v[52:55]
    s_add_u32 s14, s29, 12288
    ds_read_b64_tr_b16 a[234:235], v21 offset:14336
    buffer_load_dwordx4 a[168:171], v8, s[60:63], s14 offen offset:0 sc1
    v_mfma_f32_16x16x32_bf16 v[52:55], a[200:203], a[52:55], v[52:55]
    ds_read_b64_tr_b16 a[236:237], v21 offset:16384
    ds_read_b64_tr_b16 a[238:239], v21 offset:18432
    v_mfma_f32_16x16x32_bf16 v[52:55], a[252:255], a[44:47], v[52:55]
    buffer_load_dwordx4 v26, s[56:59], s9 offen offset:1024 lds
    v_mfma_f32_16x16x32_bf16 v[56:59], a[208:211], a[40:43], v[56:59]
    ds_read_b64 v[74:75], v233 offset:64
    v_mfma_f32_16x16x32_bf16 v[56:59], a[212:215], a[48:51], v[56:59]
    ds_read_b64_tr_b16 a[240:241], v21 offset:20480
    ds_read_b64_tr_b16 a[242:243], v21 offset:22528
    v_mfma_f32_16x16x32_bf16 v[56:59], a[216:219], a[56:59], v[56:59]
    s_waitcnt lgkmcnt(5)
    ds_read_b64_tr_b16 a[244:245], v22 offset:12288
    v_mfma_f32_16x16x32_bf16 v[64:67], a[216:219], a[60:63], v[64:67]
    ds_read_b64_tr_b16 a[246:247], v22 offset:14336
    v_mfma_f32_16x16x32_bf16 v[64:67], a[212:215], a[52:55], v[64:67]
    ds_read_b64 v[76:77], v233 offset:128
    v_mfma_f32_16x16x32_bf16 v[64:67], a[208:211], a[44:47], v[64:67]
    ds_read_b64_tr_b16 a[248:249], v22 offset:16384
    ds_read_b64_tr_b16 a[250:251], v22 offset:18432
    v_mfma_f32_16x16x32_bf16 v[60:63], a[220:223], a[40:43], v[60:63]
    ds_read_b64_tr_b16 a[252:253], v22 offset:20480
    ds_read_b64_tr_b16 a[254:255], v22 offset:22528
    v_mfma_f32_16x16x32_bf16 v[60:63], a[224:227], a[48:51], v[60:63]
    buffer_load_dwordx4 v27, s[56:59], s9 offen offset:2048 lds
    v_mfma_f32_16x16x32_bf16 v[60:63], a[228:231], a[56:59], v[60:63]
    ds_read_b64 v[78:79], v233 offset:192
    v_and_b32 v1, 1, v0
    v_mfma_f32_16x16x32_bf16 v[68:71], a[228:231], a[60:63], v[68:71]
    ds_read_b64_tr_b16 a[200:201], v23 offset:12288
    ds_read_b64_tr_b16 a[202:203], v23 offset:14336
    v_mfma_f32_16x16x32_bf16 v[68:71], a[224:227], a[52:55], v[68:71]
    s_waitcnt lgkmcnt(5)
    ds_read_b64_tr_b16 a[204:205], v23 offset:16384
    v_mfma_f32_16x16x32_bf16 v[68:71], a[220:223], a[44:47], v[68:71]
    ds_read_b64_tr_b16 a[206:207], v23 offset:18432
    v_mul_u32_u24 v2, 1152, v1
    v_mfma_f32_16x16x32_bf16 v[40:43], a[232:235], a[64:67], v[40:43]
    ds_read_b64 v[240:241], v235 offset:0
    ds_read_b64_tr_b16 a[208:209], v23 offset:20480
    v_mfma_f32_16x16x32_bf16 v[40:43], a[236:239], v[120:123], v[40:43]
    ds_read_b64_tr_b16 a[210:211], v23 offset:22528
    buffer_load_dwordx4 a[172:175], v8, s[60:63], s14 offen offset:1024 sc1
    v_mfma_f32_16x16x32_bf16 v[40:43], a[240:243], v[128:131], v[40:43]
    s_add_u32 m0, s8, 0x12c00
    ds_read_b64_tr_b16 a[212:213], v24 offset:12288
    ds_read_b64_tr_b16 a[214:215], v24 offset:14336
    v_mfma_f32_16x16x32_bf16 v[48:51], a[240:243], v[132:135], v[48:51]
    buffer_load_dwordx4 v28, s[56:59], s9 offen offset:0 lds
    v_mfma_f32_16x16x32_bf16 v[48:51], a[236:239], v[124:127], v[48:51]
    ds_read_b64 v[242:243], v235 offset:512
    v_add_u32 v13, s38, v2
    v_mfma_f32_16x16x32_bf16 v[48:51], a[232:235], a[68:71], v[48:51]
    ds_read_b64_tr_b16 a[216:217], v24 offset:16384
    ds_read_b64_tr_b16 a[218:219], v24 offset:18432
    v_mfma_f32_16x16x32_bf16 v[44:47], a[244:247], a[64:67], v[44:47]
    s_waitcnt lgkmcnt(5)
    ds_read_b64_tr_b16 a[220:221], v24 offset:20480
    v_mfma_f32_16x16x32_bf16 v[44:47], a[248:251], v[120:123], v[44:47]
    ds_read_b64_tr_b16 a[222:223], v24 offset:22528
    v_add_u32 v15, s39, v2
    v_mfma_f32_16x16x32_bf16 v[44:47], a[252:255], v[128:131], v[44:47]
    ds_read_b64 v[244:245], v235 offset:1024
    v_and_b32 v1, 3, v0
    v_mfma_f32_16x16x32_bf16 v[52:55], a[252:255], v[132:135], v[52:55]
    ds_read_b64_tr_b16 a[224:225], v21 offset:24576
    ds_read_b64_tr_b16 a[226:227], v21 offset:26624
    v_mfma_f32_16x16x32_bf16 v[52:55], a[248:251], v[124:127], v[52:55]
    ds_read_b64_tr_b16 a[228:229], v21 offset:28672
    ds_read_b64_tr_b16 a[230:231], v21 offset:30720
    v_mfma_f32_16x16x32_bf16 v[52:55], a[244:247], a[68:71], v[52:55]
    buffer_load_dwordx4 v29, s[56:59], s9 offen offset:1024 lds
    v_mfma_f32_16x16x32_bf16 v[56:59], a[200:203], a[64:67], v[56:59]
    ds_read_b64 v[246:247], v235 offset:1536
    v_mfma_f32_16x16x32_bf16 v[56:59], a[204:207], v[120:123], v[56:59]
    ds_read_b64_tr_b16 a[232:233], v21 offset:32768
    ds_read_b64_tr_b16 a[234:235], v21 offset:34816
    v_mfma_f32_16x16x32_bf16 v[56:59], a[208:211], v[128:131], v[56:59]
    s_waitcnt lgkmcnt(5)
    ds_read_b64_tr_b16 a[236:237], v22 offset:24576
    v_mul_u32_u24 v1, 3456, v1
    v_mfma_f32_16x16x32_bf16 v[64:67], a[208:211], v[132:135], v[64:67]
    ds_read_b64_tr_b16 a[238:239], v22 offset:26624
    v_add_u32 v14, s47, v1
    v_mfma_f32_16x16x32_bf16 v[64:67], a[204:207], v[124:127], v[64:67]
    s_waitcnt vmcnt(9)
    buffer_store_dword v7, v7, s[60:63], 0 offen offset:384 sc1
    ds_read_b64 v[248:249], v236
    ds_read_b64_tr_b16 a[240:241], v22 offset:28672
    v_mfma_f32_16x16x32_bf16 v[64:67], a[200:203], a[68:71], v[64:67]
    ds_read_b64_tr_b16 a[242:243], v22 offset:30720
    v_mfma_f32_16x16x32_bf16 v[60:63], a[212:215], a[64:67], v[60:63]
    ds_read_b64_tr_b16 a[244:245], v22 offset:32768
    ds_read_b64_tr_b16 a[246:247], v22 offset:34816
    v_mfma_f32_16x16x32_bf16 v[60:63], a[216:219], v[120:123], v[60:63]
    buffer_load_dwordx4 v30, s[56:59], s9 offen offset:2048 lds
    v_mfma_f32_16x16x32_bf16 v[60:63], a[220:223], v[128:131], v[60:63]
    ds_read_b64_tr_b16 a[248:249], v23 offset:24576
    ds_read_b64_tr_b16 a[250:251], v23 offset:26624
    v_mfma_f32_16x16x32_bf16 v[68:71], a[220:223], v[132:135], v[68:71]
    buffer_load_dwordx4 a[176:179], v8, s[60:63], s14 offen offset:2048 sc1
    v_mfma_f32_16x16x32_bf16 v[68:71], a[216:219], v[124:127], v[68:71]
    s_waitcnt lgkmcnt(4)
    ds_read_b64_tr_b16 a[252:253], v23 offset:28672
    v_mfma_f32_16x16x32_bf16 v[68:71], a[212:215], a[68:71], v[68:71]
    ds_read_b64_tr_b16 a[254:255], v23 offset:30720
    v_mfma_f32_16x16x32_bf16 v[200:203], a[224:227], a[40:43], v[200:203]
    s_barrier
    v_mfma_f32_16x16x32_bf16 v[200:203], a[228:231], a[48:51], v[200:203]
    ds_read_b64_tr_b16 a[200:201], v23 offset:32768
    ds_read_b64_tr_b16 a[202:203], v23 offset:34816
    v_mfma_f32_16x16x32_bf16 v[200:203], a[232:235], a[56:59], v[200:203]
    s_add_u32 s9, s19, s95
    s_add_u32 s9, s9, 221184
    ds_read_b64_tr_b16 a[204:205], v24 offset:24576
    v_mfma_f32_16x16x32_bf16 v[208:211], a[232:235], a[60:63], v[208:211]
    s_add_u32 m0, s8, 0x18000
    ds_read_b64_tr_b16 a[206:207], v24 offset:26624
    buffer_load_dwordx4 v25, s[56:59], s9 offen offset:0 lds
    v_mfma_f32_16x16x32_bf16 v[208:211], a[228:231], a[52:55], v[208:211]
    ds_read_b64_tr_b16 a[208:209], v24 offset:28672
    v_mfma_f32_16x16x32_bf16 v[208:211], a[224:227], a[44:47], v[208:211]
    ds_read_b64_tr_b16 a[210:211], v24 offset:30720
    v_mfma_f32_16x16x32_bf16 v[204:207], a[236:239], a[40:43], v[204:207]
    s_waitcnt lgkmcnt(4)
    ds_read_b64_tr_b16 a[212:213], v24 offset:32768
    v_mfma_f32_16x16x32_bf16 v[204:207], a[240:243], a[48:51], v[204:207]
    ds_read_b64_tr_b16 a[214:215], v24 offset:34816
    v_mfma_f32_16x16x32_bf16 v[204:207], a[244:247], a[56:59], v[204:207]
    ds_read_b64_tr_b16 a[216:217], v21 offset:36864
    ds_read_b64_tr_b16 a[218:219], v21 offset:38912
    v_mfma_f32_16x16x32_bf16 v[212:215], a[244:247], a[60:63], v[212:215]
    buffer_load_dwordx4 a[180:183], v8, s[60:63], s14 offen offset:3072 sc1
    v_mfma_f32_16x16x32_bf16 v[212:215], a[240:243], a[52:55], v[212:215]
    ds_read_b64_tr_b16 a[220:221], v21 offset:40960
    ds_read_b64_tr_b16 a[222:223], v21 offset:43008
    v_mfma_f32_16x16x32_bf16 v[212:215], a[236:239], a[44:47], v[212:215]
    buffer_load_dwordx4 v26, s[56:59], s9 offen offset:1024 lds
    v_mfma_f32_16x16x32_bf16 v[216:219], a[248:251], a[40:43], v[216:219]
    ds_read_b64_tr_b16 a[224:225], v21 offset:45056
    v_mfma_f32_16x16x32_bf16 v[216:219], a[252:255], a[48:51], v[216:219]
    ds_read_b64_tr_b16 a[226:227], v21 offset:47104
    v_lshlrev_b32 v252, 16, v249
    v_mfma_f32_16x16x32_bf16 v[216:219], a[200:203], a[56:59], v[216:219]
    s_waitcnt lgkmcnt(4)
    ds_read_b64_tr_b16 a[228:229], v22 offset:36864
    v_mfma_f32_16x16x32_bf16 v[224:227], a[200:203], a[60:63], v[224:227]
    ds_read_b64_tr_b16 a[230:231], v22 offset:38912
    v_and_b32 v253, s15, v249
    v_mfma_f32_16x16x32_bf16 v[224:227], a[252:255], a[52:55], v[224:227]
    ds_read_b64_tr_b16 a[232:233], v22 offset:40960
    ds_read_b64_tr_b16 a[234:235], v22 offset:43008
    v_mfma_f32_16x16x32_bf16 v[224:227], a[248:251], a[44:47], v[224:227]
    s_add_u32 s24, s30, 12288
    buffer_load_dwordx4 a[184:187], v8, s[60:63], s24 offen offset:0 sc1
    v_mfma_f32_16x16x32_bf16 v[220:223], a[204:207], a[40:43], v[220:223]
    ds_read_b64_tr_b16 a[236:237], v22 offset:45056
    ds_read_b64_tr_b16 a[238:239], v22 offset:47104
    v_mfma_f32_16x16x32_bf16 v[220:223], a[208:211], a[48:51], v[220:223]
    buffer_load_dwordx4 v27, s[56:59], s9 offen offset:2048 lds
    v_mfma_f32_16x16x32_bf16 v[220:223], a[212:215], a[56:59], v[220:223]
    ds_read_b64_tr_b16 a[240:241], v23 offset:36864
    v_mfma_f32_16x16x32_bf16 v[228:231], a[212:215], a[60:63], v[228:231]
    ds_read_b64_tr_b16 a[242:243], v23 offset:38912
    v_lshlrev_b32 v250, 16, v248
    v_mfma_f32_16x16x32_bf16 v[228:231], a[208:211], a[52:55], v[228:231]
    s_waitcnt lgkmcnt(4)
    ds_read_b64_tr_b16 a[244:245], v23 offset:40960
    v_and_b32 v251, s15, v248
    v_mfma_f32_16x16x32_bf16 v[228:231], a[204:207], a[44:47], v[228:231]
    ds_read_b64_tr_b16 a[246:247], v23 offset:43008
    v_lshlrev_b32 v88, 16, v240
    v_mfma_f32_16x16x32_bf16 v[200:203], a[216:219], a[64:67], v[200:203]
    ds_read_b64_tr_b16 a[248:249], v23 offset:45056
    ds_read_b64_tr_b16 a[250:251], v23 offset:47104
    v_mfma_f32_16x16x32_bf16 v[200:203], a[220:223], v[120:123], v[200:203]
    s_add_u32 s14, s29, 16384
    buffer_load_dwordx4 v[136:139], v8, s[60:63], s14 offen offset:0 sc1
    v_mfma_f32_16x16x32_bf16 v[200:203], a[224:227], v[128:131], v[200:203]
    s_add_u32 m0, s8, 0x18c00
    ds_read_b64_tr_b16 a[252:253], v24 offset:36864
    ds_read_b64_tr_b16 a[254:255], v24 offset:38912
    v_mfma_f32_16x16x32_bf16 v[208:211], a[224:227], v[132:135], v[208:211]
    buffer_load_dwordx4 v28, s[56:59], s9 offen offset:0 lds
    v_mfma_f32_16x16x32_bf16 v[208:211], a[220:223], v[124:127], v[208:211]
    ds_read_b64_tr_b16 a[200:201], v24 offset:40960
    v_mfma_f32_16x16x32_bf16 v[208:211], a[216:219], a[68:71], v[208:211]
L_pf13:
    s_cbranch_execz L_rf13
    ds_read_b64_tr_b16 a[202:203], v24 offset:43008
    v_and_b32 v89, s15, v240
    v_mfma_f32_16x16x32_bf16 v[204:207], a[228:231], a[64:67], v[204:207]
    s_waitcnt lgkmcnt(4)
    ds_read_b64_tr_b16 a[204:205], v24 offset:45056
    v_mfma_f32_16x16x32_bf16 v[204:207], a[232:235], v[120:123], v[204:207]
    ds_read_b64_tr_b16 a[206:207], v24 offset:47104
    v_fma_f32 v32, v88, v73, v72
    v_mfma_f32_16x16x32_bf16 v[204:207], a[236:239], v[128:131], v[204:207]
    ds_read_b64_tr_b16 a[208:209], v112 offset:0
    ds_read_b64_tr_b16 a[210:211], v112 offset:2048
    v_mfma_f32_16x16x32_bf16 v[212:215], a[236:239], v[132:135], v[212:215]
    buffer_load_dwordx4 a[188:191], v8, s[60:63], s24 offen offset:1024 sc1
    v_mfma_f32_16x16x32_bf16 v[212:215], a[232:235], v[124:127], v[212:215]
    ds_read_b64_tr_b16 a[212:213], v112 offset:4096
    ds_read_b64_tr_b16 a[214:215], v112 offset:6144
    v_mfma_f32_16x16x32_bf16 v[212:215], a[228:231], a[68:71], v[212:215]
    buffer_load_dwordx4 v29, s[56:59], s9 offen offset:1024 lds
    v_mfma_f32_16x16x32_bf16 v[216:219], a[240:243], a[64:67], v[216:219]
    ds_read_b64_tr_b16 a[216:217], v112 offset:8192
    v_mfma_f32_16x16x32_bf16 v[216:219], a[244:247], v[120:123], v[216:219]
    ds_read_b64_tr_b16 a[218:219], v112 offset:10240
    v_fma_f32 v33, v89, v73, v72
    v_mfma_f32_16x16x32_bf16 v[216:219], a[248:251], v[128:131], v[216:219]
    s_waitcnt lgkmcnt(4)
    ds_read_b64_tr_b16 a[220:221], v113 offset:0
    v_mfma_f32_16x16x32_bf16 v[224:227], a[248:251], v[132:135], v[224:227]
    ds_read_b64_tr_b16 a[222:223], v113 offset:2048
    v_fmac_f32 v88, v32, v250
    v_mfma_f32_16x16x32_bf16 v[224:227], a[244:247], v[124:127], v[224:227]
    ds_read_b64_tr_b16 a[224:225], v113 offset:4096
    ds_read_b64_tr_b16 a[226:227], v113 offset:6144
    v_mfma_f32_16x16x32_bf16 v[224:227], a[240:243], a[68:71], v[224:227]
    buffer_load_dword v12, v9, s[60:63], 0 offen offset:384 sc1
    v_mfma_f32_16x16x32_bf16 v[220:223], a[252:255], a[64:67], v[220:223]
    ds_read_b64_tr_b16 a[228:229], v113 offset:8192
    ds_read_b64_tr_b16 a[230:231], v113 offset:10240
    v_mfma_f32_16x16x32_bf16 v[220:223], a[200:203], v[120:123], v[220:223]
    buffer_load_dwordx4 v30, s[56:59], s9 offen offset:2048 lds
    v_mfma_f32_16x16x32_bf16 v[220:223], a[204:207], v[128:131], v[220:223]
    ds_read_b64_tr_b16 a[232:233], v114 offset:0
    ds_read_b64_tr_b16 a[234:235], v114 offset:2048
    v_mfma_f32_16x16x32_bf16 v[228:231], a[204:207], v[132:135], v[228:231]
    buffer_load_dwordx4 v[140:143], v8, s[60:63], s14 offen offset:1024 sc1
    v_mfma_f32_16x16x32_bf16 v[228:231], a[200:203], v[124:127], v[228:231]
    s_waitcnt lgkmcnt(4)
    ds_read_b64_tr_b16 a[236:237], v114 offset:4096
    v_mfma_f32_16x16x32_bf16 v[228:231], a[252:255], a[68:71], v[228:231]
    ds_read_b64_tr_b16 a[238:239], v114 offset:6144
    v_mfma_f32_16x16x32_bf16 v[40:43], a[208:211], a[120:123], v[40:43]
    s_barrier
    v_mfma_f32_16x16x32_bf16 v[40:43], a[212:215], a[128:131], v[40:43]
    ds_read_b64_tr_b16 a[240:241], v114 offset:8192
    ds_read_b64_tr_b16 a[242:243], v114 offset:10240
    v_mfma_f32_16x16x32_bf16 v[40:43], a[216:219], a[136:139], v[40:43]
    s_add_u32 s9, s20, s95
    s_add_u32 s9, s9, 221184
    ds_read_b64_tr_b16 a[244:245], v115 offset:0
    v_mfma_f32_16x16x32_bf16 v[48:51], a[216:219], a[140:143], v[48:51]
    s_add_u32 m0, s8, 0x1e000
    ds_read_b64_tr_b16 a[246:247], v115 offset:2048
    buffer_load_dwordx4 v25, s[56:59], s9 offen offset:0 lds
    v_mfma_f32_16x16x32_bf16 v[48:51], a[212:215], a[132:135], v[48:51]
    ds_read_b64_tr_b16 a[248:249], v115 offset:4096
    ds_read_b64_tr_b16 a[250:251], v115 offset:6144
    v_mfma_f32_16x16x32_bf16 v[48:51], a[208:211], a[124:127], v[48:51]
    buffer_load_dwordx4 a[192:195], v8, s[60:63], s24 offen offset:2048 sc1
    v_mfma_f32_16x16x32_bf16 v[44:47], a[220:223], a[120:123], v[44:47]
    s_waitcnt lgkmcnt(4)
    ds_read_b64_tr_b16 a[252:253], v115 offset:8192
    v_mfma_f32_16x16x32_bf16 v[44:47], a[224:227], a[128:131], v[44:47]
    ds_read_b64_tr_b16 a[254:255], v115 offset:10240
    v_fmac_f32 v89, v33, v251
    v_mfma_f32_16x16x32_bf16 v[44:47], a[228:231], a[136:139], v[44:47]
    ds_read_b64_tr_b16 a[200:201], v112 offset:12288
    ds_read_b64_tr_b16 a[202:203], v112 offset:14336
    v_mfma_f32_16x16x32_bf16 v[52:55], a[228:231], a[140:143], v[52:55]
    buffer_load_dwordx4 v[144:147], v8, s[60:63], s14 offen offset:2048 sc1
    v_mfma_f32_16x16x32_bf16 v[52:55], a[224:227], a[132:135], v[52:55]
    ds_read_b64_tr_b16 a[204:205], v112 offset:16384
    ds_read_b64_tr_b16 a[206:207], v112 offset:18432
    v_mfma_f32_16x16x32_bf16 v[52:55], a[220:223], a[124:127], v[52:55]
    buffer_load_dwordx4 v26, s[56:59], s9 offen offset:1024 lds
    v_mfma_f32_16x16x32_bf16 v[56:59], a[232:235], a[120:123], v[56:59]
    ds_read_b64_tr_b16 a[208:209], v112 offset:20480
    v_mfma_f32_16x16x32_bf16 v[56:59], a[236:239], a[128:131], v[56:59]
    ds_read_b64_tr_b16 a[210:211], v112 offset:22528
    v_lshlrev_b32 v90, 16, v241
    v_mfma_f32_16x16x32_bf16 v[56:59], a[240:243], a[136:139], v[56:59]
    s_waitcnt lgkmcnt(4)
    ds_read_b64_tr_b16 a[212:213], v113 offset:12288
    v_and_b32 v91, s15, v241
    v_mfma_f32_16x16x32_bf16 v[64:67], a[240:243], a[140:143], v[64:67]
    ds_read_b64_tr_b16 a[214:215], v113 offset:14336
    v_fma_f32 v34, v90, v73, v72
    v_mfma_f32_16x16x32_bf16 v[64:67], a[236:239], a[132:135], v[64:67]
    ds_read_b64_tr_b16 a[216:217], v113 offset:16384
    ds_read_b64_tr_b16 a[218:219], v113 offset:18432
    v_mfma_f32_16x16x32_bf16 v[64:67], a[232:235], a[124:127], v[64:67]
    buffer_load_dwordx4 a[196:199], v8, s[60:63], s24 offen offset:3072 sc1
    v_mfma_f32_16x16x32_bf16 v[60:63], a[244:247], a[120:123], v[60:63]
    ds_read_b64_tr_b16 a[220:221], v113 offset:20480
    ds_read_b64_tr_b16 a[222:223], v113 offset:22528
    v_mfma_f32_16x16x32_bf16 v[60:63], a[248:251], a[128:131], v[60:63]
    buffer_load_dwordx4 v27, s[56:59], s9 offen offset:2048 lds
    v_mfma_f32_16x16x32_bf16 v[60:63], a[252:255], a[136:139], v[60:63]
    ds_read_b64_tr_b16 a[224:225], v114 offset:12288
    v_mfma_f32_16x16x32_bf16 v[68:71], a[252:255], a[140:143], v[68:71]
    ds_read_b64_tr_b16 a[226:227], v114 offset:14336
    v_fma_f32 v35, v91, v73, v72
    v_mfma_f32_16x16x32_bf16 v[68:71], a[248:251], a[132:135], v[68:71]
    s_waitcnt lgkmcnt(4)
    ds_read_b64_tr_b16 a[228:229], v114 offset:16384
    v_mfma_f32_16x16x32_bf16 v[68:71], a[244:247], a[124:127], v[68:71]
    ds_read_b64_tr_b16 a[230:231], v114 offset:18432
    v_fmac_f32 v90, v34, v252
    v_mfma_f32_16x16x32_bf16 v[40:43], a[200:203], a[144:147], v[40:43]
    ds_read_b64_tr_b16 a[232:233], v114 offset:20480
    ds_read_b64_tr_b16 a[234:235], v114 offset:22528
    v_mfma_f32_16x16x32_bf16 v[40:43], a[204:207], a[152:155], v[40:43]
    buffer_load_dwordx4 v[148:151], v8, s[60:63], s14 offen offset:3072 sc1
    v_mfma_f32_16x16x32_bf16 v[40:43], a[208:211], a[160:163], v[40:43]
    s_add_u32 m0, s8, 0x1ec00
    ds_read_b64_tr_b16 a[236:237], v115 offset:12288
    ds_read_b64_tr_b16 a[238:239], v115 offset:14336
    v_mfma_f32_16x16x32_bf16 v[48:51], a[208:211], a[164:167], v[48:51]
    buffer_load_dwordx4 v28, s[56:59], s9 offen offset:0 lds
    v_mfma_f32_16x16x32_bf16 v[48:51], a[204:207], a[156:159], v[48:51]
    ds_read_b64_tr_b16 a[240:241], v115 offset:16384
    v_mfma_f32_16x16x32_bf16 v[48:51], a[200:203], a[148:151], v[48:51]
    ds_read_b64_tr_b16 a[242:243], v115 offset:18432
    v_fmac_f32 v91, v35, v253
    v_mfma_f32_16x16x32_bf16 v[44:47], a[212:215], a[144:147], v[44:47]
    s_waitcnt lgkmcnt(4)
    ds_read_b64_tr_b16 a[244:245], v115 offset:20480
    v_mfma_f32_16x16x32_bf16 v[44:47], a[216:219], a[152:155], v[44:47]
    ds_read_b64_tr_b16 a[246:247], v115 offset:22528
    v_lshlrev_b32 v92, 16, v242
    v_mfma_f32_16x16x32_bf16 v[44:47], a[220:223], a[160:163], v[44:47]
    ds_read_b64_tr_b16 a[248:249], v112 offset:24576
    ds_read_b64_tr_b16 a[250:251], v112 offset:26624
    v_mfma_f32_16x16x32_bf16 v[52:55], a[220:223], a[164:167], v[52:55]
    s_add_u32 s24, s30, 16384
    buffer_load_dwordx4 v[168:171], v8, s[60:63], s24 offen offset:0 sc1
    v_mfma_f32_16x16x32_bf16 v[52:55], a[216:219], a[156:159], v[52:55]
    ds_read_b64_tr_b16 a[252:253], v112 offset:28672
    ds_read_b64_tr_b16 a[254:255], v112 offset:30720
    v_mfma_f32_16x16x32_bf16 v[52:55], a[212:215], a[148:151], v[52:55]
    buffer_load_dwordx4 v29, s[56:59], s9 offen offset:1024 lds
    v_mfma_f32_16x16x32_bf16 v[56:59], a[224:227], a[144:147], v[56:59]
    ds_read_b64_tr_b16 a[200:201], v112 offset:32768
    v_mfma_f32_16x16x32_bf16 v[56:59], a[228:231], a[152:155], v[56:59]
    ds_read_b64_tr_b16 a[202:203], v112 offset:34816
    v_and_b32 v93, s15, v242
    v_mfma_f32_16x16x32_bf16 v[56:59], a[232:235], a[160:163], v[56:59]
    s_waitcnt lgkmcnt(4)
    ds_read_b64_tr_b16 a[204:205], v113 offset:24576
    v_mfma_f32_16x16x32_bf16 v[64:67], a[232:235], a[164:167], v[64:67]
    ds_read_b64_tr_b16 a[206:207], v113 offset:26624
    v_fma_f32 v32, v92, v75, v74
    v_mfma_f32_16x16x32_bf16 v[64:67], a[228:231], a[156:159], v[64:67]
    ds_read_b64_tr_b16 a[208:209], v113 offset:28672
    v_fma_f32 v33, v93, v75, v74
    v_mfma_f32_16x16x32_bf16 v[64:67], a[224:227], a[148:151], v[64:67]
    ds_read_b64_tr_b16 a[210:211], v113 offset:30720
    v_fmac_f32 v92, v32, v250
    v_mfma_f32_16x16x32_bf16 v[60:63], a[236:239], a[144:147], v[60:63]
    ds_read_b64_tr_b16 a[212:213], v113 offset:32768
    ds_read_b64_tr_b16 a[214:215], v113 offset:34816
    v_mfma_f32_16x16x32_bf16 v[60:63], a[240:243], a[152:155], v[60:63]
    buffer_load_dwordx4 v30, s[56:59], s9 offen offset:2048 lds
    v_mfma_f32_16x16x32_bf16 v[60:63], a[244:247], a[160:163], v[60:63]
    ds_read_b64_tr_b16 a[216:217], v114 offset:24576
    ds_read_b64_tr_b16 a[218:219], v114 offset:26624
    v_mfma_f32_16x16x32_bf16 v[68:71], a[244:247], a[164:167], v[68:71]
    buffer_load_dwordx4 v[172:175], v8, s[60:63], s24 offen offset:1024 sc1
    v_mfma_f32_16x16x32_bf16 v[68:71], a[240:243], a[156:159], v[68:71]
    s_waitcnt vmcnt(34) lgkmcnt(4)
    ds_read_b64_tr_b16 a[220:221], v114 offset:28672
    v_mfma_f32_16x16x32_bf16 v[68:71], a[236:239], a[148:151], v[68:71]
    ds_read_b64_tr_b16 a[222:223], v114 offset:30720
    v_fmac_f32 v93, v33, v251
    v_mfma_f32_16x16x32_bf16 v[200:203], a[248:251], a[120:123], v[200:203]
    s_barrier
    v_mfma_f32_16x16x32_bf16 v[200:203], a[252:255], a[128:131], v[200:203]
    ds_read_b64_tr_b16 a[224:225], v114 offset:32768
    ds_read_b64_tr_b16 a[226:227], v114 offset:34816
    v_mfma_f32_16x16x32_bf16 v[200:203], a[200:203], a[136:139], v[200:203]
    s_add_u32 s9, s18, s96
    ds_read_b64_tr_b16 a[228:229], v115 offset:24576
    v_mfma_f32_16x16x32_bf16 v[208:211], a[200:203], a[140:143], v[208:211]
    s_add_u32 m0, s8, 0x0
    ds_read_b64_tr_b16 a[230:231], v115 offset:26624
    buffer_load_dwordx4 v25, s[56:59], s9 offen offset:0 lds
    v_mfma_f32_16x16x32_bf16 v[208:211], a[252:255], a[132:135], v[208:211]
    s_waitcnt vmcnt(15)
    ds_read_b64_tr_b16 a[232:233], v115 offset:28672
    v_mfma_f32_16x16x32_bf16 v[208:211], a[248:251], a[124:127], v[208:211]
    ds_read_b64_tr_b16 a[234:235], v115 offset:30720
    v_cmp_eq_u32 vcc, 0, v12
    v_mfma_f32_16x16x32_bf16 v[204:207], a[204:207], a[120:123], v[204:207]
    s_cbranch_vccnz L_fh3_spin
L_fh3_ret:
    s_waitcnt lgkmcnt(4)
    ds_read_b64_tr_b16 a[236:237], v115 offset:32768
    v_mfma_f32_16x16x32_bf16 v[204:207], a[208:211], a[128:131], v[204:207]
    ds_read_b64_tr_b16 a[238:239], v115 offset:34816
    v_lshlrev_b32 v94, 16, v243
    v_mfma_f32_16x16x32_bf16 v[204:207], a[212:215], a[136:139], v[204:207]
    ds_read_b64_tr_b16 a[240:241], v112 offset:36864
    ds_read_b64_tr_b16 a[242:243], v112 offset:38912
    v_mfma_f32_16x16x32_bf16 v[212:215], a[212:215], a[140:143], v[212:215]
    s_add_u32 s14, s29, 20480
    buffer_load_dwordx4 v[152:155], v8, s[60:63], s14 offen offset:0 sc1
    v_mfma_f32_16x16x32_bf16 v[212:215], a[208:211], a[132:135], v[212:215]
    ds_read_b64_tr_b16 a[244:245], v112 offset:40960
    ds_read_b64_tr_b16 a[246:247], v112 offset:43008
    v_mfma_f32_16x16x32_bf16 v[212:215], a[204:207], a[124:127], v[212:215]
    buffer_load_dwordx4 v26, s[56:59], s9 offen offset:1024 lds
    v_mfma_f32_16x16x32_bf16 v[216:219], a[216:219], a[120:123], v[216:219]
    ds_read_b64_tr_b16 a[248:249], v112 offset:45056
    ds_read_b64_tr_b16 a[250:251], v112 offset:47104
    v_mfma_f32_16x16x32_bf16 v[216:219], a[220:223], a[128:131], v[216:219]
    buffer_load_dwordx4 v[176:179], v8, s[60:63], s24 offen offset:2048 sc1
    v_mfma_f32_16x16x32_bf16 v[216:219], a[224:227], a[136:139], v[216:219]
    s_waitcnt lgkmcnt(4)
    ds_read_b64_tr_b16 a[252:253], v113 offset:36864
    v_mfma_f32_16x16x32_bf16 v[224:227], a[224:227], a[140:143], v[224:227]
    ds_read_b64_tr_b16 a[254:255], v113 offset:38912
    v_and_b32 v95, s15, v243
    v_mfma_f32_16x16x32_bf16 v[224:227], a[220:223], a[132:135], v[224:227]
    ds_read_b64_tr_b16 a[200:201], v113 offset:40960
    ds_read_b64_tr_b16 a[202:203], v113 offset:43008
    v_mfma_f32_16x16x32_bf16 v[224:227], a[216:219], a[124:127], v[224:227]
    buffer_load_dwordx4 v[156:159], v8, s[60:63], s14 offen offset:1024 sc1
    v_mfma_f32_16x16x32_bf16 v[220:223], a[228:231], a[120:123], v[220:223]
    ds_read_b64_tr_b16 a[204:205], v113 offset:45056
    ds_read_b64_tr_b16 a[206:207], v113 offset:47104
    v_mfma_f32_16x16x32_bf16 v[220:223], a[232:235], a[128:131], v[220:223]
    buffer_load_dwordx4 v27, s[56:59], s9 offen offset:2048 lds
    v_mfma_f32_16x16x32_bf16 v[220:223], a[236:239], a[136:139], v[220:223]
    ds_read_b64_tr_b16 a[208:209], v114 offset:36864
    ds_read_b64_tr_b16 a[210:211], v114 offset:38912
    v_mfma_f32_16x16x32_bf16 v[228:231], a[236:239], a[140:143], v[228:231]
    buffer_load_dwordx4 v[180:183], v8, s[60:63], s24 offen offset:3072 sc1
    v_mfma_f32_16x16x32_bf16 v[228:231], a[232:235], a[132:135], v[228:231]
    s_waitcnt lgkmcnt(4)
    ds_read_b64_tr_b16 a[212:213], v114 offset:40960
    v_mfma_f32_16x16x32_bf16 v[228:231], a[228:231], a[124:127], v[228:231]
    ds_read_b64_tr_b16 a[214:215], v114 offset:43008
    v_fma_f32 v34, v94, v75, v74
    v_mfma_f32_16x16x32_bf16 v[200:203], a[240:243], a[144:147], v[200:203]
    ds_read_b64_tr_b16 a[216:217], v114 offset:45056
    ds_read_b64_tr_b16 a[218:219], v114 offset:47104
    v_mfma_f32_16x16x32_bf16 v[200:203], a[244:247], a[152:155], v[200:203]
    buffer_load_dwordx4 v[160:163], v8, s[60:63], s14 offen offset:2048 sc1
    v_mfma_f32_16x16x32_bf16 v[200:203], a[248:251], a[160:163], v[200:203]
    s_add_u32 m0, s8, 0xc00
    ds_read_b64_tr_b16 a[220:221], v115 offset:36864
    ds_read_b64_tr_b16 a[222:223], v115 offset:38912
    v_mfma_f32_16x16x32_bf16 v[208:211], a[248:251], a[164:167], v[208:211]
    buffer_load_dwordx4 v28, s[56:59], s9 offen offset:0 lds
    v_mfma_f32_16x16x32_bf16 v[208:211], a[244:247], a[156:159], v[208:211]
    ds_read_b64_tr_b16 a[224:225], v115 offset:40960
    v_mfma_f32_16x16x32_bf16 v[208:211], a[240:243], a[148:151], v[208:211]
    ds_read_b64_tr_b16 a[226:227], v115 offset:43008
    v_fma_f32 v35, v95, v75, v74
    v_mfma_f32_16x16x32_bf16 v[204:207], a[252:255], a[144:147], v[204:207]
    s_waitcnt lgkmcnt(4)
    ds_read_b64_tr_b16 a[228:229], v115 offset:45056
    v_fmac_f32 v94, v34, v252
    v_mfma_f32_16x16x32_bf16 v[204:207], a[200:203], a[152:155], v[204:207]
    ds_read_b64_tr_b16 a[230:231], v115 offset:47104
    v_fmac_f32 v95, v35, v253
    v_mfma_f32_16x16x32_bf16 v[204:207], a[204:207], a[160:163], v[204:207]
    ds_read_b64_tr_b16 a[232:233], v116 offset:0
    ds_read_b64_tr_b16 a[234:235], v116 offset:2048
    v_mfma_f32_16x16x32_bf16 v[212:215], a[204:207], a[164:167], v[212:215]
    buffer_load_dwordx4 v[164:167], v8, s[60:63], s14 offen offset:3072 sc1
    v_mfma_f32_16x16x32_bf16 v[212:215], a[200:203], a[156:159], v[212:215]
    ds_read_b64_tr_b16 a[236:237], v116 offset:4096
    ds_read_b64_tr_b16 a[238:239], v116 offset:6144
    v_mfma_f32_16x16x32_bf16 v[212:215], a[252:255], a[148:151], v[212:215]
    buffer_load_dwordx4 v29, s[56:59], s9 offen offset:1024 lds
    v_mfma_f32_16x16x32_bf16 v[216:219], a[208:211], a[144:147], v[216:219]
    ds_read_b64_tr_b16 a[240:241], v116 offset:8192
    v_mfma_f32_16x16x32_bf16 v[216:219], a[212:215], a[152:155], v[216:219]
    ds_read_b64_tr_b16 a[242:243], v116 offset:10240
    v_lshlrev_b32 v96, 16, v244
    v_mfma_f32_16x16x32_bf16 v[216:219], a[216:219], a[160:163], v[216:219]
    s_waitcnt lgkmcnt(4)
    ds_read_b64_tr_b16 a[244:245], v117 offset:0
    v_mfma_f32_16x16x32_bf16 v[224:227], a[216:219], a[164:167], v[224:227]
    ds_read_b64_tr_b16 a[246:247], v117 offset:2048
    v_and_b32 v97, s15, v244
    v_mfma_f32_16x16x32_bf16 v[224:227], a[212:215], a[156:159], v[224:227]
    ds_read_b64_tr_b16 a[248:249], v117 offset:4096
    ds_read_b64_tr_b16 a[250:251], v117 offset:6144
    v_mfma_f32_16x16x32_bf16 v[224:227], a[208:211], a[148:151], v[224:227]
    s_add_u32 s24, s30, 20480
    buffer_load_dwordx4 v[184:187], v8, s[60:63], s24 offen offset:0 sc1
    v_mfma_f32_16x16x32_bf16 v[220:223], a[220:223], a[144:147], v[220:223]
    ds_read_b64_tr_b16 a[252:253], v117 offset:8192
    ds_read_b64_tr_b16 a[254:255], v117 offset:10240
    v_mfma_f32_16x16x32_bf16 v[220:223], a[224:227], a[152:155], v[220:223]
    buffer_load_dwordx4 v30, s[56:59], s9 offen offset:2048 lds
    v_mfma_f32_16x16x32_bf16 v[220:223], a[228:231], a[160:163], v[220:223]
    ds_read_b64_tr_b16 a[200:201], v19 offset:0
    v_mfma_f32_16x16x32_bf16 v[228:231], a[228:231], a[164:167], v[228:231]
    ds_read_b64_tr_b16 a[202:203], v19 offset:2048
    v_fma_f32 v32, v96, v77, v76
    v_mfma_f32_16x16x32_bf16 v[228:231], a[224:227], a[156:159], v[228:231]
    s_waitcnt vmcnt(18) lgkmcnt(4)
    ds_read_b64_tr_b16 a[204:205], v19 offset:4096
    v_mfma_f32_16x16x32_bf16 v[228:231], a[220:223], a[148:151], v[228:231]
    ds_read_b64_tr_b16 a[206:207], v19 offset:6144
    v_mfma_f32_16x16x32_bf16 v[40:43], a[232:235], a[168:171], v[40:43]
    s_barrier
    v_mfma_f32_16x16x32_bf16 v[40:43], a[236:239], a[176:179], v[40:43]
    ds_read_b64_tr_b16 a[208:209], v19 offset:8192
    ds_read_b64_tr_b16 a[210:211], v19 offset:10240
    v_mfma_f32_16x16x32_bf16 v[40:43], a[240:243], v[136:139], v[40:43]
    s_add_u32 s9, s19, s96
    ds_read_b64_tr_b16 a[212:213], v20 offset:0
    v_mfma_f32_16x16x32_bf16 v[48:51], a[240:243], v[140:143], v[48:51]
    s_add_u32 m0, s8, 0x6000
    ds_read_b64_tr_b16 a[214:215], v20 offset:2048
    buffer_load_dwordx4 v25, s[56:59], s9 offen offset:0 lds
    v_mfma_f32_16x16x32_bf16 v[48:51], a[236:239], a[180:183], v[48:51]
    ds_read_b64_tr_b16 a[216:217], v20 offset:4096
    ds_read_b64_tr_b16 a[218:219], v20 offset:6144
    v_mfma_f32_16x16x32_bf16 v[48:51], a[232:235], a[172:175], v[48:51]
    buffer_load_dwordx4 v[188:191], v8, s[60:63], s24 offen offset:1024 sc1
    v_mfma_f32_16x16x32_bf16 v[44:47], a[244:247], a[168:171], v[44:47]
    s_waitcnt lgkmcnt(4)
    ds_read_b64_tr_b16 a[220:221], v20 offset:8192
    v_mfma_f32_16x16x32_bf16 v[44:47], a[248:251], a[176:179], v[44:47]
    ds_read_b64_tr_b16 a[222:223], v20 offset:10240
    v_fma_f32 v33, v97, v77, v76
    v_mfma_f32_16x16x32_bf16 v[44:47], a[252:255], v[136:139], v[44:47]
    ds_read_b64_tr_b16 a[224:225], v116 offset:12288
    ds_read_b64_tr_b16 a[226:227], v116 offset:14336
    v_mfma_f32_16x16x32_bf16 v[52:55], a[252:255], v[140:143], v[52:55]
    buffer_load_dwordx4 v[192:195], v8, s[60:63], s24 offen offset:2048 sc1
    v_mfma_f32_16x16x32_bf16 v[52:55], a[248:251], a[180:183], v[52:55]
    ds_read_b64_tr_b16 a[228:229], v116 offset:16384
    ds_read_b64_tr_b16 a[230:231], v116 offset:18432
    v_mfma_f32_16x16x32_bf16 v[52:55], a[244:247], a[172:175], v[52:55]
    buffer_load_dwordx4 v26, s[56:59], s9 offen offset:1024 lds
    v_mfma_f32_16x16x32_bf16 v[56:59], a[200:203], a[168:171], v[56:59]
    ds_read_b64_tr_b16 a[232:233], v116 offset:20480
    v_mfma_f32_16x16x32_bf16 v[56:59], a[204:207], a[176:179], v[56:59]
    ds_read_b64_tr_b16 a[234:235], v116 offset:22528
    v_fmac_f32 v96, v32, v250
    v_mfma_f32_16x16x32_bf16 v[56:59], a[208:211], v[136:139], v[56:59]
    s_waitcnt lgkmcnt(4)
    ds_read_b64_tr_b16 a[236:237], v117 offset:12288
    v_mfma_f32_16x16x32_bf16 v[64:67], a[208:211], v[140:143], v[64:67]
    ds_read_b64_tr_b16 a[238:239], v117 offset:14336
    v_fmac_f32 v97, v33, v251
    v_mfma_f32_16x16x32_bf16 v[64:67], a[204:207], a[180:183], v[64:67]
    ds_read_b64_tr_b16 a[240:241], v117 offset:16384
    ds_read_b64_tr_b16 a[242:243], v117 offset:18432
    v_mfma_f32_16x16x32_bf16 v[64:67], a[200:203], a[172:175], v[64:67]
    buffer_load_dwordx4 v[196:199], v8, s[60:63], s24 offen offset:3072 sc1
    v_mfma_f32_16x16x32_bf16 v[60:63], a[212:215], a[168:171], v[60:63]
    ds_read_b64_tr_b16 a[244:245], v117 offset:20480
    ds_read_b64_tr_b16 a[246:247], v117 offset:22528
    v_mfma_f32_16x16x32_bf16 v[60:63], a[216:219], a[176:179], v[60:63]
    buffer_load_dwordx4 v27, s[56:59], s9 offen offset:2048 lds
    v_mfma_f32_16x16x32_bf16 v[60:63], a[220:223], v[136:139], v[60:63]
    ds_read_b64_tr_b16 a[248:249], v19 offset:12288
    v_mfma_f32_16x16x32_bf16 v[68:71], a[220:223], v[140:143], v[68:71]
    ds_read_b64_tr_b16 a[250:251], v19 offset:14336
    v_lshlrev_b32 v98, 16, v245
    v_mfma_f32_16x16x32_bf16 v[68:71], a[216:219], a[180:183], v[68:71]
    s_waitcnt vmcnt(9) lgkmcnt(4)
    ds_read_b64_tr_b16 a[252:253], v19 offset:16384
    v_and_b32 v99, s15, v245
    v_mfma_f32_16x16x32_bf16 v[68:71], a[212:215], a[172:175], v[68:71]
    ds_read_b64_tr_b16 a[254:255], v19 offset:18432
    v_fma_f32 v34, v98, v77, v76
    v_mfma_f32_16x16x32_bf16 v[40:43], a[224:227], v[144:147], v[40:43]
    ds_read_b64_tr_b16 a[200:201], v19 offset:20480
    v_mfma_f32_16x16x32_bf16 v[40:43], a[228:231], v[152:155], v[40:43]
    ds_read_b64_tr_b16 a[202:203], v19 offset:22528
    v_fma_f32 v35, v99, v77, v76
    v_mfma_f32_16x16x32_bf16 v[40:43], a[232:235], v[160:163], v[40:43]
    s_add_u32 m0, s8, 0x6c00
    ds_read_b64_tr_b16 a[204:205], v20 offset:12288
    ds_read_b64_tr_b16 a[206:207], v20 offset:14336
    v_mfma_f32_16x16x32_bf16 v[48:51], a[232:235], v[164:167], v[48:51]
    buffer_load_dwordx4 v28, s[56:59], s9 offen offset:0 lds
    v_mfma_f32_16x16x32_bf16 v[48:51], a[228:231], v[156:159], v[48:51]
    ds_read_b64_tr_b16 a[208:209], v20 offset:16384
    v_mfma_f32_16x16x32_bf16 v[48:51], a[224:227], v[148:151], v[48:51]
    ds_read_b64_tr_b16 a[210:211], v20 offset:18432
    v_fmac_f32 v98, v34, v252
    v_mfma_f32_16x16x32_bf16 v[44:47], a[236:239], v[144:147], v[44:47]
    s_waitcnt lgkmcnt(4)
    ds_read_b64_tr_b16 a[212:213], v20 offset:20480
    v_mfma_f32_16x16x32_bf16 v[44:47], a[240:243], v[152:155], v[44:47]
    ds_read_b64_tr_b16 a[214:215], v20 offset:22528
    v_fmac_f32 v99, v35, v253
    v_mfma_f32_16x16x32_bf16 v[44:47], a[244:247], v[160:163], v[44:47]
    ds_read_b64_tr_b16 a[216:217], v116 offset:24576
    v_mfma_f32_16x16x32_bf16 v[52:55], a[244:247], v[164:167], v[52:55]
    ds_read_b64_tr_b16 a[218:219], v116 offset:26624
    v_lshlrev_b32 v100, 16, v246
    v_mfma_f32_16x16x32_bf16 v[52:55], a[240:243], v[156:159], v[52:55]
    ds_read_b64_tr_b16 a[220:221], v116 offset:28672
    ds_read_b64_tr_b16 a[222:223], v116 offset:30720
    v_mfma_f32_16x16x32_bf16 v[52:55], a[236:239], v[148:151], v[52:55]
    buffer_load_dwordx4 v29, s[56:59], s9 offen offset:1024 lds
    v_mfma_f32_16x16x32_bf16 v[56:59], a[248:251], v[144:147], v[56:59]
    ds_read_b64_tr_b16 a[224:225], v116 offset:32768
    v_mfma_f32_16x16x32_bf16 v[56:59], a[252:255], v[152:155], v[56:59]
    ds_read_b64_tr_b16 a[226:227], v116 offset:34816
    v_and_b32 v101, s15, v246
    v_mfma_f32_16x16x32_bf16 v[56:59], a[200:203], v[160:163], v[56:59]
    s_waitcnt lgkmcnt(4)
    ds_read_b64_tr_b16 a[228:229], v117 offset:24576
    v_mfma_f32_16x16x32_bf16 v[64:67], a[200:203], v[164:167], v[64:67]
    ds_read_b64_tr_b16 a[230:231], v117 offset:26624
    v_fma_f32 v32, v100, v79, v78
    v_mfma_f32_16x16x32_bf16 v[64:67], a[252:255], v[156:159], v[64:67]
    ds_read_b64_tr_b16 a[232:233], v117 offset:28672
    v_fma_f32 v33, v101, v79, v78
    v_mfma_f32_16x16x32_bf16 v[64:67], a[248:251], v[148:151], v[64:67]
    ds_read_b64_tr_b16 a[234:235], v117 offset:30720
    v_fmac_f32 v100, v32, v250
    v_mfma_f32_16x16x32_bf16 v[60:63], a[204:207], v[144:147], v[60:63]
    ds_read_b64_tr_b16 a[236:237], v117 offset:32768
    ds_read_b64_tr_b16 a[238:239], v117 offset:34816
    v_mfma_f32_16x16x32_bf16 v[60:63], a[208:211], v[152:155], v[60:63]
    buffer_load_dwordx4 v30, s[56:59], s9 offen offset:2048 lds
    v_mfma_f32_16x16x32_bf16 v[60:63], a[212:215], v[160:163], v[60:63]
    ds_read_b64_tr_b16 a[240:241], v19 offset:24576
    v_mfma_f32_16x16x32_bf16 v[68:71], a[212:215], v[164:167], v[68:71]
    ds_read_b64_tr_b16 a[242:243], v19 offset:26624
    v_fmac_f32 v101, v33, v251
    v_mfma_f32_16x16x32_bf16 v[68:71], a[208:211], v[156:159], v[68:71]
    s_waitcnt lgkmcnt(4)
    ds_read_b64_tr_b16 a[244:245], v19 offset:28672
    v_mfma_f32_16x16x32_bf16 v[68:71], a[204:207], v[148:151], v[68:71]
    ds_read_b64_tr_b16 a[246:247], v19 offset:30720
    v_mfma_f32_16x16x32_bf16 v[40:43], a[216:219], a[184:187], v[40:43]
    s_barrier
    v_mfma_f32_16x16x32_bf16 v[40:43], a[220:223], a[192:195], v[40:43]
    ds_read_b64_tr_b16 a[248:249], v19 offset:32768
    ds_read_b64_tr_b16 a[250:251], v19 offset:34816
    v_mfma_f32_16x16x32_bf16 v[40:43], a[224:227], v[168:171], v[40:43]
    s_add_u32 s9, s20, s96
    ds_read_b64_tr_b16 a[252:253], v20 offset:24576
    v_mfma_f32_16x16x32_bf16 v[48:51], a[224:227], v[172:175], v[48:51]
    s_add_u32 m0, s8, 0xc000
    ds_read_b64_tr_b16 a[254:255], v20 offset:26624
    buffer_load_dwordx4 v25, s[56:59], s9 offen offset:0 lds
    v_mfma_f32_16x16x32_bf16 v[48:51], a[220:223], a[196:199], v[48:51]
    ds_read_b64_tr_b16 a[200:201], v20 offset:28672
    v_mfma_f32_16x16x32_bf16 v[48:51], a[216:219], a[188:191], v[48:51]
    ds_read_b64_tr_b16 a[202:203], v20 offset:30720
    v_mov_b32 v36, -1
    v_mfma_f32_16x16x32_bf16 v[44:47], a[228:231], a[184:187], v[44:47]
    s_waitcnt lgkmcnt(4)
    ds_read_b64_tr_b16 a[204:205], v20 offset:32768
    v_mfma_f32_16x16x32_bf16 v[44:47], a[232:235], a[192:195], v[44:47]
    ds_read_b64_tr_b16 a[206:207], v20 offset:34816
    v_mov_b32 v37, -1
    v_mfma_f32_16x16x32_bf16 v[44:47], a[236:239], v[168:171], v[44:47]
    ds_read_b64_tr_b16 a[208:209], v116 offset:36864
    v_mfma_f32_16x16x32_bf16 v[52:55], a[236:239], v[172:175], v[52:55]
    s_mul_i32 s10, s23, 32768
    ds_read_b64_tr_b16 a[210:211], v116 offset:38912
    v_lshlrev_b32 v102, 16, v247
    v_mfma_f32_16x16x32_bf16 v[52:55], a[232:235], a[196:199], v[52:55]
    ds_read_b64_tr_b16 a[212:213], v116 offset:40960
    ds_read_b64_tr_b16 a[214:215], v116 offset:43008
    v_mfma_f32_16x16x32_bf16 v[52:55], a[228:231], a[188:191], v[52:55]
    buffer_load_dwordx4 v26, s[56:59], s9 offen offset:1024 lds
    v_mfma_f32_16x16x32_bf16 v[56:59], a[240:243], a[184:187], v[56:59]
    ds_read_b64_tr_b16 a[216:217], v116 offset:45056
    v_mfma_f32_16x16x32_bf16 v[56:59], a[244:247], a[192:195], v[56:59]
    ds_read_b64_tr_b16 a[218:219], v116 offset:47104
    v_mov_b32 v38, -1
    v_mfma_f32_16x16x32_bf16 v[56:59], a[248:251], v[168:171], v[56:59]
    s_waitcnt lgkmcnt(4)
    ds_read_b64_tr_b16 a[220:221], v117 offset:36864
    v_mfma_f32_16x16x32_bf16 v[64:67], a[248:251], v[172:175], v[64:67]
    ds_read_b64_tr_b16 a[222:223], v117 offset:38912
    v_mov_b32 v39, -1
    v_mfma_f32_16x16x32_bf16 v[64:67], a[244:247], a[196:199], v[64:67]
    v_mfma_f32_16x16x32_bf16 v[64:67], a[240:243], a[188:191], v[64:67]
    buffer_store_dwordx4 v[36:39], v118, s[60:63], s10 offen offset:0 sc1
    ds_read_b64_tr_b16 a[224:225], v117 offset:40960
    ds_read_b64_tr_b16 a[226:227], v117 offset:43008
    v_mfma_f32_16x16x32_bf16 v[60:63], a[252:255], a[184:187], v[60:63]
    ds_read_b64_tr_b16 a[228:229], v117 offset:45056
    ds_read_b64_tr_b16 a[230:231], v117 offset:47104
    v_mfma_f32_16x16x32_bf16 v[60:63], a[200:203], a[192:195], v[60:63]
    buffer_load_dwordx4 v27, s[56:59], s9 offen offset:2048 lds
    v_mfma_f32_16x16x32_bf16 v[60:63], a[204:207], v[168:171], v[60:63]
    ds_read_b64_tr_b16 a[232:233], v19 offset:36864
    v_and_b32 v103, s15, v247
    v_mfma_f32_16x16x32_bf16 v[68:71], a[204:207], v[172:175], v[68:71]
    ds_read_b64_tr_b16 a[234:235], v19 offset:38912
    v_fma_f32 v34, v102, v79, v78
    v_mfma_f32_16x16x32_bf16 v[68:71], a[200:203], a[196:199], v[68:71]
    s_waitcnt vmcnt(8) lgkmcnt(4)
    ds_read_b64_tr_b16 a[236:237], v19 offset:40960
    v_mfma_f32_16x16x32_bf16 v[68:71], a[252:255], a[188:191], v[68:71]
    ds_read_b64_tr_b16 a[238:239], v19 offset:43008
    v_fma_f32 v35, v103, v79, v78
    v_mfma_f32_16x16x32_bf16 v[40:43], a[208:211], v[176:179], v[40:43]
    ds_read_b64_tr_b16 a[240:241], v19 offset:45056
    v_mfma_f32_16x16x32_bf16 v[40:43], a[212:215], v[184:187], v[40:43]
    ds_read_b64_tr_b16 a[242:243], v19 offset:47104
    v_fmac_f32 v102, v34, v252
    v_mfma_f32_16x16x32_bf16 v[40:43], a[216:219], v[192:195], v[40:43]
    s_add_u32 m0, s8, 0xcc00
    ds_read_b64_tr_b16 a[244:245], v20 offset:36864
    ds_read_b64_tr_b16 a[246:247], v20 offset:38912
    v_mfma_f32_16x16x32_bf16 v[48:51], a[216:219], v[196:199], v[48:51]
    buffer_load_dwordx4 v28, s[56:59], s9 offen offset:0 lds
    v_mfma_f32_16x16x32_bf16 v[48:51], a[212:215], v[188:191], v[48:51]
    v_mfma_f32_16x16x32_bf16 v[48:51], a[208:211], v[180:183], v[48:51]
    buffer_store_dwordx4 v[36:39], v118, s[60:63], s10 offen offset:1024 sc1
    ds_read_b64_tr_b16 a[248:249], v20 offset:40960
    ds_read_b64_tr_b16 a[250:251], v20 offset:43008
    v_mfma_f32_16x16x32_bf16 v[44:47], a[220:223], v[176:179], v[44:47]
    s_waitcnt lgkmcnt(4)
    ds_read_b64_tr_b16 a[252:253], v20 offset:45056
    v_mfma_f32_16x16x32_bf16 v[44:47], a[224:227], v[184:187], v[44:47]
    ds_read_b64_tr_b16 a[254:255], v20 offset:47104
    v_fmac_f32 v103, v35, v253
    v_mfma_f32_16x16x32_bf16 v[44:47], a[228:231], v[192:195], v[44:47]
    ds_read_b64_tr_b16 a[200:201], v21 offset:0
    v_mfma_f32_16x16x32_bf16 v[52:55], a[228:231], v[196:199], v[52:55]
    ds_read_b64_tr_b16 a[202:203], v21 offset:2048
    v_mfma_f32_16x16x32_bf16 v[52:55], a[224:227], v[188:191], v[52:55]
    ds_read_b64_tr_b16 a[204:205], v21 offset:4096
    ds_read_b64_tr_b16 a[206:207], v21 offset:6144
    v_mfma_f32_16x16x32_bf16 v[52:55], a[220:223], v[180:183], v[52:55]
    buffer_load_dwordx4 v29, s[56:59], s9 offen offset:1024 lds
    v_mfma_f32_16x16x32_bf16 v[56:59], a[232:235], v[176:179], v[56:59]
    ds_read_b64_tr_b16 a[208:209], v21 offset:8192
    v_mfma_f32_16x16x32_bf16 v[56:59], a[236:239], v[184:187], v[56:59]
    ds_read_b64_tr_b16 a[210:211], v21 offset:10240
    v_mfma_f32_16x16x32_bf16 v[56:59], a[240:243], v[192:195], v[56:59]
L_pf2:
    s_cbranch_execz L_rf2
    s_waitcnt lgkmcnt(4)
    ds_read_b64_tr_b16 a[212:213], v22 offset:0
    v_mfma_f32_16x16x32_bf16 v[64:67], a[240:243], v[196:199], v[64:67]
    ds_read_b64_tr_b16 a[214:215], v22 offset:2048
    v_mfma_f32_16x16x32_bf16 v[64:67], a[236:239], v[188:191], v[64:67]
    ds_read_b64_tr_b16 a[216:217], v22 offset:4096
    v_mfma_f32_16x16x32_bf16 v[64:67], a[232:235], v[180:183], v[64:67]
    ds_read_b64_tr_b16 a[218:219], v22 offset:6144
    v_mfma_f32_16x16x32_bf16 v[60:63], a[244:247], v[176:179], v[60:63]
    ds_read_b64_tr_b16 a[220:221], v22 offset:8192
    ds_read_b64_tr_b16 a[222:223], v22 offset:10240
    v_mfma_f32_16x16x32_bf16 v[60:63], a[248:251], v[184:187], v[60:63]
    buffer_load_dwordx4 v30, s[56:59], s9 offen offset:2048 lds
    v_mfma_f32_16x16x32_bf16 v[60:63], a[252:255], v[192:195], v[60:63]
    ds_read_b64_tr_b16 a[224:225], v23 offset:0
    v_mfma_f32_16x16x32_bf16 v[68:71], a[252:255], v[196:199], v[68:71]
    ds_read_b64_tr_b16 a[226:227], v23 offset:2048
    v_mfma_f32_16x16x32_bf16 v[68:71], a[248:251], v[188:191], v[68:71]
    s_waitcnt lgkmcnt(4)
    ds_read_b64_tr_b16 a[228:229], v23 offset:4096
    v_mfma_f32_16x16x32_bf16 v[68:71], a[244:247], v[180:183], v[68:71]
    ds_read_b64_tr_b16 a[230:231], v23 offset:6144
    v_mfma_f32_16x16x32_bf16 v[200:203], a[200:203], a[168:171], v[200:203]
    s_barrier
    v_mfma_f32_16x16x32_bf16 v[200:203], a[204:207], a[176:179], v[200:203]
    s_mul_i32 s10, s21, 32768
    ds_read_b64_tr_b16 a[232:233], v23 offset:8192
    ds_read_b64_tr_b16 a[234:235], v23 offset:10240
    v_mfma_f32_16x16x32_bf16 v[200:203], a[208:211], v[136:139], v[200:203]
    s_add_u32 s9, s18, s96
    s_add_u32 s9, s9, 221184
    ds_read_b64_tr_b16 a[236:237], v24 offset:0
    v_mfma_f32_16x16x32_bf16 v[208:211], a[208:211], v[140:143], v[208:211]
    s_add_u32 m0, s8, 0x12000
    ds_read_b64_tr_b16 a[238:239], v24 offset:2048
    buffer_load_dwordx4 v25, s[56:59], s9 offen offset:0 lds
    v_mfma_f32_16x16x32_bf16 v[208:211], a[204:207], a[180:183], v[208:211]
    ds_read_b64_tr_b16 a[240:241], v24 offset:4096
    v_cvt_pk_bf16_f32 v40, v40, v41
    v_mfma_f32_16x16x32_bf16 v[208:211], a[200:203], a[172:175], v[208:211]
    ds_read_b64_tr_b16 a[242:243], v24 offset:6144
    v_cvt_pk_bf16_f32 v41, v42, v43
    v_mfma_f32_16x16x32_bf16 v[204:207], a[212:215], a[168:171], v[204:207]
    s_waitcnt lgkmcnt(4)
    ds_read_b64_tr_b16 a[244:245], v24 offset:8192
    v_cvt_pk_bf16_f32 v42, v44, v45
    v_mfma_f32_16x16x32_bf16 v[204:207], a[216:219], a[176:179], v[204:207]
    ds_read_b64_tr_b16 a[246:247], v24 offset:10240
    v_cvt_pk_bf16_f32 v43, v46, v47
    v_mfma_f32_16x16x32_bf16 v[204:207], a[220:223], v[136:139], v[204:207]
    v_mfma_f32_16x16x32_bf16 v[212:215], a[220:223], v[140:143], v[212:215]
    buffer_store_dwordx4 v[40:43], v118, s[60:63], s10 offen offset:0 sc1
    ds_read_b64_tr_b16 a[248:249], v21 offset:12288
    ds_read_b64_tr_b16 a[250:251], v21 offset:14336
    v_mfma_f32_16x16x32_bf16 v[212:215], a[216:219], a[180:183], v[212:215]
    ds_read_b64_tr_b16 a[252:253], v21 offset:16384
    ds_read_b64_tr_b16 a[254:255], v21 offset:18432
    v_mfma_f32_16x16x32_bf16 v[212:215], a[212:215], a[172:175], v[212:215]
    buffer_load_dwordx4 v26, s[56:59], s9 offen offset:1024 lds
    v_mfma_f32_16x16x32_bf16 v[216:219], a[224:227], a[168:171], v[216:219]
    ds_read_b64_tr_b16 a[200:201], v21 offset:20480
    v_cvt_pk_bf16_f32 v48, v48, v49
    v_mfma_f32_16x16x32_bf16 v[216:219], a[228:231], a[176:179], v[216:219]
    ds_read_b64_tr_b16 a[202:203], v21 offset:22528
    v_cvt_pk_bf16_f32 v49, v50, v51
    v_mfma_f32_16x16x32_bf16 v[216:219], a[232:235], v[136:139], v[216:219]
    s_waitcnt lgkmcnt(4)
    ds_read_b64_tr_b16 a[204:205], v22 offset:12288
    v_cvt_pk_bf16_f32 v50, v52, v53
    v_mfma_f32_16x16x32_bf16 v[224:227], a[232:235], v[140:143], v[224:227]
    ds_read_b64_tr_b16 a[206:207], v22 offset:14336
    v_cvt_pk_bf16_f32 v51, v54, v55
    v_mfma_f32_16x16x32_bf16 v[224:227], a[228:231], a[180:183], v[224:227]
    v_mfma_f32_16x16x32_bf16 v[224:227], a[224:227], a[172:175], v[224:227]
    buffer_store_dwordx4 v[48:51], v118, s[60:63], s10 offen offset:1024 sc1
    ds_read_b64_tr_b16 a[208:209], v22 offset:16384
    ds_read_b64_tr_b16 a[210:211], v22 offset:18432
    v_mfma_f32_16x16x32_bf16 v[220:223], a[236:239], a[168:171], v[220:223]
    ds_read_b64_tr_b16 a[212:213], v22 offset:20480
    ds_read_b64_tr_b16 a[214:215], v22 offset:22528
    v_mfma_f32_16x16x32_bf16 v[220:223], a[240:243], a[176:179], v[220:223]
    buffer_load_dwordx4 v27, s[56:59], s9 offen offset:2048 lds
    v_mfma_f32_16x16x32_bf16 v[220:223], a[244:247], v[136:139], v[220:223]
    ds_read_b64_tr_b16 a[216:217], v23 offset:12288
    v_cvt_pk_bf16_f32 v56, v56, v57
    v_mfma_f32_16x16x32_bf16 v[228:231], a[244:247], v[140:143], v[228:231]
    ds_read_b64_tr_b16 a[218:219], v23 offset:14336
    v_cvt_pk_bf16_f32 v57, v58, v59
    v_mfma_f32_16x16x32_bf16 v[228:231], a[240:243], a[180:183], v[228:231]
    s_waitcnt lgkmcnt(4)
    ds_read_b64_tr_b16 a[220:221], v23 offset:16384
    v_cvt_pk_bf16_f32 v58, v60, v61
    v_mfma_f32_16x16x32_bf16 v[228:231], a[236:239], a[172:175], v[228:231]
    ds_read_b64_tr_b16 a[222:223], v23 offset:18432
    v_cvt_pk_bf16_f32 v59, v62, v63
    v_mfma_f32_16x16x32_bf16 v[200:203], a[248:251], v[144:147], v[200:203]
    v_mfma_f32_16x16x32_bf16 v[200:203], a[252:255], v[152:155], v[200:203]
    buffer_store_dwordx4 v[56:59], v119, s[60:63], s10 offen offset:0 sc1
    ds_read_b64_tr_b16 a[224:225], v23 offset:20480
    ds_read_b64_tr_b16 a[226:227], v23 offset:22528
    v_mfma_f32_16x16x32_bf16 v[200:203], a[200:203], v[160:163], v[200:203]
    s_add_u32 m0, s8, 0x12c00
    ds_read_b64_tr_b16 a[228:229], v24 offset:12288
    ds_read_b64_tr_b16 a[230:231], v24 offset:14336
    v_mfma_f32_16x16x32_bf16 v[208:211], a[200:203], v[164:167], v[208:211]
    buffer_load_dwordx4 v28, s[56:59], s9 offen offset:0 lds
    v_mfma_f32_16x16x32_bf16 v[208:211], a[252:255], v[156:159], v[208:211]
    ds_read_b64_tr_b16 a[232:233], v24 offset:16384
    v_cvt_pk_bf16_f32 v64, v64, v65
    v_mfma_f32_16x16x32_bf16 v[208:211], a[248:251], v[148:151], v[208:211]
    ds_read_b64_tr_b16 a[234:235], v24 offset:18432
    v_cvt_pk_bf16_f32 v65, v66, v67
    v_mfma_f32_16x16x32_bf16 v[204:207], a[204:207], v[144:147], v[204:207]
    s_waitcnt lgkmcnt(4)
    ds_read_b64_tr_b16 a[236:237], v24 offset:20480
    v_cvt_pk_bf16_f32 v66, v68, v69
    v_mfma_f32_16x16x32_bf16 v[204:207], a[208:211], v[152:155], v[204:207]
    ds_read_b64_tr_b16 a[238:239], v24 offset:22528
    v_cvt_pk_bf16_f32 v67, v70, v71
    v_mfma_f32_16x16x32_bf16 v[204:207], a[212:215], v[160:163], v[204:207]
    v_mfma_f32_16x16x32_bf16 v[212:215], a[212:215], v[164:167], v[212:215]
    buffer_store_dwordx4 v[64:67], v119, s[60:63], s10 offen offset:1024 sc1
    ds_read_b64_tr_b16 a[240:241], v21 offset:24576
    ds_read_b64_tr_b16 a[242:243], v21 offset:26624
    v_mfma_f32_16x16x32_bf16 v[212:215], a[208:211], v[156:159], v[212:215]
    ds_read_b64_tr_b16 a[244:245], v21 offset:28672
    ds_read_b64_tr_b16 a[246:247], v21 offset:30720
    v_mfma_f32_16x16x32_bf16 v[212:215], a[204:207], v[148:151], v[212:215]
    buffer_load_dwordx4 v29, s[56:59], s9 offen offset:1024 lds
    v_mfma_f32_16x16x32_bf16 v[216:219], a[216:219], v[144:147], v[216:219]
    ds_read_b64_tr_b16 a[248:249], v21 offset:32768
    v_mfma_f32_16x16x32_bf16 v[216:219], a[220:223], v[152:155], v[216:219]
    ds_read_b64_tr_b16 a[250:251], v21 offset:34816
    v_mfma_f32_16x16x32_bf16 v[216:219], a[224:227], v[160:163], v[216:219]
    s_waitcnt lgkmcnt(4)
    ds_read_b64_tr_b16 a[252:253], v22 offset:24576
    v_mfma_f32_16x16x32_bf16 v[224:227], a[224:227], v[164:167], v[224:227]
    ds_read_b64_tr_b16 a[254:255], v22 offset:26624
    v_mfma_f32_16x16x32_bf16 v[224:227], a[220:223], v[156:159], v[224:227]
    ds_read_b64_tr_b16 a[200:201], v22 offset:28672
    v_mfma_f32_16x16x32_bf16 v[224:227], a[216:219], v[148:151], v[224:227]
    ds_read_b64_tr_b16 a[202:203], v22 offset:30720
    v_mfma_f32_16x16x32_bf16 v[220:223], a[228:231], v[144:147], v[220:223]
    ds_read_b64_tr_b16 a[204:205], v22 offset:32768
    ds_read_b64_tr_b16 a[206:207], v22 offset:34816
    v_mfma_f32_16x16x32_bf16 v[220:223], a[232:235], v[152:155], v[220:223]
    buffer_load_dwordx4 v30, s[56:59], s9 offen offset:2048 lds
    v_mfma_f32_16x16x32_bf16 v[220:223], a[236:239], v[160:163], v[220:223]
    ds_read_b64_tr_b16 a[208:209], v23 offset:24576
    v_mfma_f32_16x16x32_bf16 v[228:231], a[236:239], v[164:167], v[228:231]
    ds_read_b64_tr_b16 a[210:211], v23 offset:26624
    v_mfma_f32_16x16x32_bf16 v[228:231], a[232:235], v[156:159], v[228:231]
    s_waitcnt lgkmcnt(4)
    ds_read_b64_tr_b16 a[212:213], v23 offset:28672
    v_mfma_f32_16x16x32_bf16 v[228:231], a[228:231], v[148:151], v[228:231]
    ds_read_b64_tr_b16 a[214:215], v23 offset:30720
    v_mfma_f32_16x16x32_bf16 v[200:203], a[240:243], a[184:187], v[200:203]
    s_barrier
    v_mfma_f32_16x16x32_bf16 v[200:203], a[244:247], a[192:195], v[200:203]
    ds_read_b64_tr_b16 a[216:217], v23 offset:32768
    ds_read_b64_tr_b16 a[218:219], v23 offset:34816
    v_mfma_f32_16x16x32_bf16 v[200:203], a[248:251], v[168:171], v[200:203]
    s_add_u32 s9, s19, s96
    s_add_u32 s9, s9, 221184
    ds_read_b64_tr_b16 a[220:221], v24 offset:24576
    v_mfma_f32_16x16x32_bf16 v[208:211], a[248:251], v[172:175], v[208:211]
    s_add_u32 m0, s8, 0x18000
    ds_read_b64_tr_b16 a[222:223], v24 offset:26624
    buffer_load_dwordx4 v25, s[56:59], s9 offen offset:0 lds
    v_mfma_f32_16x16x32_bf16 v[208:211], a[244:247], a[196:199], v[208:211]
    ds_read_b64_tr_b16 a[224:225], v24 offset:28672
    v_mfma_f32_16x16x32_bf16 v[208:211], a[240:243], a[188:191], v[208:211]
    ds_read_b64_tr_b16 a[226:227], v24 offset:30720
    v_mfma_f32_16x16x32_bf16 v[204:207], a[252:255], a[184:187], v[204:207]
    s_waitcnt lgkmcnt(4)
    ds_read_b64_tr_b16 a[228:229], v24 offset:32768
    v_mfma_f32_16x16x32_bf16 v[204:207], a[200:203], a[192:195], v[204:207]
    ds_read_b64_tr_b16 a[230:231], v24 offset:34816
    v_mfma_f32_16x16x32_bf16 v[204:207], a[204:207], v[168:171], v[204:207]
    ds_read_b64_tr_b16 a[232:233], v21 offset:36864
    v_mfma_f32_16x16x32_bf16 v[212:215], a[204:207], v[172:175], v[212:215]
    ds_read_b64_tr_b16 a[234:235], v21 offset:38912
    v_mfma_f32_16x16x32_bf16 v[212:215], a[200:203], a[196:199], v[212:215]
    ds_read_b64_tr_b16 a[236:237], v21 offset:40960
    ds_read_b64_tr_b16 a[238:239], v21 offset:43008
    v_mfma_f32_16x16x32_bf16 v[212:215], a[252:255], a[188:191], v[212:215]
    buffer_load_dwordx4 v26, s[56:59], s9 offen offset:1024 lds
    v_mfma_f32_16x16x32_bf16 v[216:219], a[208:211], a[184:187], v[216:219]
    ds_read_b64_tr_b16 a[240:241], v21 offset:45056
    v_mfma_f32_16x16x32_bf16 v[216:219], a[212:215], a[192:195], v[216:219]
    ds_read_b64_tr_b16 a[242:243], v21 offset:47104
    v_mfma_f32_16x16x32_bf16 v[216:219], a[216:219], v[168:171], v[216:219]
    s_waitcnt lgkmcnt(4)
    ds_read_b64_tr_b16 a[244:245], v22 offset:36864
    v_mfma_f32_16x16x32_bf16 v[224:227], a[216:219], v[172:175], v[224:227]
    ds_read_b64_tr_b16 a[246:247], v22 offset:38912
    v_mfma_f32_16x16x32_bf16 v[224:227], a[212:215], a[196:199], v[224:227]
    ds_read_b64_tr_b16 a[248:249], v22 offset:40960
    v_mfma_f32_16x16x32_bf16 v[224:227], a[208:211], a[188:191], v[224:227]
    ds_read_b64_tr_b16 a[250:251], v22 offset:43008
    v_mfma_f32_16x16x32_bf16 v[220:223], a[220:223], a[184:187], v[220:223]
    ds_read_b64_tr_b16 a[252:253], v22 offset:45056
    ds_read_b64_tr_b16 a[254:255], v22 offset:47104
    v_mfma_f32_16x16x32_bf16 v[220:223], a[224:227], a[192:195], v[220:223]
    buffer_load_dwordx4 v27, s[56:59], s9 offen offset:2048 lds
    v_mfma_f32_16x16x32_bf16 v[220:223], a[228:231], v[168:171], v[220:223]
    ds_read_b64_tr_b16 a[200:201], v23 offset:36864
    v_mfma_f32_16x16x32_bf16 v[228:231], a[228:231], v[172:175], v[228:231]
    ds_read_b64_tr_b16 a[202:203], v23 offset:38912
    v_mfma_f32_16x16x32_bf16 v[228:231], a[224:227], a[196:199], v[228:231]
    s_waitcnt lgkmcnt(4)
    ds_read_b64_tr_b16 a[204:205], v23 offset:40960
    v_mfma_f32_16x16x32_bf16 v[228:231], a[220:223], a[188:191], v[228:231]
    ds_read_b64_tr_b16 a[206:207], v23 offset:43008
    v_mfma_f32_16x16x32_bf16 v[200:203], a[232:235], v[176:179], v[200:203]
    ds_read_b64_tr_b16 a[208:209], v23 offset:45056
    v_mfma_f32_16x16x32_bf16 v[200:203], a[236:239], v[184:187], v[200:203]
    ds_read_b64_tr_b16 a[210:211], v23 offset:47104
    v_mfma_f32_16x16x32_bf16 v[200:203], a[240:243], v[192:195], v[200:203]
    s_add_u32 m0, s8, 0x18c00
    ds_read_b64_tr_b16 a[212:213], v24 offset:36864
    ds_read_b64_tr_b16 a[214:215], v24 offset:38912
    v_mfma_f32_16x16x32_bf16 v[208:211], a[240:243], v[196:199], v[208:211]
    buffer_load_dwordx4 v28, s[56:59], s9 offen offset:0 lds
    v_mfma_f32_16x16x32_bf16 v[208:211], a[236:239], v[188:191], v[208:211]
    ds_read_b64_tr_b16 a[216:217], v24 offset:40960
    v_mfma_f32_16x16x32_bf16 v[208:211], a[232:235], v[180:183], v[208:211]
    ds_read_b64_tr_b16 a[218:219], v24 offset:43008
    v_mfma_f32_16x16x32_bf16 v[204:207], a[244:247], v[176:179], v[204:207]
    s_waitcnt lgkmcnt(4)
    ds_read_b64_tr_b16 a[220:221], v24 offset:45056
    v_mfma_f32_16x16x32_bf16 v[204:207], a[248:251], v[184:187], v[204:207]
    ds_read_b64_tr_b16 a[222:223], v24 offset:47104
    v_mfma_f32_16x16x32_bf16 v[204:207], a[252:255], v[192:195], v[204:207]
    ds_read_b64_tr_b16 a[224:225], v112 offset:0
    v_mfma_f32_16x16x32_bf16 v[212:215], a[252:255], v[196:199], v[212:215]
    ds_read_b64_tr_b16 a[226:227], v112 offset:2048
    v_mfma_f32_16x16x32_bf16 v[212:215], a[248:251], v[188:191], v[212:215]
    ds_read_b64_tr_b16 a[228:229], v112 offset:4096
    ds_read_b64_tr_b16 a[230:231], v112 offset:6144
    v_mfma_f32_16x16x32_bf16 v[212:215], a[244:247], v[180:183], v[212:215]
    buffer_load_dwordx4 v29, s[56:59], s9 offen offset:1024 lds
    v_mfma_f32_16x16x32_bf16 v[216:219], a[200:203], v[176:179], v[216:219]
    s_waitcnt vmcnt(7)
    v_mfma_f32_16x16x32_bf16 v[216:219], a[204:207], v[184:187], v[216:219]
    buffer_store_dword v7, v7, s[60:63], 0 offen offset:768 sc1
    ds_read_b64_tr_b16 a[232:233], v112 offset:8192
    ds_read_b64_tr_b16 a[234:235], v112 offset:10240
    v_mfma_f32_16x16x32_bf16 v[216:219], a[208:211], v[192:195], v[216:219]
    s_waitcnt lgkmcnt(4)
    ds_read_b64_tr_b16 a[236:237], v113 offset:0
    v_mfma_f32_16x16x32_bf16 v[224:227], a[208:211], v[196:199], v[224:227]
    ds_read_b64_tr_b16 a[238:239], v113 offset:2048
    v_mfma_f32_16x16x32_bf16 v[224:227], a[204:207], v[188:191], v[224:227]
    ds_read_b64_tr_b16 a[240:241], v113 offset:4096
    v_mfma_f32_16x16x32_bf16 v[224:227], a[200:203], v[180:183], v[224:227]
    ds_read_b64_tr_b16 a[242:243], v113 offset:6144
    v_mfma_f32_16x16x32_bf16 v[220:223], a[212:215], v[176:179], v[220:223]
    ds_read_b64_tr_b16 a[244:245], v113 offset:8192
    ds_read_b64_tr_b16 a[246:247], v113 offset:10240
    v_mfma_f32_16x16x32_bf16 v[220:223], a[216:219], v[184:187], v[220:223]
    buffer_load_dwordx4 v30, s[56:59], s9 offen offset:2048 lds
    v_mfma_f32_16x16x32_bf16 v[220:223], a[220:223], v[192:195], v[220:223]
    ds_read_b64_tr_b16 a[248:249], v112 offset:12288
    v_mfma_f32_16x16x32_bf16 v[228:231], a[220:223], v[196:199], v[228:231]
    ds_read_b64_tr_b16 a[250:251], v112 offset:14336
    v_mfma_f32_16x16x32_bf16 v[228:231], a[216:219], v[188:191], v[228:231]
    s_waitcnt lgkmcnt(4)
    ds_read_b64_tr_b16 a[252:253], v112 offset:16384
    v_mfma_f32_16x16x32_bf16 v[228:231], a[212:215], v[180:183], v[228:231]
    ds_read_b64_tr_b16 a[254:255], v112 offset:18432
    v_mfma_f32_16x16x32_bf16 v[40:43], a[224:227], v[104:107], 0
    s_barrier
    v_mfma_f32_16x16x32_bf16 v[40:43], a[228:231], a[0:3], v[40:43]
    ds_read_b64_tr_b16 a[200:201], v112 offset:20480
    ds_read_b64_tr_b16 a[202:203], v112 offset:22528
    v_mfma_f32_16x16x32_bf16 v[40:43], a[232:235], a[8:11], v[40:43]
    s_add_u32 s9, s20, s96
    s_add_u32 s9, s9, 221184
    ds_read_b64_tr_b16 a[204:205], v113 offset:12288
    v_mfma_f32_16x16x32_bf16 v[48:51], a[232:235], a[12:15], 0
    s_add_u32 m0, s8, 0x1e000
    ds_read_b64_tr_b16 a[206:207], v113 offset:14336
    buffer_load_dwordx4 v25, s[56:59], s9 offen offset:0 lds
    v_mfma_f32_16x16x32_bf16 v[48:51], a[228:231], a[4:7], v[48:51]
    ds_read_b64_tr_b16 a[208:209], v113 offset:16384
    v_mfma_f32_16x16x32_bf16 v[48:51], a[224:227], v[108:111], v[48:51]
    s_mul_i32 s10, s22, 32768
    ds_read_b64_tr_b16 a[210:211], v113 offset:18432
    v_mfma_f32_16x16x32_bf16 v[44:47], a[236:239], v[104:107], 0
    s_waitcnt lgkmcnt(4)
    ds_read_b64_tr_b16 a[212:213], v113 offset:20480
    v_cvt_pk_bf16_f32 v200, v200, v201
    v_mfma_f32_16x16x32_bf16 v[44:47], a[240:243], a[0:3], v[44:47]
    ds_read_b64_tr_b16 a[214:215], v113 offset:22528
    buffer_load_dwordx4 v26, s[56:59], s9 offen offset:1024 lds
    v_mfma_f32_16x16x32_bf16 v[44:47], a[244:247], a[8:11], v[44:47]
    ds_read_b64_tr_b16 a[216:217], v112 offset:24576
    v_cvt_pk_bf16_f32 v201, v202, v203
    v_mfma_f32_16x16x32_bf16 v[52:55], a[244:247], a[12:15], 0
    ds_read_b64_tr_b16 a[218:219], v112 offset:26624
    v_cvt_pk_bf16_f32 v202, v204, v205
    v_mfma_f32_16x16x32_bf16 v[52:55], a[240:243], a[4:7], v[52:55]
    ds_read_b64_tr_b16 a[220:221], v112 offset:28672
    v_cvt_pk_bf16_f32 v203, v206, v207
    v_mfma_f32_16x16x32_bf16 v[52:55], a[236:239], v[108:111], v[52:55]
    ds_read_b64_tr_b16 a[222:223], v112 offset:30720
    buffer_load_dwordx4 v27, s[56:59], s9 offen offset:2048 lds
    v_mfma_f32_16x16x32_bf16 v[40:43], a[248:251], a[16:19], v[40:43]
    v_mfma_f32_16x16x32_bf16 v[40:43], a[252:255], a[24:27], v[40:43]
    buffer_store_dwordx4 v[200:203], v118, s[60:63], s10 offen offset:0 sc1
    ds_read_b64_tr_b16 a[224:225], v112 offset:32768
    ds_read_b64_tr_b16 a[226:227], v112 offset:34816
    v_mfma_f32_16x16x32_bf16 v[40:43], a[200:203], a[32:35], v[40:43]
    s_add_u32 m0, s8, 0x1ec00
    s_waitcnt lgkmcnt(4)
    ds_read_b64_tr_b16 a[228:229], v113 offset:24576
    v_cvt_pk_bf16_f32 v208, v208, v209
    v_mfma_f32_16x16x32_bf16 v[48:51], a[200:203], a[36:39], v[48:51]
    ds_read_b64_tr_b16 a[230:231], v113 offset:26624
    buffer_load_dwordx4 v28, s[56:59], s9 offen offset:0 lds
    v_mfma_f32_16x16x32_bf16 v[48:51], a[252:255], a[28:31], v[48:51]
    ds_read_b64_tr_b16 a[232:233], v113 offset:28672
    v_cvt_pk_bf16_f32 v209, v210, v211
    v_cvt_pk_bf16_f32 v210, v212, v213
    v_mfma_f32_16x16x32_bf16 v[48:51], a[248:251], a[20:23], v[48:51]
    ds_read_b64_tr_b16 a[234:235], v113 offset:30720
    buffer_load_dword v12, v13, s[60:63], 0 offen offset:0 sc1
    v_mfma_f32_16x16x32_bf16 v[44:47], a[204:207], a[16:19], v[44:47]
    ds_read_b64_tr_b16 a[236:237], v113 offset:32768
    v_cvt_pk_bf16_f32 v211, v214, v215
    v_mfma_f32_16x16x32_bf16 v[44:47], a[208:211], a[24:27], v[44:47]
    ds_read_b64_tr_b16 a[238:239], v113 offset:34816
    buffer_load_dwordx4 v29, s[56:59], s9 offen offset:1024 lds
    v_mfma_f32_16x16x32_bf16 v[44:47], a[212:215], a[32:35], v[44:47]
    v_mfma_f32_16x16x32_bf16 v[52:55], a[212:215], a[36:39], v[52:55]
    buffer_store_dwordx4 v[208:211], v118, s[60:63], s10 offen offset:1024 sc1
    ds_read_b64_tr_b16 a[240:241], v112 offset:36864
    ds_read_b64_tr_b16 a[242:243], v112 offset:38912
    v_mfma_f32_16x16x32_bf16 v[52:55], a[208:211], a[28:31], v[52:55]
    s_waitcnt lgkmcnt(4)
    ds_read_b64_tr_b16 a[244:245], v112 offset:40960
    ds_read_b64_tr_b16 a[246:247], v112 offset:43008
    v_mfma_f32_16x16x32_bf16 v[52:55], a[204:207], a[20:23], v[52:55]
    buffer_load_dwordx4 v30, s[56:59], s9 offen offset:2048 lds
    v_mfma_f32_16x16x32_bf16 v[40:43], a[216:219], a[72:75], v[40:43]
    ds_read_b64_tr_b16 a[248:249], v112 offset:45056
    v_cvt_pk_bf16_f32 v216, v216, v217
    v_mfma_f32_16x16x32_bf16 v[40:43], a[220:223], a[80:83], v[40:43]
    ds_read_b64_tr_b16 a[250:251], v112 offset:47104
    v_cvt_pk_bf16_f32 v217, v218, v219
    v_mfma_f32_16x16x32_bf16 v[40:43], a[224:227], a[88:91], v[40:43]
    ds_read_b64_tr_b16 a[252:253], v113 offset:36864
    v_cvt_pk_bf16_f32 v218, v220, v221
    v_mfma_f32_16x16x32_bf16 v[48:51], a[224:227], a[92:95], v[48:51]
    ds_read_b64_tr_b16 a[254:255], v113 offset:38912
    v_cvt_pk_bf16_f32 v219, v222, v223
    v_mfma_f32_16x16x32_bf16 v[48:51], a[220:223], a[84:87], v[48:51]
    v_mfma_f32_16x16x32_bf16 v[48:51], a[216:219], a[76:79], v[48:51]
    buffer_store_dwordx4 v[216:219], v119, s[60:63], s10 offen offset:0 sc1
    ds_read_b64_tr_b16 a[200:201], v113 offset:40960
    ds_read_b64_tr_b16 a[202:203], v113 offset:43008
    v_mfma_f32_16x16x32_bf16 v[44:47], a[228:231], a[72:75], v[44:47]
    s_waitcnt lgkmcnt(4)
    ds_read_b64_tr_b16 a[204:205], v113 offset:45056
    v_mfma_f32_16x16x32_bf16 v[44:47], a[232:235], a[80:83], v[44:47]
    ds_read_b64_tr_b16 a[206:207], v113 offset:47104
    v_cvt_pk_bf16_f32 v224, v224, v225
    v_mfma_f32_16x16x32_bf16 v[44:47], a[236:239], a[88:91], v[44:47]
    ds_read_b64_tr_b16 a[208:209], v116 offset:0
    v_cvt_pk_bf16_f32 v225, v226, v227
    v_mfma_f32_16x16x32_bf16 v[52:55], a[236:239], a[92:95], v[52:55]
    ds_read_b64_tr_b16 a[210:211], v116 offset:2048
    v_cvt_pk_bf16_f32 v226, v228, v229
    v_mfma_f32_16x16x32_bf16 v[52:55], a[232:235], a[84:87], v[52:55]
    ds_read_b64_tr_b16 a[212:213], v116 offset:4096
    v_mfma_f32_16x16x32_bf16 v[52:55], a[228:231], a[76:79], v[52:55]
    ds_read_b64_tr_b16 a[214:215], v116 offset:6144
    v_cvt_pk_bf16_f32 v227, v230, v231
    v_mfma_f32_16x16x32_bf16 v[40:43], a[240:243], a[96:99], v[40:43]
    v_mfma_f32_16x16x32_bf16 v[40:43], a[244:247], a[104:107], v[40:43]
    buffer_store_dwordx4 v[224:227], v119, s[60:63], s10 offen offset:1024 sc1
    ds_read_b64_tr_b16 a[216:217], v116 offset:8192
    ds_read_b64_tr_b16 a[218:219], v116 offset:10240
    v_mfma_f32_16x16x32_bf16 v[40:43], a[248:251], a[112:115], v[40:43]
    s_waitcnt lgkmcnt(4)
    ds_read_b64_tr_b16 a[220:221], v117 offset:0
    v_mfma_f32_16x16x32_bf16 v[48:51], a[248:251], a[116:119], v[48:51]
    ds_read_b64_tr_b16 a[222:223], v117 offset:2048
    v_mfma_f32_16x16x32_bf16 v[48:51], a[244:247], a[108:111], v[48:51]
    ds_read_b64_tr_b16 a[224:225], v117 offset:4096
    v_mfma_f32_16x16x32_bf16 v[48:51], a[240:243], a[100:103], v[48:51]
    ds_read_b64_tr_b16 a[226:227], v117 offset:6144
    v_mfma_f32_16x16x32_bf16 v[44:47], a[252:255], a[96:99], v[44:47]
    ds_read_b64_tr_b16 a[228:229], v117 offset:8192
    v_mfma_f32_16x16x32_bf16 v[44:47], a[200:203], a[104:107], v[44:47]
    ds_read_b64_tr_b16 a[230:231], v117 offset:10240
    v_mfma_f32_16x16x32_bf16 v[44:47], a[204:207], a[112:115], v[44:47]
    ds_read_b64_tr_b16 a[232:233], v116 offset:12288
    v_mfma_f32_16x16x32_bf16 v[52:55], a[204:207], a[116:119], v[52:55]
    ds_read_b64_tr_b16 a[234:235], v116 offset:14336
    v_mfma_f32_16x16x32_bf16 v[52:55], a[200:203], a[108:111], v[52:55]
    s_waitcnt vmcnt(11) lgkmcnt(4)
    ds_read_b64_tr_b16 a[236:237], v116 offset:16384
    v_mfma_f32_16x16x32_bf16 v[52:55], a[252:255], a[100:103], v[52:55]
    ds_read_b64_tr_b16 a[238:239], v116 offset:18432
    v_mfma_f32_16x16x32_bf16 v[40:43], a[208:211], a[120:123], v[40:43]
    s_barrier
    v_mfma_f32_16x16x32_bf16 v[40:43], a[212:215], a[128:131], v[40:43]
    ds_read_b64_tr_b16 a[240:241], v116 offset:20480
    ds_read_b64_tr_b16 a[242:243], v116 offset:22528
    v_mfma_f32_16x16x32_bf16 v[40:43], a[216:219], a[136:139], v[40:43]
    ds_read_b64_tr_b16 a[244:245], v117 offset:12288
    v_mfma_f32_16x16x32_bf16 v[48:51], a[216:219], a[140:143], v[48:51]
    ds_read_b64_tr_b16 a[246:247], v117 offset:14336
    v_mfma_f32_16x16x32_bf16 v[48:51], a[212:215], a[132:135], v[48:51]
    ds_read_b64_tr_b16 a[248:249], v117 offset:16384
    v_mfma_f32_16x16x32_bf16 v[48:51], a[208:211], a[124:127], v[48:51]
    ds_read_b64_tr_b16 a[250:251], v117 offset:18432
    v_mfma_f32_16x16x32_bf16 v[44:47], a[220:223], a[120:123], v[44:47]
    s_waitcnt lgkmcnt(4)
    ds_read_b64_tr_b16 a[252:253], v117 offset:20480
    v_mfma_f32_16x16x32_bf16 v[44:47], a[224:227], a[128:131], v[44:47]
    ds_read_b64_tr_b16 a[254:255], v117 offset:22528
    v_mfma_f32_16x16x32_bf16 v[44:47], a[228:231], a[136:139], v[44:47]
    ds_read_b64_tr_b16 a[200:201], v116 offset:24576
    v_mfma_f32_16x16x32_bf16 v[52:55], a[228:231], a[140:143], v[52:55]
    ds_read_b64_tr_b16 a[202:203], v116 offset:26624
    v_mfma_f32_16x16x32_bf16 v[52:55], a[224:227], a[132:135], v[52:55]
    ds_read_b64_tr_b16 a[204:205], v116 offset:28672
    v_mfma_f32_16x16x32_bf16 v[52:55], a[220:223], a[124:127], v[52:55]
    ds_read_b64_tr_b16 a[206:207], v116 offset:30720
    v_mfma_f32_16x16x32_bf16 v[40:43], a[232:235], a[144:147], v[40:43]
    ds_read_b64_tr_b16 a[208:209], v116 offset:32768
    v_mfma_f32_16x16x32_bf16 v[40:43], a[236:239], a[152:155], v[40:43]
    s_lshl_b32 s12, s3, 12
    s_add_u32 s12, s12, 0x24000
    ds_read_b64_tr_b16 a[210:211], v116 offset:34816
    v_mfma_f32_16x16x32_bf16 v[40:43], a[240:243], a[160:163], v[40:43]
    s_waitcnt lgkmcnt(4)
    ds_read_b64_tr_b16 a[212:213], v117 offset:24576
    v_mfma_f32_16x16x32_bf16 v[48:51], a[240:243], a[164:167], v[48:51]
    ds_read_b64_tr_b16 a[214:215], v117 offset:26624
    v_and_b32 v1, 27, v5
    v_mfma_f32_16x16x32_bf16 v[48:51], a[236:239], a[156:159], v[48:51]
    ds_read_b64_tr_b16 a[216:217], v117 offset:28672
    v_mfma_f32_16x16x32_bf16 v[48:51], a[232:235], a[148:151], v[48:51]
    ds_read_b64_tr_b16 a[218:219], v117 offset:30720
    v_mfma_f32_16x16x32_bf16 v[44:47], a[244:247], a[144:147], v[44:47]
    ds_read_b64_tr_b16 a[220:221], v117 offset:32768
    v_mfma_f32_16x16x32_bf16 v[44:47], a[248:251], a[152:155], v[44:47]
    ds_read_b64_tr_b16 a[222:223], v117 offset:34816
    v_and_b32 v2, 3, v5
    v_mfma_f32_16x16x32_bf16 v[44:47], a[252:255], a[160:163], v[44:47]
    ds_read_b64_tr_b16 a[224:225], v116 offset:36864
    v_mfma_f32_16x16x32_bf16 v[52:55], a[252:255], a[164:167], v[52:55]
    ds_read_b64_tr_b16 a[226:227], v116 offset:38912
    v_lshrrev_b32 v3, 4, v0
    v_mfma_f32_16x16x32_bf16 v[52:55], a[248:251], a[156:159], v[52:55]
    s_waitcnt lgkmcnt(4)
    ds_read_b64_tr_b16 a[228:229], v116 offset:40960
    v_mfma_f32_16x16x32_bf16 v[52:55], a[244:247], a[148:151], v[52:55]
    ds_read_b64_tr_b16 a[230:231], v116 offset:43008
    v_mfma_f32_16x16x32_bf16 v[40:43], a[200:203], a[40:43], v[40:43]
    s_waitcnt vmcnt(5)
    ds_read_b64_tr_b16 a[232:233], v116 offset:45056
    v_mfma_f32_16x16x32_bf16 v[40:43], a[204:207], a[48:51], v[40:43]
    ds_read_b64_tr_b16 a[234:235], v116 offset:47104
    v_cmp_eq_u32 vcc, 0, v12
    v_mfma_f32_16x16x32_bf16 v[40:43], a[208:211], a[56:59], v[40:43]
    s_cbranch_vccnz L_fs_spin
L_fs_ret:
    ds_read_b64_tr_b16 a[236:237], v117 offset:36864
    v_mfma_f32_16x16x32_bf16 v[48:51], a[208:211], a[60:63], v[48:51]
    ds_read_b64_tr_b16 a[238:239], v117 offset:38912
    v_xor_b32 v2, v2, v3
    v_mfma_f32_16x16x32_bf16 v[48:51], a[204:207], a[52:55], v[48:51]
    ds_read_b64_tr_b16 a[240:241], v117 offset:40960
    ds_read_b64_tr_b16 a[242:243], v117 offset:43008
    v_mfma_f32_16x16x32_bf16 v[48:51], a[200:203], a[44:47], v[48:51]
    buffer_load_dwordx4 v[200:203], v16, s[60:63], s35 offen offset:0 sc1
    v_mfma_f32_16x16x32_bf16 v[44:47], a[212:215], a[40:43], v[44:47]
    s_waitcnt lgkmcnt(4)
    ds_read_b64_tr_b16 a[244:245], v117 offset:45056
    v_mfma_f32_16x16x32_bf16 v[44:47], a[216:219], a[48:51], v[44:47]
    ds_read_b64_tr_b16 a[246:247], v117 offset:47104
    v_lshlrev_b32 v2, 4, v2
    v_mfma_f32_16x16x32_bf16 v[44:47], a[220:223], a[56:59], v[44:47]
    ds_read_b64_tr_b16 a[248:249], v21 offset:0
    v_mfma_f32_16x16x32_bf16 v[52:55], a[220:223], a[60:63], v[52:55]
    ds_read_b64_tr_b16 a[250:251], v21 offset:2048
    v_mfma_f32_16x16x32_bf16 v[52:55], a[216:219], a[52:55], v[52:55]
    ds_read_b64_tr_b16 a[252:253], v21 offset:4096
    v_mfma_f32_16x16x32_bf16 v[52:55], a[212:215], a[44:47], v[52:55]
    ds_read_b64_tr_b16 a[254:255], v21 offset:6144
    v_lshl_add_u32 v1, v1, 7, v2
    v_mfma_f32_16x16x32_bf16 v[40:43], a[224:227], a[64:67], v[40:43]
    ds_read_b64_tr_b16 a[200:201], v21 offset:8192
    ds_read_b64_tr_b16 a[202:203], v21 offset:10240
    v_mfma_f32_16x16x32_bf16 v[40:43], a[228:231], v[120:123], v[40:43]
    buffer_load_dwordx4 v[204:207], v16, s[60:63], s35 offen offset:1024 sc1
    v_mfma_f32_16x16x32_bf16 v[40:43], a[232:235], v[128:131], v[40:43]
    s_waitcnt lgkmcnt(4)
    ds_read_b64_tr_b16 a[204:205], v22 offset:0
    v_mfma_f32_16x16x32_bf16 v[48:51], a[232:235], v[132:135], v[48:51]
    ds_read_b64_tr_b16 a[206:207], v22 offset:2048
    v_add_u32 v232, s12, v1
    v_mfma_f32_16x16x32_bf16 v[48:51], a[228:231], v[124:127], v[48:51]
    ds_read_b64_tr_b16 a[208:209], v22 offset:4096
    v_mfma_f32_16x16x32_bf16 v[48:51], a[224:227], a[68:71], v[48:51]
    ds_read_b64_tr_b16 a[210:211], v22 offset:6144
    v_lshrrev_b32 v1, 3, v0
    v_mfma_f32_16x16x32_bf16 v[44:47], a[236:239], a[64:67], v[44:47]
    ds_read_b64_tr_b16 a[212:213], v22 offset:8192
    v_mfma_f32_16x16x32_bf16 v[44:47], a[240:243], v[120:123], v[44:47]
    ds_read_b64_tr_b16 a[214:215], v22 offset:10240
    v_mfma_f32_16x16x32_bf16 v[44:47], a[244:247], v[128:131], v[44:47]
    s_waitcnt vmcnt(2)
    v_mfma_f32_16x16x32_bf16 v[52:55], a[244:247], v[132:135], v[52:55]
    buffer_store_dword v7, v7, s[60:63], 0 offen offset:896 sc1
    ds_read_b64_tr_b16 a[216:217], v21 offset:12288
    ds_read_b64_tr_b16 a[218:219], v21 offset:14336
    v_mfma_f32_16x16x32_bf16 v[52:55], a[240:243], v[124:127], v[52:55]
    s_waitcnt lgkmcnt(4)
    ds_read_b64_tr_b16 a[220:221], v21 offset:16384
    v_mfma_f32_16x16x32_bf16 v[52:55], a[236:239], a[68:71], v[52:55]
    ds_read_b64_tr_b16 a[222:223], v21 offset:18432
    v_xor_b32 v2, v1, v0
    v_mfma_f32_16x16x32_bf16 v[40:43], a[248:251], a[168:171], v[40:43]
    ds_read_b64_tr_b16 a[224:225], v21 offset:20480
    ds_read_b64_tr_b16 a[226:227], v21 offset:22528
    v_mfma_f32_16x16x32_bf16 v[40:43], a[252:255], a[176:179], v[40:43]
    buffer_load_dwordx4 v[208:211], v17, s[60:63], s35 offen offset:0 sc1
    v_mfma_f32_16x16x32_bf16 v[40:43], a[200:203], v[136:139], v[40:43]
    ds_read_b64_tr_b16 a[228:229], v22 offset:12288
    v_mfma_f32_16x16x32_bf16 v[48:51], a[200:203], v[140:143], v[48:51]
L_pf6:
    s_cbranch_execz L_rf6
    ds_read_b64_tr_b16 a[230:231], v22 offset:14336
    v_and_b32 v2, 7, v2
    v_mfma_f32_16x16x32_bf16 v[48:51], a[252:255], a[180:183], v[48:51]
    s_barrier
    v_mfma_f32_16x16x32_bf16 v[48:51], a[248:251], a[172:175], v[48:51]
    ds_read_b64_tr_b16 a[232:233], v22 offset:16384
    ds_read_b64_tr_b16 a[234:235], v22 offset:18432
    v_mfma_f32_16x16x32_bf16 v[44:47], a[204:207], a[168:171], v[44:47]
    s_waitcnt lgkmcnt(4)
    ds_read_b64_tr_b16 a[236:237], v22 offset:20480
    v_mfma_f32_16x16x32_bf16 v[44:47], a[208:211], a[176:179], v[44:47]
    ds_read_b64_tr_b16 a[238:239], v22 offset:22528
    v_mfma_f32_16x16x32_bf16 v[44:47], a[212:215], v[136:139], v[44:47]
    ds_read_b64_tr_b16 a[240:241], v21 offset:24576
    ds_read_b64_tr_b16 a[242:243], v21 offset:26624
    v_mfma_f32_16x16x32_bf16 v[52:55], a[212:215], v[140:143], v[52:55]
    buffer_load_dwordx4 v[212:215], v17, s[60:63], s35 offen offset:1024 sc1
    v_mfma_f32_16x16x32_bf16 v[52:55], a[208:211], a[180:183], v[52:55]
    ds_read_b64_tr_b16 a[244:245], v21 offset:28672
    v_mfma_f32_16x16x32_bf16 v[52:55], a[204:207], a[172:175], v[52:55]
    ds_read_b64_tr_b16 a[246:247], v21 offset:30720
    v_lshlrev_b32 v2, 4, v2
    v_mfma_f32_16x16x32_bf16 v[40:43], a[216:219], v[144:147], v[40:43]
    ds_read_b64_tr_b16 a[248:249], v21 offset:32768
    v_mfma_f32_16x16x32_bf16 v[40:43], a[220:223], v[152:155], v[40:43]
    ds_read_b64_tr_b16 a[250:251], v21 offset:34816
    v_lshl_add_u32 v2, v1, 7, v2
    v_mfma_f32_16x16x32_bf16 v[40:43], a[224:227], v[160:163], v[40:43]
    s_waitcnt lgkmcnt(4)
    ds_read_b64_tr_b16 a[252:253], v22 offset:24576
    v_mfma_f32_16x16x32_bf16 v[48:51], a[224:227], v[164:167], v[48:51]
    ds_read_b64_tr_b16 a[254:255], v22 offset:26624
    v_mfma_f32_16x16x32_bf16 v[48:51], a[220:223], v[156:159], v[48:51]
    ds_read_b64_tr_b16 a[200:201], v22 offset:28672
    v_mfma_f32_16x16x32_bf16 v[48:51], a[216:219], v[148:151], v[48:51]
    ds_read_b64_tr_b16 a[202:203], v22 offset:30720
    v_add_u32 v233, s12, v2
    v_mfma_f32_16x16x32_bf16 v[44:47], a[228:231], v[144:147], v[44:47]
    ds_read_b64_tr_b16 a[204:205], v22 offset:32768
    v_mfma_f32_16x16x32_bf16 v[44:47], a[232:235], v[152:155], v[44:47]
    ds_read_b64_tr_b16 a[206:207], v22 offset:34816
    v_xor_b32 v235, 64, v232
    v_mfma_f32_16x16x32_bf16 v[44:47], a[236:239], v[160:163], v[44:47]
    ds_read_b64_tr_b16 a[208:209], v21 offset:36864
    v_mfma_f32_16x16x32_bf16 v[52:55], a[236:239], v[164:167], v[52:55]
    ds_read_b64_tr_b16 a[210:211], v21 offset:38912
    v_mfma_f32_16x16x32_bf16 v[52:55], a[232:235], v[156:159], v[52:55]
    s_waitcnt lgkmcnt(4)
    ds_read_b64_tr_b16 a[212:213], v21 offset:40960
    v_mfma_f32_16x16x32_bf16 v[52:55], a[228:231], v[148:151], v[52:55]
    ds_read_b64_tr_b16 a[214:215], v21 offset:43008
    v_mov_b32 v1, 0xbf317218
    v_mfma_f32_16x16x32_bf16 v[40:43], a[240:243], a[184:187], v[40:43]
    ds_read_b64_tr_b16 a[216:217], v21 offset:45056
    v_mfma_f32_16x16x32_bf16 v[40:43], a[244:247], a[192:195], v[40:43]
    ds_read_b64_tr_b16 a[218:219], v21 offset:47104
    v_mfma_f32_16x16x32_bf16 v[40:43], a[248:251], v[168:171], v[40:43]
    ds_read_b64_tr_b16 a[220:221], v22 offset:36864
    v_mfma_f32_16x16x32_bf16 v[48:51], a[248:251], v[172:175], v[48:51]
    ds_read_b64_tr_b16 a[222:223], v22 offset:38912
    v_mfma_f32_16x16x32_bf16 v[48:51], a[244:247], a[196:199], v[48:51]
    ds_read_b64_tr_b16 a[224:225], v22 offset:40960
    v_mfma_f32_16x16x32_bf16 v[48:51], a[240:243], a[188:191], v[48:51]
    ds_read_b64_tr_b16 a[226:227], v22 offset:43008
    v_mfma_f32_16x16x32_bf16 v[44:47], a[252:255], a[184:187], v[44:47]
    s_waitcnt lgkmcnt(4)
    ds_read_b64_tr_b16 a[228:229], v22 offset:45056
    v_mfma_f32_16x16x32_bf16 v[44:47], a[200:203], a[192:195], v[44:47]
    ds_read_b64_tr_b16 a[230:231], v22 offset:47104
    v_mfma_f32_16x16x32_bf16 v[44:47], a[204:207], v[168:171], v[44:47]
    ds_read_b64_tr_b16 a[232:233], v114 offset:0
    v_mfma_f32_16x16x32_bf16 v[52:55], a[204:207], v[172:175], v[52:55]
    ds_read_b64_tr_b16 a[234:235], v114 offset:2048
    v_mfma_f32_16x16x32_bf16 v[52:55], a[200:203], a[196:199], v[52:55]
    ds_read_b64_tr_b16 a[236:237], v114 offset:4096
    v_mfma_f32_16x16x32_bf16 v[52:55], a[252:255], a[188:191], v[52:55]
    ds_read_b64_tr_b16 a[238:239], v114 offset:6144
    v_mfma_f32_16x16x32_bf16 v[40:43], a[208:211], v[176:179], v[40:43]
    ds_read_b64_tr_b16 a[240:241], v114 offset:8192
    v_mfma_f32_16x16x32_bf16 v[40:43], a[212:215], v[184:187], v[40:43]
    ds_read_b64_tr_b16 a[242:243], v114 offset:10240
    v_mfma_f32_16x16x32_bf16 v[40:43], a[216:219], v[192:195], v[40:43]
    s_waitcnt lgkmcnt(4)
    ds_read_b64_tr_b16 a[244:245], v115 offset:0
    v_mfma_f32_16x16x32_bf16 v[48:51], a[216:219], v[196:199], v[48:51]
    ds_read_b64_tr_b16 a[246:247], v115 offset:2048
    v_mfma_f32_16x16x32_bf16 v[48:51], a[212:215], v[188:191], v[48:51]
    ds_read_b64_tr_b16 a[248:249], v115 offset:4096
    v_mfma_f32_16x16x32_bf16 v[48:51], a[208:211], v[180:183], v[48:51]
    ds_read_b64_tr_b16 a[250:251], v115 offset:6144
    v_mfma_f32_16x16x32_bf16 v[44:47], a[220:223], v[176:179], v[44:47]
    ds_read_b64_tr_b16 a[252:253], v115 offset:8192
    v_mfma_f32_16x16x32_bf16 v[44:47], a[224:227], v[184:187], v[44:47]
    ds_read_b64_tr_b16 a[254:255], v115 offset:10240
    v_mfma_f32_16x16x32_bf16 v[44:47], a[228:231], v[192:195], v[44:47]
    ds_read_b64_tr_b16 a[200:201], v114 offset:12288
    ds_read_b64_tr_b16 a[202:203], v114 offset:14336
    v_mfma_f32_16x16x32_bf16 v[52:55], a[228:231], v[196:199], v[52:55]
    buffer_load_dword v12, v14, s[60:63], 0 offen offset:0 sc1
    v_mfma_f32_16x16x32_bf16 v[52:55], a[224:227], v[188:191], v[52:55]
    s_waitcnt lgkmcnt(4)
    ds_read_b64_tr_b16 a[204:205], v114 offset:16384
    v_mfma_f32_16x16x32_bf16 v[52:55], a[220:223], v[180:183], v[52:55]
    ds_read_b64_tr_b16 a[206:207], v114 offset:18432
    v_mfma_f32_16x16x32_bf16 v[56:59], a[232:235], v[104:107], 0
    ds_read_b64_tr_b16 a[208:209], v114 offset:20480
    v_mfma_f32_16x16x32_bf16 v[56:59], a[236:239], a[0:3], v[56:59]
    ds_read_b64_tr_b16 a[210:211], v114 offset:22528
    v_mfma_f32_16x16x32_bf16 v[56:59], a[240:243], a[8:11], v[56:59]
    ds_read_b64_tr_b16 a[212:213], v115 offset:12288
    v_mfma_f32_16x16x32_bf16 v[64:67], a[240:243], a[12:15], 0
    s_mul_i32 s10, s23, 32768
    ds_read_b64_tr_b16 a[214:215], v115 offset:14336
    v_mfma_f32_16x16x32_bf16 v[64:67], a[236:239], a[4:7], v[64:67]
    ds_read_b64_tr_b16 a[216:217], v115 offset:16384
    v_cvt_pk_bf16_f32 v40, v40, v41
    v_mfma_f32_16x16x32_bf16 v[64:67], a[232:235], v[108:111], v[64:67]
    ds_read_b64_tr_b16 a[218:219], v115 offset:18432
    v_cvt_pk_bf16_f32 v41, v42, v43
    v_cvt_pk_bf16_f32 v42, v44, v45
    v_mfma_f32_16x16x32_bf16 v[60:63], a[244:247], v[104:107], 0
    s_waitcnt lgkmcnt(4)
    ds_read_b64_tr_b16 a[220:221], v115 offset:20480
    v_cvt_pk_bf16_f32 v43, v46, v47
    v_mfma_f32_16x16x32_bf16 v[60:63], a[248:251], a[0:3], v[60:63]
    ds_read_b64_tr_b16 a[222:223], v115 offset:22528
    v_min_u32 v40, -2, v40
    v_mfma_f32_16x16x32_bf16 v[60:63], a[252:255], a[8:11], v[60:63]
    ds_read_b64_tr_b16 a[224:225], v114 offset:24576
    v_min_u32 v41, -2, v41
    v_mfma_f32_16x16x32_bf16 v[68:71], a[252:255], a[12:15], 0
    ds_read_b64_tr_b16 a[226:227], v114 offset:26624
    v_min_u32 v42, -2, v42
    v_min_u32 v43, -2, v43
    v_mfma_f32_16x16x32_bf16 v[68:71], a[248:251], a[4:7], v[68:71]
    v_mfma_f32_16x16x32_bf16 v[68:71], a[244:247], v[108:111], v[68:71]
    buffer_store_dwordx4 v[40:43], v118, s[60:63], s10 offen offset:0 sc1
    ds_read_b64_tr_b16 a[228:229], v114 offset:28672
    ds_read_b64_tr_b16 a[230:231], v114 offset:30720
    v_mfma_f32_16x16x32_bf16 v[56:59], a[200:203], a[16:19], v[56:59]
    ds_read_b64_tr_b16 a[232:233], v114 offset:32768
    v_cvt_pk_bf16_f32 v48, v48, v49
    v_mfma_f32_16x16x32_bf16 v[56:59], a[204:207], a[24:27], v[56:59]
    ds_read_b64_tr_b16 a[234:235], v114 offset:34816
    v_cvt_pk_bf16_f32 v49, v50, v51
    v_cvt_pk_bf16_f32 v50, v52, v53
    v_mfma_f32_16x16x32_bf16 v[56:59], a[208:211], a[32:35], v[56:59]
    s_waitcnt lgkmcnt(4)
    ds_read_b64_tr_b16 a[236:237], v115 offset:24576
    v_cvt_pk_bf16_f32 v51, v54, v55
    v_mfma_f32_16x16x32_bf16 v[64:67], a[208:211], a[36:39], v[64:67]
    ds_read_b64_tr_b16 a[238:239], v115 offset:26624
    v_min_u32 v48, -2, v48
    v_mfma_f32_16x16x32_bf16 v[64:67], a[204:207], a[28:31], v[64:67]
    ds_read_b64_tr_b16 a[240:241], v115 offset:28672
    v_min_u32 v49, -2, v49
    v_mfma_f32_16x16x32_bf16 v[64:67], a[200:203], a[20:23], v[64:67]
    ds_read_b64_tr_b16 a[242:243], v115 offset:30720
    v_min_u32 v50, -2, v50
    v_min_u32 v51, -2, v51
    v_mfma_f32_16x16x32_bf16 v[60:63], a[212:215], a[16:19], v[60:63]
    v_mfma_f32_16x16x32_bf16 v[60:63], a[216:219], a[24:27], v[60:63]
    buffer_store_dwordx4 v[48:51], v118, s[60:63], s10 offen offset:1024 sc1
    ds_read_b64_tr_b16 a[244:245], v115 offset:32768
    ds_read_b64_tr_b16 a[246:247], v115 offset:34816
    v_mfma_f32_16x16x32_bf16 v[60:63], a[220:223], a[32:35], v[60:63]
    ds_read_b64_tr_b16 a[248:249], v114 offset:36864
    v_mfma_f32_16x16x32_bf16 v[68:71], a[220:223], a[36:39], v[68:71]
    ds_read_b64_tr_b16 a[250:251], v114 offset:38912
    v_mfma_f32_16x16x32_bf16 v[68:71], a[216:219], a[28:31], v[68:71]
    s_waitcnt lgkmcnt(4)
    ds_read_b64_tr_b16 a[252:253], v114 offset:40960
    v_mfma_f32_16x16x32_bf16 v[68:71], a[212:215], a[20:23], v[68:71]
    ds_read_b64_tr_b16 a[254:255], v114 offset:43008
    v_mfma_f32_16x16x32_bf16 v[56:59], a[224:227], a[72:75], v[56:59]
    ds_read_b64_tr_b16 a[200:201], v114 offset:45056
    v_mfma_f32_16x16x32_bf16 v[56:59], a[228:231], a[80:83], v[56:59]
    ds_read_b64_tr_b16 a[202:203], v114 offset:47104
    v_mfma_f32_16x16x32_bf16 v[56:59], a[232:235], a[88:91], v[56:59]
    ds_read_b64_tr_b16 a[204:205], v115 offset:36864
    v_mfma_f32_16x16x32_bf16 v[64:67], a[232:235], a[92:95], v[64:67]
    ds_read_b64_tr_b16 a[206:207], v115 offset:38912
    v_mfma_f32_16x16x32_bf16 v[64:67], a[228:231], a[84:87], v[64:67]
    ds_read_b64_tr_b16 a[208:209], v115 offset:40960
    v_mfma_f32_16x16x32_bf16 v[64:67], a[224:227], a[76:79], v[64:67]
    ds_read_b64_tr_b16 a[210:211], v115 offset:43008
    v_mfma_f32_16x16x32_bf16 v[60:63], a[236:239], a[72:75], v[60:63]
    s_waitcnt lgkmcnt(4)
    ds_read_b64_tr_b16 a[212:213], v115 offset:45056
    v_mfma_f32_16x16x32_bf16 v[60:63], a[240:243], a[80:83], v[60:63]
    ds_read_b64_tr_b16 a[214:215], v115 offset:47104
    v_mfma_f32_16x16x32_bf16 v[60:63], a[244:247], a[88:91], v[60:63]
    ds_read_b64_tr_b16 a[216:217], v19 offset:0
    v_mfma_f32_16x16x32_bf16 v[68:71], a[244:247], a[92:95], v[68:71]
    ds_read_b64_tr_b16 a[218:219], v19 offset:2048
    v_mfma_f32_16x16x32_bf16 v[68:71], a[240:243], a[84:87], v[68:71]
    ds_read_b64_tr_b16 a[220:221], v19 offset:4096
    v_mfma_f32_16x16x32_bf16 v[68:71], a[236:239], a[76:79], v[68:71]
    ds_read_b64_tr_b16 a[222:223], v19 offset:6144
    v_mfma_f32_16x16x32_bf16 v[56:59], a[248:251], a[96:99], v[56:59]
    ds_read_b64_tr_b16 a[224:225], v19 offset:8192
    v_mfma_f32_16x16x32_bf16 v[56:59], a[252:255], a[104:107], v[56:59]
    ds_read_b64_tr_b16 a[226:227], v19 offset:10240
    v_mfma_f32_16x16x32_bf16 v[56:59], a[200:203], a[112:115], v[56:59]
    s_waitcnt lgkmcnt(4)
    ds_read_b64_tr_b16 a[228:229], v20 offset:0
    v_mfma_f32_16x16x32_bf16 v[64:67], a[200:203], a[116:119], v[64:67]
    ds_read_b64_tr_b16 a[230:231], v20 offset:2048
    v_mfma_f32_16x16x32_bf16 v[64:67], a[252:255], a[108:111], v[64:67]
    ds_read_b64_tr_b16 a[232:233], v20 offset:4096
    v_mfma_f32_16x16x32_bf16 v[64:67], a[248:251], a[100:103], v[64:67]
    ds_read_b64_tr_b16 a[234:235], v20 offset:6144
    v_mfma_f32_16x16x32_bf16 v[60:63], a[204:207], a[96:99], v[60:63]
    ds_read_b64_tr_b16 a[236:237], v20 offset:8192
    v_mfma_f32_16x16x32_bf16 v[60:63], a[208:211], a[104:107], v[60:63]
    ds_read_b64_tr_b16 a[238:239], v20 offset:10240
    v_mfma_f32_16x16x32_bf16 v[60:63], a[212:215], a[112:115], v[60:63]
    ds_read_b64_tr_b16 a[240:241], v19 offset:12288
    v_mfma_f32_16x16x32_bf16 v[68:71], a[212:215], a[116:119], v[68:71]
    ds_read_b64_tr_b16 a[242:243], v19 offset:14336
    v_mfma_f32_16x16x32_bf16 v[68:71], a[208:211], a[108:111], v[68:71]
    s_waitcnt lgkmcnt(4)
    ds_read_b64_tr_b16 a[244:245], v19 offset:16384
    v_mfma_f32_16x16x32_bf16 v[68:71], a[204:207], a[100:103], v[68:71]
    ds_read_b64_tr_b16 a[246:247], v19 offset:18432
    v_mfma_f32_16x16x32_bf16 v[56:59], a[216:219], a[120:123], v[56:59]
    ds_read_b64_tr_b16 a[248:249], v19 offset:20480
    v_mfma_f32_16x16x32_bf16 v[56:59], a[220:223], a[128:131], v[56:59]
    ds_read_b64_tr_b16 a[250:251], v19 offset:22528
    v_mfma_f32_16x16x32_bf16 v[56:59], a[224:227], a[136:139], v[56:59]
    ds_read_b64_tr_b16 a[252:253], v20 offset:12288
    v_mfma_f32_16x16x32_bf16 v[64:67], a[224:227], a[140:143], v[64:67]
    ds_read_b64_tr_b16 a[254:255], v20 offset:14336
    v_mfma_f32_16x16x32_bf16 v[64:67], a[220:223], a[132:135], v[64:67]
    s_waitcnt vmcnt(2)
    ds_read_b64_tr_b16 a[200:201], v20 offset:16384
    v_mfma_f32_16x16x32_bf16 v[64:67], a[216:219], a[124:127], v[64:67]
    ds_read_b64_tr_b16 a[202:203], v20 offset:18432
    v_cmp_eq_u32 vcc, 0, v12
    v_mfma_f32_16x16x32_bf16 v[60:63], a[228:231], a[120:123], v[60:63]
    s_cbranch_vccnz L_fb_spin
L_fb_ret:
    s_waitcnt lgkmcnt(4)
    ds_read_b64_tr_b16 a[204:205], v20 offset:20480
    v_mfma_f32_16x16x32_bf16 v[60:63], a[232:235], a[128:131], v[60:63]
    ds_read_b64_tr_b16 a[206:207], v20 offset:22528
    v_mfma_f32_16x16x32_bf16 v[60:63], a[236:239], a[136:139], v[60:63]
    ds_read_b64_tr_b16 a[208:209], v19 offset:24576
    ds_read_b64_tr_b16 a[210:211], v19 offset:26624
    v_mfma_f32_16x16x32_bf16 v[68:71], a[236:239], a[140:143], v[68:71]
    buffer_load_dwordx4 v[216:219], v16, s[60:63], s37 offen offset:0 sc1
    v_mfma_f32_16x16x32_bf16 v[68:71], a[232:235], a[132:135], v[68:71]
    ds_read_b64_tr_b16 a[212:213], v19 offset:28672
    v_mfma_f32_16x16x32_bf16 v[68:71], a[228:231], a[124:127], v[68:71]
    ds_read_b64_tr_b16 a[214:215], v19 offset:30720
    v_mfma_f32_16x16x32_bf16 v[56:59], a[240:243], a[144:147], v[56:59]
    ds_read_b64_tr_b16 a[216:217], v19 offset:32768
    ds_read_b64_tr_b16 a[218:219], v19 offset:34816
    v_mfma_f32_16x16x32_bf16 v[56:59], a[244:247], a[152:155], v[56:59]
    buffer_load_dwordx4 v[220:223], v16, s[60:63], s37 offen offset:1024 sc1
    v_mfma_f32_16x16x32_bf16 v[56:59], a[248:251], a[160:163], v[56:59]
    s_waitcnt lgkmcnt(4)
    ds_read_b64_tr_b16 a[220:221], v20 offset:24576
    v_mfma_f32_16x16x32_bf16 v[64:67], a[248:251], a[164:167], v[64:67]
    ds_read_b64_tr_b16 a[222:223], v20 offset:26624
    v_mfma_f32_16x16x32_bf16 v[64:67], a[244:247], a[156:159], v[64:67]
    ds_read_b64_tr_b16 a[224:225], v20 offset:28672
    ds_read_b64_tr_b16 a[226:227], v20 offset:30720
    v_mfma_f32_16x16x32_bf16 v[64:67], a[240:243], a[148:151], v[64:67]
    buffer_load_dwordx4 v[224:227], v17, s[60:63], s37 offen offset:0 sc1
    v_mfma_f32_16x16x32_bf16 v[60:63], a[252:255], a[144:147], v[60:63]
    ds_read_b64_tr_b16 a[228:229], v20 offset:32768
    v_mfma_f32_16x16x32_bf16 v[60:63], a[200:203], a[152:155], v[60:63]
    ds_read_b64_tr_b16 a[230:231], v20 offset:34816
    v_mfma_f32_16x16x32_bf16 v[60:63], a[204:207], a[160:163], v[60:63]
    ds_read_b64_tr_b16 a[232:233], v19 offset:36864
    ds_read_b64_tr_b16 a[234:235], v19 offset:38912
    v_mfma_f32_16x16x32_bf16 v[68:71], a[204:207], a[164:167], v[68:71]
    buffer_load_dwordx4 v[228:231], v17, s[60:63], s37 offen offset:1024 sc1
    v_mfma_f32_16x16x32_bf16 v[68:71], a[200:203], a[156:159], v[68:71]
    s_waitcnt lgkmcnt(4)
    ds_read_b64_tr_b16 a[236:237], v19 offset:40960
    v_mfma_f32_16x16x32_bf16 v[68:71], a[252:255], a[148:151], v[68:71]
    ds_read_b64_tr_b16 a[238:239], v19 offset:43008
    v_mfma_f32_16x16x32_bf16 v[56:59], a[208:211], a[40:43], v[56:59]
    ds_read_b64_tr_b16 a[240:241], v19 offset:45056
    v_mfma_f32_16x16x32_bf16 v[56:59], a[212:215], a[48:51], v[56:59]
    ds_read_b64_tr_b16 a[242:243], v19 offset:47104
    v_mfma_f32_16x16x32_bf16 v[56:59], a[216:219], a[56:59], v[56:59]
    ds_read_b64_tr_b16 a[244:245], v20 offset:36864
    v_mfma_f32_16x16x32_bf16 v[64:67], a[216:219], a[60:63], v[64:67]
    ds_read_b64_tr_b16 a[246:247], v20 offset:38912
    v_mfma_f32_16x16x32_bf16 v[64:67], a[212:215], a[52:55], v[64:67]
    ds_read_b64_tr_b16 a[248:249], v20 offset:40960
    ds_read_b64_tr_b16 a[250:251], v20 offset:43008
    v_mfma_f32_16x16x32_bf16 v[64:67], a[208:211], a[44:47], v[64:67]
    buffer_load_dword v12, v15, s[60:63], 0 offen offset:0 sc1
    v_mfma_f32_16x16x32_bf16 v[60:63], a[220:223], a[40:43], v[60:63]
    s_waitcnt lgkmcnt(4)
    ds_read_b64_tr_b16 a[252:253], v20 offset:45056
    v_mfma_f32_16x16x32_bf16 v[60:63], a[224:227], a[48:51], v[60:63]
    ds_read_b64_tr_b16 a[254:255], v20 offset:47104
    v_mfma_f32_16x16x32_bf16 v[60:63], a[228:231], a[56:59], v[60:63]
    ds_read_b64_tr_b16 a[200:201], v23 offset:0
    v_mfma_f32_16x16x32_bf16 v[68:71], a[228:231], a[60:63], v[68:71]
    ds_read_b64_tr_b16 a[202:203], v23 offset:2048
    v_mfma_f32_16x16x32_bf16 v[68:71], a[224:227], a[52:55], v[68:71]
    ds_read_b64_tr_b16 a[204:205], v23 offset:4096
    v_mfma_f32_16x16x32_bf16 v[68:71], a[220:223], a[44:47], v[68:71]
    ds_read_b64_tr_b16 a[206:207], v23 offset:6144
    v_mfma_f32_16x16x32_bf16 v[56:59], a[232:235], a[64:67], v[56:59]
    ds_read_b64_tr_b16 a[208:209], v23 offset:8192
    v_mfma_f32_16x16x32_bf16 v[56:59], a[236:239], v[120:123], v[56:59]
    ds_read_b64_tr_b16 a[210:211], v23 offset:10240
    v_mfma_f32_16x16x32_bf16 v[56:59], a[240:243], v[128:131], v[56:59]
    s_waitcnt lgkmcnt(4)
    ds_read_b64_tr_b16 a[212:213], v24 offset:0
    v_mfma_f32_16x16x32_bf16 v[64:67], a[240:243], v[132:135], v[64:67]
    ds_read_b64_tr_b16 a[214:215], v24 offset:2048
    v_mfma_f32_16x16x32_bf16 v[64:67], a[236:239], v[124:127], v[64:67]
    ds_read_b64_tr_b16 a[216:217], v24 offset:4096
    v_mfma_f32_16x16x32_bf16 v[64:67], a[232:235], a[68:71], v[64:67]
    ds_read_b64_tr_b16 a[218:219], v24 offset:6144
    v_mfma_f32_16x16x32_bf16 v[60:63], a[244:247], a[64:67], v[60:63]
    ds_read_b64_tr_b16 a[220:221], v24 offset:8192
    v_mfma_f32_16x16x32_bf16 v[60:63], a[248:251], v[120:123], v[60:63]
    ds_read_b64_tr_b16 a[222:223], v24 offset:10240
    v_mfma_f32_16x16x32_bf16 v[60:63], a[252:255], v[128:131], v[60:63]
    ds_read_b64_tr_b16 a[224:225], v23 offset:12288
    v_mfma_f32_16x16x32_bf16 v[68:71], a[252:255], v[132:135], v[68:71]
    ds_read_b64_tr_b16 a[226:227], v23 offset:14336
    v_mfma_f32_16x16x32_bf16 v[68:71], a[248:251], v[124:127], v[68:71]
    s_waitcnt lgkmcnt(4)
    ds_read_b64_tr_b16 a[228:229], v23 offset:16384
    v_mfma_f32_16x16x32_bf16 v[68:71], a[244:247], a[68:71], v[68:71]
    ds_read_b64_tr_b16 a[230:231], v23 offset:18432
    v_mfma_f32_16x16x32_bf16 v[56:59], a[200:203], a[168:171], v[56:59]
    ds_read_b64_tr_b16 a[232:233], v23 offset:20480
    v_mfma_f32_16x16x32_bf16 v[56:59], a[204:207], a[176:179], v[56:59]
    ds_read_b64_tr_b16 a[234:235], v23 offset:22528
    v_mfma_f32_16x16x32_bf16 v[56:59], a[208:211], v[136:139], v[56:59]
    ds_read_b64_tr_b16 a[236:237], v24 offset:12288
    v_mfma_f32_16x16x32_bf16 v[64:67], a[208:211], v[140:143], v[64:67]
    ds_read_b64_tr_b16 a[238:239], v24 offset:14336
    v_mfma_f32_16x16x32_bf16 v[64:67], a[204:207], a[180:183], v[64:67]
    ds_read_b64_tr_b16 a[240:241], v24 offset:16384
    v_mfma_f32_16x16x32_bf16 v[64:67], a[200:203], a[172:175], v[64:67]
    ds_read_b64_tr_b16 a[242:243], v24 offset:18432
    v_mfma_f32_16x16x32_bf16 v[60:63], a[212:215], a[168:171], v[60:63]
    s_waitcnt lgkmcnt(4)
    ds_read_b64_tr_b16 a[244:245], v24 offset:20480
    v_mfma_f32_16x16x32_bf16 v[60:63], a[216:219], a[176:179], v[60:63]
    ds_read_b64_tr_b16 a[246:247], v24 offset:22528
    v_mfma_f32_16x16x32_bf16 v[60:63], a[220:223], v[136:139], v[60:63]
    ds_read_b64_tr_b16 a[248:249], v23 offset:24576
    v_mfma_f32_16x16x32_bf16 v[68:71], a[220:223], v[140:143], v[68:71]
    ds_read_b64_tr_b16 a[250:251], v23 offset:26624
    v_mfma_f32_16x16x32_bf16 v[68:71], a[216:219], a[180:183], v[68:71]
    s_xor_b32 s11, s6, 1
    ds_read_b64_tr_b16 a[252:253], v23 offset:28672
    ds_read_b64_tr_b16 a[254:255], v23 offset:30720
    v_mfma_f32_16x16x32_bf16 v[68:71], a[212:215], a[172:175], v[68:71]
    s_lshl_b32 s11, s11, 12
    buffer_load_dwordx4 v[28:31], v16, s[60:63], s11 offen offset:0 sc1
    v_mfma_f32_16x16x32_bf16 v[56:59], a[224:227], v[144:147], v[56:59]
    ds_read_b64_tr_b16 a[200:201], v23 offset:32768
    ds_read_b64_tr_b16 a[202:203], v23 offset:34816
    v_mfma_f32_16x16x32_bf16 v[56:59], a[228:231], v[152:155], v[56:59]
    buffer_load_dwordx4 v[36:39], v16, s[60:63], s11 offen offset:1024 sc1
    v_mfma_f32_16x16x32_bf16 v[56:59], a[232:235], v[160:163], v[56:59]
    s_waitcnt lgkmcnt(4)
    ds_read_b64_tr_b16 a[204:205], v24 offset:24576
    v_mfma_f32_16x16x32_bf16 v[64:67], a[232:235], v[164:167], v[64:67]
    ds_read_b64_tr_b16 a[206:207], v24 offset:26624
    v_mfma_f32_16x16x32_bf16 v[64:67], a[228:231], v[156:159], v[64:67]
    ds_read_b64_tr_b16 a[208:209], v24 offset:28672
    v_mfma_f32_16x16x32_bf16 v[64:67], a[224:227], v[148:151], v[64:67]
    ds_read_b64_tr_b16 a[210:211], v24 offset:30720
    v_mfma_f32_16x16x32_bf16 v[60:63], a[236:239], v[144:147], v[60:63]
    ds_read_b64_tr_b16 a[212:213], v24 offset:32768
    v_mfma_f32_16x16x32_bf16 v[60:63], a[240:243], v[152:155], v[60:63]
    ds_read_b64_tr_b16 a[214:215], v24 offset:34816
    v_mfma_f32_16x16x32_bf16 v[60:63], a[244:247], v[160:163], v[60:63]
    ds_read_b64_tr_b16 a[216:217], v23 offset:36864
    v_mfma_f32_16x16x32_bf16 v[68:71], a[244:247], v[164:167], v[68:71]
    ds_read_b64_tr_b16 a[218:219], v23 offset:38912
    v_mfma_f32_16x16x32_bf16 v[68:71], a[240:243], v[156:159], v[68:71]
    s_waitcnt lgkmcnt(4)
    ds_read_b64_tr_b16 a[220:221], v23 offset:40960
    v_mfma_f32_16x16x32_bf16 v[68:71], a[236:239], v[148:151], v[68:71]
    ds_read_b64_tr_b16 a[222:223], v23 offset:43008
    v_mfma_f32_16x16x32_bf16 v[56:59], a[248:251], a[184:187], v[56:59]
    ds_read_b64_tr_b16 a[224:225], v23 offset:45056
    v_mfma_f32_16x16x32_bf16 v[56:59], a[252:255], a[192:195], v[56:59]
    ds_read_b64_tr_b16 a[226:227], v23 offset:47104
    v_mfma_f32_16x16x32_bf16 v[56:59], a[200:203], v[168:171], v[56:59]
    ds_read_b64_tr_b16 a[228:229], v24 offset:36864
    v_mfma_f32_16x16x32_bf16 v[64:67], a[200:203], v[172:175], v[64:67]
    ds_read_b64_tr_b16 a[230:231], v24 offset:38912
    v_mfma_f32_16x16x32_bf16 v[64:67], a[252:255], a[196:199], v[64:67]
    s_waitcnt vmcnt(2)
    ds_read_b64_tr_b16 a[232:233], v24 offset:40960
    v_mfma_f32_16x16x32_bf16 v[64:67], a[248:251], a[188:191], v[64:67]
    ds_read_b64_tr_b16 a[234:235], v24 offset:43008
    v_cmp_eq_u32 vcc, 0, v12
    v_mfma_f32_16x16x32_bf16 v[60:63], a[204:207], a[184:187], v[60:63]
    s_cbranch_vccnz L_fl_spin
L_fl_ret:
    s_waitcnt lgkmcnt(4)
    ds_read_b64_tr_b16 a[236:237], v24 offset:45056
    v_mfma_f32_16x16x32_bf16 v[60:63], a[208:211], a[192:195], v[60:63]
    ds_read_b64_tr_b16 a[238:239], v24 offset:47104
    v_mfma_f32_16x16x32_bf16 v[60:63], a[212:215], v[168:171], v[60:63]
    v_mfma_f32_16x16x32_bf16 v[68:71], a[212:215], v[172:175], v[68:71]
    buffer_load_dwordx4 v[40:43], v16, s[60:63], s36 offen offset:0 sc1
    v_mfma_f32_16x16x32_bf16 v[68:71], a[208:211], a[196:199], v[68:71]
    v_mfma_f32_16x16x32_bf16 v[68:71], a[204:207], a[188:191], v[68:71]
    buffer_load_dwordx4 v[44:47], v16, s[60:63], s36 offen offset:1024 sc1
    v_mfma_f32_16x16x32_bf16 v[56:59], a[216:219], v[176:179], v[56:59]
    v_mfma_f32_16x16x32_bf16 v[56:59], a[220:223], v[184:187], v[56:59]
    buffer_load_dwordx4 v[48:51], v17, s[60:63], s36 offen offset:0 sc1
    v_mfma_f32_16x16x32_bf16 v[56:59], a[224:227], v[192:195], v[56:59]
    s_waitcnt lgkmcnt(0)
    v_mfma_f32_16x16x32_bf16 v[64:67], a[224:227], v[196:199], v[64:67]
    v_mfma_f32_16x16x32_bf16 v[64:67], a[220:223], v[188:191], v[64:67]
    v_mfma_f32_16x16x32_bf16 v[64:67], a[216:219], v[180:183], v[64:67]
    buffer_load_dwordx4 v[52:55], v17, s[60:63], s36 offen offset:1024 sc1
    v_mfma_f32_16x16x32_bf16 v[60:63], a[228:231], v[176:179], v[60:63]
    v_mfma_f32_16x16x32_bf16 v[60:63], a[232:235], v[184:187], v[60:63]
    v_mfma_f32_16x16x32_bf16 v[60:63], a[236:239], v[192:195], v[60:63]
    v_mfma_f32_16x16x32_bf16 v[68:71], a[236:239], v[196:199], v[68:71]
    v_mfma_f32_16x16x32_bf16 v[68:71], a[232:235], v[188:191], v[68:71]
    v_mfma_f32_16x16x32_bf16 v[68:71], a[228:231], v[180:183], v[68:71]
    s_mov_b32 s12, 0x3f80
    s_mov_b32 s13, 0x3f800000
    v_dot2c_f32_bf16 v56, s12, v200
    v_dot2c_f32_bf16 v57, s13, v200
    v_dot2c_f32_bf16 v58, s12, v201
    v_dot2c_f32_bf16 v59, s13, v201
    v_dot2c_f32_bf16 v60, s12, v202
    v_dot2c_f32_bf16 v61, s13, v202
    v_dot2c_f32_bf16 v62, s12, v203
    v_dot2c_f32_bf16 v63, s13, v203
    v_dot2c_f32_bf16 v64, s12, v204
    v_dot2c_f32_bf16 v65, s13, v204
    v_dot2c_f32_bf16 v66, s12, v205
    v_dot2c_f32_bf16 v67, s13, v205
    v_dot2c_f32_bf16 v68, s12, v206
    v_dot2c_f32_bf16 v69, s13, v206
    v_dot2c_f32_bf16 v70, s12, v207
    v_dot2c_f32_bf16 v71, s13, v207
    v_dot2c_f32_bf16 v56, s12, v208
    v_dot2c_f32_bf16 v57, s13, v208
    v_dot2c_f32_bf16 v58, s12, v209
    v_dot2c_f32_bf16 v59, s13, v209
    v_dot2c_f32_bf16 v60, s12, v210
    v_dot2c_f32_bf16 v61, s13, v210
    v_dot2c_f32_bf16 v62, s12, v211
    v_dot2c_f32_bf16 v63, s13, v211
    v_dot2c_f32_bf16 v64, s12, v212
    v_dot2c_f32_bf16 v65, s13, v212
    v_dot2c_f32_bf16 v66, s12, v213
    v_dot2c_f32_bf16 v67, s13, v213
    v_dot2c_f32_bf16 v68, s12, v214
    v_dot2c_f32_bf16 v69, s13, v214
    v_dot2c_f32_bf16 v70, s12, v215
    v_dot2c_f32_bf16 v71, s13, v215
    v_dot2c_f32_bf16 v56, s12, v216
    v_dot2c_f32_bf16 v57, s13, v216
    v_dot2c_f32_bf16 v58, s12, v217
    v_dot2c_f32_bf16 v59, s13, v217
    v_dot2c_f32_bf16 v60, s12, v218
    v_dot2c_f32_bf16 v61, s13, v218
    v_dot2c_f32_bf16 v62, s12, v219
    v_dot2c_f32_bf16 v63, s13, v219
    v_dot2c_f32_bf16 v64, s12, v220
    v_dot2c_f32_bf16 v65, s13, v220
    v_dot2c_f32_bf16 v66, s12, v221
    v_dot2c_f32_bf16 v67, s13, v221
    v_dot2c_f32_bf16 v68, s12, v222
    v_dot2c_f32_bf16 v69, s13, v222
    v_dot2c_f32_bf16 v70, s12, v223
    v_dot2c_f32_bf16 v71, s13, v223
    v_dot2c_f32_bf16 v56, s12, v224
    v_dot2c_f32_bf16 v57, s13, v224
    v_dot2c_f32_bf16 v58, s12, v225
    v_dot2c_f32_bf16 v59, s13, v225
    v_dot2c_f32_bf16 v60, s12, v226
    v_dot2c_f32_bf16 v61, s13, v226
    v_dot2c_f32_bf16 v62, s12, v227
    v_dot2c_f32_bf16 v63, s13, v227
    v_dot2c_f32_bf16 v64, s12, v228
    v_dot2c_f32_bf16 v65, s13, v228
    v_dot2c_f32_bf16 v66, s12, v229
    v_dot2c_f32_bf16 v67, s13, v229
    v_dot2c_f32_bf16 v68, s12, v230
    v_dot2c_f32_bf16 v69, s13, v230
    v_dot2c_f32_bf16 v70, s12, v231
    v_dot2c_f32_bf16 v71, s13, v231
    s_waitcnt vmcnt(4)
    v_max3_u32 v2, v28, v29, v30
    v_max3_u32 v3, v36, v37, v38
    v_max3_u32 v2, v2, v31, v39
    v_max_u32 v2, v2, v3
    v_cmp_eq_u32 vcc, -1, v2
    s_nop 1
    s_cbranch_vccnz L_fz_spin
L_fz_ret:
    v_dot2c_f32_bf16 v56, s12, v28
    v_dot2c_f32_bf16 v57, s13, v28
    v_dot2c_f32_bf16 v58, s12, v29
    v_dot2c_f32_bf16 v59, s13, v29
    v_dot2c_f32_bf16 v60, s12, v30
    v_dot2c_f32_bf16 v61, s13, v30
    v_dot2c_f32_bf16 v62, s12, v31
    v_dot2c_f32_bf16 v63, s13, v31
    v_dot2c_f32_bf16 v64, s12, v36
    v_dot2c_f32_bf16 v65, s13, v36
    v_dot2c_f32_bf16 v66, s12, v37
    v_dot2c_f32_bf16 v67, s13, v37
    v_dot2c_f32_bf16 v68, s12, v38
    v_dot2c_f32_bf16 v69, s13, v38
    v_dot2c_f32_bf16 v70, s12, v39
    v_dot2c_f32_bf16 v71, s13, v39
    s_waitcnt vmcnt(3)
    v_dot2c_f32_bf16 v56, s12, v40
    v_dot2c_f32_bf16 v57, s13, v40
    v_dot2c_f32_bf16 v58, s12, v41
    v_dot2c_f32_bf16 v59, s13, v41
    v_dot2c_f32_bf16 v60, s12, v42
    v_dot2c_f32_bf16 v61, s13, v42
    v_dot2c_f32_bf16 v62, s12, v43
    v_dot2c_f32_bf16 v63, s13, v43
    s_waitcnt vmcnt(2)
    v_dot2c_f32_bf16 v64, s12, v44
    v_dot2c_f32_bf16 v65, s13, v44
    v_dot2c_f32_bf16 v66, s12, v45
    v_dot2c_f32_bf16 v67, s13, v45
    v_dot2c_f32_bf16 v68, s12, v46
    v_dot2c_f32_bf16 v69, s13, v46
    v_dot2c_f32_bf16 v70, s12, v47
    v_dot2c_f32_bf16 v71, s13, v47
    s_waitcnt vmcnt(1)
    v_dot2c_f32_bf16 v56, s12, v48
    v_dot2c_f32_bf16 v57, s13, v48
    v_dot2c_f32_bf16 v58, s12, v49
    v_dot2c_f32_bf16 v59, s13, v49
    v_dot2c_f32_bf16 v60, s12, v50
    v_dot2c_f32_bf16 v61, s13, v50
    v_dot2c_f32_bf16 v62, s12, v51
    v_dot2c_f32_bf16 v63, s13, v51
    s_waitcnt vmcnt(0)
    v_dot2c_f32_bf16 v64, s12, v52
    v_dot2c_f32_bf16 v65, s13, v52
    v_dot2c_f32_bf16 v66, s12, v53
    v_dot2c_f32_bf16 v67, s13, v53
    v_dot2c_f32_bf16 v68, s12, v54
    v_dot2c_f32_bf16 v69, s13, v54
    v_dot2c_f32_bf16 v70, s12, v55
    v_dot2c_f32_bf16 v71, s13, v55
    ds_write_b128 v232, v[56:59] offset:0
    ds_write_b128 v235, v[60:63] offset:0
    ds_write_b128 v235, v[64:67] offset:512
    ds_write_b128 v232, v[68:71] offset:512
    ds_read_b128 v[240:243], v233 offset:0
    ds_read_b128 v[244:247], v233 offset:1024
    ds_read_b128 v[248:251], v233 offset:2048
    ds_read_b128 v[252:255], v233 offset:3072
    s_waitcnt lgkmcnt(3)
    v_fma_f32 v240, v240, v1, v88
    v_fma_f32 v241, v241, v1, v89
    v_fma_f32 v242, v242, v1, v90
    v_fma_f32 v243, v243, v1, v91
    s_mov_b32 s11, 0
    buffer_store_dwordx4 v[240:243], v234, s[64:67], s11 offen sc1
    s_waitcnt lgkmcnt(2)
    v_fma_f32 v244, v244, v1, v92
    v_fma_f32 v245, v245, v1, v93
    v_fma_f32 v246, v246, v1, v94
    v_fma_f32 v247, v247, v1, v95
    s_mov_b32 s11, 18432
    buffer_store_dwordx4 v[244:247], v234, s[64:67], s11 offen sc1
    s_waitcnt lgkmcnt(1)
    v_fma_f32 v248, v248, v1, v96
    v_fma_f32 v249, v249, v1, v97
    v_fma_f32 v250, v250, v1, v98
    v_fma_f32 v251, v251, v1, v99
    s_mov_b32 s11, 36864
    buffer_store_dwordx4 v[248:251], v234, s[64:67], s11 offen sc1
    s_waitcnt lgkmcnt(0)
    v_fma_f32 v252, v252, v1, v100
    v_fma_f32 v253, v253, v1, v101
    v_fma_f32 v254, v254, v1, v102
    v_fma_f32 v255, v255, v1, v103
    s_mov_b32 s11, 55296
    buffer_store_dwordx4 v[252:255], v234, s[64:67], s11 offen sc1
    s_endpgm
L_pf10:
    s_branch L_rf10
L_fc_spin:
    global_load_dword v12, v2, s[42:43] sc1
    s_add_u32 s69, s69, 1
    s_cmp_lt_u32 s69, 0x800000
    s_cselect_b64 s[100:101], -1, 0
    s_waitcnt vmcnt(0)
    v_cmp_gt_u32 vcc, 16, v12
    s_nop 0
    s_and_b64 vcc, vcc, s[100:101]
    s_cbranch_scc1 L_fc_spin
    s_branch L_fc_ret
L_fh0_spin:
    buffer_load_dword v12, v9, s[60:63], 0 offen offset:0 sc1
    s_add_u32 s69, s69, 1
    s_cmp_lt_u32 s69, 0x800000
    s_cselect_b64 s[100:101], -1, 0
    s_waitcnt vmcnt(0)
    v_cmp_eq_u32 vcc, 0, v12
    s_nop 0
    s_and_b64 vcc, vcc, s[100:101]
    s_cbranch_scc1 L_fh0_spin
    s_branch L_fh0_ret
L_fh1_spin:
    buffer_load_dword v12, v9, s[60:63], 0 offen offset:128 sc1
    s_add_u32 s69, s69, 1
    s_cmp_lt_u32 s69, 0x800000
    s_cselect_b64 s[100:101], -1, 0
    s_waitcnt vmcnt(0)
    v_cmp_eq_u32 vcc, 0, v12
    s_nop 0
    s_and_b64 vcc, vcc, s[100:101]
    s_cbranch_scc1 L_fh1_spin
    s_branch L_fh1_ret
L_fh3_spin:
    buffer_load_dword v12, v9, s[60:63], 0 offen offset:384 sc1
    s_add_u32 s69, s69, 1
    s_cmp_lt_u32 s69, 0x800000
    s_cselect_b64 s[100:101], -1, 0
    s_waitcnt vmcnt(0)
    v_cmp_eq_u32 vcc, 0, v12
    s_nop 0
    s_and_b64 vcc, vcc, s[100:101]
    s_cbranch_scc1 L_fh3_spin
    s_branch L_fh3_ret
L_fs_spin:
    buffer_load_dword v12, v13, s[60:63], 0 offen offset:0 sc1
    s_add_u32 s69, s69, 1
    s_cmp_lt_u32 s69, 0x800000
    s_cselect_b64 s[100:101], -1, 0
    s_waitcnt vmcnt(0)
    v_cmp_eq_u32 vcc, 0, v12
    s_nop 0
    s_and_b64 vcc, vcc, s[100:101]
    s_cbranch_scc1 L_fs_spin
    s_branch L_fs_ret
L_fb_spin:
    buffer_load_dword v12, v14, s[60:63], 0 offen offset:0 sc1
    s_add_u32 s69, s69, 1
    s_cmp_lt_u32 s69, 0x800000
    s_cselect_b64 s[100:101], -1, 0
    s_waitcnt vmcnt(0)
    v_cmp_eq_u32 vcc, 0, v12
    s_nop 0
    s_and_b64 vcc, vcc, s[100:101]
    s_cbranch_scc1 L_fb_spin
    s_branch L_fb_ret
L_fl_spin:
    buffer_load_dword v12, v15, s[60:63], 0 offen offset:0 sc1
    s_add_u32 s69, s69, 1
    s_cmp_lt_u32 s69, 0x800000
    s_cselect_b64 s[100:101], -1, 0
    s_waitcnt vmcnt(0)
    v_cmp_eq_u32 vcc, 0, v12
    s_nop 0
    s_and_b64 vcc, vcc, s[100:101]
    s_cbranch_scc1 L_fl_spin
    s_branch L_fl_ret
L_fz_spin:
    buffer_load_dwordx4 v[28:31], v16, s[60:63], s11 offen offset:0 sc1
    buffer_load_dwordx4 v[36:39], v16, s[60:63], s11 offen offset:1024 sc1
    s_waitcnt vmcnt(0)
    v_max3_u32 v2, v28, v29, v30
    v_max3_u32 v3, v36, v37, v38
    v_max3_u32 v2, v2, v31, v39
    v_max_u32 v2, v2, v3
    s_add_u32 s69, s69, 1
    s_cmp_lt_u32 s69, 0x800000
    s_cselect_b64 s[100:101], -1, 0
    s_waitcnt vmcnt(0)
    v_cmp_eq_u32 vcc, -1, v2
    s_nop 0
    s_and_b64 vcc, vcc, s[100:101]
    s_cbranch_scc1 L_fz_spin
    s_branch L_fz_ret
L_ssm:
    s_mov_b32 s60, s44
    s_mov_b32 s61, s45
    s_mov_b32 s62, 0x10000000
    s_mov_b32 s63, 0x20000
    s_cmp_ge_u32 s3, 2
    s_cselect_b32 s52, s24, s22
    s_cselect_b32 s53, s25, s23
    s_cselect_b32 s56, s28, s26
    s_cselect_b32 s57, s29, s27
    s_mov_b32 s54, 663552
    s_mov_b32 s55, 0x20000
    s_mov_b32 s58, 663552
    s_mov_b32 s59, 0x20000
    s_lshl_b32 s34, s6, 7
    s_lshl_b32 s35, s6, 4
    s_add_u32 s35, s35, 512
    v_lshrrev_b32 v1, 3, v0
    v_mul_u32_u24 v1, 1152, v1
    v_and_b32 v2, 7, v0
    v_lshrrev_b32 v3, 4, v0
    v_xor_b32 v2, v2, v3
    s_and_b32 s37, s3, 1
    s_lshl_b32 s14, s37, 2
    v_xor_b32 v2, s14, v2
    v_lshl_add_u32 v3, v2, 4, v1
    v_xor_b32 v2, 4, v2
    v_lshl_add_u32 v2, v2, 4, v1
    s_mul_i32 s14, s3, 72
    s_add_u32 s14, s14, s34
    s_cmp_ge_u32 s3, 2
    s_cselect_b32 s13, 160, 0
    s_sub_i32 s14, s14, s13
    s_cmp_eq_u32 s3, 2
    s_cselect_b32 s12, s35, s14
    s_sub_u32 s13, s35, 56
    s_cmp_eq_u32 s3, 1
    s_cselect_b32 s13, s13, s14
    s_add_i32 s11, s12, 0
    s_mul_i32 s11, s11, 1152
    v_add_u32 v13, s11, v3
    s_add_i32 s11, s12, 8
    s_mul_i32 s11, s11, 1152
    v_add_u32 v14, s11, v2
    s_add_i32 s11, s14, 16
    s_mul_i32 s11, s11, 1152
    v_add_u32 v15, s11, v3
    s_add_i32 s11, s14, 24
    s_mul_i32 s11, s11, 1152
    v_add_u32 v16, s11, v2
    s_add_i32 s11, s14, 32
    s_mul_i32 s11, s11, 1152
    v_add_u32 v17, s11, v3
    s_add_i32 s11, s14, 40
    s_mul_i32 s11, s11, 1152
    v_add_u32 v18, s11, v2
    s_add_i32 s11, s14, 48
    s_mul_i32 s11, s11, 1152
    v_add_u32 v19, s11, v3
    s_add_i32 s11, s13, 56
    s_mul_i32 s11, s11, 1152
    v_add_u32 v20, s11, v2
    s_add_i32 s11, s13, 64
    s_mul_i32 s11, s11, 1152
    v_add_u32 v21, s11, v3
    s_mul_i32 s8, s3, 9216
    s_lshl_b32 s12, s4, 1
    s_add_u32 s12, s12, s37
    s_mul_i32 s13, s12, 14
    v_min_u32 v2, 13, v0
    v_add_u32 v2, s13, v2
    v_min_u32 v2, 431, v2
    v_mul_u32_u24 v1, 683, v2
    v_lshrrev_b32 v1, 11, v1
    v_mul_u32_u24 v3, 3, v1
    v_sub_u32 v2, v2, v3
    s_sub_u32 s14, s35, 128
    v_mov_b32 v3, s14
    v_mov_b32 v51, s34
    v_cmp_gt_u32 vcc, 128, v1
    s_nop 1
    v_cndmask_b32 v3, v3, v51, vcc
    v_add_u32 v1, v1, v3
    v_mul_u32_u24 v1, 1152, v1
    v_mul_u32_u24 v2, 384, v2
    v_add_u32 v51, v1, v2
    s_mov_b64 exec, 0
    s_cmp_eq_u32 s3, 1
    s_cbranch_scc1 L_ws4
    s_cmp_eq_u32 s3, 2
    s_cbranch_scc1 L_ws8
    s_cmp_eq_u32 s3, 3
    s_cbranch_scc1 L_ws12
L_ws0:
    s_branch L_ps0
L_rs0:
L_ws1:
    s_branch L_ps1
L_rs1:
L_ws2:
    s_branch L_ps2
L_rs2:
L_ws3:
    s_branch L_wse
L_ws4:
    s_branch L_ps4
L_rs4:
L_ws5:
    s_branch L_ps5
L_rs5:
L_ws6:
    s_branch L_ps6
L_rs6:
L_ws7:
    s_branch L_wse
L_ws8:
    s_branch L_ps8
L_rs8:
L_ws9:
    s_branch L_ps9
L_rs9:
L_ws10:
L_ws11:
    s_branch L_wse
L_ws12:
    s_branch L_ps12
L_rs12:
L_ws13:
    s_branch L_ps13
L_rs13:
L_ws14:
L_ws15:
L_wse:
    s_mov_b64 exec, -1
L_warmed_s:
    s_mov_b32 s14, 0x3f803f80
    s_mov_b32 s15, 0xffff0000
    s_waitcnt vmcnt(8)
    ds_read_b128 v[112:115], v36 offset:0
    ds_read_b128 v[116:119], v36 offset:2048
    ds_read_b128 v[120:123], v37 offset:0
    ds_read_b128 v[124:127], v37 offset:2048
    s_add_u32 m0, s47, 12288
    s_movk_i32 s9, 0
    buffer_load_dwordx4 v40, s[48:51], s9 offen offset:0 lds
    buffer_load_dwordx4 v41, s[48:51], s9 offen offset:1024 lds
    buffer_load_dwordx4 v42, s[48:51], s9 offen offset:2048 lds
    buffer_load_dwordx4 v43, s[48:51], s9 offen offset:3072 lds
    s_waitcnt lgkmcnt(0)
    v_dot2c_f32_bf16 v9, s14, v112
    v_dot2c_f32_bf16 v11, v112, v112
    v_dot2c_f32_bf16 v10, s14, v116
    v_dot2c_f32_bf16 v12, v116, v116
    v_dot2c_f32_bf16 v9, s14, v113
    v_dot2c_f32_bf16 v11, v113, v113
    v_dot2c_f32_bf16 v10, s14, v117
    v_dot2c_f32_bf16 v12, v117, v117
    v_dot2c_f32_bf16 v9, s14, v114
    v_dot2c_f32_bf16 v11, v114, v114
    v_dot2c_f32_bf16 v10, s14, v118
    v_dot2c_f32_bf16 v12, v118, v118
    v_dot2c_f32_bf16 v9, s14, v115
    v_dot2c_f32_bf16 v11, v115, v115
    v_dot2c_f32_bf16 v10, s14, v119
    v_dot2c_f32_bf16 v12, v119, v119
    v_dot2c_f32_bf16 v9, s14, v120
    v_dot2c_f32_bf16 v11, v120, v120
    v_dot2c_f32_bf16 v10, s14, v124
    v_dot2c_f32_bf16 v12, v124, v124
    v_dot2c_f32_bf16 v9, s14, v121
    v_dot2c_f32_bf16 v11, v121, v121
    v_dot2c_f32_bf16 v10, s14, v125
    v_dot2c_f32_bf16 v12, v125, v125
    v_dot2c_f32_bf16 v9, s14, v122
    v_dot2c_f32_bf16 v11, v122, v122
    v_dot2c_f32_bf16 v10, s14, v126
    v_dot2c_f32_bf16 v12, v126, v126
    v_dot2c_f32_bf16 v9, s14, v123
    v_dot2c_f32_bf16 v11, v123, v123
    v_dot2c_f32_bf16 v10, s14, v127
    v_dot2c_f32_bf16 v12, v127, v127
    s_waitcnt vmcnt(8)
    ds_read_b128 v[128:131], v36 offset:4096
    ds_read_b128 v[132:135], v36 offset:6144
    ds_read_b128 v[136:139], v37 offset:4096
    ds_read_b128 v[140:143], v37 offset:6144
    s_add_u32 m0, s47, 16384
    s_movk_i32 s9, 384
    buffer_load_dwordx4 v40, s[48:51], s9 offen offset:0 lds
    buffer_load_dwordx4 v41, s[48:51], s9 offen offset:1024 lds
    buffer_load_dwordx4 v42, s[48:51], s9 offen offset:2048 lds
    buffer_load_dwordx4 v43, s[48:51], s9 offen offset:3072 lds
    s_waitcnt lgkmcnt(0)
    v_dot2c_f32_bf16 v9, s14, v128
    v_dot2c_f32_bf16 v11, v128, v128
    v_dot2c_f32_bf16 v10, s14, v132
    v_dot2c_f32_bf16 v12, v132, v132
    v_dot2c_f32_bf16 v9, s14, v129
    v_dot2c_f32_bf16 v11, v129, v129
    v_dot2c_f32_bf16 v10, s14, v133
    v_dot2c_f32_bf16 v12, v133, v133
    v_dot2c_f32_bf16 v9, s14, v130
    v_dot2c_f32_bf16 v11, v130, v130
    v_dot2c_f32_bf16 v10, s14, v134
    v_dot2c_f32_bf16 v12, v134, v134
    v_dot2c_f32_bf16 v9, s14, v131
    v_dot2c_f32_bf16 v11, v131, v131
    v_dot2c_f32_bf16 v10, s14, v135
    v_dot2c_f32_bf16 v12, v135, v135
    v_dot2c_f32_bf16 v9, s14, v136
    v_dot2c_f32_bf16 v11, v136, v136
    v_dot2c_f32_bf16 v10, s14, v140
    v_dot2c_f32_bf16 v12, v140, v140
    v_dot2c_f32_bf16 v9, s14, v137
    v_dot2c_f32_bf16 v11, v137, v137
    v_dot2c_f32_bf16 v10, s14, v141
    v_dot2c_f32_bf16 v12, v141, v141
    v_dot2c_f32_bf16 v9, s14, v138
    v_dot2c_f32_bf16 v11, v138, v138
    v_dot2c_f32_bf16 v10, s14, v142
    v_dot2c_f32_bf16 v12, v142, v142
    v_dot2c_f32_bf16 v9, s14, v139
    v_dot2c_f32_bf16 v11, v139, v139
    v_dot2c_f32_bf16 v10, s14, v143
    v_dot2c_f32_bf16 v12, v143, v143
    s_waitcnt vmcnt(8)
    ds_read_b128 v[144:147], v36 offset:8192
    ds_read_b128 v[148:151], v36 offset:10240
    ds_read_b128 v[152:155], v37 offset:8192
    ds_read_b128 v[156:159], v37 offset:10240
    s_add_u32 m0, s47, 20480
    s_movk_i32 s9, 768
    buffer_load_dwordx4 v40, s[48:51], s9 offen offset:0 lds
    buffer_load_dwordx4 v41, s[48:51], s9 offen offset:1024 lds
    buffer_load_dwordx4 v42, s[48:51], s9 offen offset:2048 lds
    buffer_load_dwordx4 v43, s[48:51], s9 offen offset:3072 lds
    s_waitcnt lgkmcnt(0)
    v_dot2c_f32_bf16 v9, s14, v144
    v_dot2c_f32_bf16 v11, v144, v144
    v_dot2c_f32_bf16 v10, s14, v148
    v_dot2c_f32_bf16 v12, v148, v148
    v_dot2c_f32_bf16 v9, s14, v145
    v_dot2c_f32_bf16 v11, v145, v145
    v_dot2c_f32_bf16 v10, s14, v149
    v_dot2c_f32_bf16 v12, v149, v149
    v_dot2c_f32_bf16 v9, s14, v146
    v_dot2c_f32_bf16 v11, v146, v146
    v_dot2c_f32_bf16 v10, s14, v150
    v_dot2c_f32_bf16 v12, v150, v150
    v_dot2c_f32_bf16 v9, s14, v147
    v_dot2c_f32_bf16 v11, v147, v147
    v_dot2c_f32_bf16 v10, s14, v151
    v_dot2c_f32_bf16 v12, v151, v151
    v_dot2c_f32_bf16 v9, s14, v152
    v_dot2c_f32_bf16 v11, v152, v152
    v_dot2c_f32_bf16 v10, s14, v156
    v_dot2c_f32_bf16 v12, v156, v156
    v_dot2c_f32_bf16 v9, s14, v153
    v_dot2c_f32_bf16 v11, v153, v153
    v_dot2c_f32_bf16 v10, s14, v157
    v_dot2c_f32_bf16 v12, v157, v157
    v_dot2c_f32_bf16 v9, s14, v154
    v_dot2c_f32_bf16 v11, v154, v154
    v_dot2c_f32_bf16 v10, s14, v158
    v_dot2c_f32_bf16 v12, v158, v158
    v_dot2c_f32_bf16 v9, s14, v155
    v_dot2c_f32_bf16 v11, v155, v155
    v_dot2c_f32_bf16 v10, s14, v159
    v_dot2c_f32_bf16 v12, v159, v159
    s_waitcnt vmcnt(8)
    ds_read_b128 v[160:163], v36 offset:12288
    ds_read_b128 v[164:167], v36 offset:14336
    ds_read_b128 v[168:171], v37 offset:12288
    ds_read_b128 v[172:175], v37 offset:14336
    s_add_u32 m0, s47, 24576
    s_movk_i32 s9, 128
    buffer_load_dwordx4 v40, s[48:51], s9 offen offset:0 lds
    buffer_load_dwordx4 v41, s[48:51], s9 offen offset:1024 lds
    buffer_load_dwordx4 v42, s[48:51], s9 offen offset:2048 lds
    buffer_load_dwordx4 v43, s[48:51], s9 offen offset:3072 lds
    s_waitcnt lgkmcnt(0)
    v_dot2c_f32_bf16 v9, s14, v160
    v_dot2c_f32_bf16 v11, v160, v160
    v_dot2c_f32_bf16 v10, s14, v164
    v_dot2c_f32_bf16 v12, v164, v164
    v_dot2c_f32_bf16 v9, s14, v161
    v_dot2c_f32_bf16 v11, v161, v161
    v_dot2c_f32_bf16 v10, s14, v165
    v_dot2c_f32_bf16 v12, v165, v165
    v_dot2c_f32_bf16 v9, s14, v162
    v_dot2c_f32_bf16 v11, v162, v162
    v_dot2c_f32_bf16 v10, s14, v166
    v_dot2c_f32_bf16 v12, v166, v166
    v_dot2c_f32_bf16 v9, s14, v163
    v_dot2c_f32_bf16 v11, v163, v163
    v_dot2c_f32_bf16 v10, s14, v167
    v_dot2c_f32_bf16 v12, v167, v167
    v_dot2c_f32_bf16 v9, s14, v168
    v_dot2c_f32_bf16 v11, v168, v168
    v_dot2c_f32_bf16 v10, s14, v172
    v_dot2c_f32_bf16 v12, v172, v172
    v_dot2c_f32_bf16 v9, s14, v169
    v_dot2c_f32_bf16 v11, v169, v169
    v_dot2c_f32_bf16 v10, s14, v173
    v_dot2c_f32_bf16 v12, v173, v173
    v_dot2c_f32_bf16 v9, s14, v170
    v_dot2c_f32_bf16 v11, v170, v170
    v_dot2c_f32_bf16 v10, s14, v174
    v_dot2c_f32_bf16 v12, v174, v174
    v_dot2c_f32_bf16 v9, s14, v171
    v_dot2c_f32_bf16 v11, v171, v171
    v_dot2c_f32_bf16 v10, s14, v175
    v_dot2c_f32_bf16 v12, v175, v175
    s_waitcnt vmcnt(8)
    ds_read_b128 v[176:179], v36 offset:16384
    ds_read_b128 v[180:183], v36 offset:18432
    ds_read_b128 v[184:187], v37 offset:16384
    ds_read_b128 v[188:191], v37 offset:18432
    s_add_u32 m0, s47, 28672
    s_movk_i32 s9, 512
    buffer_load_dwordx4 v40, s[48:51], s9 offen offset:0 lds
    buffer_load_dwordx4 v41, s[48:51], s9 offen offset:1024 lds
    buffer_load_dwordx4 v42, s[48:51], s9 offen offset:2048 lds
    buffer_load_dwordx4 v43, s[48:51], s9 offen offset:3072 lds
    s_waitcnt lgkmcnt(0)
    v_dot2c_f32_bf16 v9, s14, v176
    v_dot2c_f32_bf16 v11, v176, v176
    v_dot2c_f32_bf16 v10, s14, v180
    v_dot2c_f32_bf16 v12, v180, v180
    v_dot2c_f32_bf16 v9, s14, v177
    v_dot2c_f32_bf16 v11, v177, v177
    v_dot2c_f32_bf16 v10, s14, v181
    v_dot2c_f32_bf16 v12, v181, v181
    v_dot2c_f32_bf16 v9, s14, v178
    v_dot2c_f32_bf16 v11, v178, v178
    v_dot2c_f32_bf16 v10, s14, v182
    v_dot2c_f32_bf16 v12, v182, v182
    v_dot2c_f32_bf16 v9, s14, v179
    v_dot2c_f32_bf16 v11, v179, v179
    v_dot2c_f32_bf16 v10, s14, v183
    v_dot2c_f32_bf16 v12, v183, v183
    v_dot2c_f32_bf16 v9, s14, v184
    v_dot2c_f32_bf16 v11, v184, v184
    v_dot2c_f32_bf16 v10, s14, v188
    v_dot2c_f32_bf16 v12, v188, v188
    v_dot2c_f32_bf16 v9, s14, v185
    v_dot2c_f32_bf16 v11, v185, v185
    v_dot2c_f32_bf16 v10, s14, v189
    v_dot2c_f32_bf16 v12, v189, v189
    v_dot2c_f32_bf16 v9, s14, v186
    v_dot2c_f32_bf16 v11, v186, v186
    v_dot2c_f32_bf16 v10, s14, v190
    v_dot2c_f32_bf16 v12, v190, v190
    v_dot2c_f32_bf16 v9, s14, v187
    v_dot2c_f32_bf16 v11, v187, v187
    v_dot2c_f32_bf16 v10, s14, v191
    v_dot2c_f32_bf16 v12, v191, v191
    s_waitcnt vmcnt(8)
    ds_read_b128 v[192:195], v36 offset:20480
    ds_read_b128 v[196:199], v36 offset:22528
    ds_read_b128 v[200:203], v37 offset:20480
    ds_read_b128 v[204:207], v37 offset:22528
    s_add_u32 m0, s47, 32768
    s_movk_i32 s9, 896
    buffer_load_dwordx4 v40, s[48:51], s9 offen offset:0 lds
    buffer_load_dwordx4 v41, s[48:51], s9 offen offset:1024 lds
    buffer_load_dwordx4 v42, s[48:51], s9 offen offset:2048 lds
    buffer_load_dwordx4 v43, s[48:51], s9 offen offset:3072 lds
    s_waitcnt lgkmcnt(0)
    v_dot2c_f32_bf16 v9, s14, v192
    v_dot2c_f32_bf16 v11, v192, v192
    v_dot2c_f32_bf16 v10, s14, v196
    v_dot2c_f32_bf16 v12, v196, v196
    v_dot2c_f32_bf16 v9, s14, v193
    v_dot2c_f32_bf16 v11, v193, v193
    v_dot2c_f32_bf16 v10, s14, v197
    v_dot2c_f32_bf16 v12, v197, v197
    v_dot2c_f32_bf16 v9, s14, v194
    v_dot2c_f32_bf16 v11, v194, v194
    v_dot2c_f32_bf16 v10, s14, v198
    v_dot2c_f32_bf16 v12, v198, v198
    v_dot2c_f32_bf16 v9, s14, v195
    v_dot2c_f32_bf16 v11, v195, v195
    v_dot2c_f32_bf16 v10, s14, v199
    v_dot2c_f32_bf16 v12, v199, v199
    v_dot2c_f32_bf16 v9, s14, v200
    v_dot2c_f32_bf16 v11, v200, v200
    v_dot2c_f32_bf16 v10, s14, v204
    v_dot2c_f32_bf16 v12, v204, v204
    v_dot2c_f32_bf16 v9, s14, v201
    v_dot2c_f32_bf16 v11, v201, v201
    v_dot2c_f32_bf16 v10, s14, v205
    v_dot2c_f32_bf16 v12, v205, v205
    v_dot2c_f32_bf16 v9, s14, v202
    v_dot2c_f32_bf16 v11, v202, v202
    v_dot2c_f32_bf16 v10, s14, v206
    v_dot2c_f32_bf16 v12, v206, v206
    v_dot2c_f32_bf16 v9, s14, v203
    v_dot2c_f32_bf16 v11, v203, v203
    v_dot2c_f32_bf16 v10, s14, v207
    v_dot2c_f32_bf16 v12, v207, v207
    s_waitcnt vmcnt(8)
    ds_read_b128 v[208:211], v36 offset:24576
    ds_read_b128 v[212:215], v36 offset:26624
    ds_read_b128 v[216:219], v37 offset:24576
    ds_read_b128 v[220:223], v37 offset:26624
    s_waitcnt lgkmcnt(0)
    v_dot2c_f32_bf16 v9, s14, v208
    v_dot2c_f32_bf16 v11, v208, v208
    v_dot2c_f32_bf16 v10, s14, v212
    v_dot2c_f32_bf16 v12, v212, v212
    v_dot2c_f32_bf16 v9, s14, v209
    v_dot2c_f32_bf16 v11, v209, v209
    v_dot2c_f32_bf16 v10, s14, v213
    v_dot2c_f32_bf16 v12, v213, v213
    v_dot2c_f32_bf16 v9, s14, v210
    v_dot2c_f32_bf16 v11, v210, v210
    v_dot2c_f32_bf16 v10, s14, v214
    v_dot2c_f32_bf16 v12, v214, v214
    v_dot2c_f32_bf16 v9, s14, v211
    v_dot2c_f32_bf16 v11, v211, v211
    v_dot2c_f32_bf16 v10, s14, v215
    v_dot2c_f32_bf16 v12, v215, v215
    v_dot2c_f32_bf16 v9, s14, v216
    v_dot2c_f32_bf16 v11, v216, v216
    v_dot2c_f32_bf16 v10, s14, v220
    v_dot2c_f32_bf16 v12, v220, v220
    v_dot2c_f32_bf16 v9, s14, v217
    v_dot2c_f32_bf16 v11, v217, v217
    v_dot2c_f32_bf16 v10, s14, v221
    v_dot2c_f32_bf16 v12, v221, v221
    v_dot2c_f32_bf16 v9, s14, v218
    v_dot2c_f32_bf16 v11, v218, v218
    v_dot2c_f32_bf16 v10, s14, v222
    v_dot2c_f32_bf16 v12, v222, v222
    v_dot2c_f32_bf16 v9, s14, v219
    v_dot2c_f32_bf16 v11, v219, v219
    v_dot2c_f32_bf16 v10, s14, v223
    v_dot2c_f32_bf16 v12, v223, v223
    s_waitcnt vmcnt(4)
    ds_read_b128 v[224:227], v36 offset:28672
    ds_read_b128 v[228:231], v36 offset:30720
    ds_read_b128 v[232:235], v37 offset:28672
    ds_read_b128 v[236:239], v37 offset:30720
    buffer_load_dword v4, v51, s[52:55], 0 offen offset:256
    s_waitcnt lgkmcnt(0)
    v_dot2c_f32_bf16 v9, s14, v224
    v_dot2c_f32_bf16 v11, v224, v224
    v_dot2c_f32_bf16 v10, s14, v228
    v_dot2c_f32_bf16 v12, v228, v228
    v_dot2c_f32_bf16 v9, s14, v225
    v_dot2c_f32_bf16 v11, v225, v225
    v_dot2c_f32_bf16 v10, s14, v229
    v_dot2c_f32_bf16 v12, v229, v229
    v_dot2c_f32_bf16 v9, s14, v226
    v_dot2c_f32_bf16 v11, v226, v226
    v_dot2c_f32_bf16 v10, s14, v230
    v_dot2c_f32_bf16 v12, v230, v230
    v_dot2c_f32_bf16 v9, s14, v227
    v_dot2c_f32_bf16 v11, v227, v227
    v_dot2c_f32_bf16 v10, s14, v231
    v_dot2c_f32_bf16 v12, v231, v231
    v_dot2c_f32_bf16 v9, s14, v232
    v_dot2c_f32_bf16 v11, v232, v232
    v_dot2c_f32_bf16 v10, s14, v236
    v_dot2c_f32_bf16 v12, v236, v236
    v_dot2c_f32_bf16 v9, s14, v233
    v_dot2c_f32_bf16 v11, v233, v233
    v_dot2c_f32_bf16 v10, s14, v237
    v_dot2c_f32_bf16 v12, v237, v237
    v_dot2c_f32_bf16 v9, s14, v234
    v_dot2c_f32_bf16 v11, v234, v234
    v_dot2c_f32_bf16 v10, s14, v238
    v_dot2c_f32_bf16 v12, v238, v238
    v_dot2c_f32_bf16 v9, s14, v235
    v_dot2c_f32_bf16 v11, v235, v235
    v_dot2c_f32_bf16 v10, s14, v239
    v_dot2c_f32_bf16 v12, v239, v239
    s_waitcnt vmcnt(1)
    ds_read_b128 v[240:243], v36 offset:32768
    ds_read_b128 v[244:247], v36 offset:34816
    ds_read_b128 v[248:251], v37 offset:32768
    ds_read_b128 v[252:255], v37 offset:34816
    buffer_load_dword v4, v51, s[52:55], 0 offen offset:0
    s_waitcnt lgkmcnt(0)
    s_barrier
    s_mov_b32 s9, 0x100
    s_add_u32 m0, s8, 0x0
    s_nop 0
    buffer_load_dwordx4 v13, s[52:55], s9 offen lds
    s_add_u32 m0, s8, 0x400
    s_nop 0
    buffer_load_dwordx4 v14, s[52:55], s9 offen lds
    s_add_u32 m0, s8, 0x800
    s_nop 0
    buffer_load_dwordx4 v15, s[52:55], s9 offen lds
    s_add_u32 m0, s8, 0xc00
    s_nop 0
    buffer_load_dwordx4 v16, s[52:55], s9 offen lds
    v_dot2c_f32_bf16 v9, s14, v240
    v_dot2c_f32_bf16 v11, v240, v240
    v_dot2c_f32_bf16 v10, s14, v244
    v_dot2c_f32_bf16 v12, v244, v244
    v_dot2c_f32_bf16 v9, s14, v241
    v_dot2c_f32_bf16 v11, v241, v241
    v_dot2c_f32_bf16 v10, s14, v245
    v_dot2c_f32_bf16 v12, v245, v245
    v_dot2c_f32_bf16 v9, s14, v242
    v_dot2c_f32_bf16 v11, v242, v242
    v_dot2c_f32_bf16 v10, s14, v246
    v_dot2c_f32_bf16 v12, v246, v246
    v_dot2c_f32_bf16 v9, s14, v243
    v_dot2c_f32_bf16 v11, v243, v243
    v_dot2c_f32_bf16 v10, s14, v247
    v_dot2c_f32_bf16 v12, v247, v247
    v_dot2c_f32_bf16 v9, s14, v248
    v_dot2c_f32_bf16 v11, v248, v248
    v_dot2c_f32_bf16 v10, s14, v252
    v_dot2c_f32_bf16 v12, v252, v252
    v_dot2c_f32_bf16 v9, s14, v249
    v_dot2c_f32_bf16 v11, v249, v249
    v_dot2c_f32_bf16 v10, s14, v253
    v_dot2c_f32_bf16 v12, v253, v253
    v_dot2c_f32_bf16 v9, s14, v250
    v_dot2c_f32_bf16 v11, v250, v250
    v_dot2c_f32_bf16 v10, s14, v254
    v_dot2c_f32_bf16 v12, v254, v254
    v_dot2c_f32_bf16 v9, s14, v251
    v_dot2c_f32_bf16 v11, v251, v251
    v_dot2c_f32_bf16 v10, s14, v255
    v_dot2c_f32_bf16 v12, v255, v255
    s_nop 1
    v_permlane16_swap_b32 v9, v10
    v_permlane16_swap_b32 v11, v12
    v_add_f32 v9, v9, v10
    v_add_f32 v11, v11, v12
    v_mov_b32 v10, v9
    v_mov_b32 v12, v11
    s_nop 0
    v_permlane32_swap_b32 v9, v10
    v_permlane32_swap_b32 v11, v12
    v_add_f32 v9, v9, v10
    v_add_f32 v11, v11, v12
    v_mul_f32 v9, 0x3ae38e39, v9
    v_mul_f32 v11, 0x3ae38e39, v11
    v_fma_f32 v12, -v9, v9, v11
    v_max_f32 v12, 0, v12
    v_cvt_pk_bf16_f32 v10, v9, v12
    v_lshlrev_b32 v9, 16, v10
    v_and_b32 v12, 0xffff0000, v10
    v_add_f32 v12, 0x3727c5ac, v12
    v_cvt_pk_bf16_f32 v12, v12, v12
    v_and_b32 v12, 0xffff0000, v12
    v_sqrt_f32 v12, v12
    s_nop 0
    v_cvt_pk_bf16_f32 v12, v12, v12
    v_and_b32 v12, 0xffff0000, v12
    v_rcp_f32 v12, v12
    s_nop 0
    v_mul_f32 v10, 0x3f800000, v12
    v_mul_f32 v11, v10, v9
    v_xor_b32 v11, 0x80000000, v11
    s_mov_b32 s15, 0xffff0000
    v_mov_b32 v108, v10
    v_mov_b32 v109, v11
    s_nop 0
    v_permlane16_swap_b32 v10, v108
    v_permlane16_swap_b32 v11, v109
    v_mov_b32 v34, v32
    v_mov_b32 v35, v33
    v_lshlrev_b32 v88, 16, v112
    v_and_b32 v89, s15, v112
    v_lshlrev_b32 v90, 16, v113
    v_and_b32 v91, s15, v113
    v_pk_fma_f32 v[88:89], v[88:89], v[10:11], v[10:11] op_sel:[0,0,1] op_sel_hi:[1,0,1]
    v_pk_fma_f32 v[90:91], v[90:91], v[10:11], v[10:11] op_sel:[0,0,1] op_sel_hi:[1,0,1]
    v_cvt_pk_bf16_f32 v112, v88, v89
    v_cvt_pk_bf16_f32 v113, v90, v91
    v_lshlrev_b32 v88, 16, v114
    v_and_b32 v89, s15, v114
    v_lshlrev_b32 v90, 16, v115
    v_and_b32 v91, s15, v115
    v_pk_fma_f32 v[88:89], v[88:89], v[10:11], v[10:11] op_sel:[0,0,1] op_sel_hi:[1,0,1]
    v_pk_fma_f32 v[90:91], v[90:91], v[10:11], v[10:11] op_sel:[0,0,1] op_sel_hi:[1,0,1]
    v_cvt_pk_bf16_f32 v114, v88, v89
    v_cvt_pk_bf16_f32 v115, v90, v91
    v_lshlrev_b32 v92, 16, v116
    v_and_b32 v93, s15, v116
    v_lshlrev_b32 v94, 16, v117
    v_and_b32 v95, s15, v117
    v_pk_fma_f32 v[92:93], v[92:93], v[108:109], v[108:109] op_sel:[0,0,1] op_sel_hi:[1,0,1]
    v_pk_fma_f32 v[94:95], v[94:95], v[108:109], v[108:109] op_sel:[0,0,1] op_sel_hi:[1,0,1]
    v_cvt_pk_bf16_f32 v116, v92, v93
    v_cvt_pk_bf16_f32 v117, v94, v95
    v_lshlrev_b32 v92, 16, v118
    v_and_b32 v93, s15, v118
    v_lshlrev_b32 v94, 16, v119
    v_and_b32 v95, s15, v119
    v_pk_fma_f32 v[92:93], v[92:93], v[108:109], v[108:109] op_sel:[0,0,1] op_sel_hi:[1,0,1]
    v_pk_fma_f32 v[94:95], v[94:95], v[108:109], v[108:109] op_sel:[0,0,1] op_sel_hi:[1,0,1]
    v_cvt_pk_bf16_f32 v118, v92, v93
    v_cvt_pk_bf16_f32 v119, v94, v95
    s_add_u32 m0, s8, 0x1000
    s_nop 0
    buffer_load_dwordx4 v17, s[52:55], s9 offen lds
    s_add_u32 m0, s8, 0x1400
    s_nop 0
    buffer_load_dwordx4 v18, s[52:55], s9 offen lds
    v_lshlrev_b32 v88, 16, v120
    v_and_b32 v89, s15, v120
    v_lshlrev_b32 v90, 16, v121
    v_and_b32 v91, s15, v121
    v_pk_fma_f32 v[88:89], v[88:89], v[10:11], v[10:11] op_sel:[0,0,1] op_sel_hi:[1,0,1]
    v_pk_fma_f32 v[90:91], v[90:91], v[10:11], v[10:11] op_sel:[0,0,1] op_sel_hi:[1,0,1]
    v_cvt_pk_bf16_f32 v120, v88, v89
    v_cvt_pk_bf16_f32 v121, v90, v91
    v_lshlrev_b32 v88, 16, v122
    v_and_b32 v89, s15, v122
    v_lshlrev_b32 v90, 16, v123
    v_and_b32 v91, s15, v123
    v_pk_fma_f32 v[88:89], v[88:89], v[10:11], v[10:11] op_sel:[0,0,1] op_sel_hi:[1,0,1]
    v_pk_fma_f32 v[90:91], v[90:91], v[10:11], v[10:11] op_sel:[0,0,1] op_sel_hi:[1,0,1]
    v_cvt_pk_bf16_f32 v122, v88, v89
    v_cvt_pk_bf16_f32 v123, v90, v91
    s_add_u32 m0, s8, 0x1800
    s_nop 0
    buffer_load_dwordx4 v19, s[52:55], s9 offen lds
    s_add_u32 m0, s8, 0x1c00
    s_nop 0
    buffer_load_dwordx4 v20, s[52:55], s9 offen lds
    v_lshlrev_b32 v92, 16, v124
    v_and_b32 v93, s15, v124
    v_lshlrev_b32 v94, 16, v125
    v_and_b32 v95, s15, v125
    v_pk_fma_f32 v[92:93], v[92:93], v[108:109], v[108:109] op_sel:[0,0,1] op_sel_hi:[1,0,1]
    v_pk_fma_f32 v[94:95], v[94:95], v[108:109], v[108:109] op_sel:[0,0,1] op_sel_hi:[1,0,1]
    v_cvt_pk_bf16_f32 v124, v92, v93
    v_cvt_pk_bf16_f32 v125, v94, v95
    v_lshlrev_b32 v92, 16, v126
    v_and_b32 v93, s15, v126
    v_lshlrev_b32 v94, 16, v127
    v_and_b32 v95, s15, v127
    v_pk_fma_f32 v[92:93], v[92:93], v[108:109], v[108:109] op_sel:[0,0,1] op_sel_hi:[1,0,1]
    v_pk_fma_f32 v[94:95], v[94:95], v[108:109], v[108:109] op_sel:[0,0,1] op_sel_hi:[1,0,1]
    v_cvt_pk_bf16_f32 v126, v92, v93
    v_cvt_pk_bf16_f32 v127, v94, v95
    s_add_u32 m0, s8, 0x2000
    s_nop 0
    buffer_load_dwordx4 v21, s[52:55], s9 offen lds
    s_mov_b32 s9, 0x280
    s_add_u32 m0, s8, 0x9000
    s_nop 0
    buffer_load_dwordx4 v13, s[52:55], s9 offen lds
    v_lshlrev_b32 v88, 16, v128
    v_and_b32 v89, s15, v128
    v_lshlrev_b32 v90, 16, v129
    v_and_b32 v91, s15, v129
    v_pk_fma_f32 v[88:89], v[88:89], v[10:11], v[10:11] op_sel:[0,0,1] op_sel_hi:[1,0,1]
    v_pk_fma_f32 v[90:91], v[90:91], v[10:11], v[10:11] op_sel:[0,0,1] op_sel_hi:[1,0,1]
    v_cvt_pk_bf16_f32 v128, v88, v89
    v_cvt_pk_bf16_f32 v129, v90, v91
    v_lshlrev_b32 v88, 16, v130
    v_and_b32 v89, s15, v130
    v_lshlrev_b32 v90, 16, v131
    v_and_b32 v91, s15, v131
    v_pk_fma_f32 v[88:89], v[88:89], v[10:11], v[10:11] op_sel:[0,0,1] op_sel_hi:[1,0,1]
    v_pk_fma_f32 v[90:91], v[90:91], v[10:11], v[10:11] op_sel:[0,0,1] op_sel_hi:[1,0,1]
    v_cvt_pk_bf16_f32 v130, v88, v89
    v_cvt_pk_bf16_f32 v131, v90, v91
    s_add_u32 m0, s8, 0x9400
    s_nop 0
    buffer_load_dwordx4 v14, s[52:55], s9 offen lds
    s_add_u32 m0, s8, 0x9800
    s_nop 0
    buffer_load_dwordx4 v15, s[52:55], s9 offen lds
    v_lshlrev_b32 v92, 16, v132
    v_and_b32 v93, s15, v132
    v_lshlrev_b32 v94, 16, v133
    v_and_b32 v95, s15, v133
    v_pk_fma_f32 v[92:93], v[92:93], v[108:109], v[108:109] op_sel:[0,0,1] op_sel_hi:[1,0,1]
    v_pk_fma_f32 v[94:95], v[94:95], v[108:109], v[108:109] op_sel:[0,0,1] op_sel_hi:[1,0,1]
    v_cvt_pk_bf16_f32 v132, v92, v93
    v_cvt_pk_bf16_f32 v133, v94, v95
    v_lshlrev_b32 v92, 16, v134
    v_and_b32 v93, s15, v134
    v_lshlrev_b32 v94, 16, v135
    v_and_b32 v95, s15, v135
    v_pk_fma_f32 v[92:93], v[92:93], v[108:109], v[108:109] op_sel:[0,0,1] op_sel_hi:[1,0,1]
    v_pk_fma_f32 v[94:95], v[94:95], v[108:109], v[108:109] op_sel:[0,0,1] op_sel_hi:[1,0,1]
    v_cvt_pk_bf16_f32 v134, v92, v93
    v_cvt_pk_bf16_f32 v135, v94, v95
    s_add_u32 m0, s8, 0x9c00
    s_nop 0
    buffer_load_dwordx4 v16, s[52:55], s9 offen lds
    s_add_u32 m0, s8, 0xa000
    s_nop 0
    buffer_load_dwordx4 v17, s[52:55], s9 offen lds
    v_lshlrev_b32 v88, 16, v136
    v_and_b32 v89, s15, v136
    v_lshlrev_b32 v90, 16, v137
    v_and_b32 v91, s15, v137
    v_pk_fma_f32 v[88:89], v[88:89], v[10:11], v[10:11] op_sel:[0,0,1] op_sel_hi:[1,0,1]
    v_pk_fma_f32 v[90:91], v[90:91], v[10:11], v[10:11] op_sel:[0,0,1] op_sel_hi:[1,0,1]
    v_cvt_pk_bf16_f32 v136, v88, v89
    v_cvt_pk_bf16_f32 v137, v90, v91
    v_lshlrev_b32 v88, 16, v138
    v_and_b32 v89, s15, v138
    v_lshlrev_b32 v90, 16, v139
    v_and_b32 v91, s15, v139
    v_pk_fma_f32 v[88:89], v[88:89], v[10:11], v[10:11] op_sel:[0,0,1] op_sel_hi:[1,0,1]
    v_pk_fma_f32 v[90:91], v[90:91], v[10:11], v[10:11] op_sel:[0,0,1] op_sel_hi:[1,0,1]
    v_cvt_pk_bf16_f32 v138, v88, v89
    v_cvt_pk_bf16_f32 v139, v90, v91
    s_add_u32 m0, s8, 0xa400
    s_nop 0
    buffer_load_dwordx4 v18, s[52:55], s9 offen lds
    s_add_u32 m0, s8, 0xa800
    s_nop 0
    buffer_load_dwordx4 v19, s[52:55], s9 offen lds
    v_lshlrev_b32 v92, 16, v140
    v_and_b32 v93, s15, v140
    v_lshlrev_b32 v94, 16, v141
    v_and_b32 v95, s15, v141
    v_pk_fma_f32 v[92:93], v[92:93], v[108:109], v[108:109] op_sel:[0,0,1] op_sel_hi:[1,0,1]
    v_pk_fma_f32 v[94:95], v[94:95], v[108:109], v[108:109] op_sel:[0,0,1] op_sel_hi:[1,0,1]
    v_cvt_pk_bf16_f32 v140, v92, v93
    v_cvt_pk_bf16_f32 v141, v94, v95
    v_lshlrev_b32 v92, 16, v142
    v_and_b32 v93, s15, v142
    v_lshlrev_b32 v94, 16, v143
    v_and_b32 v95, s15, v143
    v_pk_fma_f32 v[92:93], v[92:93], v[108:109], v[108:109] op_sel:[0,0,1] op_sel_hi:[1,0,1]
    v_pk_fma_f32 v[94:95], v[94:95], v[108:109], v[108:109] op_sel:[0,0,1] op_sel_hi:[1,0,1]
    v_cvt_pk_bf16_f32 v142, v92, v93
    v_cvt_pk_bf16_f32 v143, v94, v95
    s_add_u32 m0, s8, 0xac00
    s_nop 0
    buffer_load_dwordx4 v20, s[52:55], s9 offen lds
    s_add_u32 m0, s8, 0xb000
    s_nop 0
    buffer_load_dwordx4 v21, s[52:55], s9 offen lds
    s_lshl_b32 s68, s4, 3
    s_lshl_b32 s38, s6, 4
    s_add_u32 s38, s38, 128
    s_cmp_ge_u32 s6, 2
    s_cselect_b32 s94, 4, 0
    s_cselect_b32 s95, 6, 1
    s_cselect_b32 s96, 7, 3
L_ps0:
    s_cbranch_execz L_rs0
    s_cselect_b32 s97, 0, 4
    s_cselect_b32 s98, 1, 6
    s_cselect_b32 s99, 3, 7
    s_mul_i32 s11, s6, 3
    s_add_u32 s11, s11, 0
    s_lshr_b32 s12, s11, 2
    s_mul_i32 s12, s12, 384
    s_bfe_u32 s13, s11, 0x10001
    s_lshl_b32 s13, s13, 6
    s_add_u32 s12, s12, s13
    s_add_u32 s25, s12, 256
    s_and_b32 s11, s11, 1
    s_mul_i32 s11, s11, 4608
    s_add_u32 s22, s11, s25
    s_mul_i32 s11, s6, 3
    s_add_u32 s11, s11, 1
    s_lshr_b32 s12, s11, 2
    s_mul_i32 s12, s12, 384
    s_bfe_u32 s13, s11, 0x10001
    s_lshl_b32 s13, s13, 6
    s_add_u32 s12, s12, s13
    s_add_u32 s26, s12, 256
    s_and_b32 s11, s11, 1
    s_mul_i32 s11, s11, 4608
    s_add_u32 s23, s11, s26
    s_mul_i32 s11, s6, 3
    s_add_u32 s11, s11, 2
    s_lshr_b32 s12, s11, 2
    s_mul_i32 s12, s12, 384
    s_bfe_u32 s13, s11, 0x10001
    s_lshl_b32 s13, s13, 6
    s_add_u32 s12, s12, s13
    s_add_u32 s27, s12, 256
    s_and_b32 s11, s11, 1
    s_mul_i32 s11, s11, 4608
    s_add_u32 s24, s11, s27
    s_lshl_b32 s13, s46, 5
    v_bfe_u32 v1, v0, 3, 2
    v_lshl_add_u32 v1, v6, 3, v1
    v_add_u32 v1, s13, v1
    v_mul_u32_u24 v1, 1152, v1
    v_and_b32 v2, 7, v0
    v_lshl_add_u32 v104, v2, 3, v1
    s_lshl_b32 s14, s3, 6
    v_add_u32 v1, s14, v0
    v_min_u32 v1, 143, v1
    v_lshlrev_b32 v50, 3, v1
    s_sub_u32 s13, s35, 128
    s_cmp_ge_u32 s3, 2
    s_cselect_b32 s13, s13, s34
    v_add_u32 v1, s13, v1
    v_lshlrev_b32 v45, 1, v1
    s_lshl_b32 s14, s6, 15
    s_add_u32 s14, s14, 0x2800000
    s_add_u32 s64, s44, s14
    s_addc_u32 s65, s45, 0
    s_mov_b32 s66, 32768
    s_mov_b32 s67, 0x20000
    s_lshl_b32 s36, s4, 11
    s_mul_i32 s14, s37, 36864
    s_lshl_b32 s13, s34, 1
    s_add_u32 s13, s13, s14
    s_lshl_b32 s12, s35, 1
    s_add_u32 s12, s12, s14
    v_lshrrev_b32 v1, 4, v0
    v_and_b32 v2, 15, v0
    v_xor_b32 v2, v2, v1
    v_mul_u32_u24 v1, 1152, v1
    v_add_u32 v1, s13, v1
    v_xor_b32 v3, 0, v2
    v_lshl_add_u32 v3, v3, 4, v1
    v_add_u32 v22, 0, v3
    v_add_u32 v26, 18432, v3
    v_xor_b32 v3, 4, v2
    v_lshl_add_u32 v3, v3, 4, v1
    v_add_u32 v23, 4608, v3
    v_add_u32 v27, 23040, v3
    v_xor_b32 v3, 8, v2
    v_lshl_add_u32 v3, v3, 4, v1
    v_add_u32 v24, 9216, v3
    v_add_u32 v28, 27648, v3
    v_xor_b32 v3, 12, v2
    v_lshl_add_u32 v3, v3, 4, v1
    v_add_u32 v25, 13824, v3
    v_add_u32 v29, 32256, v3
    v_lshrrev_b32 v1, 1, v0
    v_mul_u32_u24 v1, 1152, v1
    v_and_b32 v2, 1, v0
    v_lshl_add_u32 v1, v2, 4, v1
    v_add_u32 v30, s12, v1
    s_lshl_b32 s12, s4, 1
    s_add_u32 s12, s12, s37
    s_mul_i32 s13, s12, 18
    s_lshl_b32 s14, s34, 1
    v_min_u32 v1, 53, v0
    v_mul_u32_u24 v2, 86, v1
    v_lshrrev_b32 v2, 8, v2
    v_mul_u32_u24 v3, 3, v2
    v_sub_u32 v1, v1, v3
    v_add_u32 v2, s13, v2
    v_mul_u32_u24 v2, 1152, v2
    v_cmp_eq_u32 vcc, 2, v1
    v_lshl_add_u32 v1, v1, 7, s14
    v_mov_b32 v3, 0x400
    v_cndmask_b32 v1, v1, v3, vcc
    v_add_u32 v31, v1, v2
    s_waitcnt vmcnt(9)
    s_barrier
    ds_read_b128 a[144:147], v34 offset:0
    ds_read_b128 a[148:151], v35 offset:0
    ds_read_b128 a[152:155], v34 offset:2048
    ds_read_b128 a[156:159], v35 offset:2048
    ds_read_b128 a[160:163], v34 offset:4096
    ds_read_b128 a[164:167], v35 offset:4096
    ds_read_b128 a[168:171], v34 offset:6144
    ds_read_b128 a[172:175], v35 offset:6144
    ds_read_b128 a[176:179], v34 offset:8192
    ds_read_b128 a[180:183], v35 offset:8192
    s_waitcnt lgkmcnt(5)
    v_mfma_f32_16x16x32_bf16 a[0:3], v[112:115], a[144:147], 0
    v_lshlrev_b32 v88, 16, v144
    v_and_b32 v89, s15, v144
    v_mfma_f32_16x16x32_bf16 a[0:3], v[120:123], a[148:151], a[0:3]
    ds_read_b128 a[184:187], v34 offset:10240
    v_lshlrev_b32 v90, 16, v145
    v_mfma_f32_16x16x32_bf16 a[4:7], v[124:127], a[148:151], 0
    s_mov_b32 s9, 0x400
    v_and_b32 v91, s15, v145
    v_mfma_f32_16x16x32_bf16 a[4:7], v[116:119], a[144:147], a[4:7]
    s_add_u32 m0, s8, 0x12000
    ds_read_b128 a[188:191], v35 offset:10240
    buffer_load_dwordx4 v13, s[52:55], s9 offen lds
    v_mfma_f32_16x16x32_bf16 a[8:11], v[112:115], a[152:155], 0
    v_fma_f32 v88, v88, v10, v11
    v_fma_f32 v89, v89, v10, v11
    v_mfma_f32_16x16x32_bf16 a[8:11], v[120:123], a[156:159], a[8:11]
    s_add_u32 m0, s8, 0x12400
    ds_read_b128 a[192:195], v34 offset:12288
    buffer_load_dwordx4 v14, s[52:55], s9 offen lds
    v_mfma_f32_16x16x32_bf16 a[12:15], v[124:127], a[156:159], 0
    s_waitcnt lgkmcnt(4)
    v_fma_f32 v90, v90, v10, v11
    v_fma_f32 v91, v91, v10, v11
    v_mfma_f32_16x16x32_bf16 a[12:15], v[116:119], a[152:155], a[12:15]
    ds_read_b128 a[196:199], v35 offset:12288
    v_cvt_pk_bf16_f32 v144, v88, v89
    v_mfma_f32_16x16x32_bf16 a[16:19], v[112:115], a[160:163], 0
    s_add_u32 m0, s8, 0x12800
    ds_read_b128 a[200:203], v34 offset:14336
    v_cvt_pk_bf16_f32 v145, v90, v91
    v_mfma_f32_16x16x32_bf16 a[16:19], v[120:123], a[164:167], a[16:19]
    buffer_load_dwordx4 v15, s[52:55], s9 offen lds
    v_mfma_f32_16x16x32_bf16 a[20:23], v[124:127], a[164:167], 0
    s_add_u32 m0, s8, 0x12c00
    ds_read_b128 a[204:207], v35 offset:14336
    v_lshlrev_b32 v88, 16, v146
    v_mfma_f32_16x16x32_bf16 a[20:23], v[116:119], a[160:163], a[20:23]
    buffer_load_dwordx4 v16, s[52:55], s9 offen lds
    v_mfma_f32_16x16x32_bf16 a[24:27], v[112:115], a[168:171], 0
    v_and_b32 v89, s15, v146
    v_lshlrev_b32 v90, 16, v147
    v_mfma_f32_16x16x32_bf16 a[24:27], v[120:123], a[172:175], a[24:27]
    ds_read_b128 a[208:211], v34 offset:16384
    v_and_b32 v91, s15, v147
    v_mfma_f32_16x16x32_bf16 a[28:31], v[124:127], a[172:175], 0
    s_add_u32 m0, s8, 0x13000
    s_waitcnt lgkmcnt(4)
    v_fma_f32 v88, v88, v10, v11
    v_fma_f32 v89, v89, v10, v11
    v_mfma_f32_16x16x32_bf16 a[28:31], v[116:119], a[168:171], a[28:31]
    ds_read_b128 a[212:215], v35 offset:16384
    buffer_load_dwordx4 v17, s[52:55], s9 offen lds
    v_mfma_f32_16x16x32_bf16 a[32:35], v[112:115], a[176:179], 0
    s_add_u32 m0, s8, 0x13400
    ds_read_b128 a[144:147], v34 offset:18432
    v_fma_f32 v90, v90, v10, v11
    v_mfma_f32_16x16x32_bf16 a[32:35], v[120:123], a[180:183], a[32:35]
    buffer_load_dwordx4 v18, s[52:55], s9 offen lds
    v_mfma_f32_16x16x32_bf16 a[36:39], v[124:127], a[180:183], 0
    v_fma_f32 v91, v91, v10, v11
    v_cvt_pk_bf16_f32 v146, v88, v89
    v_mfma_f32_16x16x32_bf16 a[36:39], v[116:119], a[176:179], a[36:39]
    ds_read_b128 a[148:151], v35 offset:18432
    v_cvt_pk_bf16_f32 v147, v90, v91
    v_mfma_f32_16x16x32_bf16 a[40:43], v[112:115], a[184:187], 0
    s_add_u32 m0, s8, 0x13800
    ds_read_b128 a[152:155], v34 offset:20480
    v_lshlrev_b32 v92, 16, v148
    v_mfma_f32_16x16x32_bf16 a[40:43], v[120:123], a[188:191], a[40:43]
    buffer_load_dwordx4 v19, s[52:55], s9 offen lds
    v_mfma_f32_16x16x32_bf16 a[44:47], v[124:127], a[188:191], 0
    s_add_u32 m0, s8, 0x13c00
    s_waitcnt lgkmcnt(4)
    v_and_b32 v93, s15, v148
    v_lshlrev_b32 v94, 16, v149
    v_mfma_f32_16x16x32_bf16 a[44:47], v[116:119], a[184:187], a[44:47]
    ds_read_b128 a[156:159], v35 offset:20480
    buffer_load_dwordx4 v20, s[52:55], s9 offen lds
    v_mfma_f32_16x16x32_bf16 a[48:51], v[112:115], a[192:195], 0
    v_and_b32 v95, s15, v149
    v_fma_f32 v92, v92, v108, v109
    v_mfma_f32_16x16x32_bf16 a[48:51], v[120:123], a[196:199], a[48:51]
    ds_read_b128 a[160:163], v34 offset:22528
    v_fma_f32 v93, v93, v108, v109
    v_mfma_f32_16x16x32_bf16 a[52:55], v[124:127], a[196:199], 0
    v_fma_f32 v94, v94, v108, v109
    v_fma_f32 v95, v95, v108, v109
    v_mfma_f32_16x16x32_bf16 a[52:55], v[116:119], a[192:195], a[52:55]
    s_add_u32 m0, s8, 0x14000
    ds_read_b128 a[164:167], v35 offset:22528
    buffer_load_dwordx4 v21, s[52:55], s9 offen lds
    v_mfma_f32_16x16x32_bf16 a[56:59], v[112:115], a[200:203], 0
    s_mov_b32 s9, 0x0
    v_cvt_pk_bf16_f32 v148, v92, v93
    v_mfma_f32_16x16x32_bf16 a[56:59], v[120:123], a[204:207], a[56:59]
    s_add_u32 m0, s8, 0x1b000
    ds_read_b128 a[168:171], v34 offset:24576
    buffer_load_dwordx4 v13, s[52:55], s9 offen lds
    v_mfma_f32_16x16x32_bf16 a[60:63], v[124:127], a[204:207], 0
    s_waitcnt lgkmcnt(4)
    v_cvt_pk_bf16_f32 v149, v94, v95
    v_lshlrev_b32 v92, 16, v150
    v_mfma_f32_16x16x32_bf16 a[60:63], v[116:119], a[200:203], a[60:63]
    ds_read_b128 a[172:175], v35 offset:24576
    v_and_b32 v93, s15, v150
    v_mfma_f32_16x16x32_bf16 a[64:67], v[112:115], a[208:211], 0
    v_lshlrev_b32 v94, 16, v151
    v_and_b32 v95, s15, v151
    v_mfma_f32_16x16x32_bf16 a[64:67], v[120:123], a[212:215], a[64:67]
    s_add_u32 m0, s8, 0x1b400
    ds_read_b128 a[176:179], v34 offset:26624
    buffer_load_dwordx4 v14, s[52:55], s9 offen lds
    v_mfma_f32_16x16x32_bf16 a[68:71], v[124:127], a[212:215], 0
    s_add_u32 m0, s8, 0x1b800
    ds_read_b128 a[180:183], v35 offset:26624
    v_fma_f32 v92, v92, v108, v109
    v_mfma_f32_16x16x32_bf16 a[68:71], v[116:119], a[208:211], a[68:71]
    buffer_load_dwordx4 v15, s[52:55], s9 offen lds
    v_mfma_f32_16x16x32_bf16 a[72:75], v[112:115], a[144:147], 0
    v_fma_f32 v93, v93, v108, v109
    v_fma_f32 v94, v94, v108, v109
    v_mfma_f32_16x16x32_bf16 a[72:75], v[120:123], a[148:151], a[72:75]
    ds_read_b128 a[184:187], v34 offset:28672
    v_fma_f32 v95, v95, v108, v109
    v_cvt_pk_bf16_f32 v150, v92, v93
    v_mfma_f32_16x16x32_bf16 a[76:79], v[124:127], a[148:151], 0
    s_add_u32 m0, s8, 0x1bc00
    s_waitcnt lgkmcnt(4)
    v_cvt_pk_bf16_f32 v151, v94, v95
    v_mfma_f32_16x16x32_bf16 a[76:79], v[116:119], a[144:147], a[76:79]
    ds_read_b128 a[188:191], v35 offset:28672
    buffer_load_dwordx4 v16, s[52:55], s9 offen lds
    v_mfma_f32_16x16x32_bf16 a[80:83], v[112:115], a[152:155], 0
    v_lshlrev_b32 v88, 16, v152
    v_and_b32 v89, s15, v152
    v_mfma_f32_16x16x32_bf16 a[80:83], v[120:123], a[156:159], a[80:83]
    s_add_u32 m0, s8, 0x1c000
    ds_read_b128 a[192:195], v34 offset:30720
    buffer_load_dwordx4 v17, s[52:55], s9 offen lds
    v_mfma_f32_16x16x32_bf16 a[84:87], v[124:127], a[156:159], 0
    v_lshlrev_b32 v90, 16, v153
    v_and_b32 v91, s15, v153
    v_mfma_f32_16x16x32_bf16 a[84:87], v[116:119], a[152:155], a[84:87]
    ds_read_b128 a[196:199], v35 offset:30720
    v_fma_f32 v88, v88, v10, v11
    v_mfma_f32_16x16x32_bf16 a[88:91], v[112:115], a[160:163], 0
    v_fma_f32 v89, v89, v10, v11
    v_fma_f32 v90, v90, v10, v11
    v_mfma_f32_16x16x32_bf16 a[88:91], v[120:123], a[164:167], a[88:91]
    s_add_u32 m0, s8, 0x1c400
    ds_read_b128 a[200:203], v34 offset:32768
    buffer_load_dwordx4 v18, s[52:55], s9 offen lds
    v_mfma_f32_16x16x32_bf16 a[92:95], v[124:127], a[164:167], 0
    s_add_u32 m0, s8, 0x1c800
    s_waitcnt lgkmcnt(4)
    v_fma_f32 v91, v91, v10, v11
    v_cvt_pk_bf16_f32 v152, v88, v89
    v_mfma_f32_16x16x32_bf16 a[92:95], v[116:119], a[160:163], a[92:95]
    ds_read_b128 a[204:207], v35 offset:32768
    buffer_load_dwordx4 v19, s[52:55], s9 offen lds
    v_mfma_f32_16x16x32_bf16 a[96:99], v[112:115], a[168:171], 0
    ds_read_b128 a[208:211], v34 offset:34816
    v_add_u32 v34, 0x9000, v32
    v_mfma_f32_16x16x32_bf16 a[96:99], v[120:123], a[172:175], a[96:99]
    v_cvt_pk_bf16_f32 v153, v90, v91
    v_lshlrev_b32 v88, 16, v154
    v_mfma_f32_16x16x32_bf16 a[100:103], v[124:127], a[172:175], 0
    s_add_u32 m0, s8, 0x1cc00
    ds_read_b128 a[212:215], v35 offset:34816
    v_add_u32 v35, 0x9000, v33
    v_mfma_f32_16x16x32_bf16 a[100:103], v[116:119], a[168:171], a[100:103]
    buffer_load_dwordx4 v20, s[52:55], s9 offen lds
    v_and_b32 v89, s15, v154
    v_mfma_f32_16x16x32_bf16 a[104:107], v[112:115], a[176:179], 0
    s_add_u32 m0, s8, 0x1d000
    v_mov_b32 v42, -1
    v_mov_b32 v43, -1
    v_mfma_f32_16x16x32_bf16 a[104:107], v[120:123], a[180:183], a[104:107]
    buffer_load_dwordx4 v21, s[52:55], s9 offen lds
    v_lshlrev_b32 v90, 16, v155
    v_mfma_f32_16x16x32_bf16 a[108:111], v[124:127], a[180:183], 0
    s_waitcnt lgkmcnt(3)
    v_and_b32 v91, s15, v155
    v_fma_f32 v88, v88, v10, v11
    v_mfma_f32_16x16x32_bf16 a[108:111], v[116:119], a[176:179], a[108:111]
    v_fma_f32 v89, v89, v10, v11
    v_fma_f32 v90, v90, v10, v11
    v_mfma_f32_16x16x32_bf16 a[112:115], v[112:115], a[184:187], 0
    v_fma_f32 v91, v91, v10, v11
    v_cvt_pk_bf16_f32 v154, v88, v89
    v_mfma_f32_16x16x32_bf16 a[112:115], v[120:123], a[188:191], a[112:115]
    buffer_load_dword v4, v51, s[52:55], 0 offen offset:128
    v_cvt_pk_bf16_f32 v155, v90, v91
    v_mfma_f32_16x16x32_bf16 a[116:119], v[124:127], a[188:191], 0
    s_waitcnt vmcnt(19) lgkmcnt(0)
    s_barrier
    v_mfma_f32_16x16x32_bf16 a[116:119], v[116:119], a[184:187], a[116:119]
    ds_read_b128 a[144:147], v34 offset:0
    ds_read_b128 a[148:151], v35 offset:0
    v_mfma_f32_16x16x32_bf16 a[120:123], v[112:115], a[192:195], 0
    v_lshlrev_b32 v92, 16, v156
    v_mfma_f32_16x16x32_bf16 a[120:123], v[120:123], a[196:199], a[120:123]
    buffer_store_dwordx4 v[46:49], v44, s[60:63], 0 offen offset:0 sc1
    ds_read_b128 a[152:155], v34 offset:2048
    ds_read_b128 a[156:159], v35 offset:2048
    v_mfma_f32_16x16x32_bf16 a[124:127], v[124:127], a[196:199], 0
    s_waitcnt lgkmcnt(3)
    ds_read_b128 a[160:163], v34 offset:4096
    v_and_b32 v93, s15, v156
    v_mfma_f32_16x16x32_bf16 a[124:127], v[116:119], a[192:195], a[124:127]
    ds_read_b128 a[164:167], v35 offset:4096
    v_lshlrev_b32 v94, 16, v157
    v_and_b32 v95, s15, v157
    v_mfma_f32_16x16x32_bf16 a[128:131], v[112:115], a[200:203], 0
    v_mfma_f32_16x16x32_bf16 a[128:131], v[120:123], a[204:207], a[128:131]
    buffer_store_dwordx2 v[42:43], v50, s[64:67], s36 offen sc1
    ds_read_b128 a[168:171], v34 offset:6144
    v_fma_f32 v92, v92, v108, v109
    v_fma_f32 v93, v93, v108, v109
    v_mfma_f32_16x16x32_bf16 a[132:135], v[124:127], a[204:207], 0
    ds_read_b128 a[172:175], v35 offset:6144
    v_fma_f32 v94, v94, v108, v109
    v_mfma_f32_16x16x32_bf16 a[132:135], v[116:119], a[200:203], a[132:135]
    global_load_ushort v96, v45, s[18:19]
    v_mfma_f32_16x16x32_bf16 a[136:139], v[112:115], a[208:211], 0
    v_fma_f32 v95, v95, v108, v109
    v_cvt_pk_bf16_f32 v156, v92, v93
    v_mfma_f32_16x16x32_bf16 a[136:139], v[120:123], a[212:215], a[136:139]
    ds_read_b128 a[176:179], v34 offset:8192
    global_load_ushort v97, v45, s[20:21]
    v_mfma_f32_16x16x32_bf16 a[140:143], v[124:127], a[212:215], 0
    s_waitcnt lgkmcnt(4)
    ds_read_b128 a[180:183], v35 offset:8192
    v_cvt_pk_bf16_f32 v157, v94, v95
    v_mfma_f32_16x16x32_bf16 a[140:143], v[116:119], a[208:211], a[140:143]
    global_load_ushort v98, v45, s[30:31]
    v_mfma_f32_16x16x32_bf16 a[0:3], v[128:131], a[144:147], a[0:3]
    v_lshlrev_b32 v92, 16, v158
    v_and_b32 v93, s15, v158
    v_mfma_f32_16x16x32_bf16 a[0:3], v[136:139], a[148:151], a[0:3]
    ds_read_b128 a[184:187], v34 offset:10240
    v_lshlrev_b32 v94, 16, v159
    v_and_b32 v95, s15, v159
    v_mfma_f32_16x16x32_bf16 a[4:7], v[140:143], a[148:151], a[4:7]
    v_fma_f32 v92, v92, v108, v109
    v_fma_f32 v93, v93, v108, v109
    v_mfma_f32_16x16x32_bf16 a[4:7], v[132:135], a[144:147], a[4:7]
    ds_read_b128 a[188:191], v35 offset:10240
    v_fma_f32 v94, v94, v108, v109
    v_mfma_f32_16x16x32_bf16 a[8:11], v[128:131], a[152:155], a[8:11]
    v_fma_f32 v95, v95, v108, v109
    v_cvt_pk_bf16_f32 v158, v92, v93
    v_mfma_f32_16x16x32_bf16 a[8:11], v[136:139], a[156:159], a[8:11]
    s_add_u32 s11, s22, 0
    ds_read_b128 a[192:195], v34 offset:12288
    buffer_load_dwordx2 a[216:217], v104, s[48:51], s11 offen
    v_mfma_f32_16x16x32_bf16 a[12:15], v[140:143], a[156:159], a[12:15]
    s_add_u32 s11, s22, 18432
    s_waitcnt lgkmcnt(4)
    v_cvt_pk_bf16_f32 v159, v94, v95
    v_mfma_f32_16x16x32_bf16 a[12:15], v[132:135], a[152:155], a[12:15]
    ds_read_b128 a[196:199], v35 offset:12288
    buffer_load_dwordx2 a[218:219], v104, s[48:51], s11 offen
    v_mfma_f32_16x16x32_bf16 a[16:19], v[128:131], a[160:163], a[16:19]
    ds_read_b128 a[200:203], v34 offset:14336
    v_lshlrev_b32 v88, 16, v160
    v_mfma_f32_16x16x32_bf16 a[16:19], v[136:139], a[164:167], a[16:19]
    s_add_u32 s11, s23, 0
    buffer_load_dwordx2 a[220:221], v104, s[48:51], s11 offen
    v_mfma_f32_16x16x32_bf16 a[20:23], v[140:143], a[164:167], a[20:23]
    ds_read_b128 a[204:207], v35 offset:14336
    v_and_b32 v89, s15, v160
    v_mfma_f32_16x16x32_bf16 a[20:23], v[132:135], a[160:163], a[20:23]
    s_add_u32 s11, s23, 18432
    buffer_load_dwordx2 a[222:223], v104, s[48:51], s11 offen
    v_mfma_f32_16x16x32_bf16 a[24:27], v[128:131], a[168:171], a[24:27]
    ds_read_b128 a[208:211], v34 offset:16384
    v_lshlrev_b32 v90, 16, v161
    v_mfma_f32_16x16x32_bf16 a[24:27], v[136:139], a[172:175], a[24:27]
    s_add_u32 s11, s24, 0
    buffer_load_dwordx2 a[224:225], v104, s[48:51], s11 offen
    v_mfma_f32_16x16x32_bf16 a[28:31], v[140:143], a[172:175], a[28:31]
    s_add_u32 s11, s24, 18432
    s_waitcnt lgkmcnt(4)
    v_and_b32 v91, s15, v161
    v_mfma_f32_16x16x32_bf16 a[28:31], v[132:135], a[168:171], a[28:31]
    ds_read_b128 a[212:215], v35 offset:16384
    buffer_load_dwordx2 a[226:227], v104, s[48:51], s11 offen
    v_mfma_f32_16x16x32_bf16 a[32:35], v[128:131], a[176:179], a[32:35]
    v_fma_f32 v88, v88, v10, v11
    v_fma_f32 v89, v89, v10, v11
    v_mfma_f32_16x16x32_bf16 a[32:35], v[136:139], a[180:183], a[32:35]
    ds_read_b128 a[144:147], v34 offset:18432
    v_fma_f32 v90, v90, v10, v11
    v_mfma_f32_16x16x32_bf16 a[36:39], v[140:143], a[180:183], a[36:39]
    v_fma_f32 v91, v91, v10, v11
    v_cvt_pk_bf16_f32 v160, v88, v89
    v_mfma_f32_16x16x32_bf16 a[36:39], v[132:135], a[176:179], a[36:39]
    ds_read_b128 a[148:151], v35 offset:18432
    v_cvt_pk_bf16_f32 v161, v90, v91
    v_mfma_f32_16x16x32_bf16 a[40:43], v[128:131], a[184:187], a[40:43]
    v_lshlrev_b32 v88, 16, v162
    v_and_b32 v89, s15, v162
    v_mfma_f32_16x16x32_bf16 a[40:43], v[136:139], a[188:191], a[40:43]
    ds_read_b128 a[152:155], v34 offset:20480
    v_lshlrev_b32 v90, 16, v163
    v_mfma_f32_16x16x32_bf16 a[44:47], v[140:143], a[188:191], a[44:47]
    s_waitcnt lgkmcnt(4)
    v_and_b32 v91, s15, v163
    v_fma_f32 v88, v88, v10, v11
    v_mfma_f32_16x16x32_bf16 a[44:47], v[132:135], a[184:187], a[44:47]
    ds_read_b128 a[156:159], v35 offset:20480
    v_fma_f32 v89, v89, v10, v11
    v_mfma_f32_16x16x32_bf16 a[48:51], v[128:131], a[192:195], a[48:51]
    s_mov_b32 s9, 0x180
    v_fma_f32 v90, v90, v10, v11
    v_mfma_f32_16x16x32_bf16 a[48:51], v[136:139], a[196:199], a[48:51]
    s_add_u32 m0, s8, 0x0
    ds_read_b128 a[160:163], v34 offset:22528
    buffer_load_dwordx4 v13, s[52:55], s9 offen lds
    v_mfma_f32_16x16x32_bf16 a[52:55], v[140:143], a[196:199], a[52:55]
    v_fma_f32 v91, v91, v10, v11
    v_cvt_pk_bf16_f32 v162, v88, v89
    v_mfma_f32_16x16x32_bf16 a[52:55], v[132:135], a[192:195], a[52:55]
    ds_read_b128 a[164:167], v35 offset:22528
    v_cvt_pk_bf16_f32 v163, v90, v91
    v_mfma_f32_16x16x32_bf16 a[56:59], v[128:131], a[200:203], a[56:59]
    s_add_u32 m0, s8, 0x400
    ds_read_b128 a[168:171], v34 offset:24576
    v_lshlrev_b32 v92, 16, v164
    v_mfma_f32_16x16x32_bf16 a[56:59], v[136:139], a[204:207], a[56:59]
    buffer_load_dwordx4 v14, s[52:55], s9 offen lds
    v_mfma_f32_16x16x32_bf16 a[60:63], v[140:143], a[204:207], a[60:63]
    s_waitcnt lgkmcnt(4)
    v_and_b32 v93, s15, v164
    v_lshlrev_b32 v94, 16, v165
    v_mfma_f32_16x16x32_bf16 a[60:63], v[132:135], a[200:203], a[60:63]
    ds_read_b128 a[172:175], v35 offset:24576
    v_and_b32 v95, s15, v165
    v_mfma_f32_16x16x32_bf16 a[64:67], v[128:131], a[208:211], a[64:67]
    s_add_u32 m0, s8, 0x800
    ds_read_b128 a[176:179], v34 offset:26624
    v_fma_f32 v92, v92, v108, v109
    v_mfma_f32_16x16x32_bf16 a[64:67], v[136:139], a[212:215], a[64:67]
    buffer_load_dwordx4 v15, s[52:55], s9 offen lds
    v_mfma_f32_16x16x32_bf16 a[68:71], v[140:143], a[212:215], a[68:71]
    v_fma_f32 v93, v93, v108, v109
    v_fma_f32 v94, v94, v108, v109
    v_mfma_f32_16x16x32_bf16 a[68:71], v[132:135], a[208:211], a[68:71]
    ds_read_b128 a[180:183], v35 offset:26624
    v_fma_f32 v95, v95, v108, v109
    v_mfma_f32_16x16x32_bf16 a[72:75], v[128:131], a[144:147], a[72:75]
    s_add_u32 m0, s8, 0xc00
    ds_read_b128 a[184:187], v34 offset:28672
    v_cvt_pk_bf16_f32 v164, v92, v93
    v_mfma_f32_16x16x32_bf16 a[72:75], v[136:139], a[148:151], a[72:75]
    buffer_load_dwordx4 v16, s[52:55], s9 offen lds
    v_mfma_f32_16x16x32_bf16 a[76:79], v[140:143], a[148:151], a[76:79]
    s_waitcnt lgkmcnt(4)
    v_cvt_pk_bf16_f32 v165, v94, v95
    v_lshlrev_b32 v92, 16, v166
    v_mfma_f32_16x16x32_bf16 a[76:79], v[132:135], a[144:147], a[76:79]
    ds_read_b128 a[188:191], v35 offset:28672
    v_and_b32 v93, s15, v166
    v_mfma_f32_16x16x32_bf16 a[80:83], v[128:131], a[152:155], a[80:83]
    s_add_u32 m0, s8, 0x1000
    ds_read_b128 a[192:195], v34 offset:30720
    v_lshlrev_b32 v94, 16, v167
    v_mfma_f32_16x16x32_bf16 a[80:83], v[136:139], a[156:159], a[80:83]
    buffer_load_dwordx4 v17, s[52:55], s9 offen lds
    v_mfma_f32_16x16x32_bf16 a[84:87], v[140:143], a[156:159], a[84:87]
    v_and_b32 v95, s15, v167
    v_fma_f32 v92, v92, v108, v109
    v_mfma_f32_16x16x32_bf16 a[84:87], v[132:135], a[152:155], a[84:87]
    ds_read_b128 a[196:199], v35 offset:30720
    v_fma_f32 v93, v93, v108, v109
    v_mfma_f32_16x16x32_bf16 a[88:91], v[128:131], a[160:163], a[88:91]
    s_add_u32 m0, s8, 0x1400
    ds_read_b128 a[200:203], v34 offset:32768
    v_fma_f32 v94, v94, v108, v109
    v_mfma_f32_16x16x32_bf16 a[88:91], v[136:139], a[164:167], a[88:91]
    buffer_load_dwordx4 v18, s[52:55], s9 offen lds
    v_mfma_f32_16x16x32_bf16 a[92:95], v[140:143], a[164:167], a[92:95]
    s_waitcnt lgkmcnt(4)
    v_fma_f32 v95, v95, v108, v109
    v_cvt_pk_bf16_f32 v166, v92, v93
    v_mfma_f32_16x16x32_bf16 a[92:95], v[132:135], a[160:163], a[92:95]
    ds_read_b128 a[204:207], v35 offset:32768
    v_cvt_pk_bf16_f32 v167, v94, v95
    v_mfma_f32_16x16x32_bf16 a[96:99], v[128:131], a[168:171], a[96:99]
    s_add_u32 m0, s8, 0x1800
    ds_read_b128 a[208:211], v34 offset:34816
    v_add_u32 v34, 0x12000, v32
    v_mfma_f32_16x16x32_bf16 a[96:99], v[136:139], a[172:175], a[96:99]
    buffer_load_dwordx4 v19, s[52:55], s9 offen lds
    v_mfma_f32_16x16x32_bf16 a[100:103], v[140:143], a[172:175], a[100:103]
    ds_read_b128 a[212:215], v35 offset:34816
    v_add_u32 v35, 0x12000, v33
    v_mfma_f32_16x16x32_bf16 a[100:103], v[132:135], a[168:171], a[100:103]
    v_lshlrev_b32 v88, 16, v168
    v_and_b32 v89, s15, v168
    v_mfma_f32_16x16x32_bf16 a[104:107], v[128:131], a[176:179], a[104:107]
    s_add_u32 m0, s8, 0x1c00
    v_lshlrev_b32 v90, 16, v169
    v_and_b32 v91, s15, v169
    v_mfma_f32_16x16x32_bf16 a[104:107], v[136:139], a[180:183], a[104:107]
    buffer_load_dwordx4 v20, s[52:55], s9 offen lds
    v_mfma_f32_16x16x32_bf16 a[108:111], v[140:143], a[180:183], a[108:111]
    s_waitcnt lgkmcnt(3)
    v_fma_f32 v88, v88, v10, v11
    v_fma_f32 v89, v89, v10, v11
    v_mfma_f32_16x16x32_bf16 a[108:111], v[132:135], a[176:179], a[108:111]
    v_fma_f32 v90, v90, v10, v11
    v_fma_f32 v91, v91, v10, v11
    v_mfma_f32_16x16x32_bf16 a[112:115], v[128:131], a[184:187], a[112:115]
    s_add_u32 m0, s8, 0x2000
    v_cvt_pk_bf16_f32 v168, v88, v89
    v_cvt_pk_bf16_f32 v169, v90, v91
    v_mfma_f32_16x16x32_bf16 a[112:115], v[136:139], a[188:191], a[112:115]
    buffer_load_dwordx4 v21, s[52:55], s9 offen lds
    v_lshlrev_b32 v88, 16, v170
    v_mfma_f32_16x16x32_bf16 a[116:119], v[140:143], a[188:191], a[116:119]
    s_waitcnt vmcnt(30) lgkmcnt(0)
    s_barrier
    v_mfma_f32_16x16x32_bf16 a[116:119], v[132:135], a[184:187], a[116:119]
    ds_read_b128 a[144:147], v34 offset:0
    ds_read_b128 a[148:151], v35 offset:0
    v_mfma_f32_16x16x32_bf16 a[120:123], v[128:131], a[192:195], a[120:123]
    s_mov_b32 s9, 0x300
    ds_read_b128 a[152:155], v34 offset:2048
    v_mfma_f32_16x16x32_bf16 a[120:123], v[136:139], a[196:199], a[120:123]
    s_add_u32 m0, s8, 0x9000
    ds_read_b128 a[156:159], v35 offset:2048
    buffer_load_dwordx4 v13, s[52:55], s9 offen lds
    v_mfma_f32_16x16x32_bf16 a[124:127], v[140:143], a[196:199], a[124:127]
    s_waitcnt lgkmcnt(3)
    ds_read_b128 a[160:163], v34 offset:4096
    v_and_b32 v89, s15, v170
    v_mfma_f32_16x16x32_bf16 a[124:127], v[132:135], a[192:195], a[124:127]
    ds_read_b128 a[164:167], v35 offset:4096
    v_lshlrev_b32 v90, 16, v171
    v_mfma_f32_16x16x32_bf16 a[128:131], v[128:131], a[200:203], a[128:131]
    v_and_b32 v91, s15, v171
    v_fma_f32 v88, v88, v10, v11
    v_mfma_f32_16x16x32_bf16 a[128:131], v[136:139], a[204:207], a[128:131]
    ds_read_b128 a[168:171], v34 offset:6144
    v_fma_f32 v89, v89, v10, v11
    v_mfma_f32_16x16x32_bf16 a[132:135], v[140:143], a[204:207], a[132:135]
    v_fma_f32 v90, v90, v10, v11
    v_fma_f32 v91, v91, v10, v11
    v_mfma_f32_16x16x32_bf16 a[132:135], v[132:135], a[200:203], a[132:135]
    ds_read_b128 a[172:175], v35 offset:6144
    v_cvt_pk_bf16_f32 v170, v88, v89
    v_mfma_f32_16x16x32_bf16 a[136:139], v[128:131], a[208:211], a[136:139]
    s_add_u32 m0, s8, 0x9400
    ds_read_b128 a[176:179], v34 offset:8192
    v_cvt_pk_bf16_f32 v171, v90, v91
    v_mfma_f32_16x16x32_bf16 a[136:139], v[136:139], a[212:215], a[136:139]
    buffer_load_dwordx4 v14, s[52:55], s9 offen lds
    v_mfma_f32_16x16x32_bf16 a[140:143], v[140:143], a[212:215], a[140:143]
    s_waitcnt lgkmcnt(4)
    v_lshlrev_b32 v92, 16, v172
    v_mfma_f32_16x16x32_bf16 a[140:143], v[132:135], a[208:211], a[140:143]
    ds_read_b128 a[180:183], v35 offset:8192
    v_and_b32 v93, s15, v172
    v_mfma_f32_16x16x32_bf16 a[0:3], v[144:147], a[144:147], a[0:3]
L_ps4:
    s_cbranch_execz L_rs4
    v_lshlrev_b32 v94, 16, v173
    v_and_b32 v95, s15, v173
    v_mfma_f32_16x16x32_bf16 a[0:3], v[152:155], a[148:151], a[0:3]
    ds_read_b128 a[184:187], v34 offset:10240
    v_fma_f32 v92, v92, v108, v109
    v_mfma_f32_16x16x32_bf16 a[4:7], v[156:159], a[148:151], a[4:7]
    v_fma_f32 v93, v93, v108, v109
    v_mfma_f32_16x16x32_bf16 a[4:7], v[148:151], a[144:147], a[4:7]
    ds_read_b128 a[188:191], v35 offset:10240
    v_fma_f32 v94, v94, v108, v109
    v_mfma_f32_16x16x32_bf16 a[8:11], v[144:147], a[152:155], a[8:11]
    s_add_u32 m0, s8, 0x9800
    ds_read_b128 a[192:195], v34 offset:12288
    v_fma_f32 v95, v95, v108, v109
    v_mfma_f32_16x16x32_bf16 a[8:11], v[152:155], a[156:159], a[8:11]
    buffer_load_dwordx4 v15, s[52:55], s9 offen lds
    v_mfma_f32_16x16x32_bf16 a[12:15], v[156:159], a[156:159], a[12:15]
    s_waitcnt lgkmcnt(4)
    v_cvt_pk_bf16_f32 v172, v92, v93
    v_mfma_f32_16x16x32_bf16 a[12:15], v[148:151], a[152:155], a[12:15]
    ds_read_b128 a[196:199], v35 offset:12288
    v_cvt_pk_bf16_f32 v173, v94, v95
    v_mfma_f32_16x16x32_bf16 a[16:19], v[144:147], a[160:163], a[16:19]
    v_lshlrev_b32 v92, 16, v174
    v_mfma_f32_16x16x32_bf16 a[16:19], v[152:155], a[164:167], a[16:19]
    ds_read_b128 a[200:203], v34 offset:14336
    v_and_b32 v93, s15, v174
    v_mfma_f32_16x16x32_bf16 a[20:23], v[156:159], a[164:167], a[20:23]
    v_lshlrev_b32 v94, 16, v175
    v_and_b32 v95, s15, v175
    v_mfma_f32_16x16x32_bf16 a[20:23], v[148:151], a[160:163], a[20:23]
    ds_read_b128 a[204:207], v35 offset:14336
    v_fma_f32 v92, v92, v108, v109
    v_mfma_f32_16x16x32_bf16 a[24:27], v[144:147], a[168:171], a[24:27]
    s_add_u32 m0, s8, 0x9c00
    ds_read_b128 a[208:211], v34 offset:16384
    v_mfma_f32_16x16x32_bf16 a[24:27], v[152:155], a[172:175], a[24:27]
    buffer_load_dwordx4 v16, s[52:55], s9 offen lds
    v_mfma_f32_16x16x32_bf16 a[28:31], v[156:159], a[172:175], a[28:31]
    s_waitcnt lgkmcnt(4)
    v_fma_f32 v93, v93, v108, v109
    v_fma_f32 v94, v94, v108, v109
    v_mfma_f32_16x16x32_bf16 a[28:31], v[148:151], a[168:171], a[28:31]
    ds_read_b128 a[212:215], v35 offset:16384
    v_fma_f32 v95, v95, v108, v109
    v_mfma_f32_16x16x32_bf16 a[32:35], v[144:147], a[176:179], a[32:35]
    v_cvt_pk_bf16_f32 v174, v92, v93
    v_mfma_f32_16x16x32_bf16 a[32:35], v[152:155], a[180:183], a[32:35]
    ds_read_b128 a[144:147], v34 offset:18432
    v_cvt_pk_bf16_f32 v175, v94, v95
    v_mfma_f32_16x16x32_bf16 a[36:39], v[156:159], a[180:183], a[36:39]
    v_lshlrev_b32 v88, 16, v176
    v_and_b32 v89, s15, v176
    v_mfma_f32_16x16x32_bf16 a[36:39], v[148:151], a[176:179], a[36:39]
    ds_read_b128 a[148:151], v35 offset:18432
    v_lshlrev_b32 v90, 16, v177
    v_mfma_f32_16x16x32_bf16 a[40:43], v[144:147], a[184:187], a[40:43]
    s_add_u32 m0, s8, 0xa000
    ds_read_b128 a[152:155], v34 offset:20480
    v_mfma_f32_16x16x32_bf16 a[40:43], v[152:155], a[188:191], a[40:43]
    buffer_load_dwordx4 v17, s[52:55], s9 offen lds
    v_mfma_f32_16x16x32_bf16 a[44:47], v[156:159], a[188:191], a[44:47]
    s_waitcnt lgkmcnt(4)
    v_and_b32 v91, s15, v177
    v_fma_f32 v88, v88, v10, v11
    v_mfma_f32_16x16x32_bf16 a[44:47], v[148:151], a[184:187], a[44:47]
    ds_read_b128 a[156:159], v35 offset:20480
    v_fma_f32 v89, v89, v10, v11
    v_mfma_f32_16x16x32_bf16 a[48:51], v[144:147], a[192:195], a[48:51]
    v_fma_f32 v90, v90, v10, v11
    v_mfma_f32_16x16x32_bf16 a[48:51], v[152:155], a[196:199], a[48:51]
    ds_read_b128 a[160:163], v34 offset:22528
    v_fma_f32 v91, v91, v10, v11
    v_mfma_f32_16x16x32_bf16 a[52:55], v[156:159], a[196:199], a[52:55]
    v_cvt_pk_bf16_f32 v176, v88, v89
    v_cvt_pk_bf16_f32 v177, v90, v91
    v_mfma_f32_16x16x32_bf16 a[52:55], v[148:151], a[192:195], a[52:55]
    ds_read_b128 a[164:167], v35 offset:22528
    v_lshlrev_b32 v88, 16, v178
    v_mfma_f32_16x16x32_bf16 a[56:59], v[144:147], a[200:203], a[56:59]
    s_add_u32 m0, s8, 0xa400
    ds_read_b128 a[168:171], v34 offset:24576
    v_and_b32 v89, s15, v178
    v_mfma_f32_16x16x32_bf16 a[56:59], v[152:155], a[204:207], a[56:59]
    buffer_load_dwordx4 v18, s[52:55], s9 offen lds
    v_mfma_f32_16x16x32_bf16 a[60:63], v[156:159], a[204:207], a[60:63]
    s_waitcnt lgkmcnt(4)
    v_lshlrev_b32 v90, 16, v179
    v_mfma_f32_16x16x32_bf16 a[60:63], v[148:151], a[200:203], a[60:63]
    ds_read_b128 a[172:175], v35 offset:24576
    v_and_b32 v91, s15, v179
    v_mfma_f32_16x16x32_bf16 a[64:67], v[144:147], a[208:211], a[64:67]
    v_fma_f32 v88, v88, v10, v11
    v_fma_f32 v89, v89, v10, v11
    v_mfma_f32_16x16x32_bf16 a[64:67], v[152:155], a[212:215], a[64:67]
    ds_read_b128 a[176:179], v34 offset:26624
    v_fma_f32 v90, v90, v10, v11
    v_mfma_f32_16x16x32_bf16 a[68:71], v[156:159], a[212:215], a[68:71]
    v_fma_f32 v91, v91, v10, v11
    v_mfma_f32_16x16x32_bf16 a[68:71], v[148:151], a[208:211], a[68:71]
    ds_read_b128 a[180:183], v35 offset:26624
    v_cvt_pk_bf16_f32 v178, v88, v89
    v_mfma_f32_16x16x32_bf16 a[72:75], v[144:147], a[144:147], a[72:75]
    s_add_u32 m0, s8, 0xa800
    ds_read_b128 a[184:187], v34 offset:28672
    v_cvt_pk_bf16_f32 v179, v90, v91
    v_mfma_f32_16x16x32_bf16 a[72:75], v[152:155], a[148:151], a[72:75]
    buffer_load_dwordx4 v19, s[52:55], s9 offen lds
    v_mfma_f32_16x16x32_bf16 a[76:79], v[156:159], a[148:151], a[76:79]
    s_waitcnt lgkmcnt(4)
    v_lshlrev_b32 v92, 16, v180
    v_mfma_f32_16x16x32_bf16 a[76:79], v[148:151], a[144:147], a[76:79]
    ds_read_b128 a[188:191], v35 offset:28672
    v_and_b32 v93, s15, v180
    v_mfma_f32_16x16x32_bf16 a[80:83], v[144:147], a[152:155], a[80:83]
    v_lshlrev_b32 v94, 16, v181
    v_and_b32 v95, s15, v181
    v_mfma_f32_16x16x32_bf16 a[80:83], v[152:155], a[156:159], a[80:83]
    ds_read_b128 a[192:195], v34 offset:30720
    v_fma_f32 v92, v92, v108, v109
    v_mfma_f32_16x16x32_bf16 a[84:87], v[156:159], a[156:159], a[84:87]
    v_fma_f32 v93, v93, v108, v109
    v_mfma_f32_16x16x32_bf16 a[84:87], v[148:151], a[152:155], a[84:87]
    ds_read_b128 a[196:199], v35 offset:30720
    v_fma_f32 v94, v94, v108, v109
    v_mfma_f32_16x16x32_bf16 a[88:91], v[144:147], a[160:163], a[88:91]
    s_add_u32 m0, s8, 0xac00
    ds_read_b128 a[200:203], v34 offset:32768
    v_mfma_f32_16x16x32_bf16 a[88:91], v[152:155], a[164:167], a[88:91]
    buffer_load_dwordx4 v20, s[52:55], s9 offen lds
    v_mfma_f32_16x16x32_bf16 a[92:95], v[156:159], a[164:167], a[92:95]
    s_waitcnt lgkmcnt(4)
    v_fma_f32 v95, v95, v108, v109
    v_cvt_pk_bf16_f32 v180, v92, v93
    v_mfma_f32_16x16x32_bf16 a[92:95], v[148:151], a[160:163], a[92:95]
    ds_read_b128 a[204:207], v35 offset:32768
    v_cvt_pk_bf16_f32 v181, v94, v95
    v_mfma_f32_16x16x32_bf16 a[96:99], v[144:147], a[168:171], a[96:99]
    ds_read_b128 a[208:211], v34 offset:34816
    v_mfma_f32_16x16x32_bf16 a[96:99], v[152:155], a[172:175], a[96:99]
    v_add_u32 v34, 0x1b000, v32
    v_lshlrev_b32 v92, 16, v182
    v_mfma_f32_16x16x32_bf16 a[100:103], v[156:159], a[172:175], a[100:103]
    ds_read_b128 a[212:215], v35 offset:34816
    v_mfma_f32_16x16x32_bf16 a[100:103], v[148:151], a[168:171], a[100:103]
    v_add_u32 v35, 0x1b000, v33
    v_and_b32 v93, s15, v182
    v_mfma_f32_16x16x32_bf16 a[104:107], v[144:147], a[176:179], a[104:107]
    s_add_u32 m0, s8, 0xb000
    v_lshlrev_b32 v94, 16, v183
    v_mfma_f32_16x16x32_bf16 a[104:107], v[152:155], a[180:183], a[104:107]
    buffer_load_dwordx4 v21, s[52:55], s9 offen lds
    v_mfma_f32_16x16x32_bf16 a[108:111], v[156:159], a[180:183], a[108:111]
    s_waitcnt lgkmcnt(3)
    v_and_b32 v95, s15, v183
    v_fma_f32 v92, v92, v108, v109
    v_mfma_f32_16x16x32_bf16 a[108:111], v[148:151], a[176:179], a[108:111]
    v_fma_f32 v93, v93, v108, v109
    v_fma_f32 v94, v94, v108, v109
    v_mfma_f32_16x16x32_bf16 a[112:115], v[144:147], a[184:187], a[112:115]
    v_fma_f32 v95, v95, v108, v109
    v_mfma_f32_16x16x32_bf16 a[112:115], v[152:155], a[188:191], a[112:115]
    v_cvt_pk_bf16_f32 v182, v92, v93
    v_cvt_pk_bf16_f32 v183, v94, v95
    v_mfma_f32_16x16x32_bf16 a[116:119], v[156:159], a[188:191], a[116:119]
    s_waitcnt vmcnt(27) lgkmcnt(0)
    s_barrier
    ds_read_b128 a[144:147], v34 offset:0
    ds_read_b128 a[148:151], v35 offset:0
    s_cmp_lg_u32 s3, 0
    s_cbranch_scc1 L_ssm_an
    s_mov_b64 exec, 1
    v_mov_b32 v43, 1
    v_mov_b32 v42, s38
    global_atomic_add v42, v43, s[42:43]
    v_mov_b32 v42, s68
    global_atomic_add v42, v43, s[42:43]
    s_mov_b64 exec, -1
L_ssm_an:
    v_mfma_f32_16x16x32_bf16 a[116:119], v[148:151], a[184:187], a[116:119]
    v_mfma_f32_16x16x32_bf16 a[120:123], v[144:147], a[192:195], a[120:123]
    s_mov_b32 s9, 0x80
    ds_read_b128 a[152:155], v34 offset:2048
    v_mfma_f32_16x16x32_bf16 a[120:123], v[152:155], a[196:199], a[120:123]
    s_add_u32 m0, s8, 0x12000
    ds_read_b128 a[156:159], v35 offset:2048
    buffer_load_dwordx4 v13, s[52:55], s9 offen lds
    v_mfma_f32_16x16x32_bf16 a[124:127], v[156:159], a[196:199], a[124:127]
    s_waitcnt lgkmcnt(3)
    ds_read_b128 a[160:163], v34 offset:4096
    v_lshlrev_b32 v88, 16, v184
    v_mfma_f32_16x16x32_bf16 a[124:127], v[148:151], a[192:195], a[124:127]
    ds_read_b128 a[164:167], v35 offset:4096
    v_and_b32 v89, s15, v184
    v_mfma_f32_16x16x32_bf16 a[128:131], v[144:147], a[200:203], a[128:131]
    v_lshlrev_b32 v90, 16, v185
    v_and_b32 v91, s15, v185
    v_mfma_f32_16x16x32_bf16 a[128:131], v[152:155], a[204:207], a[128:131]
    ds_read_b128 a[168:171], v34 offset:6144
    v_fma_f32 v88, v88, v10, v11
    v_mfma_f32_16x16x32_bf16 a[132:135], v[156:159], a[204:207], a[132:135]
    v_fma_f32 v89, v89, v10, v11
    v_fma_f32 v90, v90, v10, v11
    v_mfma_f32_16x16x32_bf16 a[132:135], v[148:151], a[200:203], a[132:135]
    ds_read_b128 a[172:175], v35 offset:6144
    v_fma_f32 v91, v91, v10, v11
    v_mfma_f32_16x16x32_bf16 a[136:139], v[144:147], a[208:211], a[136:139]
    v_cvt_pk_bf16_f32 v184, v88, v89
    v_cvt_pk_bf16_f32 v185, v90, v91
    v_mfma_f32_16x16x32_bf16 a[136:139], v[152:155], a[212:215], a[136:139]
    s_add_u32 m0, s8, 0x12400
    ds_read_b128 a[176:179], v34 offset:8192
    buffer_load_dwordx4 v14, s[52:55], s9 offen lds
    v_mfma_f32_16x16x32_bf16 a[140:143], v[156:159], a[212:215], a[140:143]
    s_waitcnt lgkmcnt(4)
    v_lshlrev_b32 v88, 16, v186
    v_and_b32 v89, s15, v186
    v_mfma_f32_16x16x32_bf16 a[140:143], v[148:151], a[208:211], a[140:143]
    ds_read_b128 a[180:183], v35 offset:8192
    v_lshlrev_b32 v90, 16, v187
    v_mfma_f32_16x16x32_bf16 a[0:3], v[160:163], a[144:147], a[0:3]
    v_and_b32 v91, s15, v187
    v_fma_f32 v88, v88, v10, v11
    v_mfma_f32_16x16x32_bf16 a[0:3], v[168:171], a[148:151], a[0:3]
    ds_read_b128 a[184:187], v34 offset:10240
    v_fma_f32 v89, v89, v10, v11
    v_mfma_f32_16x16x32_bf16 a[4:7], v[172:175], a[148:151], a[4:7]
    v_fma_f32 v90, v90, v10, v11
    v_fma_f32 v91, v91, v10, v11
    v_mfma_f32_16x16x32_bf16 a[4:7], v[164:167], a[144:147], a[4:7]
    ds_read_b128 a[188:191], v35 offset:10240
    v_cvt_pk_bf16_f32 v186, v88, v89
    v_mfma_f32_16x16x32_bf16 a[8:11], v[160:163], a[152:155], a[8:11]
    s_add_u32 m0, s8, 0x12800
    ds_read_b128 a[192:195], v34 offset:12288
    v_cvt_pk_bf16_f32 v187, v90, v91
    v_mfma_f32_16x16x32_bf16 a[8:11], v[168:171], a[156:159], a[8:11]
    buffer_load_dwordx4 v15, s[52:55], s9 offen lds
    v_mfma_f32_16x16x32_bf16 a[12:15], v[172:175], a[156:159], a[12:15]
    s_waitcnt lgkmcnt(4)
    v_lshlrev_b32 v92, 16, v188
    v_and_b32 v93, s15, v188
    v_mfma_f32_16x16x32_bf16 a[12:15], v[164:167], a[152:155], a[12:15]
    ds_read_b128 a[196:199], v35 offset:12288
    v_lshlrev_b32 v94, 16, v189
    v_mfma_f32_16x16x32_bf16 a[16:19], v[160:163], a[160:163], a[16:19]
    v_and_b32 v95, s15, v189
    v_mfma_f32_16x16x32_bf16 a[16:19], v[168:171], a[164:167], a[16:19]
    ds_read_b128 a[200:203], v34 offset:14336
    v_fma_f32 v92, v92, v108, v109
    v_mfma_f32_16x16x32_bf16 a[20:23], v[172:175], a[164:167], a[20:23]
    v_fma_f32 v93, v93, v108, v109
    v_fma_f32 v94, v94, v108, v109
    v_mfma_f32_16x16x32_bf16 a[20:23], v[164:167], a[160:163], a[20:23]
    ds_read_b128 a[204:207], v35 offset:14336
    v_fma_f32 v95, v95, v108, v109
    v_mfma_f32_16x16x32_bf16 a[24:27], v[160:163], a[168:171], a[24:27]
    s_add_u32 m0, s8, 0x12c00
    ds_read_b128 a[208:211], v34 offset:16384
    v_cvt_pk_bf16_f32 v188, v92, v93
    v_mfma_f32_16x16x32_bf16 a[24:27], v[168:171], a[172:175], a[24:27]
    buffer_load_dwordx4 v16, s[52:55], s9 offen lds
    v_mfma_f32_16x16x32_bf16 a[28:31], v[172:175], a[172:175], a[28:31]
    s_waitcnt lgkmcnt(4)
    v_cvt_pk_bf16_f32 v189, v94, v95
    v_mfma_f32_16x16x32_bf16 a[28:31], v[164:167], a[168:171], a[28:31]
    ds_read_b128 a[212:215], v35 offset:16384
    v_lshlrev_b32 v92, 16, v190
    v_mfma_f32_16x16x32_bf16 a[32:35], v[160:163], a[176:179], a[32:35]
    v_and_b32 v93, s15, v190
    v_lshlrev_b32 v94, 16, v191
    v_mfma_f32_16x16x32_bf16 a[32:35], v[168:171], a[180:183], a[32:35]
    ds_read_b128 a[144:147], v34 offset:18432
    v_and_b32 v95, s15, v191
    v_mfma_f32_16x16x32_bf16 a[36:39], v[172:175], a[180:183], a[36:39]
    v_fma_f32 v92, v92, v108, v109
    v_fma_f32 v93, v93, v108, v109
    v_mfma_f32_16x16x32_bf16 a[36:39], v[164:167], a[176:179], a[36:39]
    ds_read_b128 a[148:151], v35 offset:18432
    v_fma_f32 v94, v94, v108, v109
    v_mfma_f32_16x16x32_bf16 a[40:43], v[160:163], a[184:187], a[40:43]
    s_add_u32 m0, s8, 0x13000
    ds_read_b128 a[152:155], v34 offset:20480
    v_mfma_f32_16x16x32_bf16 a[40:43], v[168:171], a[188:191], a[40:43]
    buffer_load_dwordx4 v17, s[52:55], s9 offen lds
    v_mfma_f32_16x16x32_bf16 a[44:47], v[172:175], a[188:191], a[44:47]
    s_waitcnt lgkmcnt(4)
    v_fma_f32 v95, v95, v108, v109
    v_cvt_pk_bf16_f32 v190, v92, v93
    v_mfma_f32_16x16x32_bf16 a[44:47], v[164:167], a[184:187], a[44:47]
    ds_read_b128 a[156:159], v35 offset:20480
    v_cvt_pk_bf16_f32 v191, v94, v95
    v_mfma_f32_16x16x32_bf16 a[48:51], v[160:163], a[192:195], a[48:51]
    v_mov_b32 v40, s38
    v_mov_b32 v41, s68
    v_mfma_f32_16x16x32_bf16 a[48:51], v[168:171], a[196:199], a[48:51]
    ds_read_b128 a[160:163], v34 offset:22528
    v_cmp_gt_u32 vcc, 32, v0
    v_mfma_f32_16x16x32_bf16 a[52:55], v[172:175], a[196:199], a[52:55]
    s_nop 0
    v_cndmask_b32 v40, v40, v41, vcc
    v_lshlrev_b32 v88, 16, v192
    v_mfma_f32_16x16x32_bf16 a[52:55], v[164:167], a[192:195], a[52:55]
    ds_read_b128 a[164:167], v35 offset:22528
    v_and_b32 v89, s15, v192
    v_mfma_f32_16x16x32_bf16 a[56:59], v[160:163], a[200:203], a[56:59]
    s_add_u32 m0, s8, 0x13400
    ds_read_b128 a[168:171], v34 offset:24576
    v_mfma_f32_16x16x32_bf16 a[56:59], v[168:171], a[204:207], a[56:59]
    buffer_load_dwordx4 v18, s[52:55], s9 offen lds
    v_mfma_f32_16x16x32_bf16 a[60:63], v[172:175], a[204:207], a[60:63]
    s_waitcnt lgkmcnt(4)
    v_lshlrev_b32 v90, 16, v193
    v_and_b32 v91, s15, v193
    v_mfma_f32_16x16x32_bf16 a[60:63], v[164:167], a[200:203], a[60:63]
    ds_read_b128 a[172:175], v35 offset:24576
    v_fma_f32 v88, v88, v10, v11
    v_mfma_f32_16x16x32_bf16 a[64:67], v[160:163], a[208:211], a[64:67]
    v_fma_f32 v89, v89, v10, v11
    v_fma_f32 v90, v90, v10, v11
    v_mfma_f32_16x16x32_bf16 a[64:67], v[168:171], a[212:215], a[64:67]
    ds_read_b128 a[176:179], v34 offset:26624
    v_fma_f32 v91, v91, v10, v11
    v_mfma_f32_16x16x32_bf16 a[68:71], v[172:175], a[212:215], a[68:71]
    v_cvt_pk_bf16_f32 v192, v88, v89
    v_cvt_pk_bf16_f32 v193, v90, v91
    v_mfma_f32_16x16x32_bf16 a[68:71], v[164:167], a[208:211], a[68:71]
    ds_read_b128 a[180:183], v35 offset:26624
    v_lshlrev_b32 v88, 16, v194
    v_mfma_f32_16x16x32_bf16 a[72:75], v[160:163], a[144:147], a[72:75]
    s_add_u32 m0, s8, 0x13800
    ds_read_b128 a[184:187], v34 offset:28672
    v_mfma_f32_16x16x32_bf16 a[72:75], v[168:171], a[148:151], a[72:75]
    buffer_load_dwordx4 v19, s[52:55], s9 offen lds
    v_mfma_f32_16x16x32_bf16 a[76:79], v[172:175], a[148:151], a[76:79]
    s_waitcnt lgkmcnt(4)
    v_and_b32 v89, s15, v194
    v_lshlrev_b32 v90, 16, v195
    v_mfma_f32_16x16x32_bf16 a[76:79], v[164:167], a[144:147], a[76:79]
    ds_read_b128 a[188:191], v35 offset:28672
    v_and_b32 v91, s15, v195
    v_mfma_f32_16x16x32_bf16 a[80:83], v[160:163], a[152:155], a[80:83]
    v_fma_f32 v88, v88, v10, v11
    v_fma_f32 v89, v89, v10, v11
    v_mfma_f32_16x16x32_bf16 a[80:83], v[168:171], a[156:159], a[80:83]
    ds_read_b128 a[192:195], v34 offset:30720
    v_fma_f32 v90, v90, v10, v11
    v_mfma_f32_16x16x32_bf16 a[84:87], v[172:175], a[156:159], a[84:87]
    v_fma_f32 v91, v91, v10, v11
    v_mfma_f32_16x16x32_bf16 a[84:87], v[164:167], a[152:155], a[84:87]
    ds_read_b128 a[196:199], v35 offset:30720
    v_cvt_pk_bf16_f32 v194, v88, v89
    v_mfma_f32_16x16x32_bf16 a[88:91], v[160:163], a[160:163], a[88:91]
    s_add_u32 m0, s8, 0x13c00
    ds_read_b128 a[200:203], v34 offset:32768
    v_cvt_pk_bf16_f32 v195, v90, v91
    v_mfma_f32_16x16x32_bf16 a[88:91], v[168:171], a[164:167], a[88:91]
    buffer_load_dwordx4 v20, s[52:55], s9 offen lds
    v_mfma_f32_16x16x32_bf16 a[92:95], v[172:175], a[164:167], a[92:95]
    s_waitcnt lgkmcnt(4)
    v_lshlrev_b32 v92, 16, v196
    v_and_b32 v93, s15, v196
    v_mfma_f32_16x16x32_bf16 a[92:95], v[164:167], a[160:163], a[92:95]
    ds_read_b128 a[204:207], v35 offset:32768
    v_lshlrev_b32 v94, 16, v197
    v_mfma_f32_16x16x32_bf16 a[96:99], v[160:163], a[168:171], a[96:99]
    ds_read_b128 a[208:211], v34 offset:34816
    v_mfma_f32_16x16x32_bf16 a[96:99], v[168:171], a[172:175], a[96:99]
    v_add_u32 v34, 0x0, v32
    v_and_b32 v95, s15, v197
    v_mfma_f32_16x16x32_bf16 a[100:103], v[172:175], a[172:175], a[100:103]
    ds_read_b128 a[212:215], v35 offset:34816
    v_add_u32 v35, 0x0, v33
    v_mfma_f32_16x16x32_bf16 a[100:103], v[164:167], a[168:171], a[100:103]
    v_fma_f32 v92, v92, v108, v109
    v_fma_f32 v93, v93, v108, v109
    v_mfma_f32_16x16x32_bf16 a[104:107], v[160:163], a[176:179], a[104:107]
    s_add_u32 m0, s8, 0x14000
    v_fma_f32 v94, v94, v108, v109
    v_fma_f32 v95, v95, v108, v109
    v_mfma_f32_16x16x32_bf16 a[104:107], v[168:171], a[180:183], a[104:107]
    buffer_load_dwordx4 v21, s[52:55], s9 offen lds
    v_mfma_f32_16x16x32_bf16 a[108:111], v[172:175], a[180:183], a[108:111]
    s_waitcnt lgkmcnt(3)
    v_cvt_pk_bf16_f32 v196, v92, v93
    v_mfma_f32_16x16x32_bf16 a[108:111], v[164:167], a[176:179], a[108:111]
    v_cvt_pk_bf16_f32 v197, v94, v95
    v_lshlrev_b32 v92, 16, v198
    v_mfma_f32_16x16x32_bf16 a[112:115], v[160:163], a[184:187], a[112:115]
    v_and_b32 v93, s15, v198
    v_lshlrev_b32 v94, 16, v199
    v_mfma_f32_16x16x32_bf16 a[112:115], v[168:171], a[188:191], a[112:115]
    v_and_b32 v95, s15, v199
    v_fma_f32 v92, v92, v108, v109
    v_mfma_f32_16x16x32_bf16 a[116:119], v[172:175], a[188:191], a[116:119]
    s_waitcnt vmcnt(18) lgkmcnt(0)
    s_barrier
    v_mfma_f32_16x16x32_bf16 a[116:119], v[164:167], a[184:187], a[116:119]
    ds_read_b128 a[144:147], v34 offset:0
    ds_read_b128 a[148:151], v35 offset:0
    v_mfma_f32_16x16x32_bf16 a[120:123], v[160:163], a[192:195], a[120:123]
    s_mov_b32 s9, 0x200
    ds_read_b128 a[152:155], v34 offset:2048
    v_mfma_f32_16x16x32_bf16 a[120:123], v[168:171], a[196:199], a[120:123]
    s_add_u32 m0, s8, 0x1b000
    ds_read_b128 a[156:159], v35 offset:2048
    buffer_load_dwordx4 v13, s[52:55], s9 offen lds
    v_mfma_f32_16x16x32_bf16 a[124:127], v[172:175], a[196:199], a[124:127]
    s_waitcnt lgkmcnt(3)
    ds_read_b128 a[160:163], v34 offset:4096
    v_fma_f32 v93, v93, v108, v109
    v_mfma_f32_16x16x32_bf16 a[124:127], v[164:167], a[192:195], a[124:127]
    ds_read_b128 a[164:167], v35 offset:4096
    v_fma_f32 v94, v94, v108, v109
    v_mfma_f32_16x16x32_bf16 a[128:131], v[160:163], a[200:203], a[128:131]
    v_lshlrev_b32 v96, 16, v96
    v_mfma_f32_16x16x32_bf16 a[128:131], v[168:171], a[204:207], a[128:131]
    ds_read_b128 a[168:171], v34 offset:6144
    v_fma_f32 v95, v95, v108, v109
    v_mfma_f32_16x16x32_bf16 a[132:135], v[172:175], a[204:207], a[132:135]
    v_lshlrev_b32 v97, 16, v97
    v_cvt_pk_bf16_f32 v198, v92, v93
    v_mfma_f32_16x16x32_bf16 a[132:135], v[164:167], a[200:203], a[132:135]
    ds_read_b128 a[172:175], v35 offset:6144
    v_cvt_pk_bf16_f32 v199, v94, v95
    v_mfma_f32_16x16x32_bf16 a[136:139], v[160:163], a[208:211], a[136:139]
    s_add_u32 m0, s8, 0x1b400
    ds_read_b128 a[176:179], v34 offset:8192
    v_lshlrev_b32 v88, 16, v200
    v_mfma_f32_16x16x32_bf16 a[136:139], v[168:171], a[212:215], a[136:139]
    buffer_load_dwordx4 v14, s[52:55], s9 offen lds
    v_mfma_f32_16x16x32_bf16 a[140:143], v[172:175], a[212:215], a[140:143]
    s_waitcnt lgkmcnt(4)
    v_lshlrev_b32 v98, 16, v98
    v_and_b32 v89, s15, v200
    v_mfma_f32_16x16x32_bf16 a[140:143], v[164:167], a[208:211], a[140:143]
    ds_read_b128 a[180:183], v35 offset:8192
    v_lshlrev_b32 v90, 16, v201
    v_and_b32 v91, s15, v201
    v_mfma_f32_16x16x32_bf16 a[0:3], v[176:179], a[144:147], a[0:3]
    v_mul_f32 v98, 0x3fb8aa3b, v98
    v_fma_f32 v88, v88, v10, v11
    v_mfma_f32_16x16x32_bf16 a[0:3], v[184:187], a[148:151], a[0:3]
    ds_read_b128 a[184:187], v34 offset:10240
    v_fma_f32 v89, v89, v10, v11
    v_mfma_f32_16x16x32_bf16 a[4:7], v[188:191], a[148:151], a[4:7]
    v_exp_f32 v98, v98
    v_mfma_f32_16x16x32_bf16 a[4:7], v[180:183], a[144:147], a[4:7]
    ds_read_b128 a[188:191], v35 offset:10240
    v_fma_f32 v90, v90, v10, v11
    v_fma_f32 v91, v91, v10, v11
    v_mfma_f32_16x16x32_bf16 a[8:11], v[176:179], a[152:155], a[8:11]
    s_add_u32 m0, s8, 0x1b800
    ds_read_b128 a[192:195], v34 offset:12288
    v_cvt_pk_bf16_f32 v200, v88, v89
    v_mfma_f32_16x16x32_bf16 a[8:11], v[184:187], a[156:159], a[8:11]
    buffer_load_dwordx4 v15, s[52:55], s9 offen lds
    v_mfma_f32_16x16x32_bf16 a[12:15], v[188:191], a[156:159], a[12:15]
    s_waitcnt lgkmcnt(4)
    v_cvt_pk_bf16_f32 v201, v90, v91
    v_lshlrev_b32 v88, 16, v202
    v_mfma_f32_16x16x32_bf16 a[12:15], v[180:183], a[152:155], a[12:15]
    ds_read_b128 a[196:199], v35 offset:12288
    v_and_b32 v89, s15, v202
    v_mfma_f32_16x16x32_bf16 a[16:19], v[176:179], a[160:163], a[16:19]
    v_cvt_pk_bf16_f32 v98, v98, v98
    v_lshlrev_b32 v90, 16, v203
    v_mfma_f32_16x16x32_bf16 a[16:19], v[184:187], a[164:167], a[16:19]
    ds_read_b128 a[200:203], v34 offset:14336
    v_and_b32 v91, s15, v203
    v_fma_f32 v88, v88, v10, v11
    v_mfma_f32_16x16x32_bf16 a[20:23], v[188:191], a[164:167], a[20:23]
    v_and_b32 v98, 0xffff0000, v98
    v_fma_f32 v89, v89, v10, v11
    v_mfma_f32_16x16x32_bf16 a[20:23], v[180:183], a[160:163], a[20:23]
    ds_read_b128 a[204:207], v35 offset:14336
    v_fma_f32 v90, v90, v10, v11
    v_mfma_f32_16x16x32_bf16 a[24:27], v[176:179], a[168:171], a[24:27]
    v_fma_f32 v91, v91, v10, v11
    v_cvt_pk_bf16_f32 v202, v88, v89
    v_mfma_f32_16x16x32_bf16 a[24:27], v[184:187], a[172:175], a[24:27]
    s_add_u32 m0, s8, 0x1bc00
    ds_read_b128 a[208:211], v34 offset:16384
    buffer_load_dwordx4 v16, s[52:55], s9 offen lds
    v_mfma_f32_16x16x32_bf16 a[28:31], v[188:191], a[172:175], a[28:31]
    s_waitcnt lgkmcnt(4)
    v_mul_f32 v1, v98, v96
    v_mul_f32 v2, v98, v97
    v_mfma_f32_16x16x32_bf16 a[28:31], v[180:183], a[168:171], a[28:31]
    ds_read_b128 a[212:215], v35 offset:16384
    v_cvt_pk_bf16_f32 v203, v90, v91
    v_mfma_f32_16x16x32_bf16 a[32:35], v[176:179], a[176:179], a[32:35]
    v_mul_f32 v1, 0x3fb8aa3b, v1
    v_lshlrev_b32 v92, 16, v204
    v_mfma_f32_16x16x32_bf16 a[32:35], v[184:187], a[180:183], a[32:35]
    ds_read_b128 a[144:147], v34 offset:18432
    v_and_b32 v93, s15, v204
    v_mfma_f32_16x16x32_bf16 a[36:39], v[188:191], a[180:183], a[36:39]
    v_mul_f32 v2, 0.15915494, v2
    v_lshlrev_b32 v94, 16, v205
    v_mfma_f32_16x16x32_bf16 a[36:39], v[180:183], a[176:179], a[36:39]
    ds_read_b128 a[148:151], v35 offset:18432
    v_and_b32 v95, s15, v205
    v_mfma_f32_16x16x32_bf16 a[40:43], v[176:179], a[184:187], a[40:43]
    s_add_u32 m0, s8, 0x1c000
    ds_read_b128 a[152:155], v34 offset:20480
    v_fma_f32 v92, v92, v108, v109
    v_mfma_f32_16x16x32_bf16 a[40:43], v[184:187], a[188:191], a[40:43]
    buffer_load_dwordx4 v17, s[52:55], s9 offen lds
    v_mfma_f32_16x16x32_bf16 a[44:47], v[188:191], a[188:191], a[44:47]
    s_waitcnt lgkmcnt(4)
    v_fma_f32 v93, v93, v108, v109
    v_fma_f32 v94, v94, v108, v109
    v_mfma_f32_16x16x32_bf16 a[44:47], v[180:183], a[184:187], a[44:47]
    ds_read_b128 a[156:159], v35 offset:20480
    v_fma_f32 v95, v95, v108, v109
    v_mfma_f32_16x16x32_bf16 a[48:51], v[176:179], a[192:195], a[48:51]
    v_exp_f32 v1, v1
    v_mfma_f32_16x16x32_bf16 a[48:51], v[184:187], a[196:199], a[48:51]
    ds_read_b128 a[160:163], v34 offset:22528
    v_cvt_pk_bf16_f32 v204, v92, v93
    v_cvt_pk_bf16_f32 v205, v94, v95
    v_mfma_f32_16x16x32_bf16 a[52:55], v[188:191], a[196:199], a[52:55]
    v_fract_f32 v2, v2
    v_lshlrev_b32 v92, 16, v206
    v_mfma_f32_16x16x32_bf16 a[52:55], v[180:183], a[192:195], a[52:55]
    ds_read_b128 a[164:167], v35 offset:22528
    v_and_b32 v93, s15, v206
    v_mfma_f32_16x16x32_bf16 a[56:59], v[176:179], a[200:203], a[56:59]
    s_add_u32 m0, s8, 0x1c400
    ds_read_b128 a[168:171], v34 offset:24576
    v_lshlrev_b32 v94, 16, v207
    v_mfma_f32_16x16x32_bf16 a[56:59], v[184:187], a[204:207], a[56:59]
    buffer_load_dwordx4 v18, s[52:55], s9 offen lds
    v_mfma_f32_16x16x32_bf16 a[60:63], v[188:191], a[204:207], a[60:63]
    s_waitcnt lgkmcnt(4)
    v_and_b32 v95, s15, v207
    v_fma_f32 v92, v92, v108, v109
    v_mfma_f32_16x16x32_bf16 a[60:63], v[180:183], a[200:203], a[60:63]
    ds_read_b128 a[172:175], v35 offset:24576
    v_fma_f32 v93, v93, v108, v109
    v_mfma_f32_16x16x32_bf16 a[64:67], v[176:179], a[208:211], a[64:67]
    v_cos_f32 v3, v2
    v_mfma_f32_16x16x32_bf16 a[64:67], v[184:187], a[212:215], a[64:67]
    ds_read_b128 a[176:179], v34 offset:26624
    v_fma_f32 v94, v94, v108, v109
    v_mfma_f32_16x16x32_bf16 a[68:71], v[188:191], a[212:215], a[68:71]
    v_fma_f32 v95, v95, v108, v109
    v_cvt_pk_bf16_f32 v206, v92, v93
    v_mfma_f32_16x16x32_bf16 a[68:71], v[180:183], a[208:211], a[68:71]
    ds_read_b128 a[180:183], v35 offset:26624
    v_cvt_pk_bf16_f32 v207, v94, v95
    v_mfma_f32_16x16x32_bf16 a[72:75], v[176:179], a[144:147], a[72:75]
    s_add_u32 m0, s8, 0x1c800
    ds_read_b128 a[184:187], v34 offset:28672
    v_lshlrev_b32 v88, 16, v208
    v_mfma_f32_16x16x32_bf16 a[72:75], v[184:187], a[148:151], a[72:75]
    buffer_load_dwordx4 v19, s[52:55], s9 offen lds
    v_mfma_f32_16x16x32_bf16 a[76:79], v[188:191], a[148:151], a[76:79]
    s_waitcnt lgkmcnt(4)
    v_sin_f32 v2, v2
    v_mfma_f32_16x16x32_bf16 a[76:79], v[180:183], a[144:147], a[76:79]
    ds_read_b128 a[188:191], v35 offset:28672
    v_and_b32 v89, s15, v208
    v_lshlrev_b32 v90, 16, v209
    v_mfma_f32_16x16x32_bf16 a[80:83], v[176:179], a[152:155], a[80:83]
    v_mul_f32 v100, v1, v3
    v_and_b32 v91, s15, v209
    v_mfma_f32_16x16x32_bf16 a[80:83], v[184:187], a[156:159], a[80:83]
    ds_read_b128 a[192:195], v34 offset:30720
    v_fma_f32 v88, v88, v10, v11
    v_mfma_f32_16x16x32_bf16 a[84:87], v[188:191], a[156:159], a[84:87]
    v_mul_f32 v101, v1, v2
    v_fma_f32 v89, v89, v10, v11
    v_mfma_f32_16x16x32_bf16 a[84:87], v[180:183], a[152:155], a[84:87]
L_ps8:
    s_cbranch_execz L_rs8
    ds_read_b128 a[196:199], v35 offset:30720
    v_fma_f32 v90, v90, v10, v11
    v_fma_f32 v91, v91, v10, v11
    v_mfma_f32_16x16x32_bf16 a[88:91], v[176:179], a[160:163], a[88:91]
    s_add_u32 m0, s8, 0x1cc00
    ds_read_b128 a[200:203], v34 offset:32768
    v_cvt_pk_bf16_f32 v208, v88, v89
    v_mfma_f32_16x16x32_bf16 a[88:91], v[184:187], a[164:167], a[88:91]
    buffer_load_dwordx4 v20, s[52:55], s9 offen lds
    v_mfma_f32_16x16x32_bf16 a[92:95], v[188:191], a[164:167], a[92:95]
    s_waitcnt lgkmcnt(4)
    v_mul_f32 v1, v96, v96
    v_cvt_pk_bf16_f32 v209, v90, v91
    v_mfma_f32_16x16x32_bf16 a[92:95], v[180:183], a[160:163], a[92:95]
    ds_read_b128 a[204:207], v35 offset:32768
    v_lshlrev_b32 v88, 16, v210
    v_mfma_f32_16x16x32_bf16 a[96:99], v[176:179], a[168:171], a[96:99]
    ds_read_b128 a[208:211], v34 offset:34816
    v_add_u32 v34, 0x9000, v32
    v_mfma_f32_16x16x32_bf16 a[96:99], v[184:187], a[172:175], a[96:99]
    v_and_b32 v89, s15, v210
    v_lshlrev_b32 v90, 16, v211
    v_and_b32 v91, s15, v211
    v_mfma_f32_16x16x32_bf16 a[100:103], v[188:191], a[172:175], a[100:103]
    ds_read_b128 a[212:215], v35 offset:34816
    v_add_u32 v35, 0x9000, v33
    v_mfma_f32_16x16x32_bf16 a[100:103], v[180:183], a[168:171], a[100:103]
    v_fma_f32 v88, v88, v10, v11
    v_fma_f32 v89, v89, v10, v11
    v_mfma_f32_16x16x32_bf16 a[104:107], v[176:179], a[176:179], a[104:107]
    s_add_u32 m0, s8, 0x1d000
    v_fma_f32 v90, v90, v10, v11
    v_fma_f32 v91, v91, v10, v11
    v_mfma_f32_16x16x32_bf16 a[104:107], v[184:187], a[180:183], a[104:107]
    buffer_load_dwordx4 v21, s[52:55], s9 offen lds
    v_cvt_pk_bf16_f32 v210, v88, v89
    v_mfma_f32_16x16x32_bf16 a[108:111], v[188:191], a[180:183], a[108:111]
    s_waitcnt lgkmcnt(3)
    v_fmac_f32 v1, v97, v97
    v_mfma_f32_16x16x32_bf16 a[108:111], v[180:183], a[176:179], a[108:111]
    v_rcp_f32 v1, v1
    v_cvt_pk_bf16_f32 v211, v90, v91
    v_mfma_f32_16x16x32_bf16 a[112:115], v[176:179], a[184:187], a[112:115]
    v_add_f32 v2, -1.0, v100
    v_lshlrev_b32 v92, 16, v212
    v_mfma_f32_16x16x32_bf16 a[112:115], v[184:187], a[188:191], a[112:115]
    v_and_b32 v93, s15, v212
    v_lshlrev_b32 v94, 16, v213
    v_and_b32 v95, s15, v213
    v_mfma_f32_16x16x32_bf16 a[116:119], v[188:191], a[188:191], a[116:119]
    s_waitcnt vmcnt(18) lgkmcnt(0)
    s_barrier
    v_mfma_f32_16x16x32_bf16 a[116:119], v[180:183], a[184:187], a[116:119]
    ds_read_b128 a[144:147], v34 offset:0
    ds_read_b128 a[148:151], v35 offset:0
    v_mfma_f32_16x16x32_bf16 a[120:123], v[176:179], a[192:195], a[120:123]
    s_mov_b32 s9, 0x380
    ds_read_b128 a[152:155], v34 offset:2048
    v_fma_f32 v92, v92, v108, v109
    v_mfma_f32_16x16x32_bf16 a[120:123], v[184:187], a[196:199], a[120:123]
    s_add_u32 m0, s8, 0x0
    ds_read_b128 a[156:159], v35 offset:2048
    buffer_load_dwordx4 v13, s[52:55], s9 offen lds
    v_mfma_f32_16x16x32_bf16 a[124:127], v[188:191], a[196:199], a[124:127]
    s_waitcnt lgkmcnt(3)
    ds_read_b128 a[160:163], v34 offset:4096
    v_fma_f32 v93, v93, v108, v109
    v_mfma_f32_16x16x32_bf16 a[124:127], v[180:183], a[192:195], a[124:127]
    ds_read_b128 a[164:167], v35 offset:4096
    v_fma_f32 v94, v94, v108, v109
    v_mfma_f32_16x16x32_bf16 a[128:131], v[176:179], a[200:203], a[128:131]
    v_fma_f32 v95, v95, v108, v109
    v_cvt_pk_bf16_f32 v212, v92, v93
    v_mfma_f32_16x16x32_bf16 a[128:131], v[184:187], a[204:207], a[128:131]
    s_add_u32 m0, s8, 0x400
    ds_read_b128 a[168:171], v34 offset:6144
    buffer_load_dwordx4 v14, s[52:55], s9 offen lds
    v_mfma_f32_16x16x32_bf16 a[132:135], v[188:191], a[204:207], a[132:135]
    v_mul_f32 v1, 0xc038aa3b, v1
    v_mul_f32 v3, v2, v96
    v_mfma_f32_16x16x32_bf16 a[132:135], v[180:183], a[200:203], a[132:135]
    ds_read_b128 a[172:175], v35 offset:6144
    v_cvt_pk_bf16_f32 v213, v94, v95
    v_lshlrev_b32 v92, 16, v214
    v_mfma_f32_16x16x32_bf16 a[136:139], v[176:179], a[208:211], a[136:139]
    v_and_b32 v93, s15, v214
    v_lshlrev_b32 v94, 16, v215
    v_mfma_f32_16x16x32_bf16 a[136:139], v[184:187], a[212:215], a[136:139]
    s_add_u32 m0, s8, 0x800
    ds_read_b128 a[176:179], v34 offset:8192
    buffer_load_dwordx4 v15, s[52:55], s9 offen lds
    v_mfma_f32_16x16x32_bf16 a[140:143], v[188:191], a[212:215], a[140:143]
    s_waitcnt lgkmcnt(4)
    v_fmac_f32 v3, v101, v97
    v_and_b32 v95, s15, v215
    v_mfma_f32_16x16x32_bf16 a[140:143], v[180:183], a[208:211], a[140:143]
    ds_read_b128 a[180:183], v35 offset:8192
    v_fma_f32 v92, v92, v108, v109
    v_mfma_f32_16x16x32_bf16 a[0:3], v[192:195], a[144:147], a[0:3]
    v_fma_f32 v93, v93, v108, v109
    v_fma_f32 v94, v94, v108, v109
    v_mfma_f32_16x16x32_bf16 a[0:3], v[200:203], a[148:151], a[0:3]
    s_add_u32 m0, s8, 0xc00
    ds_read_b128 a[184:187], v34 offset:10240
    buffer_load_dwordx4 v16, s[52:55], s9 offen lds
    v_mfma_f32_16x16x32_bf16 a[4:7], v[204:207], a[148:151], a[4:7]
    v_mul_f32 v98, v101, v96
    v_fma_f32 v95, v95, v108, v109
    v_mfma_f32_16x16x32_bf16 a[4:7], v[196:199], a[144:147], a[4:7]
    ds_read_b128 a[188:191], v35 offset:10240
    v_cvt_pk_bf16_f32 v214, v92, v93
    v_cvt_pk_bf16_f32 v215, v94, v95
    v_mfma_f32_16x16x32_bf16 a[8:11], v[192:195], a[152:155], a[8:11]
    v_lshlrev_b32 v88, 16, v216
    v_and_b32 v89, s15, v216
    v_mfma_f32_16x16x32_bf16 a[8:11], v[200:203], a[156:159], a[8:11]
    s_add_u32 m0, s8, 0x1000
    ds_read_b128 a[192:195], v34 offset:12288
    buffer_load_dwordx4 v17, s[52:55], s9 offen lds
    v_mfma_f32_16x16x32_bf16 a[12:15], v[204:207], a[156:159], a[12:15]
    s_waitcnt lgkmcnt(4)
    v_fma_f32 v98, -v2, v97, v98
    v_lshlrev_b32 v90, 16, v217
    v_mfma_f32_16x16x32_bf16 a[12:15], v[196:199], a[152:155], a[12:15]
    ds_read_b128 a[196:199], v35 offset:12288
    v_and_b32 v91, s15, v217
    v_mfma_f32_16x16x32_bf16 a[16:19], v[192:195], a[160:163], a[16:19]
    v_fma_f32 v88, v88, v10, v11
    v_fma_f32 v89, v89, v10, v11
    v_mfma_f32_16x16x32_bf16 a[16:19], v[200:203], a[164:167], a[16:19]
    s_add_u32 m0, s8, 0x1400
    ds_read_b128 a[200:203], v34 offset:14336
    buffer_load_dwordx4 v18, s[52:55], s9 offen lds
    v_mfma_f32_16x16x32_bf16 a[20:23], v[204:207], a[164:167], a[20:23]
    v_mul_f32 v102, v3, v1
    v_fma_f32 v90, v90, v10, v11
    v_mfma_f32_16x16x32_bf16 a[20:23], v[196:199], a[160:163], a[20:23]
    ds_read_b128 a[204:207], v35 offset:14336
    v_fma_f32 v91, v91, v10, v11
    v_mfma_f32_16x16x32_bf16 a[24:27], v[192:195], a[168:171], a[24:27]
    v_cvt_pk_bf16_f32 v216, v88, v89
    v_cvt_pk_bf16_f32 v217, v90, v91
    v_mfma_f32_16x16x32_bf16 a[24:27], v[200:203], a[172:175], a[24:27]
    s_add_u32 m0, s8, 0x1800
    ds_read_b128 a[208:211], v34 offset:16384
    buffer_load_dwordx4 v19, s[52:55], s9 offen lds
    v_mfma_f32_16x16x32_bf16 a[28:31], v[204:207], a[172:175], a[28:31]
    s_waitcnt lgkmcnt(4)
    v_mul_f32 v103, v98, v1
    v_lshlrev_b32 v88, 16, v218
    v_mfma_f32_16x16x32_bf16 a[28:31], v[196:199], a[168:171], a[28:31]
    ds_read_b128 a[212:215], v35 offset:16384
    v_and_b32 v89, s15, v218
    v_mfma_f32_16x16x32_bf16 a[32:35], v[192:195], a[176:179], a[32:35]
    v_lshlrev_b32 v90, 16, v219
    v_and_b32 v91, s15, v219
    v_mfma_f32_16x16x32_bf16 a[32:35], v[200:203], a[180:183], a[32:35]
    s_add_u32 m0, s8, 0x1c00
    ds_read_b128 a[144:147], v34 offset:18432
    buffer_load_dwordx4 v20, s[52:55], s9 offen lds
    v_mfma_f32_16x16x32_bf16 a[36:39], v[204:207], a[180:183], a[36:39]
    v_mov_b32 v48, v102
    v_fma_f32 v88, v88, v10, v11
    v_mfma_f32_16x16x32_bf16 a[36:39], v[196:199], a[176:179], a[36:39]
    ds_read_b128 a[148:151], v35 offset:18432
    v_fma_f32 v89, v89, v10, v11
    v_mfma_f32_16x16x32_bf16 a[40:43], v[192:195], a[184:187], a[40:43]
    v_fma_f32 v90, v90, v10, v11
    v_fma_f32 v91, v91, v10, v11
    v_mfma_f32_16x16x32_bf16 a[40:43], v[200:203], a[188:191], a[40:43]
    s_add_u32 m0, s8, 0x2000
    ds_read_b128 a[152:155], v34 offset:20480
    buffer_load_dwordx4 v21, s[52:55], s9 offen lds
    v_mfma_f32_16x16x32_bf16 a[44:47], v[204:207], a[188:191], a[44:47]
    s_waitcnt lgkmcnt(4)
    v_mov_b32 v49, v103
    v_cvt_pk_bf16_f32 v218, v88, v89
    v_mfma_f32_16x16x32_bf16 a[44:47], v[196:199], a[184:187], a[44:47]
    ds_read_b128 a[156:159], v35 offset:20480
    v_cvt_pk_bf16_f32 v219, v90, v91
    v_mfma_f32_16x16x32_bf16 a[48:51], v[192:195], a[192:195], a[48:51]
    ds_read_b128 a[160:163], v34 offset:22528
    v_lshlrev_b32 v92, 16, v220
    v_mfma_f32_16x16x32_bf16 a[48:51], v[200:203], a[196:199], a[48:51]
    global_load_dword v41, v40, s[42:43] sc1
    v_mfma_f32_16x16x32_bf16 a[52:55], v[204:207], a[196:199], a[52:55]
    v_lshlrev_b32 v3, 1, v50
    v_and_b32 v93, s15, v220
    v_mfma_f32_16x16x32_bf16 a[52:55], v[196:199], a[192:195], a[52:55]
    ds_read_b128 a[164:167], v35 offset:22528
    v_lshlrev_b32 v94, 16, v221
    v_mfma_f32_16x16x32_bf16 a[56:59], v[192:195], a[200:203], a[56:59]
    ds_read_b128 a[168:171], v34 offset:24576
    v_and_b32 v95, s15, v221
    v_mfma_f32_16x16x32_bf16 a[56:59], v[200:203], a[204:207], a[56:59]
    buffer_load_dword v4, v31, s[56:59], 0 offen
    v_mfma_f32_16x16x32_bf16 a[60:63], v[204:207], a[204:207], a[60:63]
    s_waitcnt lgkmcnt(4)
    v_add_u32 v3, 0x24000, v3
    v_fma_f32 v92, v92, v108, v109
    v_mfma_f32_16x16x32_bf16 a[60:63], v[196:199], a[200:203], a[60:63]
    ds_read_b128 a[172:175], v35 offset:24576
    v_fma_f32 v93, v93, v108, v109
    v_mfma_f32_16x16x32_bf16 a[64:67], v[192:195], a[208:211], a[64:67]
    v_fma_f32 v94, v94, v108, v109
    v_fma_f32 v95, v95, v108, v109
    v_mfma_f32_16x16x32_bf16 a[64:67], v[200:203], a[212:215], a[64:67]
    ds_read_b128 a[176:179], v34 offset:26624
    v_cvt_pk_bf16_f32 v220, v92, v93
    v_cvt_pk_bf16_f32 v221, v94, v95
    v_mfma_f32_16x16x32_bf16 a[68:71], v[204:207], a[212:215], a[68:71]
    ds_write_b128 v3, v[100:103]
    v_mfma_f32_16x16x32_bf16 a[68:71], v[196:199], a[208:211], a[68:71]
    ds_read_b128 a[180:183], v35 offset:26624
    v_mfma_f32_16x16x32_bf16 a[72:75], v[192:195], a[144:147], a[72:75]
    v_mul_f32 v1, v101, v101
    v_lshlrev_b32 v92, 16, v222
    v_mfma_f32_16x16x32_bf16 a[72:75], v[200:203], a[148:151], a[72:75]
    ds_read_b128 a[184:187], v34 offset:28672
    v_and_b32 v93, s15, v222
    v_mfma_f32_16x16x32_bf16 a[76:79], v[204:207], a[148:151], a[76:79]
    s_waitcnt lgkmcnt(5)
    v_lshlrev_b32 v94, 16, v223
    v_and_b32 v95, s15, v223
    v_mfma_f32_16x16x32_bf16 a[76:79], v[196:199], a[144:147], a[76:79]
    ds_read_b128 a[188:191], v35 offset:28672
    v_fma_f32 v92, v92, v108, v109
    v_mfma_f32_16x16x32_bf16 a[80:83], v[192:195], a[152:155], a[80:83]
    v_mul_f32 v2, v100, v101
    v_fma_f32 v93, v93, v108, v109
    v_mfma_f32_16x16x32_bf16 a[80:83], v[200:203], a[156:159], a[80:83]
    ds_read_b128 a[192:195], v34 offset:30720
    v_fma_f32 v94, v94, v108, v109
    v_mfma_f32_16x16x32_bf16 a[84:87], v[204:207], a[156:159], a[84:87]
    v_fma_f32 v95, v95, v108, v109
    v_cvt_pk_bf16_f32 v222, v92, v93
    v_mfma_f32_16x16x32_bf16 a[84:87], v[196:199], a[152:155], a[84:87]
    ds_read_b128 a[196:199], v35 offset:30720
    v_cvt_pk_bf16_f32 v223, v94, v95
    v_mfma_f32_16x16x32_bf16 a[88:91], v[192:195], a[160:163], a[88:91]
    v_fma_f32 v44, v100, v100, -v1
    v_lshlrev_b32 v88, 16, v224
    v_mfma_f32_16x16x32_bf16 a[88:91], v[200:203], a[164:167], a[88:91]
    ds_read_b128 a[200:203], v34 offset:32768
    v_and_b32 v89, s15, v224
    v_mfma_f32_16x16x32_bf16 a[92:95], v[204:207], a[164:167], a[92:95]
    s_waitcnt lgkmcnt(4)
    v_lshlrev_b32 v90, 16, v225
    v_and_b32 v91, s15, v225
    v_mfma_f32_16x16x32_bf16 a[92:95], v[196:199], a[160:163], a[92:95]
    ds_read_b128 a[204:207], v35 offset:32768
    v_fma_f32 v88, v88, v10, v11
    v_mfma_f32_16x16x32_bf16 a[96:99], v[192:195], a[168:171], a[96:99]
    ds_read_b128 a[208:211], v34 offset:34816
    v_mfma_f32_16x16x32_bf16 a[96:99], v[200:203], a[172:175], a[96:99]
    v_add_u32 v34, 0x12000, v32
    v_fma_f32 v89, v89, v10, v11
    v_mfma_f32_16x16x32_bf16 a[100:103], v[204:207], a[172:175], a[100:103]
    ds_read_b128 a[212:215], v35 offset:34816
    v_add_u32 v35, 0x12000, v33
    v_mfma_f32_16x16x32_bf16 a[100:103], v[196:199], a[168:171], a[100:103]
    v_fma_f32 v90, v90, v10, v11
    v_fma_f32 v91, v91, v10, v11
    v_mfma_f32_16x16x32_bf16 a[104:107], v[192:195], a[176:179], a[104:107]
    v_add_f32 v45, v2, v2
    v_mul_f32 v1, v45, v45
    v_mfma_f32_16x16x32_bf16 a[104:107], v[200:203], a[180:183], a[104:107]
    v_cvt_pk_bf16_f32 v224, v88, v89
    v_cvt_pk_bf16_f32 v225, v90, v91
    v_mfma_f32_16x16x32_bf16 a[108:111], v[204:207], a[180:183], a[108:111]
    s_waitcnt lgkmcnt(3)
    v_mul_f32 v2, v44, v45
    v_fma_f32 v44, v44, v44, -v1
    v_mfma_f32_16x16x32_bf16 a[108:111], v[196:199], a[176:179], a[108:111]
    v_lshlrev_b32 v88, 16, v226
    v_and_b32 v89, s15, v226
    v_mfma_f32_16x16x32_bf16 a[112:115], v[192:195], a[184:187], a[112:115]
    v_add_f32 v45, v2, v2
    v_lshlrev_b32 v90, 16, v227
    v_mfma_f32_16x16x32_bf16 a[112:115], v[200:203], a[188:191], a[112:115]
    v_and_b32 v91, s15, v227
    v_fma_f32 v88, v88, v10, v11
    v_mfma_f32_16x16x32_bf16 a[116:119], v[204:207], a[188:191], a[116:119]
    s_waitcnt vmcnt(20) lgkmcnt(0)
    s_barrier
    v_mfma_f32_16x16x32_bf16 a[116:119], v[196:199], a[184:187], a[116:119]
    ds_read_b128 a[144:147], v34 offset:0
    ds_read_b128 a[148:151], v35 offset:0
    v_mfma_f32_16x16x32_bf16 a[120:123], v[192:195], a[192:195], a[120:123]
    ds_read_b128 a[152:155], v34 offset:2048
    v_mfma_f32_16x16x32_bf16 a[120:123], v[200:203], a[196:199], a[120:123]
    ds_read_b128 a[156:159], v35 offset:2048
    v_fma_f32 v89, v89, v10, v11
    v_mfma_f32_16x16x32_bf16 a[124:127], v[204:207], a[196:199], a[124:127]
    s_waitcnt lgkmcnt(3)
    ds_read_b128 a[160:163], v34 offset:4096
    v_fma_f32 v90, v90, v10, v11
    v_mfma_f32_16x16x32_bf16 a[124:127], v[196:199], a[192:195], a[124:127]
    ds_read_b128 a[164:167], v35 offset:4096
    v_fma_f32 v91, v91, v10, v11
    v_mfma_f32_16x16x32_bf16 a[128:131], v[192:195], a[200:203], a[128:131]
    v_mul_f32 v1, v45, v45
    v_cvt_pk_bf16_f32 v226, v88, v89
    v_mfma_f32_16x16x32_bf16 a[128:131], v[200:203], a[204:207], a[128:131]
    ds_read_b128 a[168:171], v34 offset:6144
    v_cvt_pk_bf16_f32 v227, v90, v91
    v_mfma_f32_16x16x32_bf16 a[132:135], v[204:207], a[204:207], a[132:135]
    v_lshlrev_b32 v92, 16, v228
    v_and_b32 v93, s15, v228
    v_mfma_f32_16x16x32_bf16 a[132:135], v[196:199], a[200:203], a[132:135]
    ds_read_b128 a[172:175], v35 offset:6144
    v_lshlrev_b32 v94, 16, v229
    v_mfma_f32_16x16x32_bf16 a[136:139], v[192:195], a[208:211], a[136:139]
    v_mul_f32 v2, v44, v45
    v_mfma_f32_16x16x32_bf16 a[136:139], v[200:203], a[212:215], a[136:139]
    ds_read_b128 a[176:179], v34 offset:8192
    v_and_b32 v95, s15, v229
    v_mfma_f32_16x16x32_bf16 a[140:143], v[204:207], a[212:215], a[140:143]
    s_waitcnt lgkmcnt(4)
    v_fma_f32 v92, v92, v108, v109
    v_fma_f32 v93, v93, v108, v109
    v_mfma_f32_16x16x32_bf16 a[140:143], v[196:199], a[208:211], a[140:143]
    ds_read_b128 a[180:183], v35 offset:8192
    v_fma_f32 v94, v94, v108, v109
    v_mfma_f32_16x16x32_bf16 a[0:3], v[208:211], a[144:147], a[0:3]
    v_fma_f32 v44, v44, v44, -v1
    v_mfma_f32_16x16x32_bf16 a[0:3], v[216:219], a[148:151], a[0:3]
    ds_read_b128 a[184:187], v34 offset:10240
    v_fma_f32 v95, v95, v108, v109
    v_mfma_f32_16x16x32_bf16 a[4:7], v[220:223], a[148:151], a[4:7]
    v_cvt_pk_bf16_f32 v228, v92, v93
    v_cvt_pk_bf16_f32 v229, v94, v95
    v_mfma_f32_16x16x32_bf16 a[4:7], v[212:215], a[144:147], a[4:7]
    ds_read_b128 a[188:191], v35 offset:10240
    v_lshlrev_b32 v92, 16, v230
    v_mfma_f32_16x16x32_bf16 a[8:11], v[208:211], a[152:155], a[8:11]
    v_add_f32 v45, v2, v2
    v_mfma_f32_16x16x32_bf16 a[8:11], v[216:219], a[156:159], a[8:11]
    ds_read_b128 a[192:195], v34 offset:12288
    v_and_b32 v93, s15, v230
    v_mfma_f32_16x16x32_bf16 a[12:15], v[220:223], a[156:159], a[12:15]
    s_waitcnt lgkmcnt(4)
    v_mul_f32 v1, v45, v45
    v_lshlrev_b32 v94, 16, v231
    v_mfma_f32_16x16x32_bf16 a[12:15], v[212:215], a[152:155], a[12:15]
    ds_read_b128 a[196:199], v35 offset:12288
    v_and_b32 v95, s15, v231
    v_mfma_f32_16x16x32_bf16 a[16:19], v[208:211], a[160:163], a[16:19]
    v_fma_f32 v92, v92, v108, v109
    v_mfma_f32_16x16x32_bf16 a[16:19], v[216:219], a[164:167], a[16:19]
    ds_read_b128 a[200:203], v34 offset:14336
    v_fma_f32 v93, v93, v108, v109
    v_mfma_f32_16x16x32_bf16 a[20:23], v[220:223], a[164:167], a[20:23]
    v_mul_f32 v2, v44, v45
    v_fma_f32 v94, v94, v108, v109
    v_mfma_f32_16x16x32_bf16 a[20:23], v[212:215], a[160:163], a[20:23]
    ds_read_b128 a[204:207], v35 offset:14336
    v_fma_f32 v95, v95, v108, v109
    v_mfma_f32_16x16x32_bf16 a[24:27], v[208:211], a[168:171], a[24:27]
    v_cvt_pk_bf16_f32 v230, v92, v93
    v_mfma_f32_16x16x32_bf16 a[24:27], v[216:219], a[172:175], a[24:27]
    ds_read_b128 a[208:211], v34 offset:16384
    v_cvt_pk_bf16_f32 v231, v94, v95
    v_mfma_f32_16x16x32_bf16 a[28:31], v[220:223], a[172:175], a[28:31]
    s_waitcnt lgkmcnt(4)
    v_fma_f32 v46, v44, v44, -v1
    v_lshlrev_b32 v88, 16, v232
    v_mfma_f32_16x16x32_bf16 a[28:31], v[212:215], a[168:171], a[28:31]
    ds_read_b128 a[212:215], v35 offset:16384
    v_and_b32 v89, s15, v232
    v_mfma_f32_16x16x32_bf16 a[32:35], v[208:211], a[176:179], a[32:35]
    s_waitcnt vmcnt(1)
    v_cmp_gt_u32 vcc, 16, v41
    v_mfma_f32_16x16x32_bf16 a[32:35], v[216:219], a[180:183], a[32:35]
    ds_read_b128 a[144:147], v34 offset:18432
    v_lshlrev_b32 v90, 16, v233
    v_mfma_f32_16x16x32_bf16 a[36:39], v[220:223], a[180:183], a[36:39]
    s_cbranch_vccnz L_sc0_spin
L_sc0_ret:
    v_and_b32 v91, s15, v233
    v_fma_f32 v88, v88, v10, v11
    v_mfma_f32_16x16x32_bf16 a[36:39], v[212:215], a[176:179], a[36:39]
    ds_read_b128 a[148:151], v35 offset:18432
    v_fma_f32 v89, v89, v10, v11
    v_mfma_f32_16x16x32_bf16 a[40:43], v[208:211], a[184:187], a[40:43]
    v_add_f32 v47, v2, v2
    v_mfma_f32_16x16x32_bf16 a[40:43], v[216:219], a[188:191], a[40:43]
    ds_read_b128 a[152:155], v34 offset:20480
    v_fma_f32 v90, v90, v10, v11
    v_mfma_f32_16x16x32_bf16 a[44:47], v[220:223], a[188:191], a[44:47]
    s_waitcnt lgkmcnt(4)
    v_mul_f32 v1, v47, v47
    v_fma_f32 v91, v91, v10, v11
    v_mfma_f32_16x16x32_bf16 a[44:47], v[212:215], a[184:187], a[44:47]
    ds_read_b128 a[156:159], v35 offset:20480
    v_cvt_pk_bf16_f32 v232, v88, v89
    v_mfma_f32_16x16x32_bf16 a[48:51], v[208:211], a[192:195], a[48:51]
    v_cvt_pk_bf16_f32 v233, v90, v91
    v_lshlrev_b32 v88, 16, v234
    v_mfma_f32_16x16x32_bf16 a[48:51], v[216:219], a[196:199], a[48:51]
    ds_read_b128 a[160:163], v34 offset:22528
    v_and_b32 v89, s15, v234
    v_mfma_f32_16x16x32_bf16 a[52:55], v[220:223], a[196:199], a[52:55]
    v_mul_f32 v2, v46, v47
    v_mfma_f32_16x16x32_bf16 a[52:55], v[212:215], a[192:195], a[52:55]
    ds_read_b128 a[164:167], v35 offset:22528
    v_lshlrev_b32 v90, 16, v235
    v_mfma_f32_16x16x32_bf16 a[56:59], v[208:211], a[200:203], a[56:59]
    v_and_b32 v91, s15, v235
    v_fma_f32 v88, v88, v10, v11
    v_mfma_f32_16x16x32_bf16 a[56:59], v[216:219], a[204:207], a[56:59]
    ds_read_b128 a[168:171], v34 offset:24576
    v_fma_f32 v89, v89, v10, v11
    v_mfma_f32_16x16x32_bf16 a[60:63], v[220:223], a[204:207], a[60:63]
    s_waitcnt lgkmcnt(4)
    v_fma_f32 v46, v46, v46, -v1
    v_mfma_f32_16x16x32_bf16 a[60:63], v[212:215], a[200:203], a[60:63]
    ds_read_b128 a[172:175], v35 offset:24576
    v_fma_f32 v90, v90, v10, v11
    v_mfma_f32_16x16x32_bf16 a[64:67], v[208:211], a[208:211], a[64:67]
    v_fma_f32 v91, v91, v10, v11
    v_cvt_pk_bf16_f32 v234, v88, v89
    v_mfma_f32_16x16x32_bf16 a[64:67], v[216:219], a[212:215], a[64:67]
    ds_read_b128 a[176:179], v34 offset:26624
    v_cvt_pk_bf16_f32 v235, v90, v91
    v_mfma_f32_16x16x32_bf16 a[68:71], v[220:223], a[212:215], a[68:71]
    v_add_f32 v47, v2, v2
    v_lshlrev_b32 v92, 16, v236
    v_mfma_f32_16x16x32_bf16 a[68:71], v[212:215], a[208:211], a[68:71]
    ds_read_b128 a[180:183], v35 offset:26624
    v_and_b32 v93, s15, v236
    v_mfma_f32_16x16x32_bf16 a[72:75], v[208:211], a[144:147], a[72:75]
    v_lshlrev_b32 v94, 16, v237
    v_mfma_f32_16x16x32_bf16 a[72:75], v[216:219], a[148:151], a[72:75]
    ds_read_b128 a[184:187], v34 offset:28672
    v_and_b32 v95, s15, v237
    v_mfma_f32_16x16x32_bf16 a[76:79], v[220:223], a[148:151], a[76:79]
    s_waitcnt lgkmcnt(4)
    v_mul_f32 v1, v47, v47
    v_fma_f32 v92, v92, v108, v109
    v_mfma_f32_16x16x32_bf16 a[76:79], v[212:215], a[144:147], a[76:79]
    ds_read_b128 a[188:191], v35 offset:28672
    v_fma_f32 v93, v93, v108, v109
    v_mfma_f32_16x16x32_bf16 a[80:83], v[208:211], a[152:155], a[80:83]
    v_mul_f32 v2, v46, v47
    v_fma_f32 v94, v94, v108, v109
    v_mfma_f32_16x16x32_bf16 a[80:83], v[216:219], a[156:159], a[80:83]
    ds_read_b128 a[192:195], v34 offset:30720
    v_fma_f32 v95, v95, v108, v109
    v_mfma_f32_16x16x32_bf16 a[84:87], v[220:223], a[156:159], a[84:87]
    v_cvt_pk_bf16_f32 v236, v92, v93
    v_cvt_pk_bf16_f32 v237, v94, v95
    v_mfma_f32_16x16x32_bf16 a[84:87], v[212:215], a[152:155], a[84:87]
    ds_read_b128 a[196:199], v35 offset:30720
    v_lshlrev_b32 v92, 16, v238
    v_mfma_f32_16x16x32_bf16 a[88:91], v[208:211], a[160:163], a[88:91]
    v_fma_f32 v46, v46, v46, -v1
    v_mfma_f32_16x16x32_bf16 a[88:91], v[216:219], a[164:167], a[88:91]
    ds_read_b128 a[200:203], v34 offset:32768
    v_and_b32 v93, s15, v238
    v_mfma_f32_16x16x32_bf16 a[92:95], v[220:223], a[164:167], a[92:95]
    s_waitcnt lgkmcnt(4)
    v_lshlrev_b32 v94, 16, v239
    v_and_b32 v95, s15, v239
    v_mfma_f32_16x16x32_bf16 a[92:95], v[212:215], a[160:163], a[92:95]
    ds_read_b128 a[204:207], v35 offset:32768
    v_fma_f32 v92, v92, v108, v109
    v_mfma_f32_16x16x32_bf16 a[96:99], v[208:211], a[168:171], a[96:99]
    ds_read_b128 a[208:211], v34 offset:34816
    v_add_u32 v34, 0x1b000, v32
    v_mfma_f32_16x16x32_bf16 a[96:99], v[216:219], a[172:175], a[96:99]
    v_fma_f32 v93, v93, v108, v109
    v_fma_f32 v94, v94, v108, v109
    v_mfma_f32_16x16x32_bf16 a[100:103], v[220:223], a[172:175], a[100:103]
    ds_read_b128 a[212:215], v35 offset:34816
    v_mfma_f32_16x16x32_bf16 a[100:103], v[212:215], a[168:171], a[100:103]
    v_add_u32 v35, 0x1b000, v33
    v_fma_f32 v95, v95, v108, v109
    v_mfma_f32_16x16x32_bf16 a[104:107], v[208:211], a[176:179], a[104:107]
    v_add_f32 v47, v2, v2
    v_mul_f32 v1, v47, v47
    v_mfma_f32_16x16x32_bf16 a[104:107], v[216:219], a[180:183], a[104:107]
    v_cvt_pk_bf16_f32 v238, v92, v93
    v_cvt_pk_bf16_f32 v239, v94, v95
    v_mfma_f32_16x16x32_bf16 a[108:111], v[220:223], a[180:183], a[108:111]
    s_waitcnt lgkmcnt(3)
    v_mul_f32 v2, v46, v47
    v_lshlrev_b32 v88, 16, v240
    v_mfma_f32_16x16x32_bf16 a[108:111], v[212:215], a[176:179], a[108:111]
    v_and_b32 v89, s15, v240
    v_lshlrev_b32 v90, 16, v241
    v_mfma_f32_16x16x32_bf16 a[112:115], v[208:211], a[184:187], a[112:115]
    v_fma_f32 v46, v46, v46, -v1
    v_add_f32 v47, v2, v2
    v_mfma_f32_16x16x32_bf16 a[112:115], v[216:219], a[188:191], a[112:115]
    v_and_b32 v91, s15, v241
    v_fma_f32 v88, v88, v10, v11
    v_mfma_f32_16x16x32_bf16 a[116:119], v[220:223], a[188:191], a[116:119]
    s_waitcnt lgkmcnt(0)
    s_barrier
    v_mfma_f32_16x16x32_bf16 a[116:119], v[212:215], a[184:187], a[116:119]
    ds_read_b128 a[144:147], v34 offset:0
    ds_read_b128 a[148:151], v35 offset:0
    v_mfma_f32_16x16x32_bf16 a[120:123], v[208:211], a[192:195], a[120:123]
    ds_read_b128 a[152:155], v34 offset:2048
    v_mfma_f32_16x16x32_bf16 a[120:123], v[216:219], a[196:199], a[120:123]
    ds_read_b128 a[156:159], v35 offset:2048
    v_fma_f32 v89, v89, v10, v11
    v_mfma_f32_16x16x32_bf16 a[124:127], v[220:223], a[196:199], a[124:127]
    s_waitcnt lgkmcnt(3)
    ds_read_b128 a[160:163], v34 offset:4096
    v_fma_f32 v90, v90, v10, v11
    v_mfma_f32_16x16x32_bf16 a[124:127], v[212:215], a[192:195], a[124:127]
    ds_read_b128 a[164:167], v35 offset:4096
    v_fma_f32 v91, v91, v10, v11
    v_mfma_f32_16x16x32_bf16 a[128:131], v[208:211], a[200:203], a[128:131]
    v_cvt_pk_bf16_f32 v240, v88, v89
    v_cvt_pk_bf16_f32 v241, v90, v91
    v_mfma_f32_16x16x32_bf16 a[128:131], v[216:219], a[204:207], a[128:131]
    ds_read_b128 a[168:171], v34 offset:6144
    v_lshlrev_b32 v88, 16, v242
    v_mfma_f32_16x16x32_bf16 a[132:135], v[220:223], a[204:207], a[132:135]
    s_lshl_b32 s14, s3, 2
    v_and_b32 v89, s15, v242
    v_lshlrev_b32 v90, 16, v243
    v_mfma_f32_16x16x32_bf16 a[132:135], v[212:215], a[200:203], a[132:135]
    s_lshl_b32 s12, s3, 12
    ds_read_b128 a[172:175], v35 offset:6144
    v_and_b32 v91, s15, v243
    v_mfma_f32_16x16x32_bf16 a[136:139], v[208:211], a[208:211], a[136:139]
    v_fma_f32 v88, v88, v10, v11
    v_mfma_f32_16x16x32_bf16 a[136:139], v[216:219], a[212:215], a[136:139]
    s_add_u32 s12, s12, 0x24000
    ds_read_b128 a[176:179], v34 offset:8192
    v_fma_f32 v89, v89, v10, v11
    v_mfma_f32_16x16x32_bf16 a[140:143], v[220:223], a[212:215], a[140:143]
    s_waitcnt lgkmcnt(4)
    v_and_b32 v1, 15, v0
    v_fma_f32 v90, v90, v10, v11
    v_mfma_f32_16x16x32_bf16 a[140:143], v[212:215], a[208:211], a[140:143]
    ds_read_b128 a[180:183], v35 offset:8192
    v_fma_f32 v91, v91, v10, v11
    v_mfma_f32_16x16x32_bf16 a[0:3], v[224:227], a[144:147], a[0:3]
    v_lshlrev_b32 v2, 4, v1
    v_cvt_pk_bf16_f32 v242, v88, v89
    v_mfma_f32_16x16x32_bf16 a[0:3], v[232:235], a[148:151], a[0:3]
    ds_read_b128 a[184:187], v34 offset:10240
    v_cvt_pk_bf16_f32 v243, v90, v91
    v_mfma_f32_16x16x32_bf16 a[4:7], v[236:239], a[148:151], a[4:7]
    v_lshlrev_b32 v92, 16, v244
    v_and_b32 v93, s15, v244
    v_mfma_f32_16x16x32_bf16 a[4:7], v[228:231], a[144:147], a[4:7]
    ds_read_b128 a[188:191], v35 offset:10240
    v_lshlrev_b32 v94, 16, v245
    v_mfma_f32_16x16x32_bf16 a[8:11], v[224:227], a[152:155], a[8:11]
    v_add_u32 v40, 0x24000, v2
    v_and_b32 v95, s15, v245
    v_mfma_f32_16x16x32_bf16 a[8:11], v[232:235], a[156:159], a[8:11]
    ds_read_b128 a[192:195], v34 offset:12288
    v_fma_f32 v92, v92, v108, v109
    v_mfma_f32_16x16x32_bf16 a[12:15], v[236:239], a[156:159], a[12:15]
    s_waitcnt lgkmcnt(4)
    v_lshrrev_b32 v2, 4, v0
    v_fma_f32 v93, v93, v108, v109
    v_mfma_f32_16x16x32_bf16 a[12:15], v[228:231], a[152:155], a[12:15]
    ds_read_b128 a[196:199], v35 offset:12288
    v_fma_f32 v94, v94, v108, v109
    v_mfma_f32_16x16x32_bf16 a[16:19], v[224:227], a[160:163], a[16:19]
    v_add_u32 v3, s14, v2
    v_fma_f32 v95, v95, v108, v109
    v_mfma_f32_16x16x32_bf16 a[16:19], v[232:235], a[164:167], a[16:19]
    ds_read_b128 a[200:203], v34 offset:14336
    v_cvt_pk_bf16_f32 v244, v92, v93
    v_mfma_f32_16x16x32_bf16 a[20:23], v[236:239], a[164:167], a[20:23]
    v_cvt_pk_bf16_f32 v245, v94, v95
    v_lshlrev_b32 v92, 16, v246
    v_mfma_f32_16x16x32_bf16 a[20:23], v[228:231], a[160:163], a[20:23]
    ds_read_b128 a[204:207], v35 offset:14336
    v_and_b32 v93, s15, v246
    v_lshlrev_b32 v94, 16, v247
    v_mfma_f32_16x16x32_bf16 a[24:27], v[224:227], a[168:171], a[24:27]
    s_mov_b32 s9, 0x24000
    v_and_b32 v95, s15, v247
    v_mfma_f32_16x16x32_bf16 a[24:27], v[232:235], a[172:175], a[24:27]
    s_add_u32 m0, s8, 0x9000
    ds_read_b128 a[208:211], v34 offset:16384
    buffer_load_dwordx4 v22, s[56:59], s9 offen lds
    v_mfma_f32_16x16x32_bf16 a[28:31], v[236:239], a[172:175], a[28:31]
L_ps12:
    s_cbranch_execz L_rs12
    s_waitcnt lgkmcnt(4)
    v_mul_u32_u24 v3, 1152, v3
    v_fma_f32 v92, v92, v108, v109
    v_mfma_f32_16x16x32_bf16 a[28:31], v[228:231], a[168:171], a[28:31]
    ds_read_b128 a[212:215], v35 offset:16384
    v_fma_f32 v93, v93, v108, v109
    v_mfma_f32_16x16x32_bf16 a[32:35], v[224:227], a[176:179], a[32:35]
    s_add_u32 m0, s8, 0x9400
    ds_read_b128 a[144:147], v34 offset:18432
    v_fma_f32 v94, v94, v108, v109
    v_mfma_f32_16x16x32_bf16 a[32:35], v[232:235], a[180:183], a[32:35]
    buffer_load_dwordx4 v23, s[56:59], s9 offen lds
    v_mfma_f32_16x16x32_bf16 a[36:39], v[236:239], a[180:183], a[36:39]
    v_lshl_add_u32 v31, v1, 3, v3
    v_fma_f32 v95, v95, v108, v109
    v_mfma_f32_16x16x32_bf16 a[36:39], v[228:231], a[176:179], a[36:39]
    ds_read_b128 a[148:151], v35 offset:18432
    v_cvt_pk_bf16_f32 v246, v92, v93
    v_mfma_f32_16x16x32_bf16 a[40:43], v[224:227], a[184:187], a[40:43]
    s_add_u32 m0, s8, 0x9800
    ds_read_b128 a[152:155], v34 offset:20480
    v_cvt_pk_bf16_f32 v247, v94, v95
    v_mfma_f32_16x16x32_bf16 a[40:43], v[232:235], a[188:191], a[40:43]
    buffer_load_dwordx4 v24, s[56:59], s9 offen lds
    v_mfma_f32_16x16x32_bf16 a[44:47], v[236:239], a[188:191], a[44:47]
    s_waitcnt lgkmcnt(4)
    ds_read_b128 v[52:55], v40 offset:0
    v_bfe_u32 v3, v0, 1, 2
    v_mfma_f32_16x16x32_bf16 a[44:47], v[228:231], a[184:187], a[44:47]
    ds_read_b128 a[156:159], v35 offset:20480
    v_lshlrev_b32 v88, 16, v248
    v_and_b32 v89, s15, v248
    v_mfma_f32_16x16x32_bf16 a[48:51], v[224:227], a[192:195], a[48:51]
    v_lshlrev_b32 v90, 16, v249
    v_and_b32 v91, s15, v249
    v_mfma_f32_16x16x32_bf16 a[48:51], v[232:235], a[196:199], a[48:51]
    s_add_u32 m0, s8, 0x9c00
    ds_read_b128 a[160:163], v34 offset:22528
    buffer_load_dwordx4 v25, s[56:59], s9 offen lds
    v_mfma_f32_16x16x32_bf16 a[52:55], v[236:239], a[196:199], a[52:55]
    ds_read_b128 v[56:59], v40 offset:256
    v_xor_b32 v3, v3, v2
    v_mfma_f32_16x16x32_bf16 a[52:55], v[228:231], a[192:195], a[52:55]
    ds_read_b128 a[164:167], v35 offset:22528
    v_fma_f32 v88, v88, v10, v11
    v_fma_f32 v89, v89, v10, v11
    v_mfma_f32_16x16x32_bf16 a[56:59], v[224:227], a[200:203], a[56:59]
    v_fma_f32 v90, v90, v10, v11
    v_fma_f32 v91, v91, v10, v11
    v_mfma_f32_16x16x32_bf16 a[56:59], v[232:235], a[204:207], a[56:59]
    s_add_u32 m0, s8, 0xa000
    ds_read_b128 a[168:171], v34 offset:24576
    buffer_load_dwordx4 v26, s[56:59], s9 offen lds
    v_mfma_f32_16x16x32_bf16 a[60:63], v[236:239], a[204:207], a[60:63]
    s_waitcnt lgkmcnt(6)
    ds_read_b128 v[60:63], v40 offset:512
    v_lshlrev_b32 v3, 4, v3
    v_mfma_f32_16x16x32_bf16 a[60:63], v[228:231], a[200:203], a[60:63]
    ds_read_b128 a[172:175], v35 offset:24576
    v_cvt_pk_bf16_f32 v248, v88, v89
    v_cvt_pk_bf16_f32 v249, v90, v91
    v_mfma_f32_16x16x32_bf16 a[64:67], v[224:227], a[208:211], a[64:67]
    v_lshlrev_b32 v88, 16, v250
    v_and_b32 v89, s15, v250
    v_mfma_f32_16x16x32_bf16 a[64:67], v[232:235], a[212:215], a[64:67]
    s_add_u32 m0, s8, 0xa400
    ds_read_b128 a[176:179], v34 offset:26624
    buffer_load_dwordx4 v27, s[56:59], s9 offen lds
    v_mfma_f32_16x16x32_bf16 a[68:71], v[236:239], a[212:215], a[68:71]
    ds_read_b128 v[64:67], v40 offset:768
    v_lshl_add_u32 v3, v1, 6, v3
    v_mfma_f32_16x16x32_bf16 a[68:71], v[228:231], a[208:211], a[68:71]
    ds_read_b128 a[180:183], v35 offset:26624
    v_lshlrev_b32 v90, 16, v251
    v_and_b32 v91, s15, v251
    v_mfma_f32_16x16x32_bf16 a[72:75], v[224:227], a[144:147], a[72:75]
    v_fma_f32 v88, v88, v10, v11
    v_fma_f32 v89, v89, v10, v11
    v_mfma_f32_16x16x32_bf16 a[72:75], v[232:235], a[148:151], a[72:75]
    s_add_u32 m0, s8, 0xa800
    ds_read_b128 a[184:187], v34 offset:28672
    buffer_load_dwordx4 v28, s[56:59], s9 offen lds
    v_mfma_f32_16x16x32_bf16 a[76:79], v[236:239], a[148:151], a[76:79]
    s_waitcnt lgkmcnt(6)
    ds_read_b128 v[68:71], v40 offset:1024
    v_add_u32 v51, s12, v3
    v_mfma_f32_16x16x32_bf16 a[76:79], v[228:231], a[144:147], a[76:79]
    ds_read_b128 a[188:191], v35 offset:28672
    v_fma_f32 v90, v90, v10, v11
    v_fma_f32 v91, v91, v10, v11
    v_mfma_f32_16x16x32_bf16 a[80:83], v[224:227], a[152:155], a[80:83]
    v_cvt_pk_bf16_f32 v250, v88, v89
    v_cvt_pk_bf16_f32 v251, v90, v91
    v_mfma_f32_16x16x32_bf16 a[80:83], v[232:235], a[156:159], a[80:83]
    s_add_u32 m0, s8, 0xac00
    ds_read_b128 a[192:195], v34 offset:30720
    buffer_load_dwordx4 v29, s[56:59], s9 offen lds
    v_mfma_f32_16x16x32_bf16 a[84:87], v[236:239], a[156:159], a[84:87]
    ds_read_b128 v[72:75], v40 offset:1280
    v_bfe_u32 v1, v0, 2, 2
    v_mfma_f32_16x16x32_bf16 a[84:87], v[228:231], a[152:155], a[84:87]
    ds_read_b128 a[196:199], v35 offset:30720
    v_lshlrev_b32 v92, 16, v252
    v_and_b32 v93, s15, v252
    v_mfma_f32_16x16x32_bf16 a[88:91], v[224:227], a[160:163], a[88:91]
    v_lshlrev_b32 v94, 16, v253
    v_and_b32 v95, s15, v253
    v_mfma_f32_16x16x32_bf16 a[88:91], v[232:235], a[164:167], a[88:91]
    s_add_u32 m0, s8, 0xb000
    ds_read_b128 a[200:203], v34 offset:32768
    buffer_load_dwordx4 v30, s[56:59], s9 offen lds
    v_mfma_f32_16x16x32_bf16 a[92:95], v[236:239], a[164:167], a[92:95]
    s_waitcnt lgkmcnt(6)
    ds_read_b128 v[76:79], v40 offset:1536
    v_fma_f32 v92, v92, v108, v109
    v_mfma_f32_16x16x32_bf16 a[92:95], v[228:231], a[160:163], a[92:95]
    ds_read_b128 a[204:207], v35 offset:32768
    v_fma_f32 v93, v93, v108, v109
    v_fma_f32 v94, v94, v108, v109
    v_mfma_f32_16x16x32_bf16 a[96:99], v[224:227], a[168:171], a[96:99]
    s_mov_b32 s9, 0x5a000
    ds_read_b128 a[208:211], v34 offset:34816
    v_add_u32 v34, 0x0, v32
    v_mfma_f32_16x16x32_bf16 a[96:99], v[232:235], a[172:175], a[96:99]
    s_add_u32 m0, s8, 0x12000
    s_nop 0
    buffer_load_dwordx4 v22, s[56:59], s9 offen lds
    v_fma_f32 v95, v95, v108, v109
    v_mfma_f32_16x16x32_bf16 a[100:103], v[236:239], a[172:175], a[100:103]
    ds_read_b128 v[80:83], v40 offset:1792
    ds_read_b128 a[212:215], v35 offset:34816
    v_mfma_f32_16x16x32_bf16 a[100:103], v[228:231], a[168:171], a[100:103]
    v_add_u32 v35, 0x0, v33
    v_cvt_pk_bf16_f32 v252, v92, v93
    v_cvt_pk_bf16_f32 v253, v94, v95
    v_lshlrev_b32 v92, 16, v254
    v_mfma_f32_16x16x32_bf16 a[104:107], v[224:227], a[176:179], a[104:107]
    s_add_u32 m0, s8, 0x12400
    v_lshl_add_u32 v1, v2, 3, v1
    v_and_b32 v93, s15, v254
    v_mfma_f32_16x16x32_bf16 a[104:107], v[232:235], a[180:183], a[104:107]
    buffer_load_dwordx4 v23, s[56:59], s9 offen lds
    v_lshlrev_b32 v94, 16, v255
    v_mfma_f32_16x16x32_bf16 a[108:111], v[236:239], a[180:183], a[108:111]
    s_waitcnt lgkmcnt(5)
    v_lshlrev_b32 v1, 6, v1
    v_bfe_u32 v2, v0, 3, 1
    v_mfma_f32_16x16x32_bf16 a[108:111], v[228:231], a[176:179], a[108:111]
    ds_read_b128 v[84:87], v40 offset:2048
    v_and_b32 v95, s15, v255
    v_fma_f32 v92, v92, v108, v109
    v_mfma_f32_16x16x32_bf16 a[112:115], v[224:227], a[184:187], a[112:115]
    s_add_u32 m0, s8, 0x12800
    v_and_b32 v3, 3, v0
    v_fma_f32 v93, v93, v108, v109
    v_mfma_f32_16x16x32_bf16 a[112:115], v[232:235], a[188:191], a[112:115]
    buffer_load_dwordx4 v24, s[56:59], s9 offen lds
    v_fma_f32 v94, v94, v108, v109
    v_mfma_f32_16x16x32_bf16 a[116:119], v[236:239], a[188:191], a[116:119]
    s_waitcnt lgkmcnt(1)
    s_barrier
    v_mfma_f32_16x16x32_bf16 a[116:119], v[228:231], a[184:187], a[116:119]
    ds_read_b128 a[144:147], v34 offset:0
    ds_read_b128 a[148:151], v35 offset:0
    v_mfma_f32_16x16x32_bf16 a[120:123], v[224:227], a[192:195], a[120:123]
    ds_read_b128 a[152:155], v34 offset:2048
    v_fma_f32 v95, v95, v108, v109
    v_mfma_f32_16x16x32_bf16 a[120:123], v[232:235], a[196:199], a[120:123]
    s_add_u32 m0, s8, 0x12c00
    ds_read_b128 a[156:159], v35 offset:2048
    buffer_load_dwordx4 v25, s[56:59], s9 offen lds
    v_mfma_f32_16x16x32_bf16 a[124:127], v[236:239], a[196:199], a[124:127]
    s_waitcnt lgkmcnt(3)
    ds_read_b128 a[160:163], v34 offset:4096
    v_xor_b32 v2, v2, v3
    v_mfma_f32_16x16x32_bf16 a[124:127], v[228:231], a[192:195], a[124:127]
    ds_read_b128 a[164:167], v35 offset:4096
    v_cvt_pk_bf16_f32 v254, v92, v93
    v_cvt_pk_bf16_f32 v255, v94, v95
    v_mfma_f32_16x16x32_bf16 a[128:131], v[224:227], a[200:203], a[128:131]
    s_add_u32 m0, s8, 0x13000
    ds_read_b128 a[168:171], v34 offset:6144
    v_mfma_f32_16x16x32_bf16 a[128:131], v[232:235], a[204:207], a[128:131]
    buffer_load_dwordx4 v26, s[56:59], s9 offen lds
    v_mfma_f32_16x16x32_bf16 a[132:135], v[236:239], a[204:207], a[132:135]
    v_lshl_add_u32 v1, v2, 4, v1
    v_mfma_f32_16x16x32_bf16 a[132:135], v[228:231], a[200:203], a[132:135]
    ds_read_b128 a[172:175], v35 offset:6144
    v_add_u32 v8, s12, v1
    v_mfma_f32_16x16x32_bf16 a[136:139], v[224:227], a[208:211], a[136:139]
    s_add_u32 m0, s8, 0x13400
    ds_read_b128 a[176:179], v34 offset:8192
    v_mfma_f32_16x16x32_bf16 a[136:139], v[232:235], a[212:215], a[136:139]
    buffer_load_dwordx4 v27, s[56:59], s9 offen lds
    v_mfma_f32_16x16x32_bf16 a[140:143], v[236:239], a[212:215], a[140:143]
    s_waitcnt lgkmcnt(4)
    v_xor_b32 v13, 32, v8
    v_mfma_f32_16x16x32_bf16 a[140:143], v[228:231], a[208:211], a[140:143]
    ds_read_b128 a[180:183], v35 offset:8192
    v_add_u32 v13, 256, v13
    v_mfma_f32_16x16x32_bf16 a[0:3], v[240:243], a[144:147], a[0:3]
    s_add_u32 m0, s8, 0x13800
    ds_read_b128 a[184:187], v34 offset:10240
    v_mfma_f32_16x16x32_bf16 a[0:3], v[248:251], a[148:151], a[0:3]
    buffer_load_dwordx4 v28, s[56:59], s9 offen lds
    v_mfma_f32_16x16x32_bf16 a[4:7], v[252:255], a[148:151], a[4:7]
    v_mfma_f32_16x16x32_bf16 a[4:7], v[244:247], a[144:147], a[4:7]
    ds_read_b128 a[188:191], v35 offset:10240
    v_mfma_f32_16x16x32_bf16 a[8:11], v[240:243], a[152:155], a[8:11]
    s_add_u32 m0, s8, 0x13c00
    ds_read_b128 a[192:195], v34 offset:12288
    v_mfma_f32_16x16x32_bf16 a[8:11], v[248:251], a[156:159], a[8:11]
    buffer_load_dwordx4 v29, s[56:59], s9 offen lds
    v_mfma_f32_16x16x32_bf16 a[12:15], v[252:255], a[156:159], a[12:15]
    s_waitcnt lgkmcnt(4)
    v_mfma_f32_16x16x32_bf16 a[12:15], v[244:247], a[152:155], a[12:15]
    ds_read_b128 a[196:199], v35 offset:12288
    v_mfma_f32_16x16x32_bf16 a[16:19], v[240:243], a[160:163], a[16:19]
    v_accvgpr_read_b32 v96, a0
    v_accvgpr_read_b32 v98, a1
    v_accvgpr_read_b32 v100, a2
    v_mfma_f32_16x16x32_bf16 a[16:19], v[248:251], a[164:167], a[16:19]
    s_add_u32 m0, s8, 0x14000
    ds_read_b128 a[200:203], v34 offset:14336
    buffer_load_dwordx4 v30, s[56:59], s9 offen lds
    v_mfma_f32_16x16x32_bf16 a[20:23], v[252:255], a[164:167], a[20:23]
    v_accvgpr_read_b32 v102, a3
    v_accvgpr_read_b32 v104, a4
    v_mfma_f32_16x16x32_bf16 a[20:23], v[244:247], a[160:163], a[20:23]
    ds_read_b128 a[204:207], v35 offset:14336
    v_accvgpr_read_b32 v106, a5
    v_accvgpr_read_b32 v108, a6
    v_accvgpr_read_b32 v110, a7
    v_mfma_f32_16x16x32_bf16 a[24:27], v[240:243], a[168:171], a[24:27]
    s_mov_b32 s9, 0x90000
    v_accvgpr_read_b32 v112, a8
    v_accvgpr_read_b32 v114, a9
    v_accvgpr_read_b32 v116, a10
    v_mfma_f32_16x16x32_bf16 a[24:27], v[248:251], a[172:175], a[24:27]
    s_add_u32 m0, s8, 0x1b000
    ds_read_b128 a[208:211], v34 offset:16384
    buffer_load_dwordx4 v22, s[56:59], s9 offen lds
    v_mfma_f32_16x16x32_bf16 a[28:31], v[252:255], a[172:175], a[28:31]
    s_waitcnt lgkmcnt(4)
    v_accvgpr_read_b32 v118, a11
    v_accvgpr_read_b32 v120, a12
    v_mfma_f32_16x16x32_bf16 a[28:31], v[244:247], a[168:171], a[28:31]
    ds_read_b128 a[212:215], v35 offset:16384
    v_accvgpr_read_b32 v122, a13
    v_accvgpr_read_b32 v124, a14
    v_accvgpr_read_b32 v126, a15
    v_mfma_f32_16x16x32_bf16 a[32:35], v[240:243], a[176:179], a[32:35]
    v_accvgpr_read_b32 v128, a16
    v_accvgpr_read_b32 v130, a17
    v_accvgpr_read_b32 v132, a18
    v_mfma_f32_16x16x32_bf16 a[32:35], v[248:251], a[180:183], a[32:35]
    s_add_u32 m0, s8, 0x1b400
    ds_read_b128 a[144:147], v34 offset:18432
    buffer_load_dwordx4 v23, s[56:59], s9 offen lds
    v_mfma_f32_16x16x32_bf16 a[36:39], v[252:255], a[180:183], a[36:39]
    v_accvgpr_read_b32 v134, a19
    v_accvgpr_read_b32 v136, a20
    v_mfma_f32_16x16x32_bf16 a[36:39], v[244:247], a[176:179], a[36:39]
    ds_read_b128 a[148:151], v35 offset:18432
    v_accvgpr_read_b32 v138, a21
    v_accvgpr_read_b32 v140, a22
    v_accvgpr_read_b32 v142, a23
    v_mfma_f32_16x16x32_bf16 a[40:43], v[240:243], a[184:187], a[40:43]
    v_accvgpr_read_b32 v144, a24
    v_accvgpr_read_b32 v146, a25
    v_accvgpr_read_b32 v148, a26
    v_mfma_f32_16x16x32_bf16 a[40:43], v[248:251], a[188:191], a[40:43]
    s_add_u32 m0, s8, 0x1b800
    ds_read_b128 a[152:155], v34 offset:20480
    buffer_load_dwordx4 v24, s[56:59], s9 offen lds
    v_mfma_f32_16x16x32_bf16 a[44:47], v[252:255], a[188:191], a[44:47]
    s_waitcnt lgkmcnt(4)
    v_accvgpr_read_b32 v150, a27
    v_accvgpr_read_b32 v152, a28
    v_mfma_f32_16x16x32_bf16 a[44:47], v[244:247], a[184:187], a[44:47]
    ds_read_b128 a[156:159], v35 offset:20480
    v_accvgpr_read_b32 v154, a29
    v_accvgpr_read_b32 v156, a30
    v_accvgpr_read_b32 v158, a31
    v_mfma_f32_16x16x32_bf16 a[48:51], v[240:243], a[192:195], a[48:51]
    v_accvgpr_read_b32 v160, a32
    v_accvgpr_read_b32 v162, a33
    v_accvgpr_read_b32 v164, a34
    v_mfma_f32_16x16x32_bf16 a[48:51], v[248:251], a[196:199], a[48:51]
    s_add_u32 m0, s8, 0x1bc00
    ds_read_b128 a[160:163], v34 offset:22528
    buffer_load_dwordx4 v25, s[56:59], s9 offen lds
    v_mfma_f32_16x16x32_bf16 a[52:55], v[252:255], a[196:199], a[52:55]
    v_accvgpr_read_b32 v166, a35
    v_accvgpr_read_b32 v168, a36
    v_mfma_f32_16x16x32_bf16 a[52:55], v[244:247], a[192:195], a[52:55]
    ds_read_b128 a[164:167], v35 offset:22528
    v_accvgpr_read_b32 v170, a37
    v_accvgpr_read_b32 v172, a38
    v_accvgpr_read_b32 v174, a39
    v_mfma_f32_16x16x32_bf16 a[56:59], v[240:243], a[200:203], a[56:59]
    v_accvgpr_read_b32 v176, a40
    v_accvgpr_read_b32 v178, a41
    v_accvgpr_read_b32 v180, a42
    v_mfma_f32_16x16x32_bf16 a[56:59], v[248:251], a[204:207], a[56:59]
    s_add_u32 m0, s8, 0x1c000
    ds_read_b128 a[168:171], v34 offset:24576
    buffer_load_dwordx4 v26, s[56:59], s9 offen lds
    v_mfma_f32_16x16x32_bf16 a[60:63], v[252:255], a[204:207], a[60:63]
    s_waitcnt lgkmcnt(4)
    v_accvgpr_read_b32 v182, a43
    v_accvgpr_read_b32 v184, a44
    v_mfma_f32_16x16x32_bf16 a[60:63], v[244:247], a[200:203], a[60:63]
    ds_read_b128 a[172:175], v35 offset:24576
    v_accvgpr_read_b32 v186, a45
    v_accvgpr_read_b32 v188, a46
    v_accvgpr_read_b32 v190, a47
    v_mfma_f32_16x16x32_bf16 a[64:67], v[240:243], a[208:211], a[64:67]
    v_accvgpr_read_b32 v192, a48
    v_accvgpr_read_b32 v194, a49
    v_accvgpr_read_b32 v196, a50
    v_mfma_f32_16x16x32_bf16 a[64:67], v[248:251], a[212:215], a[64:67]
    s_add_u32 m0, s8, 0x1c400
    ds_read_b128 a[176:179], v34 offset:26624
    buffer_load_dwordx4 v27, s[56:59], s9 offen lds
    v_mfma_f32_16x16x32_bf16 a[68:71], v[252:255], a[212:215], a[68:71]
    v_accvgpr_read_b32 v198, a51
    v_accvgpr_read_b32 v200, a52
    v_mfma_f32_16x16x32_bf16 a[68:71], v[244:247], a[208:211], a[68:71]
    ds_read_b128 a[180:183], v35 offset:26624
    v_accvgpr_read_b32 v202, a53
    v_accvgpr_read_b32 v204, a54
    v_accvgpr_read_b32 v206, a55
    v_mfma_f32_16x16x32_bf16 a[72:75], v[240:243], a[144:147], a[72:75]
    v_accvgpr_read_b32 v208, a56
    v_accvgpr_read_b32 v210, a57
    v_accvgpr_read_b32 v212, a58
    v_mfma_f32_16x16x32_bf16 a[72:75], v[248:251], a[148:151], a[72:75]
    s_add_u32 m0, s8, 0x1c800
    ds_read_b128 a[184:187], v34 offset:28672
    buffer_load_dwordx4 v28, s[56:59], s9 offen lds
    v_mfma_f32_16x16x32_bf16 a[76:79], v[252:255], a[148:151], a[76:79]
    s_waitcnt lgkmcnt(4)
    v_accvgpr_read_b32 v214, a59
    v_accvgpr_read_b32 v216, a60
    v_mfma_f32_16x16x32_bf16 a[76:79], v[244:247], a[144:147], a[76:79]
    ds_read_b128 a[188:191], v35 offset:28672
    v_accvgpr_read_b32 v218, a61
    v_accvgpr_read_b32 v220, a62
    v_accvgpr_read_b32 v222, a63
    v_mfma_f32_16x16x32_bf16 a[80:83], v[240:243], a[152:155], a[80:83]
    v_accvgpr_read_b32 v224, a64
    v_accvgpr_read_b32 v226, a65
    v_accvgpr_read_b32 v228, a66
    v_mfma_f32_16x16x32_bf16 a[80:83], v[248:251], a[156:159], a[80:83]
    s_add_u32 m0, s8, 0x1cc00
    ds_read_b128 a[192:195], v34 offset:30720
    buffer_load_dwordx4 v29, s[56:59], s9 offen lds
    v_mfma_f32_16x16x32_bf16 a[84:87], v[252:255], a[156:159], a[84:87]
    v_accvgpr_read_b32 v230, a67
    v_accvgpr_read_b32 v232, a68
    v_mfma_f32_16x16x32_bf16 a[84:87], v[244:247], a[152:155], a[84:87]
    ds_read_b128 a[196:199], v35 offset:30720
    v_accvgpr_read_b32 v234, a69
    v_accvgpr_read_b32 v236, a70
    v_accvgpr_read_b32 v238, a71
    v_mfma_f32_16x16x32_bf16 a[88:91], v[240:243], a[160:163], a[88:91]
    v_accvgpr_read_b32 v225, a72
    v_accvgpr_read_b32 v227, a73
    v_accvgpr_read_b32 v229, a74
    v_mfma_f32_16x16x32_bf16 a[88:91], v[248:251], a[164:167], a[88:91]
    s_add_u32 m0, s8, 0x1d000
    ds_read_b128 a[200:203], v34 offset:32768
    buffer_load_dwordx4 v30, s[56:59], s9 offen lds
    v_mfma_f32_16x16x32_bf16 a[92:95], v[252:255], a[164:167], a[92:95]
    s_waitcnt lgkmcnt(4)
    v_accvgpr_read_b32 v231, a75
    v_accvgpr_read_b32 v233, a76
    v_mfma_f32_16x16x32_bf16 a[92:95], v[244:247], a[160:163], a[92:95]
    ds_read_b128 a[204:207], v35 offset:32768
    v_accvgpr_read_b32 v235, a77
    v_accvgpr_read_b32 v237, a78
    v_accvgpr_read_b32 v239, a79
    v_mfma_f32_16x16x32_bf16 a[96:99], v[240:243], a[168:171], a[96:99]
    v_accvgpr_read_b32 v97, a80
    v_accvgpr_read_b32 v99, a81
    v_mfma_f32_16x16x32_bf16 a[96:99], v[248:251], a[172:175], a[96:99]
    ds_read_b128 a[208:211], v34 offset:34816
    v_accvgpr_read_b32 v101, a82
    v_accvgpr_read_b32 v103, a83
    v_mfma_f32_16x16x32_bf16 a[100:103], v[252:255], a[172:175], a[100:103]
    v_accvgpr_read_b32 v105, a84
    v_accvgpr_read_b32 v107, a85
    v_mfma_f32_16x16x32_bf16 a[100:103], v[244:247], a[168:171], a[100:103]
    ds_read_b128 a[212:215], v35 offset:34816
    v_accvgpr_read_b32 v109, a86
    v_accvgpr_read_b32 v111, a87
    v_mfma_f32_16x16x32_bf16 a[104:107], v[240:243], a[176:179], a[104:107]
    v_accvgpr_read_b32 v113, a88
    v_accvgpr_read_b32 v115, a89
    v_mfma_f32_16x16x32_bf16 a[104:107], v[248:251], a[180:183], a[104:107]
    v_accvgpr_read_b32 v117, a90
    v_accvgpr_read_b32 v119, a91
    v_mfma_f32_16x16x32_bf16 a[108:111], v[252:255], a[180:183], a[108:111]
    s_waitcnt lgkmcnt(3)
    v_accvgpr_read_b32 v121, a92
    v_accvgpr_read_b32 v123, a93
    v_mfma_f32_16x16x32_bf16 a[108:111], v[244:247], a[176:179], a[108:111]
    v_accvgpr_read_b32 v125, a94
    v_accvgpr_read_b32 v127, a95
    v_mfma_f32_16x16x32_bf16 a[112:115], v[240:243], a[184:187], a[112:115]
    v_accvgpr_read_b32 v129, a96
    v_accvgpr_read_b32 v131, a97
    v_mfma_f32_16x16x32_bf16 a[112:115], v[248:251], a[188:191], a[112:115]
    v_accvgpr_read_b32 v133, a98
    v_accvgpr_read_b32 v135, a99
    v_mfma_f32_16x16x32_bf16 a[116:119], v[252:255], a[188:191], a[116:119]
    v_accvgpr_read_b32 v137, a100
    v_accvgpr_read_b32 v139, a101
    v_mfma_f32_16x16x32_bf16 a[116:119], v[244:247], a[184:187], a[116:119]
    v_accvgpr_read_b32 v141, a102
    v_accvgpr_read_b32 v143, a103
    v_mfma_f32_16x16x32_bf16 a[120:123], v[240:243], a[192:195], a[120:123]
    s_waitcnt lgkmcnt(0)
    s_barrier
    v_mfma_f32_16x16x32_bf16 a[120:123], v[248:251], a[196:199], a[120:123]
    v_accvgpr_read_b32 v145, a104
    v_accvgpr_read_b32 v147, a105
    v_accvgpr_read_b32 v149, a106
    v_mfma_f32_16x16x32_bf16 a[124:127], v[252:255], a[196:199], a[124:127]
    v_accvgpr_read_b32 v151, a107
    v_accvgpr_read_b32 v153, a108
    v_mfma_f32_16x16x32_bf16 a[124:127], v[244:247], a[192:195], a[124:127]
    v_accvgpr_read_b32 v155, a109
    v_accvgpr_read_b32 v157, a110
    v_accvgpr_read_b32 v159, a111
    v_mfma_f32_16x16x32_bf16 a[128:131], v[240:243], a[200:203], a[128:131]
    v_accvgpr_read_b32 v161, a112
    v_accvgpr_read_b32 v163, a113
    v_mfma_f32_16x16x32_bf16 a[128:131], v[248:251], a[204:207], a[128:131]
    v_accvgpr_read_b32 v165, a114
    v_accvgpr_read_b32 v167, a115
    v_mfma_f32_16x16x32_bf16 a[132:135], v[252:255], a[204:207], a[132:135]
    v_accvgpr_read_b32 v169, a116
    v_accvgpr_read_b32 v171, a117
    v_mfma_f32_16x16x32_bf16 a[132:135], v[244:247], a[200:203], a[132:135]
    v_accvgpr_read_b32 v173, a118
    v_accvgpr_read_b32 v175, a119
    v_mfma_f32_16x16x32_bf16 a[136:139], v[240:243], a[208:211], a[136:139]
    v_accvgpr_read_b32 v177, a120
    v_accvgpr_read_b32 v179, a121
    v_mfma_f32_16x16x32_bf16 a[136:139], v[248:251], a[212:215], a[136:139]
    v_accvgpr_read_b32 v181, a122
    v_accvgpr_read_b32 v183, a123
    v_mfma_f32_16x16x32_bf16 a[140:143], v[252:255], a[212:215], a[140:143]
    v_accvgpr_read_b32 v185, a124
    v_accvgpr_read_b32 v187, a125
    v_mfma_f32_16x16x32_bf16 a[140:143], v[244:247], a[208:211], a[140:143]
    v_accvgpr_read_b32 v189, a126
    v_accvgpr_read_b32 v191, a127
    v_accvgpr_read_b32 v193, a128
    v_accvgpr_read_b32 v195, a129
    v_accvgpr_read_b32 v197, a130
    v_accvgpr_read_b32 v199, a131
    v_accvgpr_read_b32 v201, a132
    v_accvgpr_read_b32 v203, a133
    v_accvgpr_read_b32 v205, a134
    v_accvgpr_read_b32 v207, a135
    v_accvgpr_read_b32 v209, a136
    v_accvgpr_read_b32 v211, a137
    v_accvgpr_read_b32 v213, a138
    v_accvgpr_read_b32 v215, a139
    v_accvgpr_read_b32 v217, a140
    v_accvgpr_read_b32 v219, a141
    v_accvgpr_read_b32 v221, a142
    v_accvgpr_read_b32 v223, a143
    v_pk_fma_f32 v[240:241], v[96:97], v[52:53], v[98:99] op_sel_hi:[1,0,1]
    v_pk_fma_f32 v[242:243], v[112:113], v[56:57], v[114:115] op_sel_hi:[1,0,1]
    v_pk_fma_f32 v[244:245], v[128:129], v[60:61], v[130:131] op_sel_hi:[1,0,1]
    v_pk_fma_f32 v[246:247], v[144:145], v[64:65], v[146:147] op_sel_hi:[1,0,1]
    v_pk_fma_f32 v[248:249], v[160:161], v[68:69], v[162:163] op_sel_hi:[1,0,1]
    v_pk_fma_f32 v[250:251], v[176:177], v[72:73], v[178:179] op_sel_hi:[1,0,1]
    v_pk_fma_f32 v[252:253], v[192:193], v[76:77], v[194:195] op_sel_hi:[1,0,1]
    v_pk_fma_f32 v[254:255], v[208:209], v[80:81], v[210:211] op_sel_hi:[1,0,1]
    v_pk_fma_f32 v[88:89], v[224:225], v[84:85], v[226:227] op_sel_hi:[1,0,1]
    v_pk_fma_f32 v[240:241], v[96:97], v[52:53], v[240:241] op_sel:[1,1,0] op_sel_hi:[0,1,1] neg_lo:[1,0,0]
    v_pk_fma_f32 v[242:243], v[112:113], v[56:57], v[242:243] op_sel:[1,1,0] op_sel_hi:[0,1,1] neg_lo:[1,0,0]
    v_pk_fma_f32 v[244:245], v[128:129], v[60:61], v[244:245] op_sel:[1,1,0] op_sel_hi:[0,1,1] neg_lo:[1,0,0]
    v_pk_fma_f32 v[246:247], v[144:145], v[64:65], v[246:247] op_sel:[1,1,0] op_sel_hi:[0,1,1] neg_lo:[1,0,0]
    v_pk_fma_f32 v[248:249], v[160:161], v[68:69], v[248:249] op_sel:[1,1,0] op_sel_hi:[0,1,1] neg_lo:[1,0,0]
    v_pk_fma_f32 v[250:251], v[176:177], v[72:73], v[250:251] op_sel:[1,1,0] op_sel_hi:[0,1,1] neg_lo:[1,0,0]
    v_pk_fma_f32 v[252:253], v[192:193], v[76:77], v[252:253] op_sel:[1,1,0] op_sel_hi:[0,1,1] neg_lo:[1,0,0]
    v_pk_fma_f32 v[254:255], v[208:209], v[80:81], v[254:255] op_sel:[1,1,0] op_sel_hi:[0,1,1] neg_lo:[1,0,0]
    v_pk_fma_f32 v[88:89], v[224:225], v[84:85], v[88:89] op_sel:[1,1,0] op_sel_hi:[0,1,1] neg_lo:[1,0,0]
    v_pk_fma_f32 v[90:91], v[240:241], v[52:53], v[100:101] op_sel_hi:[1,0,1]
    v_pk_fma_f32 v[92:93], v[242:243], v[56:57], v[116:117] op_sel_hi:[1,0,1]
    v_pk_fma_f32 v[94:95], v[244:245], v[60:61], v[132:133] op_sel_hi:[1,0,1]
    v_pk_fma_f32 v[32:33], v[246:247], v[64:65], v[148:149] op_sel_hi:[1,0,1]
    v_pk_fma_f32 v[34:35], v[248:249], v[68:69], v[164:165] op_sel_hi:[1,0,1]
    v_pk_fma_f32 v[36:37], v[250:251], v[72:73], v[180:181] op_sel_hi:[1,0,1]
    v_pk_fma_f32 v[38:39], v[252:253], v[76:77], v[196:197] op_sel_hi:[1,0,1]
    v_pk_fma_f32 v[40:41], v[254:255], v[80:81], v[212:213] op_sel_hi:[1,0,1]
    v_pk_fma_f32 v[42:43], v[88:89], v[84:85], v[228:229] op_sel_hi:[1,0,1]
    v_pk_fma_f32 v[90:91], v[240:241], v[52:53], v[90:91] op_sel:[1,1,0] op_sel_hi:[0,1,1] neg_lo:[1,0,0]
    v_pk_fma_f32 v[92:93], v[242:243], v[56:57], v[92:93] op_sel:[1,1,0] op_sel_hi:[0,1,1] neg_lo:[1,0,0]
    v_pk_fma_f32 v[94:95], v[244:245], v[60:61], v[94:95] op_sel:[1,1,0] op_sel_hi:[0,1,1] neg_lo:[1,0,0]
    v_pk_fma_f32 v[32:33], v[246:247], v[64:65], v[32:33] op_sel:[1,1,0] op_sel_hi:[0,1,1] neg_lo:[1,0,0]
    v_pk_fma_f32 v[34:35], v[248:249], v[68:69], v[34:35] op_sel:[1,1,0] op_sel_hi:[0,1,1] neg_lo:[1,0,0]
    v_pk_fma_f32 v[36:37], v[250:251], v[72:73], v[36:37] op_sel:[1,1,0] op_sel_hi:[0,1,1] neg_lo:[1,0,0]
    v_pk_fma_f32 v[38:39], v[252:253], v[76:77], v[38:39] op_sel:[1,1,0] op_sel_hi:[0,1,1] neg_lo:[1,0,0]
    v_pk_fma_f32 v[40:41], v[254:255], v[80:81], v[40:41] op_sel:[1,1,0] op_sel_hi:[0,1,1] neg_lo:[1,0,0]
    v_pk_fma_f32 v[42:43], v[88:89], v[84:85], v[42:43] op_sel:[1,1,0] op_sel_hi:[0,1,1] neg_lo:[1,0,0]
    v_pk_fma_f32 v[240:241], v[90:91], v[52:53], v[102:103] op_sel_hi:[1,0,1]
    v_pk_fma_f32 v[242:243], v[92:93], v[56:57], v[118:119] op_sel_hi:[1,0,1]
    v_pk_fma_f32 v[244:245], v[94:95], v[60:61], v[134:135] op_sel_hi:[1,0,1]
    v_pk_fma_f32 v[246:247], v[32:33], v[64:65], v[150:151] op_sel_hi:[1,0,1]
    v_pk_fma_f32 v[248:249], v[34:35], v[68:69], v[166:167] op_sel_hi:[1,0,1]
    v_pk_fma_f32 v[250:251], v[36:37], v[72:73], v[182:183] op_sel_hi:[1,0,1]
    v_pk_fma_f32 v[252:253], v[38:39], v[76:77], v[198:199] op_sel_hi:[1,0,1]
    v_pk_fma_f32 v[254:255], v[40:41], v[80:81], v[214:215] op_sel_hi:[1,0,1]
    v_pk_fma_f32 v[88:89], v[42:43], v[84:85], v[230:231] op_sel_hi:[1,0,1]
    v_pk_fma_f32 v[240:241], v[90:91], v[52:53], v[240:241] op_sel:[1,1,0] op_sel_hi:[0,1,1] neg_lo:[1,0,0]
    v_pk_fma_f32 v[242:243], v[92:93], v[56:57], v[242:243] op_sel:[1,1,0] op_sel_hi:[0,1,1] neg_lo:[1,0,0]
    v_pk_fma_f32 v[244:245], v[94:95], v[60:61], v[244:245] op_sel:[1,1,0] op_sel_hi:[0,1,1] neg_lo:[1,0,0]
    v_pk_fma_f32 v[246:247], v[32:33], v[64:65], v[246:247] op_sel:[1,1,0] op_sel_hi:[0,1,1] neg_lo:[1,0,0]
    v_pk_fma_f32 v[248:249], v[34:35], v[68:69], v[248:249] op_sel:[1,1,0] op_sel_hi:[0,1,1] neg_lo:[1,0,0]
    v_pk_fma_f32 v[250:251], v[36:37], v[72:73], v[250:251] op_sel:[1,1,0] op_sel_hi:[0,1,1] neg_lo:[1,0,0]
    v_pk_fma_f32 v[252:253], v[38:39], v[76:77], v[252:253] op_sel:[1,1,0] op_sel_hi:[0,1,1] neg_lo:[1,0,0]
    v_pk_fma_f32 v[254:255], v[40:41], v[80:81], v[254:255] op_sel:[1,1,0] op_sel_hi:[0,1,1] neg_lo:[1,0,0]
    v_pk_fma_f32 v[88:89], v[42:43], v[84:85], v[88:89] op_sel:[1,1,0] op_sel_hi:[0,1,1] neg_lo:[1,0,0]
    v_pk_fma_f32 v[90:91], v[240:241], v[52:53], v[104:105] op_sel_hi:[1,0,1]
    v_pk_fma_f32 v[92:93], v[242:243], v[56:57], v[120:121] op_sel_hi:[1,0,1]
    v_pk_fma_f32 v[94:95], v[244:245], v[60:61], v[136:137] op_sel_hi:[1,0,1]
    v_pk_fma_f32 v[32:33], v[246:247], v[64:65], v[152:153] op_sel_hi:[1,0,1]
    v_pk_fma_f32 v[34:35], v[248:249], v[68:69], v[168:169] op_sel_hi:[1,0,1]
    v_pk_fma_f32 v[36:37], v[250:251], v[72:73], v[184:185] op_sel_hi:[1,0,1]
    v_pk_fma_f32 v[38:39], v[252:253], v[76:77], v[200:201] op_sel_hi:[1,0,1]
    v_pk_fma_f32 v[40:41], v[254:255], v[80:81], v[216:217] op_sel_hi:[1,0,1]
L_ps1:
    s_cbranch_execz L_rs1
    v_pk_fma_f32 v[42:43], v[88:89], v[84:85], v[232:233] op_sel_hi:[1,0,1]
    v_pk_fma_f32 v[90:91], v[240:241], v[52:53], v[90:91] op_sel:[1,1,0] op_sel_hi:[0,1,1] neg_lo:[1,0,0]
    v_pk_fma_f32 v[92:93], v[242:243], v[56:57], v[92:93] op_sel:[1,1,0] op_sel_hi:[0,1,1] neg_lo:[1,0,0]
    v_pk_fma_f32 v[94:95], v[244:245], v[60:61], v[94:95] op_sel:[1,1,0] op_sel_hi:[0,1,1] neg_lo:[1,0,0]
    v_pk_fma_f32 v[32:33], v[246:247], v[64:65], v[32:33] op_sel:[1,1,0] op_sel_hi:[0,1,1] neg_lo:[1,0,0]
    v_pk_fma_f32 v[34:35], v[248:249], v[68:69], v[34:35] op_sel:[1,1,0] op_sel_hi:[0,1,1] neg_lo:[1,0,0]
    v_pk_fma_f32 v[36:37], v[250:251], v[72:73], v[36:37] op_sel:[1,1,0] op_sel_hi:[0,1,1] neg_lo:[1,0,0]
    v_pk_fma_f32 v[38:39], v[252:253], v[76:77], v[38:39] op_sel:[1,1,0] op_sel_hi:[0,1,1] neg_lo:[1,0,0]
    v_pk_fma_f32 v[40:41], v[254:255], v[80:81], v[40:41] op_sel:[1,1,0] op_sel_hi:[0,1,1] neg_lo:[1,0,0]
    v_pk_fma_f32 v[42:43], v[88:89], v[84:85], v[42:43] op_sel:[1,1,0] op_sel_hi:[0,1,1] neg_lo:[1,0,0]
    v_pk_fma_f32 v[240:241], v[90:91], v[52:53], v[106:107] op_sel_hi:[1,0,1]
    v_pk_fma_f32 v[242:243], v[92:93], v[56:57], v[122:123] op_sel_hi:[1,0,1]
    v_pk_fma_f32 v[244:245], v[94:95], v[60:61], v[138:139] op_sel_hi:[1,0,1]
    v_pk_fma_f32 v[246:247], v[32:33], v[64:65], v[154:155] op_sel_hi:[1,0,1]
    v_pk_fma_f32 v[248:249], v[34:35], v[68:69], v[170:171] op_sel_hi:[1,0,1]
    v_pk_fma_f32 v[250:251], v[36:37], v[72:73], v[186:187] op_sel_hi:[1,0,1]
    v_pk_fma_f32 v[252:253], v[38:39], v[76:77], v[202:203] op_sel_hi:[1,0,1]
    v_pk_fma_f32 v[254:255], v[40:41], v[80:81], v[218:219] op_sel_hi:[1,0,1]
    v_pk_fma_f32 v[88:89], v[42:43], v[84:85], v[234:235] op_sel_hi:[1,0,1]
    v_pk_fma_f32 v[240:241], v[90:91], v[52:53], v[240:241] op_sel:[1,1,0] op_sel_hi:[0,1,1] neg_lo:[1,0,0]
    v_pk_fma_f32 v[242:243], v[92:93], v[56:57], v[242:243] op_sel:[1,1,0] op_sel_hi:[0,1,1] neg_lo:[1,0,0]
    v_pk_fma_f32 v[244:245], v[94:95], v[60:61], v[244:245] op_sel:[1,1,0] op_sel_hi:[0,1,1] neg_lo:[1,0,0]
    v_pk_fma_f32 v[246:247], v[32:33], v[64:65], v[246:247] op_sel:[1,1,0] op_sel_hi:[0,1,1] neg_lo:[1,0,0]
    v_pk_fma_f32 v[248:249], v[34:35], v[68:69], v[248:249] op_sel:[1,1,0] op_sel_hi:[0,1,1] neg_lo:[1,0,0]
    v_pk_fma_f32 v[250:251], v[36:37], v[72:73], v[250:251] op_sel:[1,1,0] op_sel_hi:[0,1,1] neg_lo:[1,0,0]
    v_pk_fma_f32 v[252:253], v[38:39], v[76:77], v[252:253] op_sel:[1,1,0] op_sel_hi:[0,1,1] neg_lo:[1,0,0]
    v_pk_fma_f32 v[254:255], v[40:41], v[80:81], v[254:255] op_sel:[1,1,0] op_sel_hi:[0,1,1] neg_lo:[1,0,0]
    v_pk_fma_f32 v[88:89], v[42:43], v[84:85], v[88:89] op_sel:[1,1,0] op_sel_hi:[0,1,1] neg_lo:[1,0,0]
    v_pk_fma_f32 v[90:91], v[240:241], v[52:53], v[108:109] op_sel_hi:[1,0,1]
    v_pk_fma_f32 v[92:93], v[242:243], v[56:57], v[124:125] op_sel_hi:[1,0,1]
    v_pk_fma_f32 v[94:95], v[244:245], v[60:61], v[140:141] op_sel_hi:[1,0,1]
    v_pk_fma_f32 v[32:33], v[246:247], v[64:65], v[156:157] op_sel_hi:[1,0,1]
    v_pk_fma_f32 v[34:35], v[248:249], v[68:69], v[172:173] op_sel_hi:[1,0,1]
    v_pk_fma_f32 v[36:37], v[250:251], v[72:73], v[188:189] op_sel_hi:[1,0,1]
    v_pk_fma_f32 v[38:39], v[252:253], v[76:77], v[204:205] op_sel_hi:[1,0,1]
    v_pk_fma_f32 v[40:41], v[254:255], v[80:81], v[220:221] op_sel_hi:[1,0,1]
    v_pk_fma_f32 v[42:43], v[88:89], v[84:85], v[236:237] op_sel_hi:[1,0,1]
    v_pk_fma_f32 v[90:91], v[240:241], v[52:53], v[90:91] op_sel:[1,1,0] op_sel_hi:[0,1,1] neg_lo:[1,0,0]
    v_pk_fma_f32 v[92:93], v[242:243], v[56:57], v[92:93] op_sel:[1,1,0] op_sel_hi:[0,1,1] neg_lo:[1,0,0]
    v_pk_fma_f32 v[94:95], v[244:245], v[60:61], v[94:95] op_sel:[1,1,0] op_sel_hi:[0,1,1] neg_lo:[1,0,0]
    v_pk_fma_f32 v[32:33], v[246:247], v[64:65], v[32:33] op_sel:[1,1,0] op_sel_hi:[0,1,1] neg_lo:[1,0,0]
    v_pk_fma_f32 v[34:35], v[248:249], v[68:69], v[34:35] op_sel:[1,1,0] op_sel_hi:[0,1,1] neg_lo:[1,0,0]
    v_pk_fma_f32 v[36:37], v[250:251], v[72:73], v[36:37] op_sel:[1,1,0] op_sel_hi:[0,1,1] neg_lo:[1,0,0]
    v_pk_fma_f32 v[38:39], v[252:253], v[76:77], v[38:39] op_sel:[1,1,0] op_sel_hi:[0,1,1] neg_lo:[1,0,0]
    v_pk_fma_f32 v[40:41], v[254:255], v[80:81], v[40:41] op_sel:[1,1,0] op_sel_hi:[0,1,1] neg_lo:[1,0,0]
    v_pk_fma_f32 v[42:43], v[88:89], v[84:85], v[42:43] op_sel:[1,1,0] op_sel_hi:[0,1,1] neg_lo:[1,0,0]
    v_pk_fma_f32 v[240:241], v[90:91], v[52:53], v[110:111] op_sel_hi:[1,0,1]
    v_pk_fma_f32 v[242:243], v[92:93], v[56:57], v[126:127] op_sel_hi:[1,0,1]
    v_pk_fma_f32 v[244:245], v[94:95], v[60:61], v[142:143] op_sel_hi:[1,0,1]
    v_pk_fma_f32 v[246:247], v[32:33], v[64:65], v[158:159] op_sel_hi:[1,0,1]
    v_pk_fma_f32 v[248:249], v[34:35], v[68:69], v[174:175] op_sel_hi:[1,0,1]
    v_pk_fma_f32 v[250:251], v[36:37], v[72:73], v[190:191] op_sel_hi:[1,0,1]
    v_pk_fma_f32 v[252:253], v[38:39], v[76:77], v[206:207] op_sel_hi:[1,0,1]
    v_pk_fma_f32 v[254:255], v[40:41], v[80:81], v[222:223] op_sel_hi:[1,0,1]
    v_pk_fma_f32 v[88:89], v[42:43], v[84:85], v[238:239] op_sel_hi:[1,0,1]
    v_pk_fma_f32 v[240:241], v[90:91], v[52:53], v[240:241] op_sel:[1,1,0] op_sel_hi:[0,1,1] neg_lo:[1,0,0]
    v_pk_fma_f32 v[242:243], v[92:93], v[56:57], v[242:243] op_sel:[1,1,0] op_sel_hi:[0,1,1] neg_lo:[1,0,0]
    v_pk_fma_f32 v[244:245], v[94:95], v[60:61], v[244:245] op_sel:[1,1,0] op_sel_hi:[0,1,1] neg_lo:[1,0,0]
    v_pk_fma_f32 v[246:247], v[32:33], v[64:65], v[246:247] op_sel:[1,1,0] op_sel_hi:[0,1,1] neg_lo:[1,0,0]
    v_pk_fma_f32 v[248:249], v[34:35], v[68:69], v[248:249] op_sel:[1,1,0] op_sel_hi:[0,1,1] neg_lo:[1,0,0]
    v_pk_fma_f32 v[250:251], v[36:37], v[72:73], v[250:251] op_sel:[1,1,0] op_sel_hi:[0,1,1] neg_lo:[1,0,0]
    v_pk_fma_f32 v[252:253], v[38:39], v[76:77], v[252:253] op_sel:[1,1,0] op_sel_hi:[0,1,1] neg_lo:[1,0,0]
    v_pk_fma_f32 v[254:255], v[40:41], v[80:81], v[254:255] op_sel:[1,1,0] op_sel_hi:[0,1,1] neg_lo:[1,0,0]
    v_pk_fma_f32 v[88:89], v[42:43], v[84:85], v[88:89] op_sel:[1,1,0] op_sel_hi:[0,1,1] neg_lo:[1,0,0]
    ds_write_b64 v31, v[240:241] offset:0
    ds_write_b64 v31, v[242:243] offset:128
    ds_write_b64 v31, v[244:245] offset:256
    ds_write_b64 v31, v[246:247] offset:384
    ds_write_b64 v31, v[248:249] offset:512
    ds_write_b64 v31, v[250:251] offset:640
    ds_write_b64 v31, v[252:253] offset:768
    ds_write_b64 v31, v[254:255] offset:896
    ds_write_b64 v31, v[88:89] offset:1024
    s_waitcnt lgkmcnt(0)
    s_barrier
    s_cmp_eq_u32 s3, 3
    s_cbranch_scc1 L_ssm_s1
    ds_read_b64 v[240:241], v50 offset:0
    ds_read_b64 v[242:243], v50 offset:1152
    ds_read_b64 v[244:245], v50 offset:2304
    ds_read_b64 v[246:247], v50 offset:3456
    ds_read_b64 v[248:249], v50 offset:4608
    ds_read_b64 v[250:251], v50 offset:5760
    ds_read_b64 v[252:253], v50 offset:6912
    ds_read_b64 v[254:255], v50 offset:8064
    ds_read_b64 v[88:89], v50 offset:9216
    ds_read_b64 v[90:91], v50 offset:10368
    ds_read_b64 v[92:93], v50 offset:11520
    ds_read_b64 v[94:95], v50 offset:12672
    ds_read_b64 v[32:33], v50 offset:13824
    ds_read_b64 v[34:35], v50 offset:14976
    ds_read_b64 v[36:37], v50 offset:16128
    ds_read_b64 v[38:39], v50 offset:17280
    s_waitcnt lgkmcnt(14)
    v_pk_fma_f32 v[42:43], v[240:241], v[44:45], v[242:243] op_sel_hi:[1,0,1]
    v_pk_fma_f32 v[42:43], v[240:241], v[44:45], v[42:43] op_sel:[1,1,0] op_sel_hi:[0,1,1] neg_lo:[1,0,0]
    s_waitcnt lgkmcnt(13)
    v_pk_fma_f32 v[40:41], v[42:43], v[44:45], v[244:245] op_sel_hi:[1,0,1]
    v_pk_fma_f32 v[40:41], v[42:43], v[44:45], v[40:41] op_sel:[1,1,0] op_sel_hi:[0,1,1] neg_lo:[1,0,0]
    s_waitcnt lgkmcnt(12)
    v_pk_fma_f32 v[42:43], v[40:41], v[44:45], v[246:247] op_sel_hi:[1,0,1]
    v_pk_fma_f32 v[42:43], v[40:41], v[44:45], v[42:43] op_sel:[1,1,0] op_sel_hi:[0,1,1] neg_lo:[1,0,0]
    s_waitcnt lgkmcnt(11)
    v_pk_fma_f32 v[40:41], v[42:43], v[44:45], v[248:249] op_sel_hi:[1,0,1]
    v_pk_fma_f32 v[40:41], v[42:43], v[44:45], v[40:41] op_sel:[1,1,0] op_sel_hi:[0,1,1] neg_lo:[1,0,0]
    s_waitcnt lgkmcnt(10)
    v_pk_fma_f32 v[42:43], v[40:41], v[44:45], v[250:251] op_sel_hi:[1,0,1]
    v_pk_fma_f32 v[42:43], v[40:41], v[44:45], v[42:43] op_sel:[1,1,0] op_sel_hi:[0,1,1] neg_lo:[1,0,0]
    s_waitcnt lgkmcnt(9)
    v_pk_fma_f32 v[40:41], v[42:43], v[44:45], v[252:253] op_sel_hi:[1,0,1]
    v_pk_fma_f32 v[40:41], v[42:43], v[44:45], v[40:41] op_sel:[1,1,0] op_sel_hi:[0,1,1] neg_lo:[1,0,0]
    s_waitcnt lgkmcnt(8)
    v_pk_fma_f32 v[42:43], v[40:41], v[44:45], v[254:255] op_sel_hi:[1,0,1]
    v_pk_fma_f32 v[42:43], v[40:41], v[44:45], v[42:43] op_sel:[1,1,0] op_sel_hi:[0,1,1] neg_lo:[1,0,0]
    s_waitcnt lgkmcnt(7)
    v_pk_fma_f32 v[40:41], v[42:43], v[44:45], v[88:89] op_sel_hi:[1,0,1]
    v_pk_fma_f32 v[40:41], v[42:43], v[44:45], v[40:41] op_sel:[1,1,0] op_sel_hi:[0,1,1] neg_lo:[1,0,0]
    s_waitcnt lgkmcnt(6)
    v_pk_fma_f32 v[42:43], v[40:41], v[44:45], v[90:91] op_sel_hi:[1,0,1]
    v_pk_fma_f32 v[42:43], v[40:41], v[44:45], v[42:43] op_sel:[1,1,0] op_sel_hi:[0,1,1] neg_lo:[1,0,0]
    s_waitcnt lgkmcnt(5)
    v_pk_fma_f32 v[40:41], v[42:43], v[44:45], v[92:93] op_sel_hi:[1,0,1]
    v_pk_fma_f32 v[40:41], v[42:43], v[44:45], v[40:41] op_sel:[1,1,0] op_sel_hi:[0,1,1] neg_lo:[1,0,0]
    s_waitcnt lgkmcnt(4)
    v_pk_fma_f32 v[42:43], v[40:41], v[44:45], v[94:95] op_sel_hi:[1,0,1]
    v_pk_fma_f32 v[42:43], v[40:41], v[44:45], v[42:43] op_sel:[1,1,0] op_sel_hi:[0,1,1] neg_lo:[1,0,0]
    s_waitcnt lgkmcnt(3)
    v_pk_fma_f32 v[40:41], v[42:43], v[44:45], v[32:33] op_sel_hi:[1,0,1]
    v_pk_fma_f32 v[40:41], v[42:43], v[44:45], v[40:41] op_sel:[1,1,0] op_sel_hi:[0,1,1] neg_lo:[1,0,0]
    s_waitcnt lgkmcnt(2)
    v_pk_fma_f32 v[42:43], v[40:41], v[44:45], v[34:35] op_sel_hi:[1,0,1]
    v_pk_fma_f32 v[42:43], v[40:41], v[44:45], v[42:43] op_sel:[1,1,0] op_sel_hi:[0,1,1] neg_lo:[1,0,0]
    s_waitcnt lgkmcnt(1)
    v_pk_fma_f32 v[40:41], v[42:43], v[44:45], v[36:37] op_sel_hi:[1,0,1]
    v_pk_fma_f32 v[40:41], v[42:43], v[44:45], v[40:41] op_sel:[1,1,0] op_sel_hi:[0,1,1] neg_lo:[1,0,0]
    s_waitcnt lgkmcnt(0)
    v_pk_fma_f32 v[42:43], v[40:41], v[44:45], v[38:39] op_sel_hi:[1,0,1]
    v_pk_fma_f32 v[42:43], v[40:41], v[44:45], v[42:43] op_sel:[1,1,0] op_sel_hi:[0,1,1] neg_lo:[1,0,0]
    v_min_u32 v42, -2, v42
    v_min_u32 v43, -2, v43
    buffer_store_dwordx2 v[42:43], v50, s[64:67], s36 offen sc1
L_ssm_s1:
    v_pk_mul_f32 v[14:15], v[96:97], v[54:55] op_sel:[1,1] op_sel_hi:[0,1] neg_lo:[1,0]
    v_pk_mul_f32 v[16:17], v[98:99], v[54:55] op_sel:[1,1] op_sel_hi:[0,1] neg_lo:[1,0]
    v_pk_mul_f32 v[18:19], v[100:101], v[54:55] op_sel:[1,1] op_sel_hi:[0,1] neg_lo:[1,0]
    v_pk_mul_f32 v[20:21], v[102:103], v[54:55] op_sel:[1,1] op_sel_hi:[0,1] neg_lo:[1,0]
    v_pk_fma_f32 v[96:97], v[96:97], v[54:55], v[14:15] op_sel_hi:[1,0,1]
    v_pk_fma_f32 v[98:99], v[98:99], v[54:55], v[16:17] op_sel_hi:[1,0,1]
    v_pk_fma_f32 v[100:101], v[100:101], v[54:55], v[18:19] op_sel_hi:[1,0,1]
    v_pk_fma_f32 v[102:103], v[102:103], v[54:55], v[20:21] op_sel_hi:[1,0,1]
    v_pk_mul_f32 v[14:15], v[104:105], v[54:55] op_sel:[1,1] op_sel_hi:[0,1] neg_lo:[1,0]
    v_pk_mul_f32 v[16:17], v[106:107], v[54:55] op_sel:[1,1] op_sel_hi:[0,1] neg_lo:[1,0]
    v_pk_mul_f32 v[18:19], v[108:109], v[54:55] op_sel:[1,1] op_sel_hi:[0,1] neg_lo:[1,0]
    v_pk_mul_f32 v[20:21], v[110:111], v[54:55] op_sel:[1,1] op_sel_hi:[0,1] neg_lo:[1,0]
    v_pk_fma_f32 v[104:105], v[104:105], v[54:55], v[14:15] op_sel_hi:[1,0,1]
    v_pk_fma_f32 v[106:107], v[106:107], v[54:55], v[16:17] op_sel_hi:[1,0,1]
    v_pk_fma_f32 v[108:109], v[108:109], v[54:55], v[18:19] op_sel_hi:[1,0,1]
    v_pk_fma_f32 v[110:111], v[110:111], v[54:55], v[20:21] op_sel_hi:[1,0,1]
    v_pk_mul_f32 v[14:15], v[112:113], v[58:59] op_sel:[1,1] op_sel_hi:[0,1] neg_lo:[1,0]
    v_pk_mul_f32 v[16:17], v[114:115], v[58:59] op_sel:[1,1] op_sel_hi:[0,1] neg_lo:[1,0]
    v_pk_mul_f32 v[18:19], v[116:117], v[58:59] op_sel:[1,1] op_sel_hi:[0,1] neg_lo:[1,0]
    v_pk_mul_f32 v[20:21], v[118:119], v[58:59] op_sel:[1,1] op_sel_hi:[0,1] neg_lo:[1,0]
    v_pk_fma_f32 v[112:113], v[112:113], v[58:59], v[14:15] op_sel_hi:[1,0,1]
    v_pk_fma_f32 v[114:115], v[114:115], v[58:59], v[16:17] op_sel_hi:[1,0,1]
    v_pk_fma_f32 v[116:117], v[116:117], v[58:59], v[18:19] op_sel_hi:[1,0,1]
    v_pk_fma_f32 v[118:119], v[118:119], v[58:59], v[20:21] op_sel_hi:[1,0,1]
    v_pk_mul_f32 v[14:15], v[120:121], v[58:59] op_sel:[1,1] op_sel_hi:[0,1] neg_lo:[1,0]
    v_pk_mul_f32 v[16:17], v[122:123], v[58:59] op_sel:[1,1] op_sel_hi:[0,1] neg_lo:[1,0]
    v_pk_mul_f32 v[18:19], v[124:125], v[58:59] op_sel:[1,1] op_sel_hi:[0,1] neg_lo:[1,0]
    v_pk_mul_f32 v[20:21], v[126:127], v[58:59] op_sel:[1,1] op_sel_hi:[0,1] neg_lo:[1,0]
    v_pk_fma_f32 v[120:121], v[120:121], v[58:59], v[14:15] op_sel_hi:[1,0,1]
    v_pk_fma_f32 v[122:123], v[122:123], v[58:59], v[16:17] op_sel_hi:[1,0,1]
    v_pk_fma_f32 v[124:125], v[124:125], v[58:59], v[18:19] op_sel_hi:[1,0,1]
    v_pk_fma_f32 v[126:127], v[126:127], v[58:59], v[20:21] op_sel_hi:[1,0,1]
    v_pk_mul_f32 v[14:15], v[128:129], v[62:63] op_sel:[1,1] op_sel_hi:[0,1] neg_lo:[1,0]
    v_pk_mul_f32 v[16:17], v[130:131], v[62:63] op_sel:[1,1] op_sel_hi:[0,1] neg_lo:[1,0]
    v_pk_mul_f32 v[18:19], v[132:133], v[62:63] op_sel:[1,1] op_sel_hi:[0,1] neg_lo:[1,0]
    v_pk_mul_f32 v[20:21], v[134:135], v[62:63] op_sel:[1,1] op_sel_hi:[0,1] neg_lo:[1,0]
    v_pk_fma_f32 v[128:129], v[128:129], v[62:63], v[14:15] op_sel_hi:[1,0,1]
    v_pk_fma_f32 v[130:131], v[130:131], v[62:63], v[16:17] op_sel_hi:[1,0,1]
    v_pk_fma_f32 v[132:133], v[132:133], v[62:63], v[18:19] op_sel_hi:[1,0,1]
    v_pk_fma_f32 v[134:135], v[134:135], v[62:63], v[20:21] op_sel_hi:[1,0,1]
    v_pk_mul_f32 v[14:15], v[136:137], v[62:63] op_sel:[1,1] op_sel_hi:[0,1] neg_lo:[1,0]
    v_pk_mul_f32 v[16:17], v[138:139], v[62:63] op_sel:[1,1] op_sel_hi:[0,1] neg_lo:[1,0]
    v_pk_mul_f32 v[18:19], v[140:141], v[62:63] op_sel:[1,1] op_sel_hi:[0,1] neg_lo:[1,0]
    v_pk_mul_f32 v[20:21], v[142:143], v[62:63] op_sel:[1,1] op_sel_hi:[0,1] neg_lo:[1,0]
    v_pk_fma_f32 v[136:137], v[136:137], v[62:63], v[14:15] op_sel_hi:[1,0,1]
    v_pk_fma_f32 v[138:139], v[138:139], v[62:63], v[16:17] op_sel_hi:[1,0,1]
    v_pk_fma_f32 v[140:141], v[140:141], v[62:63], v[18:19] op_sel_hi:[1,0,1]
    v_pk_fma_f32 v[142:143], v[142:143], v[62:63], v[20:21] op_sel_hi:[1,0,1]
    v_pk_mul_f32 v[14:15], v[144:145], v[66:67] op_sel:[1,1] op_sel_hi:[0,1] neg_lo:[1,0]
    v_pk_mul_f32 v[16:17], v[146:147], v[66:67] op_sel:[1,1] op_sel_hi:[0,1] neg_lo:[1,0]
    v_pk_mul_f32 v[18:19], v[148:149], v[66:67] op_sel:[1,1] op_sel_hi:[0,1] neg_lo:[1,0]
    v_pk_mul_f32 v[20:21], v[150:151], v[66:67] op_sel:[1,1] op_sel_hi:[0,1] neg_lo:[1,0]
    v_pk_fma_f32 v[144:145], v[144:145], v[66:67], v[14:15] op_sel_hi:[1,0,1]
    v_pk_fma_f32 v[146:147], v[146:147], v[66:67], v[16:17] op_sel_hi:[1,0,1]
    v_pk_fma_f32 v[148:149], v[148:149], v[66:67], v[18:19] op_sel_hi:[1,0,1]
    v_pk_fma_f32 v[150:151], v[150:151], v[66:67], v[20:21] op_sel_hi:[1,0,1]
    v_pk_mul_f32 v[14:15], v[152:153], v[66:67] op_sel:[1,1] op_sel_hi:[0,1] neg_lo:[1,0]
    v_pk_mul_f32 v[16:17], v[154:155], v[66:67] op_sel:[1,1] op_sel_hi:[0,1] neg_lo:[1,0]
    v_pk_mul_f32 v[18:19], v[156:157], v[66:67] op_sel:[1,1] op_sel_hi:[0,1] neg_lo:[1,0]
    v_pk_mul_f32 v[20:21], v[158:159], v[66:67] op_sel:[1,1] op_sel_hi:[0,1] neg_lo:[1,0]
    v_pk_fma_f32 v[152:153], v[152:153], v[66:67], v[14:15] op_sel_hi:[1,0,1]
    v_pk_fma_f32 v[154:155], v[154:155], v[66:67], v[16:17] op_sel_hi:[1,0,1]
    v_pk_fma_f32 v[156:157], v[156:157], v[66:67], v[18:19] op_sel_hi:[1,0,1]
    v_pk_fma_f32 v[158:159], v[158:159], v[66:67], v[20:21] op_sel_hi:[1,0,1]
    v_pk_mul_f32 v[14:15], v[160:161], v[70:71] op_sel:[1,1] op_sel_hi:[0,1] neg_lo:[1,0]
    v_pk_mul_f32 v[16:17], v[162:163], v[70:71] op_sel:[1,1] op_sel_hi:[0,1] neg_lo:[1,0]
    v_pk_mul_f32 v[18:19], v[164:165], v[70:71] op_sel:[1,1] op_sel_hi:[0,1] neg_lo:[1,0]
    v_pk_mul_f32 v[20:21], v[166:167], v[70:71] op_sel:[1,1] op_sel_hi:[0,1] neg_lo:[1,0]
    v_pk_fma_f32 v[160:161], v[160:161], v[70:71], v[14:15] op_sel_hi:[1,0,1]
    v_pk_fma_f32 v[162:163], v[162:163], v[70:71], v[16:17] op_sel_hi:[1,0,1]
    v_pk_fma_f32 v[164:165], v[164:165], v[70:71], v[18:19] op_sel_hi:[1,0,1]
    v_pk_fma_f32 v[166:167], v[166:167], v[70:71], v[20:21] op_sel_hi:[1,0,1]
    v_pk_mul_f32 v[14:15], v[168:169], v[70:71] op_sel:[1,1] op_sel_hi:[0,1] neg_lo:[1,0]
    v_pk_mul_f32 v[16:17], v[170:171], v[70:71] op_sel:[1,1] op_sel_hi:[0,1] neg_lo:[1,0]
    v_pk_mul_f32 v[18:19], v[172:173], v[70:71] op_sel:[1,1] op_sel_hi:[0,1] neg_lo:[1,0]
    v_pk_mul_f32 v[20:21], v[174:175], v[70:71] op_sel:[1,1] op_sel_hi:[0,1] neg_lo:[1,0]
    v_pk_fma_f32 v[168:169], v[168:169], v[70:71], v[14:15] op_sel_hi:[1,0,1]
    v_pk_fma_f32 v[170:171], v[170:171], v[70:71], v[16:17] op_sel_hi:[1,0,1]
    v_pk_fma_f32 v[172:173], v[172:173], v[70:71], v[18:19] op_sel_hi:[1,0,1]
    v_pk_fma_f32 v[174:175], v[174:175], v[70:71], v[20:21] op_sel_hi:[1,0,1]
    v_pk_mul_f32 v[14:15], v[176:177], v[74:75] op_sel:[1,1] op_sel_hi:[0,1] neg_lo:[1,0]
    v_pk_mul_f32 v[16:17], v[178:179], v[74:75] op_sel:[1,1] op_sel_hi:[0,1] neg_lo:[1,0]
    v_pk_mul_f32 v[18:19], v[180:181], v[74:75] op_sel:[1,1] op_sel_hi:[0,1] neg_lo:[1,0]
    v_pk_mul_f32 v[20:21], v[182:183], v[74:75] op_sel:[1,1] op_sel_hi:[0,1] neg_lo:[1,0]
    v_pk_fma_f32 v[176:177], v[176:177], v[74:75], v[14:15] op_sel_hi:[1,0,1]
    v_pk_fma_f32 v[178:179], v[178:179], v[74:75], v[16:17] op_sel_hi:[1,0,1]
    v_pk_fma_f32 v[180:181], v[180:181], v[74:75], v[18:19] op_sel_hi:[1,0,1]
    v_pk_fma_f32 v[182:183], v[182:183], v[74:75], v[20:21] op_sel_hi:[1,0,1]
    v_pk_mul_f32 v[14:15], v[184:185], v[74:75] op_sel:[1,1] op_sel_hi:[0,1] neg_lo:[1,0]
    v_pk_mul_f32 v[16:17], v[186:187], v[74:75] op_sel:[1,1] op_sel_hi:[0,1] neg_lo:[1,0]
    v_pk_mul_f32 v[18:19], v[188:189], v[74:75] op_sel:[1,1] op_sel_hi:[0,1] neg_lo:[1,0]
    v_pk_mul_f32 v[20:21], v[190:191], v[74:75] op_sel:[1,1] op_sel_hi:[0,1] neg_lo:[1,0]
    v_pk_fma_f32 v[184:185], v[184:185], v[74:75], v[14:15] op_sel_hi:[1,0,1]
    v_pk_fma_f32 v[186:187], v[186:187], v[74:75], v[16:17] op_sel_hi:[1,0,1]
    v_pk_fma_f32 v[188:189], v[188:189], v[74:75], v[18:19] op_sel_hi:[1,0,1]
    v_pk_fma_f32 v[190:191], v[190:191], v[74:75], v[20:21] op_sel_hi:[1,0,1]
    v_pk_mul_f32 v[14:15], v[192:193], v[78:79] op_sel:[1,1] op_sel_hi:[0,1] neg_lo:[1,0]
    v_pk_mul_f32 v[16:17], v[194:195], v[78:79] op_sel:[1,1] op_sel_hi:[0,1] neg_lo:[1,0]
    v_pk_mul_f32 v[18:19], v[196:197], v[78:79] op_sel:[1,1] op_sel_hi:[0,1] neg_lo:[1,0]
    v_pk_mul_f32 v[20:21], v[198:199], v[78:79] op_sel:[1,1] op_sel_hi:[0,1] neg_lo:[1,0]
    v_pk_fma_f32 v[192:193], v[192:193], v[78:79], v[14:15] op_sel_hi:[1,0,1]
    v_pk_fma_f32 v[194:195], v[194:195], v[78:79], v[16:17] op_sel_hi:[1,0,1]
    v_pk_fma_f32 v[196:197], v[196:197], v[78:79], v[18:19] op_sel_hi:[1,0,1]
    v_pk_fma_f32 v[198:199], v[198:199], v[78:79], v[20:21] op_sel_hi:[1,0,1]
    v_pk_mul_f32 v[14:15], v[200:201], v[78:79] op_sel:[1,1] op_sel_hi:[0,1] neg_lo:[1,0]
    v_pk_mul_f32 v[16:17], v[202:203], v[78:79] op_sel:[1,1] op_sel_hi:[0,1] neg_lo:[1,0]
    v_pk_mul_f32 v[18:19], v[204:205], v[78:79] op_sel:[1,1] op_sel_hi:[0,1] neg_lo:[1,0]
    v_pk_mul_f32 v[20:21], v[206:207], v[78:79] op_sel:[1,1] op_sel_hi:[0,1] neg_lo:[1,0]
    v_pk_fma_f32 v[200:201], v[200:201], v[78:79], v[14:15] op_sel_hi:[1,0,1]
    v_pk_fma_f32 v[202:203], v[202:203], v[78:79], v[16:17] op_sel_hi:[1,0,1]
    v_pk_fma_f32 v[204:205], v[204:205], v[78:79], v[18:19] op_sel_hi:[1,0,1]
    v_pk_fma_f32 v[206:207], v[206:207], v[78:79], v[20:21] op_sel_hi:[1,0,1]
    v_pk_mul_f32 v[14:15], v[208:209], v[82:83] op_sel:[1,1] op_sel_hi:[0,1] neg_lo:[1,0]
    v_pk_mul_f32 v[16:17], v[210:211], v[82:83] op_sel:[1,1] op_sel_hi:[0,1] neg_lo:[1,0]
    v_pk_mul_f32 v[18:19], v[212:213], v[82:83] op_sel:[1,1] op_sel_hi:[0,1] neg_lo:[1,0]
    v_pk_mul_f32 v[20:21], v[214:215], v[82:83] op_sel:[1,1] op_sel_hi:[0,1] neg_lo:[1,0]
    v_pk_fma_f32 v[208:209], v[208:209], v[82:83], v[14:15] op_sel_hi:[1,0,1]
    v_pk_fma_f32 v[210:211], v[210:211], v[82:83], v[16:17] op_sel_hi:[1,0,1]
    v_pk_fma_f32 v[212:213], v[212:213], v[82:83], v[18:19] op_sel_hi:[1,0,1]
    v_pk_fma_f32 v[214:215], v[214:215], v[82:83], v[20:21] op_sel_hi:[1,0,1]
    v_pk_mul_f32 v[14:15], v[216:217], v[82:83] op_sel:[1,1] op_sel_hi:[0,1] neg_lo:[1,0]
    v_pk_mul_f32 v[16:17], v[218:219], v[82:83] op_sel:[1,1] op_sel_hi:[0,1] neg_lo:[1,0]
    v_pk_mul_f32 v[18:19], v[220:221], v[82:83] op_sel:[1,1] op_sel_hi:[0,1] neg_lo:[1,0]
    v_pk_mul_f32 v[20:21], v[222:223], v[82:83] op_sel:[1,1] op_sel_hi:[0,1] neg_lo:[1,0]
    v_pk_fma_f32 v[216:217], v[216:217], v[82:83], v[14:15] op_sel_hi:[1,0,1]
    v_pk_fma_f32 v[218:219], v[218:219], v[82:83], v[16:17] op_sel_hi:[1,0,1]
    v_pk_fma_f32 v[220:221], v[220:221], v[82:83], v[18:19] op_sel_hi:[1,0,1]
    v_pk_fma_f32 v[222:223], v[222:223], v[82:83], v[20:21] op_sel_hi:[1,0,1]
    v_pk_mul_f32 v[14:15], v[224:225], v[86:87] op_sel:[1,1] op_sel_hi:[0,1] neg_lo:[1,0]
    v_pk_mul_f32 v[16:17], v[226:227], v[86:87] op_sel:[1,1] op_sel_hi:[0,1] neg_lo:[1,0]
    v_pk_mul_f32 v[18:19], v[228:229], v[86:87] op_sel:[1,1] op_sel_hi:[0,1] neg_lo:[1,0]
    v_pk_mul_f32 v[20:21], v[230:231], v[86:87] op_sel:[1,1] op_sel_hi:[0,1] neg_lo:[1,0]
    v_pk_fma_f32 v[224:225], v[224:225], v[86:87], v[14:15] op_sel_hi:[1,0,1]
    v_pk_fma_f32 v[226:227], v[226:227], v[86:87], v[16:17] op_sel_hi:[1,0,1]
    v_pk_fma_f32 v[228:229], v[228:229], v[86:87], v[18:19] op_sel_hi:[1,0,1]
    v_pk_fma_f32 v[230:231], v[230:231], v[86:87], v[20:21] op_sel_hi:[1,0,1]
    v_pk_mul_f32 v[14:15], v[232:233], v[86:87] op_sel:[1,1] op_sel_hi:[0,1] neg_lo:[1,0]
    v_pk_mul_f32 v[16:17], v[234:235], v[86:87] op_sel:[1,1] op_sel_hi:[0,1] neg_lo:[1,0]
    v_pk_mul_f32 v[18:19], v[236:237], v[86:87] op_sel:[1,1] op_sel_hi:[0,1] neg_lo:[1,0]
    v_pk_mul_f32 v[20:21], v[238:239], v[86:87] op_sel:[1,1] op_sel_hi:[0,1] neg_lo:[1,0]
    v_pk_fma_f32 v[232:233], v[232:233], v[86:87], v[14:15] op_sel_hi:[1,0,1]
    v_pk_fma_f32 v[234:235], v[234:235], v[86:87], v[16:17] op_sel_hi:[1,0,1]
    v_pk_fma_f32 v[236:237], v[236:237], v[86:87], v[18:19] op_sel_hi:[1,0,1]
    v_pk_fma_f32 v[238:239], v[238:239], v[86:87], v[20:21] op_sel_hi:[1,0,1]
    s_sub_u32 s14, s36, 30720
    s_cmp_eq_u32 s3, 3
    s_cbranch_scc1 L_ssm_s2
    v_add_u32 v1, s14, v50
    buffer_load_dwordx2 v[14:15], v1, s[64:67], 0 offen sc1
    v_add_u32 v1, 2048, v1
    buffer_load_dwordx2 v[16:17], v1, s[64:67], 0 offen sc1
    v_add_u32 v1, 2048, v1
    buffer_load_dwordx2 v[18:19], v1, s[64:67], 0 offen sc1
    v_add_u32 v1, 2048, v1
    buffer_load_dwordx2 v[20:21], v1, s[64:67], 0 offen sc1
    v_add_u32 v1, 2048, v1
    buffer_load_dwordx2 v[10:11], v1, s[64:67], 0 offen sc1
    v_add_u32 v1, 2048, v1
    buffer_load_dwordx2 v[2:3], v1, s[64:67], 0 offen sc1
    v_add_u32 v1, 2048, v1
    buffer_load_dwordx2 v[54:55], v1, s[64:67], 0 offen sc1
    v_add_u32 v1, 2048, v1
    buffer_load_dwordx2 v[58:59], v1, s[64:67], 0 offen sc1
    v_add_u32 v1, 2048, v1
    buffer_load_dwordx2 v[62:63], v1, s[64:67], 0 offen sc1
    v_add_u32 v1, 2048, v1
    buffer_load_dwordx2 v[66:67], v1, s[64:67], 0 offen sc1
    v_add_u32 v1, 2048, v1
    buffer_load_dwordx2 v[70:71], v1, s[64:67], 0 offen sc1
    v_add_u32 v1, 2048, v1
    buffer_load_dwordx2 v[74:75], v1, s[64:67], 0 offen sc1
    v_add_u32 v1, 2048, v1
    buffer_load_dwordx2 v[78:79], v1, s[64:67], 0 offen sc1
    v_add_u32 v1, 2048, v1
    buffer_load_dwordx2 v[82:83], v1, s[64:67], 0 offen sc1
    v_add_u32 v1, 2048, v1
    buffer_load_dwordx2 v[86:87], v1, s[64:67], 0 offen sc1
    v_add_u32 v1, 2048, v1
    v_pk_mul_f32 v[40:41], v[240:241], v[48:49] op_sel:[1,1] op_sel_hi:[0,1] neg_lo:[1,0]
    v_pk_mul_f32 v[42:43], v[242:243], v[48:49] op_sel:[1,1] op_sel_hi:[0,1] neg_lo:[1,0]
    v_pk_fma_f32 v[240:241], v[240:241], v[48:49], v[40:41] op_sel_hi:[1,0,1]
    v_pk_fma_f32 v[242:243], v[242:243], v[48:49], v[42:43] op_sel_hi:[1,0,1]
    v_pk_mul_f32 v[40:41], v[244:245], v[48:49] op_sel:[1,1] op_sel_hi:[0,1] neg_lo:[1,0]
    v_pk_mul_f32 v[42:43], v[246:247], v[48:49] op_sel:[1,1] op_sel_hi:[0,1] neg_lo:[1,0]
    v_pk_fma_f32 v[244:245], v[244:245], v[48:49], v[40:41] op_sel_hi:[1,0,1]
    v_pk_fma_f32 v[246:247], v[246:247], v[48:49], v[42:43] op_sel_hi:[1,0,1]
    v_pk_mul_f32 v[40:41], v[248:249], v[48:49] op_sel:[1,1] op_sel_hi:[0,1] neg_lo:[1,0]
    v_pk_mul_f32 v[42:43], v[250:251], v[48:49] op_sel:[1,1] op_sel_hi:[0,1] neg_lo:[1,0]
    v_pk_fma_f32 v[248:249], v[248:249], v[48:49], v[40:41] op_sel_hi:[1,0,1]
    v_pk_fma_f32 v[250:251], v[250:251], v[48:49], v[42:43] op_sel_hi:[1,0,1]
    v_pk_mul_f32 v[40:41], v[252:253], v[48:49] op_sel:[1,1] op_sel_hi:[0,1] neg_lo:[1,0]
    v_pk_mul_f32 v[42:43], v[254:255], v[48:49] op_sel:[1,1] op_sel_hi:[0,1] neg_lo:[1,0]
    v_pk_fma_f32 v[252:253], v[252:253], v[48:49], v[40:41] op_sel_hi:[1,0,1]
    v_pk_fma_f32 v[254:255], v[254:255], v[48:49], v[42:43] op_sel_hi:[1,0,1]
    v_pk_mul_f32 v[40:41], v[88:89], v[48:49] op_sel:[1,1] op_sel_hi:[0,1] neg_lo:[1,0]
    v_pk_mul_f32 v[42:43], v[90:91], v[48:49] op_sel:[1,1] op_sel_hi:[0,1] neg_lo:[1,0]
    v_pk_fma_f32 v[88:89], v[88:89], v[48:49], v[40:41] op_sel_hi:[1,0,1]
    v_pk_fma_f32 v[90:91], v[90:91], v[48:49], v[42:43] op_sel_hi:[1,0,1]
    v_pk_mul_f32 v[40:41], v[92:93], v[48:49] op_sel:[1,1] op_sel_hi:[0,1] neg_lo:[1,0]
    v_pk_mul_f32 v[42:43], v[94:95], v[48:49] op_sel:[1,1] op_sel_hi:[0,1] neg_lo:[1,0]
    v_pk_fma_f32 v[92:93], v[92:93], v[48:49], v[40:41] op_sel_hi:[1,0,1]
    v_pk_fma_f32 v[94:95], v[94:95], v[48:49], v[42:43] op_sel_hi:[1,0,1]
    v_pk_mul_f32 v[40:41], v[32:33], v[48:49] op_sel:[1,1] op_sel_hi:[0,1] neg_lo:[1,0]
    v_pk_mul_f32 v[42:43], v[34:35], v[48:49] op_sel:[1,1] op_sel_hi:[0,1] neg_lo:[1,0]
    v_pk_fma_f32 v[32:33], v[32:33], v[48:49], v[40:41] op_sel_hi:[1,0,1]
    v_pk_fma_f32 v[34:35], v[34:35], v[48:49], v[42:43] op_sel_hi:[1,0,1]
    v_pk_mul_f32 v[40:41], v[36:37], v[48:49] op_sel:[1,1] op_sel_hi:[0,1] neg_lo:[1,0]
    v_pk_fma_f32 v[36:37], v[36:37], v[48:49], v[40:41] op_sel_hi:[1,0,1]
    s_branch L_ssm_p2
L_ssm_p1:
    v_add_u32 v1, s14, v50
    buffer_load_dwordx2 v[14:15], v1, s[64:67], 0 offen sc1
    v_add_u32 v1, 2048, v1
    buffer_load_dwordx2 v[16:17], v1, s[64:67], 0 offen sc1
    v_add_u32 v1, 2048, v1
    buffer_load_dwordx2 v[18:19], v1, s[64:67], 0 offen sc1
    v_add_u32 v1, 2048, v1
    buffer_load_dwordx2 v[20:21], v1, s[64:67], 0 offen sc1
    v_add_u32 v1, 2048, v1
    buffer_load_dwordx2 v[10:11], v1, s[64:67], 0 offen sc1
    v_add_u32 v1, 2048, v1
    buffer_load_dwordx2 v[2:3], v1, s[64:67], 0 offen sc1
    v_add_u32 v1, 2048, v1
    buffer_load_dwordx2 v[54:55], v1, s[64:67], 0 offen sc1
    v_add_u32 v1, 2048, v1
    buffer_load_dwordx2 v[58:59], v1, s[64:67], 0 offen sc1
    v_add_u32 v1, 2048, v1
    buffer_load_dwordx2 v[62:63], v1, s[64:67], 0 offen sc1
    v_add_u32 v1, 2048, v1
    buffer_load_dwordx2 v[66:67], v1, s[64:67], 0 offen sc1
    v_add_u32 v1, 2048, v1
    buffer_load_dwordx2 v[70:71], v1, s[64:67], 0 offen sc1
    v_add_u32 v1, 2048, v1
    buffer_load_dwordx2 v[74:75], v1, s[64:67], 0 offen sc1
    v_add_u32 v1, 2048, v1
    buffer_load_dwordx2 v[78:79], v1, s[64:67], 0 offen sc1
    v_add_u32 v1, 2048, v1
    buffer_load_dwordx2 v[82:83], v1, s[64:67], 0 offen sc1
    v_add_u32 v1, 2048, v1
    buffer_load_dwordx2 v[86:87], v1, s[64:67], 0 offen sc1
    v_add_u32 v1, 2048, v1
L_ssm_p2:
    s_waitcnt vmcnt(0)
    v_max_u32 v1, v14, v15
    v_max3_u32 v1, v1, v16, v17
    v_max3_u32 v1, v1, v18, v19
    v_max3_u32 v1, v1, v20, v21
    v_max3_u32 v1, v1, v10, v11
    v_max3_u32 v1, v1, v2, v3
    v_max3_u32 v1, v1, v54, v55
    v_max3_u32 v1, v1, v58, v59
    v_max3_u32 v1, v1, v62, v63
    v_max3_u32 v1, v1, v66, v67
    v_max3_u32 v1, v1, v70, v71
    v_max3_u32 v1, v1, v74, v75
    v_max3_u32 v1, v1, v78, v79
    v_max3_u32 v1, v1, v82, v83
    v_max3_u32 v1, v1, v86, v87
    v_cmp_eq_u32 vcc, -1, v1
    s_add_u32 s69, s69, 1
    s_cmp_lt_u32 s69, 0x800000
    s_cselect_b64 s[12:13], -1, 0
    s_and_b64 vcc, vcc, s[12:13]
    s_cbranch_scc1 L_ssm_p1
    v_pk_fma_f32 v[42:43], v[14:15], v[46:47], v[16:17] op_sel_hi:[1,0,1]
    v_pk_fma_f32 v[42:43], v[14:15], v[46:47], v[42:43] op_sel:[1,1,0] op_sel_hi:[0,1,1] neg_lo:[1,0,0]
    v_pk_fma_f32 v[40:41], v[42:43], v[46:47], v[18:19] op_sel_hi:[1,0,1]
    v_pk_fma_f32 v[40:41], v[42:43], v[46:47], v[40:41] op_sel:[1,1,0] op_sel_hi:[0,1,1] neg_lo:[1,0,0]
    v_pk_fma_f32 v[42:43], v[40:41], v[46:47], v[20:21] op_sel_hi:[1,0,1]
    v_pk_fma_f32 v[42:43], v[40:41], v[46:47], v[42:43] op_sel:[1,1,0] op_sel_hi:[0,1,1] neg_lo:[1,0,0]
    v_pk_fma_f32 v[40:41], v[42:43], v[46:47], v[10:11] op_sel_hi:[1,0,1]
    v_pk_fma_f32 v[40:41], v[42:43], v[46:47], v[40:41] op_sel:[1,1,0] op_sel_hi:[0,1,1] neg_lo:[1,0,0]
    v_pk_fma_f32 v[42:43], v[40:41], v[46:47], v[2:3] op_sel_hi:[1,0,1]
    v_pk_fma_f32 v[42:43], v[40:41], v[46:47], v[42:43] op_sel:[1,1,0] op_sel_hi:[0,1,1] neg_lo:[1,0,0]
    v_pk_fma_f32 v[40:41], v[42:43], v[46:47], v[54:55] op_sel_hi:[1,0,1]
    v_pk_fma_f32 v[40:41], v[42:43], v[46:47], v[40:41] op_sel:[1,1,0] op_sel_hi:[0,1,1] neg_lo:[1,0,0]
    v_pk_fma_f32 v[42:43], v[40:41], v[46:47], v[58:59] op_sel_hi:[1,0,1]
    v_pk_fma_f32 v[42:43], v[40:41], v[46:47], v[42:43] op_sel:[1,1,0] op_sel_hi:[0,1,1] neg_lo:[1,0,0]
    v_pk_fma_f32 v[40:41], v[42:43], v[46:47], v[62:63] op_sel_hi:[1,0,1]
    v_pk_fma_f32 v[40:41], v[42:43], v[46:47], v[40:41] op_sel:[1,1,0] op_sel_hi:[0,1,1] neg_lo:[1,0,0]
    v_pk_fma_f32 v[42:43], v[40:41], v[46:47], v[66:67] op_sel_hi:[1,0,1]
    v_pk_fma_f32 v[42:43], v[40:41], v[46:47], v[42:43] op_sel:[1,1,0] op_sel_hi:[0,1,1] neg_lo:[1,0,0]
    v_pk_fma_f32 v[40:41], v[42:43], v[46:47], v[70:71] op_sel_hi:[1,0,1]
    v_pk_fma_f32 v[40:41], v[42:43], v[46:47], v[40:41] op_sel:[1,1,0] op_sel_hi:[0,1,1] neg_lo:[1,0,0]
    v_pk_fma_f32 v[42:43], v[40:41], v[46:47], v[74:75] op_sel_hi:[1,0,1]
    v_pk_fma_f32 v[42:43], v[40:41], v[46:47], v[42:43] op_sel:[1,1,0] op_sel_hi:[0,1,1] neg_lo:[1,0,0]
    v_pk_fma_f32 v[40:41], v[42:43], v[46:47], v[78:79] op_sel_hi:[1,0,1]
    v_pk_fma_f32 v[40:41], v[42:43], v[46:47], v[40:41] op_sel:[1,1,0] op_sel_hi:[0,1,1] neg_lo:[1,0,0]
    v_pk_fma_f32 v[42:43], v[40:41], v[46:47], v[82:83] op_sel_hi:[1,0,1]
    v_pk_fma_f32 v[42:43], v[40:41], v[46:47], v[42:43] op_sel:[1,1,0] op_sel_hi:[0,1,1] neg_lo:[1,0,0]
    v_pk_fma_f32 v[40:41], v[42:43], v[46:47], v[86:87] op_sel_hi:[1,0,1]
    v_pk_fma_f32 v[40:41], v[42:43], v[46:47], v[40:41] op_sel:[1,1,0] op_sel_hi:[0,1,1] neg_lo:[1,0,0]
    v_pk_mul_f32 v[14:15], v[40:41], v[48:49] op_sel:[1,1] op_sel_hi:[0,1] neg_lo:[1,0]
    v_pk_fma_f32 v[40:41], v[40:41], v[48:49], v[14:15] op_sel_hi:[1,0,1]
    v_pk_fma_f32 v[240:241], v[40:41], v[44:45], v[240:241] op_sel_hi:[1,0,1]
    v_pk_fma_f32 v[240:241], v[40:41], v[44:45], v[240:241] op_sel:[1,1,0] op_sel_hi:[0,1,1] neg_lo:[1,0,0]
    v_pk_fma_f32 v[242:243], v[240:241], v[44:45], v[242:243] op_sel_hi:[1,0,1]
    v_pk_fma_f32 v[242:243], v[240:241], v[44:45], v[242:243] op_sel:[1,1,0] op_sel_hi:[0,1,1] neg_lo:[1,0,0]
    v_pk_fma_f32 v[244:245], v[242:243], v[44:45], v[244:245] op_sel_hi:[1,0,1]
    v_pk_fma_f32 v[244:245], v[242:243], v[44:45], v[244:245] op_sel:[1,1,0] op_sel_hi:[0,1,1] neg_lo:[1,0,0]
    v_pk_fma_f32 v[246:247], v[244:245], v[44:45], v[246:247] op_sel_hi:[1,0,1]
    v_pk_fma_f32 v[246:247], v[244:245], v[44:45], v[246:247] op_sel:[1,1,0] op_sel_hi:[0,1,1] neg_lo:[1,0,0]
    v_pk_fma_f32 v[248:249], v[246:247], v[44:45], v[248:249] op_sel_hi:[1,0,1]
    v_pk_fma_f32 v[248:249], v[246:247], v[44:45], v[248:249] op_sel:[1,1,0] op_sel_hi:[0,1,1] neg_lo:[1,0,0]
    v_pk_fma_f32 v[250:251], v[248:249], v[44:45], v[250:251] op_sel_hi:[1,0,1]
    v_pk_fma_f32 v[250:251], v[248:249], v[44:45], v[250:251] op_sel:[1,1,0] op_sel_hi:[0,1,1] neg_lo:[1,0,0]
    v_pk_fma_f32 v[252:253], v[250:251], v[44:45], v[252:253] op_sel_hi:[1,0,1]
    v_pk_fma_f32 v[252:253], v[250:251], v[44:45], v[252:253] op_sel:[1,1,0] op_sel_hi:[0,1,1] neg_lo:[1,0,0]
    v_pk_fma_f32 v[254:255], v[252:253], v[44:45], v[254:255] op_sel_hi:[1,0,1]
    v_pk_fma_f32 v[254:255], v[252:253], v[44:45], v[254:255] op_sel:[1,1,0] op_sel_hi:[0,1,1] neg_lo:[1,0,0]
    v_pk_fma_f32 v[88:89], v[254:255], v[44:45], v[88:89] op_sel_hi:[1,0,1]
    v_pk_fma_f32 v[88:89], v[254:255], v[44:45], v[88:89] op_sel:[1,1,0] op_sel_hi:[0,1,1] neg_lo:[1,0,0]
    v_pk_fma_f32 v[90:91], v[88:89], v[44:45], v[90:91] op_sel_hi:[1,0,1]
    v_pk_fma_f32 v[90:91], v[88:89], v[44:45], v[90:91] op_sel:[1,1,0] op_sel_hi:[0,1,1] neg_lo:[1,0,0]
    v_pk_fma_f32 v[92:93], v[90:91], v[44:45], v[92:93] op_sel_hi:[1,0,1]
    v_pk_fma_f32 v[92:93], v[90:91], v[44:45], v[92:93] op_sel:[1,1,0] op_sel_hi:[0,1,1] neg_lo:[1,0,0]
    v_pk_fma_f32 v[94:95], v[92:93], v[44:45], v[94:95] op_sel_hi:[1,0,1]
    v_pk_fma_f32 v[94:95], v[92:93], v[44:45], v[94:95] op_sel:[1,1,0] op_sel_hi:[0,1,1] neg_lo:[1,0,0]
    v_pk_fma_f32 v[32:33], v[94:95], v[44:45], v[32:33] op_sel_hi:[1,0,1]
    v_pk_fma_f32 v[32:33], v[94:95], v[44:45], v[32:33] op_sel:[1,1,0] op_sel_hi:[0,1,1] neg_lo:[1,0,0]
    v_pk_fma_f32 v[34:35], v[32:33], v[44:45], v[34:35] op_sel_hi:[1,0,1]
    v_pk_fma_f32 v[34:35], v[32:33], v[44:45], v[34:35] op_sel:[1,1,0] op_sel_hi:[0,1,1] neg_lo:[1,0,0]
    v_pk_fma_f32 v[36:37], v[34:35], v[44:45], v[36:37] op_sel_hi:[1,0,1]
    v_pk_fma_f32 v[36:37], v[34:35], v[44:45], v[36:37] op_sel:[1,1,0] op_sel_hi:[0,1,1] neg_lo:[1,0,0]
    ds_write_b64 v50, v[40:41] offset:0
    ds_write_b64 v50, v[240:241] offset:1152
    ds_write_b64 v50, v[242:243] offset:2304
    ds_write_b64 v50, v[244:245] offset:3456
    ds_write_b64 v50, v[246:247] offset:4608
    ds_write_b64 v50, v[248:249] offset:5760
    ds_write_b64 v50, v[250:251] offset:6912
    ds_write_b64 v50, v[252:253] offset:8064
    ds_write_b64 v50, v[254:255] offset:9216
    ds_write_b64 v50, v[88:89] offset:10368
    ds_write_b64 v50, v[90:91] offset:11520
    ds_write_b64 v50, v[92:93] offset:12672
    ds_write_b64 v50, v[94:95] offset:13824
    ds_write_b64 v50, v[32:33] offset:14976
    ds_write_b64 v50, v[34:35] offset:16128
    ds_write_b64 v50, v[36:37] offset:17280
L_ssm_s2:
    s_waitcnt vmcnt(0) lgkmcnt(0)
    s_barrier
    ds_read_b64 v[240:241], v31 offset:0
    ds_read_b64 v[242:243], v31 offset:128
    ds_read_b64 v[244:245], v31 offset:256
    ds_read_b64 v[246:247], v31 offset:384
    ds_read_b64 v[248:249], v31 offset:512
    ds_read_b64 v[250:251], v31 offset:640
    ds_read_b64 v[252:253], v31 offset:768
    ds_read_b64 v[254:255], v31 offset:896
    ds_read_b64 v[88:89], v31 offset:1024
    v_and_b32 v1, 15, v0
    v_lshrrev_b32 v2, 4, v0
    v_xor_b32 v2, v2, v1
    v_lshlrev_b32 v3, 8, v1
    v_add_u32 v3, 0x9000, v3
    v_xor_b32 v40, 0, v2
    v_lshl_add_u32 v40, v40, 4, v3
    v_xor_b32 v41, 4, v2
    v_lshl_add_u32 v41, v41, 4, v3
    v_xor_b32 v42, 8, v2
    v_lshl_add_u32 v42, v42, 4, v3
    v_xor_b32 v43, 12, v2
    v_lshl_add_u32 v43, v43, 4, v3
    v_bfe_u32 v2, v0, 4, 1
    v_lshlrev_b32 v2, 4, v2
    v_lshl_add_u32 v2, v1, 5, v2
    v_mul_u32_u24 v3, 18432, v6
    v_add_u32 v2, v2, v3
    v_add_u32 v44, 0xb000, v2
    v_lshl_add_u32 v45, v6, 10, v8
    v_lshl_add_u32 v46, v6, 10, v13
    s_waitcnt lgkmcnt(8)
    v_pk_fma_f32 v[96:97], v[240:241], v[52:53], v[96:97] op_sel_hi:[1,0,1]
    s_waitcnt lgkmcnt(7)
    v_pk_fma_f32 v[112:113], v[242:243], v[56:57], v[112:113] op_sel_hi:[1,0,1]
    s_waitcnt lgkmcnt(6)
    v_pk_fma_f32 v[128:129], v[244:245], v[60:61], v[128:129] op_sel_hi:[1,0,1]
    s_waitcnt lgkmcnt(5)
    v_pk_fma_f32 v[144:145], v[246:247], v[64:65], v[144:145] op_sel_hi:[1,0,1]
    s_waitcnt lgkmcnt(4)
    v_pk_fma_f32 v[160:161], v[248:249], v[68:69], v[160:161] op_sel_hi:[1,0,1]
    s_waitcnt lgkmcnt(3)
    v_pk_fma_f32 v[176:177], v[250:251], v[72:73], v[176:177] op_sel_hi:[1,0,1]
    s_waitcnt lgkmcnt(2)
    v_pk_fma_f32 v[192:193], v[252:253], v[76:77], v[192:193] op_sel_hi:[1,0,1]
    s_waitcnt lgkmcnt(1)
    v_pk_fma_f32 v[208:209], v[254:255], v[80:81], v[208:209] op_sel_hi:[1,0,1]
    s_waitcnt lgkmcnt(0)
    v_pk_fma_f32 v[224:225], v[88:89], v[84:85], v[224:225] op_sel_hi:[1,0,1]
    v_pk_fma_f32 v[96:97], v[240:241], v[52:53], v[96:97] op_sel:[1,1,0] op_sel_hi:[0,1,1] neg_lo:[1,0,0]
    v_pk_fma_f32 v[112:113], v[242:243], v[56:57], v[112:113] op_sel:[1,1,0] op_sel_hi:[0,1,1] neg_lo:[1,0,0]
    v_pk_fma_f32 v[128:129], v[244:245], v[60:61], v[128:129] op_sel:[1,1,0] op_sel_hi:[0,1,1] neg_lo:[1,0,0]
    v_pk_fma_f32 v[144:145], v[246:247], v[64:65], v[144:145] op_sel:[1,1,0] op_sel_hi:[0,1,1] neg_lo:[1,0,0]
    v_pk_fma_f32 v[160:161], v[248:249], v[68:69], v[160:161] op_sel:[1,1,0] op_sel_hi:[0,1,1] neg_lo:[1,0,0]
    v_pk_fma_f32 v[176:177], v[250:251], v[72:73], v[176:177] op_sel:[1,1,0] op_sel_hi:[0,1,1] neg_lo:[1,0,0]
    v_pk_fma_f32 v[192:193], v[252:253], v[76:77], v[192:193] op_sel:[1,1,0] op_sel_hi:[0,1,1] neg_lo:[1,0,0]
    v_pk_fma_f32 v[208:209], v[254:255], v[80:81], v[208:209] op_sel:[1,1,0] op_sel_hi:[0,1,1] neg_lo:[1,0,0]
    v_pk_fma_f32 v[224:225], v[88:89], v[84:85], v[224:225] op_sel:[1,1,0] op_sel_hi:[0,1,1] neg_lo:[1,0,0]
    v_pk_fma_f32 v[98:99], v[96:97], v[52:53], v[98:99] op_sel_hi:[1,0,1]
L_ps5:
    s_cbranch_execz L_rs5
    v_pk_fma_f32 v[114:115], v[112:113], v[56:57], v[114:115] op_sel_hi:[1,0,1]
    v_pk_fma_f32 v[130:131], v[128:129], v[60:61], v[130:131] op_sel_hi:[1,0,1]
    v_pk_fma_f32 v[146:147], v[144:145], v[64:65], v[146:147] op_sel_hi:[1,0,1]
    v_pk_fma_f32 v[162:163], v[160:161], v[68:69], v[162:163] op_sel_hi:[1,0,1]
    v_pk_fma_f32 v[178:179], v[176:177], v[72:73], v[178:179] op_sel_hi:[1,0,1]
    v_pk_fma_f32 v[194:195], v[192:193], v[76:77], v[194:195] op_sel_hi:[1,0,1]
    v_pk_fma_f32 v[210:211], v[208:209], v[80:81], v[210:211] op_sel_hi:[1,0,1]
    v_pk_fma_f32 v[226:227], v[224:225], v[84:85], v[226:227] op_sel_hi:[1,0,1]
    v_pk_fma_f32 v[98:99], v[96:97], v[52:53], v[98:99] op_sel:[1,1,0] op_sel_hi:[0,1,1] neg_lo:[1,0,0]
    v_pk_fma_f32 v[114:115], v[112:113], v[56:57], v[114:115] op_sel:[1,1,0] op_sel_hi:[0,1,1] neg_lo:[1,0,0]
    v_pk_fma_f32 v[130:131], v[128:129], v[60:61], v[130:131] op_sel:[1,1,0] op_sel_hi:[0,1,1] neg_lo:[1,0,0]
    v_pk_fma_f32 v[146:147], v[144:145], v[64:65], v[146:147] op_sel:[1,1,0] op_sel_hi:[0,1,1] neg_lo:[1,0,0]
    v_pk_fma_f32 v[162:163], v[160:161], v[68:69], v[162:163] op_sel:[1,1,0] op_sel_hi:[0,1,1] neg_lo:[1,0,0]
    v_pk_fma_f32 v[178:179], v[176:177], v[72:73], v[178:179] op_sel:[1,1,0] op_sel_hi:[0,1,1] neg_lo:[1,0,0]
    v_pk_fma_f32 v[194:195], v[192:193], v[76:77], v[194:195] op_sel:[1,1,0] op_sel_hi:[0,1,1] neg_lo:[1,0,0]
    v_pk_fma_f32 v[210:211], v[208:209], v[80:81], v[210:211] op_sel:[1,1,0] op_sel_hi:[0,1,1] neg_lo:[1,0,0]
    v_pk_fma_f32 v[226:227], v[224:225], v[84:85], v[226:227] op_sel:[1,1,0] op_sel_hi:[0,1,1] neg_lo:[1,0,0]
    v_pk_fma_f32 v[100:101], v[98:99], v[52:53], v[100:101] op_sel_hi:[1,0,1]
    v_pk_fma_f32 v[116:117], v[114:115], v[56:57], v[116:117] op_sel_hi:[1,0,1]
    v_pk_fma_f32 v[132:133], v[130:131], v[60:61], v[132:133] op_sel_hi:[1,0,1]
    v_pk_fma_f32 v[148:149], v[146:147], v[64:65], v[148:149] op_sel_hi:[1,0,1]
    v_pk_fma_f32 v[164:165], v[162:163], v[68:69], v[164:165] op_sel_hi:[1,0,1]
    v_pk_fma_f32 v[180:181], v[178:179], v[72:73], v[180:181] op_sel_hi:[1,0,1]
    v_pk_fma_f32 v[196:197], v[194:195], v[76:77], v[196:197] op_sel_hi:[1,0,1]
    v_pk_fma_f32 v[212:213], v[210:211], v[80:81], v[212:213] op_sel_hi:[1,0,1]
    v_pk_fma_f32 v[228:229], v[226:227], v[84:85], v[228:229] op_sel_hi:[1,0,1]
    v_pk_fma_f32 v[100:101], v[98:99], v[52:53], v[100:101] op_sel:[1,1,0] op_sel_hi:[0,1,1] neg_lo:[1,0,0]
    v_pk_fma_f32 v[116:117], v[114:115], v[56:57], v[116:117] op_sel:[1,1,0] op_sel_hi:[0,1,1] neg_lo:[1,0,0]
    v_pk_fma_f32 v[132:133], v[130:131], v[60:61], v[132:133] op_sel:[1,1,0] op_sel_hi:[0,1,1] neg_lo:[1,0,0]
    v_pk_fma_f32 v[148:149], v[146:147], v[64:65], v[148:149] op_sel:[1,1,0] op_sel_hi:[0,1,1] neg_lo:[1,0,0]
    v_pk_fma_f32 v[164:165], v[162:163], v[68:69], v[164:165] op_sel:[1,1,0] op_sel_hi:[0,1,1] neg_lo:[1,0,0]
    v_pk_fma_f32 v[180:181], v[178:179], v[72:73], v[180:181] op_sel:[1,1,0] op_sel_hi:[0,1,1] neg_lo:[1,0,0]
    v_pk_fma_f32 v[196:197], v[194:195], v[76:77], v[196:197] op_sel:[1,1,0] op_sel_hi:[0,1,1] neg_lo:[1,0,0]
    v_pk_fma_f32 v[212:213], v[210:211], v[80:81], v[212:213] op_sel:[1,1,0] op_sel_hi:[0,1,1] neg_lo:[1,0,0]
    v_pk_fma_f32 v[228:229], v[226:227], v[84:85], v[228:229] op_sel:[1,1,0] op_sel_hi:[0,1,1] neg_lo:[1,0,0]
    v_pk_fma_f32 v[102:103], v[100:101], v[52:53], v[102:103] op_sel_hi:[1,0,1]
    v_pk_fma_f32 v[118:119], v[116:117], v[56:57], v[118:119] op_sel_hi:[1,0,1]
    v_pk_fma_f32 v[134:135], v[132:133], v[60:61], v[134:135] op_sel_hi:[1,0,1]
    v_pk_fma_f32 v[150:151], v[148:149], v[64:65], v[150:151] op_sel_hi:[1,0,1]
    v_pk_fma_f32 v[166:167], v[164:165], v[68:69], v[166:167] op_sel_hi:[1,0,1]
    v_pk_fma_f32 v[182:183], v[180:181], v[72:73], v[182:183] op_sel_hi:[1,0,1]
    v_pk_fma_f32 v[198:199], v[196:197], v[76:77], v[198:199] op_sel_hi:[1,0,1]
    v_pk_fma_f32 v[214:215], v[212:213], v[80:81], v[214:215] op_sel_hi:[1,0,1]
    v_pk_fma_f32 v[230:231], v[228:229], v[84:85], v[230:231] op_sel_hi:[1,0,1]
    v_pk_fma_f32 v[102:103], v[100:101], v[52:53], v[102:103] op_sel:[1,1,0] op_sel_hi:[0,1,1] neg_lo:[1,0,0]
    v_pk_fma_f32 v[118:119], v[116:117], v[56:57], v[118:119] op_sel:[1,1,0] op_sel_hi:[0,1,1] neg_lo:[1,0,0]
    v_pk_fma_f32 v[134:135], v[132:133], v[60:61], v[134:135] op_sel:[1,1,0] op_sel_hi:[0,1,1] neg_lo:[1,0,0]
    v_pk_fma_f32 v[150:151], v[148:149], v[64:65], v[150:151] op_sel:[1,1,0] op_sel_hi:[0,1,1] neg_lo:[1,0,0]
    v_pk_fma_f32 v[166:167], v[164:165], v[68:69], v[166:167] op_sel:[1,1,0] op_sel_hi:[0,1,1] neg_lo:[1,0,0]
    v_pk_fma_f32 v[182:183], v[180:181], v[72:73], v[182:183] op_sel:[1,1,0] op_sel_hi:[0,1,1] neg_lo:[1,0,0]
    v_pk_fma_f32 v[198:199], v[196:197], v[76:77], v[198:199] op_sel:[1,1,0] op_sel_hi:[0,1,1] neg_lo:[1,0,0]
    v_pk_fma_f32 v[214:215], v[212:213], v[80:81], v[214:215] op_sel:[1,1,0] op_sel_hi:[0,1,1] neg_lo:[1,0,0]
    v_pk_fma_f32 v[230:231], v[228:229], v[84:85], v[230:231] op_sel:[1,1,0] op_sel_hi:[0,1,1] neg_lo:[1,0,0]
    v_pk_fma_f32 v[104:105], v[102:103], v[52:53], v[104:105] op_sel_hi:[1,0,1]
    v_pk_fma_f32 v[120:121], v[118:119], v[56:57], v[120:121] op_sel_hi:[1,0,1]
    v_pk_fma_f32 v[136:137], v[134:135], v[60:61], v[136:137] op_sel_hi:[1,0,1]
    v_pk_fma_f32 v[152:153], v[150:151], v[64:65], v[152:153] op_sel_hi:[1,0,1]
    v_pk_fma_f32 v[168:169], v[166:167], v[68:69], v[168:169] op_sel_hi:[1,0,1]
    v_pk_fma_f32 v[184:185], v[182:183], v[72:73], v[184:185] op_sel_hi:[1,0,1]
    v_pk_fma_f32 v[200:201], v[198:199], v[76:77], v[200:201] op_sel_hi:[1,0,1]
    v_pk_fma_f32 v[216:217], v[214:215], v[80:81], v[216:217] op_sel_hi:[1,0,1]
    v_pk_fma_f32 v[232:233], v[230:231], v[84:85], v[232:233] op_sel_hi:[1,0,1]
    v_pk_fma_f32 v[104:105], v[102:103], v[52:53], v[104:105] op_sel:[1,1,0] op_sel_hi:[0,1,1] neg_lo:[1,0,0]
    v_pk_fma_f32 v[120:121], v[118:119], v[56:57], v[120:121] op_sel:[1,1,0] op_sel_hi:[0,1,1] neg_lo:[1,0,0]
    v_pk_fma_f32 v[136:137], v[134:135], v[60:61], v[136:137] op_sel:[1,1,0] op_sel_hi:[0,1,1] neg_lo:[1,0,0]
    v_pk_fma_f32 v[152:153], v[150:151], v[64:65], v[152:153] op_sel:[1,1,0] op_sel_hi:[0,1,1] neg_lo:[1,0,0]
    v_pk_fma_f32 v[168:169], v[166:167], v[68:69], v[168:169] op_sel:[1,1,0] op_sel_hi:[0,1,1] neg_lo:[1,0,0]
    v_pk_fma_f32 v[184:185], v[182:183], v[72:73], v[184:185] op_sel:[1,1,0] op_sel_hi:[0,1,1] neg_lo:[1,0,0]
    v_pk_fma_f32 v[200:201], v[198:199], v[76:77], v[200:201] op_sel:[1,1,0] op_sel_hi:[0,1,1] neg_lo:[1,0,0]
    v_pk_fma_f32 v[216:217], v[214:215], v[80:81], v[216:217] op_sel:[1,1,0] op_sel_hi:[0,1,1] neg_lo:[1,0,0]
    v_pk_fma_f32 v[232:233], v[230:231], v[84:85], v[232:233] op_sel:[1,1,0] op_sel_hi:[0,1,1] neg_lo:[1,0,0]
    v_pk_fma_f32 v[106:107], v[104:105], v[52:53], v[106:107] op_sel_hi:[1,0,1]
    v_pk_fma_f32 v[122:123], v[120:121], v[56:57], v[122:123] op_sel_hi:[1,0,1]
    v_pk_fma_f32 v[138:139], v[136:137], v[60:61], v[138:139] op_sel_hi:[1,0,1]
    v_pk_fma_f32 v[154:155], v[152:153], v[64:65], v[154:155] op_sel_hi:[1,0,1]
    v_pk_fma_f32 v[170:171], v[168:169], v[68:69], v[170:171] op_sel_hi:[1,0,1]
    v_pk_fma_f32 v[186:187], v[184:185], v[72:73], v[186:187] op_sel_hi:[1,0,1]
    v_pk_fma_f32 v[202:203], v[200:201], v[76:77], v[202:203] op_sel_hi:[1,0,1]
    v_pk_fma_f32 v[218:219], v[216:217], v[80:81], v[218:219] op_sel_hi:[1,0,1]
    v_pk_fma_f32 v[234:235], v[232:233], v[84:85], v[234:235] op_sel_hi:[1,0,1]
    v_pk_fma_f32 v[106:107], v[104:105], v[52:53], v[106:107] op_sel:[1,1,0] op_sel_hi:[0,1,1] neg_lo:[1,0,0]
    v_pk_fma_f32 v[122:123], v[120:121], v[56:57], v[122:123] op_sel:[1,1,0] op_sel_hi:[0,1,1] neg_lo:[1,0,0]
    v_pk_fma_f32 v[138:139], v[136:137], v[60:61], v[138:139] op_sel:[1,1,0] op_sel_hi:[0,1,1] neg_lo:[1,0,0]
    v_pk_fma_f32 v[154:155], v[152:153], v[64:65], v[154:155] op_sel:[1,1,0] op_sel_hi:[0,1,1] neg_lo:[1,0,0]
    v_pk_fma_f32 v[170:171], v[168:169], v[68:69], v[170:171] op_sel:[1,1,0] op_sel_hi:[0,1,1] neg_lo:[1,0,0]
    v_pk_fma_f32 v[186:187], v[184:185], v[72:73], v[186:187] op_sel:[1,1,0] op_sel_hi:[0,1,1] neg_lo:[1,0,0]
    v_pk_fma_f32 v[202:203], v[200:201], v[76:77], v[202:203] op_sel:[1,1,0] op_sel_hi:[0,1,1] neg_lo:[1,0,0]
    v_pk_fma_f32 v[218:219], v[216:217], v[80:81], v[218:219] op_sel:[1,1,0] op_sel_hi:[0,1,1] neg_lo:[1,0,0]
    v_pk_fma_f32 v[234:235], v[232:233], v[84:85], v[234:235] op_sel:[1,1,0] op_sel_hi:[0,1,1] neg_lo:[1,0,0]
    v_pk_fma_f32 v[108:109], v[106:107], v[52:53], v[108:109] op_sel_hi:[1,0,1]
    v_pk_fma_f32 v[124:125], v[122:123], v[56:57], v[124:125] op_sel_hi:[1,0,1]
    v_pk_fma_f32 v[140:141], v[138:139], v[60:61], v[140:141] op_sel_hi:[1,0,1]
    v_pk_fma_f32 v[156:157], v[154:155], v[64:65], v[156:157] op_sel_hi:[1,0,1]
    v_pk_fma_f32 v[172:173], v[170:171], v[68:69], v[172:173] op_sel_hi:[1,0,1]
    v_pk_fma_f32 v[188:189], v[186:187], v[72:73], v[188:189] op_sel_hi:[1,0,1]
    v_pk_fma_f32 v[204:205], v[202:203], v[76:77], v[204:205] op_sel_hi:[1,0,1]
    v_pk_fma_f32 v[220:221], v[218:219], v[80:81], v[220:221] op_sel_hi:[1,0,1]
    v_pk_fma_f32 v[236:237], v[234:235], v[84:85], v[236:237] op_sel_hi:[1,0,1]
    v_pk_fma_f32 v[108:109], v[106:107], v[52:53], v[108:109] op_sel:[1,1,0] op_sel_hi:[0,1,1] neg_lo:[1,0,0]
    v_pk_fma_f32 v[124:125], v[122:123], v[56:57], v[124:125] op_sel:[1,1,0] op_sel_hi:[0,1,1] neg_lo:[1,0,0]
    v_pk_fma_f32 v[140:141], v[138:139], v[60:61], v[140:141] op_sel:[1,1,0] op_sel_hi:[0,1,1] neg_lo:[1,0,0]
    v_pk_fma_f32 v[156:157], v[154:155], v[64:65], v[156:157] op_sel:[1,1,0] op_sel_hi:[0,1,1] neg_lo:[1,0,0]
    v_pk_fma_f32 v[172:173], v[170:171], v[68:69], v[172:173] op_sel:[1,1,0] op_sel_hi:[0,1,1] neg_lo:[1,0,0]
    v_pk_fma_f32 v[188:189], v[186:187], v[72:73], v[188:189] op_sel:[1,1,0] op_sel_hi:[0,1,1] neg_lo:[1,0,0]
    v_pk_fma_f32 v[204:205], v[202:203], v[76:77], v[204:205] op_sel:[1,1,0] op_sel_hi:[0,1,1] neg_lo:[1,0,0]
    v_pk_fma_f32 v[220:221], v[218:219], v[80:81], v[220:221] op_sel:[1,1,0] op_sel_hi:[0,1,1] neg_lo:[1,0,0]
    v_pk_fma_f32 v[236:237], v[234:235], v[84:85], v[236:237] op_sel:[1,1,0] op_sel_hi:[0,1,1] neg_lo:[1,0,0]
    v_pk_fma_f32 v[110:111], v[108:109], v[52:53], v[110:111] op_sel_hi:[1,0,1]
    v_pk_fma_f32 v[126:127], v[124:125], v[56:57], v[126:127] op_sel_hi:[1,0,1]
    v_pk_fma_f32 v[142:143], v[140:141], v[60:61], v[142:143] op_sel_hi:[1,0,1]
    v_pk_fma_f32 v[158:159], v[156:157], v[64:65], v[158:159] op_sel_hi:[1,0,1]
    v_pk_fma_f32 v[174:175], v[172:173], v[68:69], v[174:175] op_sel_hi:[1,0,1]
    v_pk_fma_f32 v[190:191], v[188:189], v[72:73], v[190:191] op_sel_hi:[1,0,1]
    v_pk_fma_f32 v[206:207], v[204:205], v[76:77], v[206:207] op_sel_hi:[1,0,1]
    v_pk_fma_f32 v[222:223], v[220:221], v[80:81], v[222:223] op_sel_hi:[1,0,1]
    v_pk_fma_f32 v[238:239], v[236:237], v[84:85], v[238:239] op_sel_hi:[1,0,1]
    v_pk_fma_f32 v[110:111], v[108:109], v[52:53], v[110:111] op_sel:[1,1,0] op_sel_hi:[0,1,1] neg_lo:[1,0,0]
    v_pk_fma_f32 v[126:127], v[124:125], v[56:57], v[126:127] op_sel:[1,1,0] op_sel_hi:[0,1,1] neg_lo:[1,0,0]
    v_pk_fma_f32 v[142:143], v[140:141], v[60:61], v[142:143] op_sel:[1,1,0] op_sel_hi:[0,1,1] neg_lo:[1,0,0]
    v_pk_fma_f32 v[158:159], v[156:157], v[64:65], v[158:159] op_sel:[1,1,0] op_sel_hi:[0,1,1] neg_lo:[1,0,0]
    v_pk_fma_f32 v[174:175], v[172:173], v[68:69], v[174:175] op_sel:[1,1,0] op_sel_hi:[0,1,1] neg_lo:[1,0,0]
    v_pk_fma_f32 v[190:191], v[188:189], v[72:73], v[190:191] op_sel:[1,1,0] op_sel_hi:[0,1,1] neg_lo:[1,0,0]
    v_pk_fma_f32 v[206:207], v[204:205], v[76:77], v[206:207] op_sel:[1,1,0] op_sel_hi:[0,1,1] neg_lo:[1,0,0]
    v_pk_fma_f32 v[222:223], v[220:221], v[80:81], v[222:223] op_sel:[1,1,0] op_sel_hi:[0,1,1] neg_lo:[1,0,0]
    v_pk_fma_f32 v[238:239], v[236:237], v[84:85], v[238:239] op_sel:[1,1,0] op_sel_hi:[0,1,1] neg_lo:[1,0,0]
    v_cvt_pk_bf16_f32 v32, -v97, -v99
    v_cvt_pk_bf16_f32 v33, -v101, -v103
    v_cvt_pk_bf16_f32 v34, -v105, -v107
    v_cvt_pk_bf16_f32 v35, -v109, -v111
    ds_write_b128 v51, v[32:35] offset:2048
    v_cvt_pk_bf16_f32 v96, v96, v98
    v_cvt_pk_bf16_f32 v97, v100, v102
    v_cvt_pk_bf16_f32 v98, v104, v106
    v_cvt_pk_bf16_f32 v99, v108, v110
    ds_write_b128 v51, v[96:99] offset:0
    v_cvt_pk_bf16_f32 v36, -v113, -v115
    v_cvt_pk_bf16_f32 v37, -v117, -v119
    v_cvt_pk_bf16_f32 v38, -v121, -v123
    v_cvt_pk_bf16_f32 v39, -v125, -v127
    ds_write_b128 v51, v[36:39] offset:3072
    v_cvt_pk_bf16_f32 v112, v112, v114
    v_cvt_pk_bf16_f32 v113, v116, v118
    v_cvt_pk_bf16_f32 v114, v120, v122
    v_cvt_pk_bf16_f32 v115, v124, v126
    ds_write_b128 v51, v[112:115] offset:1024
    ds_read_b64_tr_b16 a[0:1], v8 offset:0
    ds_read_b64_tr_b16 a[2:3], v13 offset:0
    ds_read_b64_tr_b16 a[4:5], v8 offset:8
    ds_read_b64_tr_b16 a[6:7], v13 offset:8
    ds_read_b64_tr_b16 a[8:9], v8 offset:2048
    ds_read_b64_tr_b16 a[10:11], v13 offset:2048
    ds_read_b64_tr_b16 a[12:13], v8 offset:2056
    ds_read_b64_tr_b16 a[14:15], v13 offset:2056
    ds_read_b128 a[144:147], v40 offset:0
    ds_read_b128 a[148:151], v40 offset:4096
    ds_read_b128 a[152:155], v40 offset:9216
    ds_read_b128 a[156:159], v40 offset:13312
    ds_read_b128 a[160:163], v40 offset:18432
    ds_read_b128 a[164:167], v40 offset:22528
    ds_read_b128 a[168:171], v40 offset:27648
    ds_read_b128 a[172:175], v40 offset:31744
    ds_read_b128 a[176:179], v41 offset:0
    ds_read_b128 a[180:183], v41 offset:4096
    v_cvt_pk_bf16_f32 v32, -v129, -v131
    v_cvt_pk_bf16_f32 v33, -v133, -v135
    v_cvt_pk_bf16_f32 v34, -v137, -v139
    v_cvt_pk_bf16_f32 v35, -v141, -v143
    ds_write_b128 v51, v[32:35] offset:2048
    v_cvt_pk_bf16_f32 v128, v128, v130
    v_cvt_pk_bf16_f32 v129, v132, v134
    v_cvt_pk_bf16_f32 v130, v136, v138
    v_cvt_pk_bf16_f32 v131, v140, v142
    ds_write_b128 v51, v[128:131] offset:0
    v_cvt_pk_bf16_f32 v36, -v145, -v147
    v_cvt_pk_bf16_f32 v37, -v149, -v151
    v_cvt_pk_bf16_f32 v38, -v153, -v155
    v_cvt_pk_bf16_f32 v39, -v157, -v159
    ds_write_b128 v51, v[36:39] offset:3072
    v_cvt_pk_bf16_f32 v144, v144, v146
    v_cvt_pk_bf16_f32 v145, v148, v150
    v_cvt_pk_bf16_f32 v146, v152, v154
    v_cvt_pk_bf16_f32 v147, v156, v158
    ds_write_b128 v51, v[144:147] offset:1024
    ds_read_b64_tr_b16 a[16:17], v8 offset:0
    ds_read_b64_tr_b16 a[18:19], v13 offset:0
    ds_read_b64_tr_b16 a[20:21], v8 offset:8
    ds_read_b64_tr_b16 a[22:23], v13 offset:8
    ds_read_b64_tr_b16 a[24:25], v8 offset:2048
    ds_read_b64_tr_b16 a[26:27], v13 offset:2048
    ds_read_b64_tr_b16 a[28:29], v8 offset:2056
    ds_read_b64_tr_b16 a[30:31], v13 offset:2056
    s_waitcnt lgkmcnt(15)
    v_mfma_f32_16x16x32_bf16 v[96:99], a[144:147], a[0:3], 0
    v_cvt_pk_bf16_f32 v32, -v161, -v163
    v_cvt_pk_bf16_f32 v33, -v165, -v167
    v_mfma_f32_16x16x32_bf16 v[104:107], a[144:147], a[4:7], 0
    ds_read_b128 a[184:187], v41 offset:9216
    v_cvt_pk_bf16_f32 v34, -v169, -v171
    v_cvt_pk_bf16_f32 v35, -v173, -v175
    v_add_u32 v40, 0x9000, v40
    v_mfma_f32_16x16x32_bf16 v[100:103], a[148:151], a[0:3], 0
    v_cvt_pk_bf16_f32 v160, v160, v162
    v_cvt_pk_bf16_f32 v161, v164, v166
    v_mfma_f32_16x16x32_bf16 v[108:111], a[148:151], a[4:7], 0
    ds_read_b128 a[188:191], v41 offset:13312
    ds_write_b128 v51, v[32:35] offset:2048
    v_cvt_pk_bf16_f32 v162, v168, v170
    v_cvt_pk_bf16_f32 v163, v172, v174
    v_mfma_f32_16x16x32_bf16 v[112:115], a[152:155], a[0:3], 0
    v_cvt_pk_bf16_f32 v36, -v177, -v179
    v_cvt_pk_bf16_f32 v37, -v181, -v183
    v_mfma_f32_16x16x32_bf16 v[120:123], a[152:155], a[4:7], 0
    ds_read_b128 a[192:195], v41 offset:18432
    ds_write_b128 v51, v[160:163] offset:0
    v_cvt_pk_bf16_f32 v38, -v185, -v187
    v_cvt_pk_bf16_f32 v39, -v189, -v191
    v_mfma_f32_16x16x32_bf16 v[116:119], a[156:159], a[0:3], 0
    s_waitcnt lgkmcnt(15)
    v_cvt_pk_bf16_f32 v176, v176, v178
    v_cvt_pk_bf16_f32 v177, v180, v182
    v_mfma_f32_16x16x32_bf16 v[124:127], a[156:159], a[4:7], 0
    ds_read_b128 a[196:199], v41 offset:22528
    ds_write_b128 v51, v[36:39] offset:3072
    v_cvt_pk_bf16_f32 v178, v184, v186
    v_cvt_pk_bf16_f32 v179, v188, v190
    v_mfma_f32_16x16x32_bf16 v[96:99], a[160:163], a[8:11], v[96:99]
    ds_read_b128 a[200:203], v41 offset:27648
    v_mfma_f32_16x16x32_bf16 v[104:107], a[160:163], a[12:15], v[104:107]
    ds_write_b128 v51, v[176:179] offset:1024
    v_mfma_f32_16x16x32_bf16 v[100:103], a[164:167], a[8:11], v[100:103]
    ds_read_b128 a[204:207], v41 offset:31744
    ds_read_b64_tr_b16 a[32:33], v8 offset:0
    v_mfma_f32_16x16x32_bf16 v[108:111], a[164:167], a[12:15], v[108:111]
    ds_read_b64_tr_b16 a[34:35], v13 offset:0
    ds_read_b64_tr_b16 a[36:37], v8 offset:8
    v_mfma_f32_16x16x32_bf16 v[112:115], a[168:171], a[8:11], v[112:115]
    ds_read_b128 a[208:211], v42 offset:0
    v_add_u32 v41, 0x9000, v41
    v_mfma_f32_16x16x32_bf16 v[120:123], a[168:171], a[12:15], v[120:123]
    ds_read_b64_tr_b16 a[38:39], v13 offset:8
    ds_read_b64_tr_b16 a[40:41], v8 offset:2048
    ds_read_b64_tr_b16 a[42:43], v13 offset:2048
    v_mfma_f32_16x16x32_bf16 v[116:119], a[172:175], a[8:11], v[116:119]
    s_waitcnt lgkmcnt(13)
    ds_read_b128 a[212:215], v42 offset:4096
    v_mfma_f32_16x16x32_bf16 v[124:127], a[172:175], a[12:15], v[124:127]
    ds_read_b64_tr_b16 a[44:45], v8 offset:2056
    ds_read_b64_tr_b16 a[46:47], v13 offset:2056
    v_mfma_f32_16x16x32_bf16 v[96:99], a[176:179], a[16:19], v[96:99]
    v_cvt_pk_bf16_f32 v32, -v193, -v195
    v_cvt_pk_bf16_f32 v33, -v197, -v199
    v_mfma_f32_16x16x32_bf16 v[104:107], a[176:179], a[20:23], v[104:107]
    ds_read_b128 a[144:147], v42 offset:9216
    v_cvt_pk_bf16_f32 v34, -v201, -v203
    v_cvt_pk_bf16_f32 v35, -v205, -v207
    v_mfma_f32_16x16x32_bf16 v[100:103], a[180:183], a[16:19], v[100:103]
    v_cvt_pk_bf16_f32 v192, v192, v194
    v_cvt_pk_bf16_f32 v193, v196, v198
    v_mfma_f32_16x16x32_bf16 v[108:111], a[180:183], a[20:23], v[108:111]
    ds_read_b128 a[148:151], v42 offset:13312
    ds_write_b128 v51, v[32:35] offset:2048
    v_cvt_pk_bf16_f32 v194, v200, v202
    v_cvt_pk_bf16_f32 v195, v204, v206
    v_mfma_f32_16x16x32_bf16 v[112:115], a[184:187], a[16:19], v[112:115]
    v_cvt_pk_bf16_f32 v36, -v209, -v211
    v_cvt_pk_bf16_f32 v37, -v213, -v215
    v_mfma_f32_16x16x32_bf16 v[120:123], a[184:187], a[20:23], v[120:123]
    ds_read_b128 a[152:155], v42 offset:18432
    ds_write_b128 v51, v[192:195] offset:0
    v_cvt_pk_bf16_f32 v38, -v217, -v219
    v_cvt_pk_bf16_f32 v39, -v221, -v223
    v_mfma_f32_16x16x32_bf16 v[116:119], a[188:191], a[16:19], v[116:119]
    s_waitcnt lgkmcnt(11)
    v_cvt_pk_bf16_f32 v208, v208, v210
    v_cvt_pk_bf16_f32 v209, v212, v214
    v_mfma_f32_16x16x32_bf16 v[124:127], a[188:191], a[20:23], v[124:127]
    ds_read_b128 a[156:159], v42 offset:22528
    ds_write_b128 v51, v[36:39] offset:3072
    v_cvt_pk_bf16_f32 v210, v216, v218
    v_cvt_pk_bf16_f32 v211, v220, v222
    v_mfma_f32_16x16x32_bf16 v[96:99], a[192:195], a[24:27], v[96:99]
    ds_read_b128 a[160:163], v42 offset:27648
    v_mfma_f32_16x16x32_bf16 v[104:107], a[192:195], a[28:31], v[104:107]
    ds_write_b128 v51, v[208:211] offset:1024
    v_mfma_f32_16x16x32_bf16 v[100:103], a[196:199], a[24:27], v[100:103]
    ds_read_b128 a[164:167], v42 offset:31744
    ds_read_b64_tr_b16 a[48:49], v8 offset:0
    v_mfma_f32_16x16x32_bf16 v[108:111], a[196:199], a[28:31], v[108:111]
    ds_read_b64_tr_b16 a[50:51], v13 offset:0
    ds_read_b64_tr_b16 a[52:53], v8 offset:8
    v_mfma_f32_16x16x32_bf16 v[112:115], a[200:203], a[24:27], v[112:115]
    ds_read_b128 a[168:171], v43 offset:0
    v_add_u32 v42, 0x9000, v42
    v_mfma_f32_16x16x32_bf16 v[120:123], a[200:203], a[28:31], v[120:123]
    ds_read_b64_tr_b16 a[54:55], v13 offset:8
    ds_read_b64_tr_b16 a[56:57], v8 offset:2048
    ds_read_b64_tr_b16 a[58:59], v13 offset:2048
    v_mfma_f32_16x16x32_bf16 v[116:119], a[204:207], a[24:27], v[116:119]
    s_waitcnt lgkmcnt(13)
    ds_read_b128 a[172:175], v43 offset:4096
    v_mfma_f32_16x16x32_bf16 v[124:127], a[204:207], a[28:31], v[124:127]
    ds_read_b64_tr_b16 a[60:61], v8 offset:2056
    ds_read_b64_tr_b16 a[62:63], v13 offset:2056
    v_mfma_f32_16x16x32_bf16 v[96:99], a[208:211], a[32:35], v[96:99]
    v_cvt_pk_bf16_f32 v32, -v225, -v227
    v_cvt_pk_bf16_f32 v33, -v229, -v231
    v_mfma_f32_16x16x32_bf16 v[104:107], a[208:211], a[36:39], v[104:107]
    ds_read_b128 a[176:179], v43 offset:9216
    v_cvt_pk_bf16_f32 v34, -v233, -v235
    v_cvt_pk_bf16_f32 v35, -v237, -v239
    v_mfma_f32_16x16x32_bf16 v[100:103], a[212:215], a[32:35], v[100:103]
    v_cvt_pk_bf16_f32 v224, v224, v226
    v_cvt_pk_bf16_f32 v225, v228, v230
    v_mfma_f32_16x16x32_bf16 v[108:111], a[212:215], a[36:39], v[108:111]
    ds_read_b128 a[180:183], v43 offset:13312
    ds_write_b128 v51, v[32:35] offset:2048
    v_cvt_pk_bf16_f32 v226, v232, v234
    v_cvt_pk_bf16_f32 v227, v236, v238
    v_mfma_f32_16x16x32_bf16 v[112:115], a[144:147], a[32:35], v[112:115]
    ds_read_b128 a[184:187], v43 offset:18432
    v_mfma_f32_16x16x32_bf16 v[120:123], a[144:147], a[36:39], v[120:123]
    ds_write_b128 v51, v[224:227] offset:0
    v_mfma_f32_16x16x32_bf16 v[116:119], a[148:151], a[32:35], v[116:119]
    s_waitcnt lgkmcnt(11)
    v_mfma_f32_16x16x32_bf16 v[124:127], a[148:151], a[36:39], v[124:127]
    ds_read_b128 a[188:191], v43 offset:22528
    v_mfma_f32_16x16x32_bf16 v[96:99], a[152:155], a[40:43], v[96:99]
    v_mfma_f32_16x16x32_bf16 v[104:107], a[152:155], a[44:47], v[104:107]
    ds_read_b128 a[192:195], v43 offset:27648
    v_mfma_f32_16x16x32_bf16 v[100:103], a[156:159], a[40:43], v[100:103]
    ds_read_b128 a[196:199], v43 offset:31744
    ds_read_b64_tr_b16 a[64:65], v45 offset:0
    v_mfma_f32_16x16x32_bf16 v[108:111], a[156:159], a[44:47], v[108:111]
    ds_read_b64_tr_b16 a[66:67], v46 offset:0
    ds_read_b64_tr_b16 a[68:69], v45 offset:8
    v_mfma_f32_16x16x32_bf16 v[112:115], a[160:163], a[40:43], v[112:115]
    ds_read_b128 a[200:203], v44 offset:0
    v_mfma_f32_16x16x32_bf16 v[120:123], a[160:163], a[44:47], v[120:123]
    ds_read_b64_tr_b16 a[70:71], v46 offset:8
    v_add_u32 v43, 0x9000, v43
    v_mfma_f32_16x16x32_bf16 v[116:119], a[164:167], a[40:43], v[116:119]
    s_waitcnt lgkmcnt(9)
    v_mfma_f32_16x16x32_bf16 v[124:127], a[164:167], a[44:47], v[124:127]
    ds_read_b128 a[204:207], v44 offset:512
    v_mfma_f32_16x16x32_bf16 v[96:99], a[168:171], a[48:51], v[96:99]
    ds_read_b128 a[208:211], v44 offset:9216
    v_mfma_f32_16x16x32_bf16 v[104:107], a[168:171], a[52:55], v[104:107]
    s_mul_i32 s12, s46, 294912
    s_mul_i32 s13, s46, 18432
    s_add_u32 s13, s13, 0x2900000
    v_mfma_f32_16x16x32_bf16 v[100:103], a[172:175], a[48:51], v[100:103]
    ds_read_b128 a[212:215], v44 offset:9728
    v_mfma_f32_16x16x32_bf16 v[108:111], a[172:175], a[52:55], v[108:111]
    s_mul_i32 s39, s6, 3
    s_mul_i32 s14, s6, 3
    s_lshl_b32 s11, s6, 12
    v_mfma_f32_16x16x32_bf16 v[112:115], a[176:179], a[48:51], v[112:115]
    v_add_u32 v44, 0x9000, v44
    v_lshl_add_u32 v8, v0, 4, s12
    v_mfma_f32_16x16x32_bf16 v[120:123], a[176:179], a[52:55], v[120:123]
    v_add_u32 v1, 0x4000, v8
    v_add_u32 v13, s11, v1
    v_mfma_f32_16x16x32_bf16 v[116:119], a[180:183], a[48:51], v[116:119]
    s_waitcnt lgkmcnt(4)
    v_min_u32 v1, 11, v0
    v_mul_u32_u24 v1, 1152, v1
    v_mfma_f32_16x16x32_bf16 v[124:127], a[180:183], a[52:55], v[124:127]
    v_add_u32 v14, s13, v1
    v_and_b32 v1, 3, v0
    v_add_u32 v1, 12, v1
    v_mfma_f32_16x16x32_bf16 v[96:99], a[184:187], a[56:59], v[96:99]
    v_mul_u32_u24 v1, 1152, v1
    v_add_u32 v31, s13, v1
    v_mfma_f32_16x16x32_bf16 v[104:107], a[184:187], a[60:63], v[104:107]
    v_mov_b32 v1, s14
    v_add_u32 v1, 0, v1
    v_mfma_f32_16x16x32_bf16 v[100:103], a[188:191], a[56:59], v[100:103]
    s_waitcnt lgkmcnt(0)
    s_barrier
    v_mfma_f32_16x16x32_bf16 v[108:111], a[188:191], a[60:63], v[108:111]
    ds_read_b128 a[144:147], v40 offset:0
    ds_read_b128 a[148:151], v40 offset:18432
    v_mfma_f32_16x16x32_bf16 v[112:115], a[192:195], a[56:59], v[112:115]
    s_mul_i32 s9, s94, 73728
    ds_read_b128 a[152:155], v41 offset:0
    v_mfma_f32_16x16x32_bf16 v[120:123], a[192:195], a[60:63], v[120:123]
    s_add_u32 m0, s8, 0x0
    ds_read_b128 a[156:159], v40 offset:4096
    buffer_load_dwordx4 v22, s[56:59], s9 offen lds
    v_mfma_f32_16x16x32_bf16 v[116:119], a[196:199], a[56:59], v[116:119]
    s_waitcnt lgkmcnt(3)
    ds_read_b128 a[160:163], v40 offset:22528
    v_lshrrev_b32 v2, 2, v1
    v_mfma_f32_16x16x32_bf16 v[124:127], a[196:199], a[60:63], v[124:127]
    ds_read_b128 a[164:167], v41 offset:4096
    v_mul_u32_u24 v2, 98304, v2
    v_and_b32 v1, 3, v1
    v_mfma_f32_16x16x32_bf16 v[96:99], a[200:203], a[64:67], v[96:99]
    s_add_u32 m0, s8, 0x400
    ds_read_b128 a[168:171], v40 offset:9216
    v_lshl_add_u32 v1, v1, 10, v2
    v_mfma_f32_16x16x32_bf16 v[104:107], a[200:203], a[68:71], v[104:107]
    buffer_load_dwordx4 v23, s[56:59], s9 offen lds
    v_mfma_f32_16x16x32_bf16 v[100:103], a[204:207], a[64:67], v[100:103]
    v_add_u32 v1, 65536, v1
    v_add_u32 v17, v1, v8
    v_mfma_f32_16x16x32_bf16 v[108:111], a[204:207], a[68:71], v[108:111]
    ds_read_b128 a[172:175], v40 offset:27648
    v_mov_b32 v1, s14
    v_mfma_f32_16x16x32_bf16 v[112:115], a[208:211], a[64:67], v[112:115]
    v_add_u32 v1, 1, v1
    v_lshrrev_b32 v2, 2, v1
    v_mfma_f32_16x16x32_bf16 v[120:123], a[208:211], a[68:71], v[120:123]
    s_add_u32 m0, s8, 0x800
    ds_read_b128 a[176:179], v41 offset:9216
    buffer_load_dwordx4 v24, s[56:59], s9 offen lds
    v_mfma_f32_16x16x32_bf16 v[116:119], a[212:215], a[64:67], v[116:119]
    s_waitcnt lgkmcnt(4)
    v_mul_u32_u24 v2, 98304, v2
    v_and_b32 v1, 3, v1
    v_mfma_f32_16x16x32_bf16 v[124:127], a[212:215], a[68:71], v[124:127]
    ds_read_b128 a[180:183], v40 offset:13312
    v_lshl_add_u32 v1, v1, 10, v2
    v_mfma_f32_16x16x32_bf16 v[128:131], a[144:147], a[0:3], 0
    s_add_u32 m0, s8, 0xc00
    ds_read_b128 a[184:187], v40 offset:31744
    v_add_u32 v1, 65536, v1
    v_mfma_f32_16x16x32_bf16 v[128:131], a[148:151], a[8:11], v[128:131]
    buffer_load_dwordx4 v25, s[56:59], s9 offen lds
    v_mfma_f32_16x16x32_bf16 v[128:131], a[152:155], a[16:19], v[128:131]
    v_add_u32 v40, 0x9000, v40
    v_add_u32 v18, v1, v8
    v_mfma_f32_16x16x32_bf16 v[136:139], a[152:155], a[20:23], 0
    s_mov_b32 s10, 0x10000
    ds_read_b128 a[188:191], v41 offset:13312
    v_mov_b32 v1, s14
    v_mfma_f32_16x16x32_bf16 v[136:139], a[148:151], a[12:15], v[136:139]
    v_add_u32 v1, 2, v1
    v_lshrrev_b32 v2, 2, v1
    v_mfma_f32_16x16x32_bf16 v[136:139], a[144:147], a[4:7], v[136:139]
    s_add_u32 m0, s8, 0x1000
    ds_read_b128 a[192:195], v41 offset:18432
    buffer_load_dwordx4 v26, s[56:59], s9 offen lds
    v_mfma_f32_16x16x32_bf16 v[132:135], a[156:159], a[0:3], 0
    s_waitcnt lgkmcnt(4)
    v_mul_u32_u24 v2, 98304, v2
    v_and_b32 v1, 3, v1
    v_mfma_f32_16x16x32_bf16 v[132:135], a[160:163], a[8:11], v[132:135]
    ds_read_b128 a[196:199], v42 offset:0
    v_lshl_add_u32 v1, v1, 10, v2
    v_mfma_f32_16x16x32_bf16 v[132:135], a[164:167], a[16:19], v[132:135]
    s_add_u32 m0, s8, 0x1400
    ds_read_b128 a[200:203], v42 offset:18432
    v_cvt_pk_bf16_f32 v96, v96, v97
    v_mfma_f32_16x16x32_bf16 v[140:143], a[164:167], a[20:23], 0
    buffer_load_dwordx4 v27, s[56:59], s9 offen lds
    v_mfma_f32_16x16x32_bf16 v[140:143], a[160:163], a[12:15], v[140:143]
    v_cvt_pk_bf16_f32 v97, v98, v99
    v_cvt_pk_bf16_f32 v98, v100, v101
    v_mfma_f32_16x16x32_bf16 v[140:143], a[156:159], a[4:7], v[140:143]
    ds_read_b128 a[204:207], v41 offset:22528
    v_add_u32 v1, 65536, v1
    v_add_u32 v19, v1, v8
    v_mfma_f32_16x16x32_bf16 v[144:147], a[168:171], a[0:3], 0
    s_add_u32 m0, s8, 0x1800
    ds_read_b128 a[208:211], v42 offset:4096
    v_cvt_pk_bf16_f32 v99, v102, v103
    v_mfma_f32_16x16x32_bf16 v[144:147], a[172:175], a[8:11], v[144:147]
    buffer_load_dwordx4 v28, s[56:59], s9 offen lds
    v_mfma_f32_16x16x32_bf16 v[144:147], a[176:179], a[16:19], v[144:147]
    s_waitcnt lgkmcnt(4)
    v_mfma_f32_16x16x32_bf16 v[152:155], a[176:179], a[20:23], 0
    buffer_store_dwordx4 v[96:99], v13, s[60:63], s10 offen offset:0 sc1
    ds_read_b128 a[212:215], v42 offset:22528
    v_mfma_f32_16x16x32_bf16 v[152:155], a[172:175], a[12:15], v[152:155]
    s_add_u32 m0, s8, 0x1c00
    ds_read_b128 a[144:147], v41 offset:27648
    v_mfma_f32_16x16x32_bf16 v[152:155], a[168:171], a[4:7], v[152:155]
    buffer_load_dwordx4 v29, s[56:59], s9 offen lds
    v_mfma_f32_16x16x32_bf16 v[148:151], a[180:183], a[0:3], 0
    v_mfma_f32_16x16x32_bf16 v[148:151], a[184:187], a[8:11], v[148:151]
    s_mul_i32 s12, s3, 6144
    s_add_u32 s12, s12, 73728
    ds_read_b128 a[148:151], v42 offset:9216
    v_mfma_f32_16x16x32_bf16 v[148:151], a[188:191], a[16:19], v[148:151]
    v_cvt_pk_bf16_f32 v104, v104, v105
    v_cvt_pk_bf16_f32 v105, v106, v107
    v_mfma_f32_16x16x32_bf16 v[156:159], a[188:191], a[20:23], 0
    s_add_u32 m0, s8, 0x2000
    ds_read_b128 a[152:155], v42 offset:27648
    buffer_load_dwordx4 v30, s[56:59], s9 offen lds
    v_mfma_f32_16x16x32_bf16 v[156:159], a[184:187], a[12:15], v[156:159]
    s_lshl_b32 s13, s46, 5
    s_lshl_b32 s14, s3, 12
    s_waitcnt lgkmcnt(4)
    v_mfma_f32_16x16x32_bf16 v[156:159], a[180:183], a[4:7], v[156:159]
    ds_read_b128 a[156:159], v41 offset:31744
    v_cvt_pk_bf16_f32 v106, v108, v109
    v_cvt_pk_bf16_f32 v107, v110, v111
    v_mfma_f32_16x16x32_bf16 v[128:131], a[192:195], a[24:27], v[128:131]
    s_mul_i32 s9, s95, 73728
    s_add_u32 m0, s8, 0x9000
    v_add_u32 v41, 0x9000, v41
    v_mfma_f32_16x16x32_bf16 v[128:131], a[196:199], a[32:35], v[128:131]
    s_add_u32 s14, s14, 0x24000
    ds_read_b128 a[160:163], v42 offset:13312
    buffer_load_dwordx4 v22, s[56:59], s9 offen lds
    v_mfma_f32_16x16x32_bf16 v[128:131], a[200:203], a[40:43], v[128:131]
    v_mfma_f32_16x16x32_bf16 v[136:139], a[200:203], a[44:47], v[136:139]
    buffer_store_dwordx4 v[104:107], v13, s[60:63], s10 offen offset:1024 sc1
    ds_read_b128 a[164:167], v42 offset:31744
    v_mfma_f32_16x16x32_bf16 v[136:139], a[196:199], a[36:39], v[136:139]
    s_add_u32 m0, s8, 0x9400
    ds_read_b128 a[168:171], v43 offset:0
    v_add_u32 v42, 0x9000, v42
    v_mfma_f32_16x16x32_bf16 v[136:139], a[192:195], a[28:31], v[136:139]
    buffer_load_dwordx4 v23, s[56:59], s9 offen lds
    v_mfma_f32_16x16x32_bf16 v[132:135], a[204:207], a[24:27], v[132:135]
    s_add_u32 s11, s39, 0
    s_and_b32 s11, s11, 1
    s_waitcnt lgkmcnt(4)
    v_mfma_f32_16x16x32_bf16 v[132:135], a[208:211], a[32:35], v[132:135]
    ds_read_b128 a[172:175], v43 offset:18432
    v_mul_f32_e64 v10, -v9, v12
    v_mfma_f32_16x16x32_bf16 v[132:135], a[212:215], a[40:43], v[132:135]
    s_add_u32 m0, s8, 0x9800
    ds_read_b128 a[176:179], v44 offset:0
    v_mov_b32 v11, v12
    v_mfma_f32_16x16x32_bf16 v[140:143], a[212:215], a[44:47], v[140:143]
L_ps9:
    s_cbranch_execz L_rs9
    buffer_load_dwordx4 v24, s[56:59], s9 offen lds
    v_mfma_f32_16x16x32_bf16 v[140:143], a[208:211], a[36:39], v[140:143]
    v_and_b32 v1, 31, v5
    v_lshl_add_u32 v16, v1, 3, s14
    v_mfma_f32_16x16x32_bf16 v[140:143], a[204:207], a[28:31], v[140:143]
    s_lshl_b32 s28, s11, 5
    s_lshl_b32 s18, s22, 1
    ds_read_b128 a[180:183], v43 offset:4096
    v_mfma_f32_16x16x32_bf16 v[144:147], a[144:147], a[24:27], v[144:147]
    s_add_u32 m0, s8, 0x9c00
    ds_read_b128 a[184:187], v43 offset:22528
    v_cvt_pk_bf16_f32 v112, v112, v113
    v_mfma_f32_16x16x32_bf16 v[144:147], a[148:151], a[32:35], v[144:147]
    buffer_load_dwordx4 v25, s[56:59], s9 offen lds
    v_mfma_f32_16x16x32_bf16 v[144:147], a[152:155], a[40:43], v[144:147]
    s_add_u32 s11, s39, 1
    s_and_b32 s11, s11, 1
    s_waitcnt lgkmcnt(4)
    v_mfma_f32_16x16x32_bf16 v[152:155], a[152:155], a[44:47], v[152:155]
    ds_read_b128 a[188:191], v44 offset:512
    v_cvt_pk_bf16_f32 v113, v114, v115
    v_cvt_pk_bf16_f32 v114, v116, v117
    v_mfma_f32_16x16x32_bf16 v[152:155], a[148:151], a[36:39], v[152:155]
    s_add_u32 m0, s8, 0xa000
    ds_read_b128 a[192:195], v43 offset:9216
    v_cvt_pk_bf16_f32 v115, v118, v119
    v_mfma_f32_16x16x32_bf16 v[152:155], a[144:147], a[28:31], v[152:155]
    buffer_load_dwordx4 v26, s[56:59], s9 offen lds
    v_mfma_f32_16x16x32_bf16 v[148:151], a[156:159], a[24:27], v[148:151]
    v_mfma_f32_16x16x32_bf16 v[148:151], a[160:163], a[32:35], v[148:151]
    s_lshl_b32 s29, s11, 5
    s_lshl_b32 s19, s23, 1
    buffer_store_dwordx4 v[112:115], v13, s[60:63], s10 offen offset:2048 sc1
    ds_read_b128 a[196:199], v43 offset:27648
    v_and_b32 v1, 15, v0
    v_mfma_f32_16x16x32_bf16 v[148:151], a[164:167], a[40:43], v[148:151]
    s_add_u32 m0, s8, 0xa400
    ds_read_b128 a[200:203], v44 offset:9216
    v_cvt_pk_bf16_f32 v120, v120, v121
    v_mfma_f32_16x16x32_bf16 v[156:159], a[164:167], a[44:47], v[156:159]
    buffer_load_dwordx4 v27, s[56:59], s9 offen lds
    v_mfma_f32_16x16x32_bf16 v[156:159], a[160:163], a[36:39], v[156:159]
    s_add_u32 s11, s39, 2
    s_and_b32 s11, s11, 1
    s_waitcnt lgkmcnt(4)
    v_mfma_f32_16x16x32_bf16 v[156:159], a[156:159], a[28:31], v[156:159]
    ds_read_b128 a[204:207], v43 offset:13312
    v_cvt_pk_bf16_f32 v121, v122, v123
    v_cvt_pk_bf16_f32 v122, v124, v125
    v_mfma_f32_16x16x32_bf16 v[128:131], a[168:171], a[48:51], v[128:131]
    s_add_u32 m0, s8, 0xa800
    ds_read_b128 a[208:211], v43 offset:31744
    v_cvt_pk_bf16_f32 v123, v126, v127
    v_mfma_f32_16x16x32_bf16 v[128:131], a[172:175], a[56:59], v[128:131]
    buffer_load_dwordx4 v28, s[56:59], s9 offen lds
    v_mfma_f32_16x16x32_bf16 v[128:131], a[176:179], a[64:67], v[128:131]
    v_mfma_f32_16x16x32_bf16 v[136:139], a[176:179], a[68:71], v[136:139]
    s_lshl_b32 s30, s11, 5
    s_lshl_b32 s20, s24, 1
    buffer_store_dwordx4 v[120:123], v13, s[60:63], s10 offen offset:3072 sc1
    ds_read_b128 a[212:215], v44 offset:9728
    v_add_u32 v43, 0x9000, v43
    v_mfma_f32_16x16x32_bf16 v[136:139], a[172:175], a[60:63], v[136:139]
    s_add_u32 m0, s8, 0xac00
    v_add_u32 v44, 0x9000, v44
    v_mfma_f32_16x16x32_bf16 v[136:139], a[168:171], a[52:55], v[136:139]
    buffer_load_dwordx4 v29, s[56:59], s9 offen lds
    v_mfma_f32_16x16x32_bf16 v[132:135], a[180:183], a[48:51], v[132:135]
    s_waitcnt lgkmcnt(3)
    v_lshrrev_b32 v2, 4, v0
    v_mfma_f32_16x16x32_bf16 v[132:135], a[184:187], a[56:59], v[132:135]
    v_xor_b32 v2, v2, v0
    v_and_b32 v2, 7, v2
    v_mfma_f32_16x16x32_bf16 v[132:135], a[188:191], a[64:67], v[132:135]
    s_add_u32 m0, s8, 0xb000
    v_lshlrev_b32 v2, 4, v2
    v_lshl_add_u32 v1, v1, 7, v2
    v_mfma_f32_16x16x32_bf16 v[140:143], a[188:191], a[68:71], v[140:143]
    buffer_load_dwordx4 v30, s[56:59], s9 offen lds
    v_mfma_f32_16x16x32_bf16 v[140:143], a[184:187], a[60:63], v[140:143]
    s_waitcnt lgkmcnt(0)
    s_barrier
    v_mfma_f32_16x16x32_bf16 v[140:143], a[180:183], a[52:55], v[140:143]
    ds_read_b128 a[144:147], v40 offset:0
    ds_read_b128 a[148:151], v40 offset:18432
    v_mfma_f32_16x16x32_bf16 v[144:147], a[192:195], a[48:51], v[144:147]
    s_mul_i32 s9, s96, 73728
    ds_read_b128 a[152:155], v41 offset:0
    v_mfma_f32_16x16x32_bf16 v[144:147], a[196:199], a[56:59], v[144:147]
    s_add_u32 m0, s8, 0x12000
    ds_read_b128 a[156:159], v40 offset:4096
    buffer_load_dwordx4 v22, s[56:59], s9 offen lds
    v_mfma_f32_16x16x32_bf16 v[144:147], a[200:203], a[64:67], v[144:147]
    s_waitcnt lgkmcnt(3)
    ds_read_b128 a[160:163], v40 offset:22528
    v_mfma_f32_16x16x32_bf16 v[152:155], a[200:203], a[68:71], v[152:155]
    ds_read_b128 a[164:167], v41 offset:4096
    v_add_u32 v80, s12, v1
    v_mfma_f32_16x16x32_bf16 v[152:155], a[196:199], a[60:63], v[152:155]
    v_xor_b32 v81, 64, v80
    v_mfma_f32_16x16x32_bf16 v[152:155], a[192:195], a[52:55], v[152:155]
    ds_read_b128 a[168:171], v40 offset:9216
    v_lshrrev_b32 v1, 3, v0
    v_mfma_f32_16x16x32_bf16 v[148:151], a[204:207], a[48:51], v[148:151]
    v_xor_b32 v2, v1, v0
    v_mfma_f32_16x16x32_bf16 v[148:151], a[208:211], a[56:59], v[148:151]
    ds_read_b128 a[172:175], v40 offset:27648
    v_and_b32 v2, 7, v2
    v_mfma_f32_16x16x32_bf16 v[148:151], a[212:215], a[64:67], v[148:151]
    s_add_u32 m0, s8, 0x12400
    ds_read_b128 a[176:179], v41 offset:9216
    v_lshlrev_b32 v2, 4, v2
    v_mfma_f32_16x16x32_bf16 v[156:159], a[212:215], a[68:71], v[156:159]
    buffer_load_dwordx4 v23, s[56:59], s9 offen lds
    v_mfma_f32_16x16x32_bf16 v[156:159], a[208:211], a[60:63], v[156:159]
    s_waitcnt lgkmcnt(4)
    v_lshl_add_u32 v2, v1, 7, v2
    v_mfma_f32_16x16x32_bf16 v[156:159], a[204:207], a[52:55], v[156:159]
    ds_read_b128 a[180:183], v40 offset:13312
    v_add_u32 v84, s12, v2
    v_mfma_f32_16x16x32_bf16 v[96:99], a[144:147], a[0:3], 0
    v_and_b32 v1, 3, v1
    v_mfma_f32_16x16x32_bf16 v[96:99], a[148:151], a[8:11], v[96:99]
    ds_read_b128 a[184:187], v40 offset:31744
    v_lshl_add_u32 v1, v6, 3, v1
    v_mfma_f32_16x16x32_bf16 v[96:99], a[152:155], a[16:19], v[96:99]
    v_add_u32 v40, 0xfffe5000, v40
    v_mfma_f32_16x16x32_bf16 v[104:107], a[152:155], a[20:23], 0
    s_mov_b32 s10, 0x28000
    ds_read_b128 a[188:191], v41 offset:13312
    v_lshl_add_u32 v3, v1, 3, s14
    v_mfma_f32_16x16x32_bf16 v[104:107], a[148:151], a[12:15], v[104:107]
    s_add_u32 m0, s8, 0x12800
    ds_read_b128 a[192:195], v41 offset:18432
    v_add_u32 v1, s13, v1
    v_mfma_f32_16x16x32_bf16 v[104:107], a[144:147], a[4:7], v[104:107]
    buffer_load_dwordx4 v24, s[56:59], s9 offen lds
    v_mfma_f32_16x16x32_bf16 v[100:103], a[156:159], a[0:3], 0
    s_waitcnt lgkmcnt(4)
    v_mul_u32_u24 v1, 1152, v1
    v_mfma_f32_16x16x32_bf16 v[100:103], a[160:163], a[8:11], v[100:103]
    ds_read_b128 a[196:199], v42 offset:0
    v_and_b32 v2, 7, v0
    v_mfma_f32_16x16x32_bf16 v[100:103], a[164:167], a[16:19], v[100:103]
    v_lshlrev_b32 v2, 3, v2
    v_mfma_f32_16x16x32_bf16 v[108:111], a[164:167], a[20:23], 0
    ds_read_b128 a[200:203], v42 offset:18432
    v_add_u32 v89, v1, v2
    v_mfma_f32_16x16x32_bf16 v[108:111], a[160:163], a[12:15], v[108:111]
    v_cvt_pk_bf16_f32 v128, v128, v129
    v_mfma_f32_16x16x32_bf16 v[108:111], a[156:159], a[4:7], v[108:111]
    ds_read_b128 a[204:207], v41 offset:22528
    v_cvt_pk_bf16_f32 v129, v130, v131
    v_mfma_f32_16x16x32_bf16 v[112:115], a[168:171], a[0:3], 0
    s_add_u32 m0, s8, 0x12c00
    ds_read_b128 a[208:211], v42 offset:4096
    v_lshlrev_b32 v85, 1, v89
    v_mfma_f32_16x16x32_bf16 v[112:115], a[172:175], a[8:11], v[112:115]
    buffer_load_dwordx4 v25, s[56:59], s9 offen lds
    v_mfma_f32_16x16x32_bf16 v[112:115], a[176:179], a[16:19], v[112:115]
    s_waitcnt lgkmcnt(4)
    v_cvt_pk_bf16_f32 v130, v132, v133
    v_mfma_f32_16x16x32_bf16 v[120:123], a[176:179], a[20:23], 0
    ds_read_b128 a[212:215], v42 offset:22528
    v_cvt_pk_bf16_f32 v131, v134, v135
    v_mfma_f32_16x16x32_bf16 v[120:123], a[172:175], a[12:15], v[120:123]
    v_mfma_f32_16x16x32_bf16 v[120:123], a[168:171], a[4:7], v[120:123]
    buffer_store_dwordx4 v[128:131], v13, s[60:63], s10 offen offset:0 sc1
    ds_read_b128 a[144:147], v41 offset:27648
    v_mfma_f32_16x16x32_bf16 v[116:119], a[180:183], a[0:3], 0
    v_add_u32 v86, s28, v3
    v_mfma_f32_16x16x32_bf16 v[116:119], a[184:187], a[8:11], v[116:119]
    ds_read_b128 a[148:151], v42 offset:9216
    v_add_u32 v90, s25, v2
    v_mfma_f32_16x16x32_bf16 v[116:119], a[188:191], a[16:19], v[116:119]
    s_add_u32 m0, s8, 0x13000
    ds_read_b128 a[152:155], v42 offset:27648
    v_mfma_f32_16x16x32_bf16 v[124:127], a[188:191], a[20:23], 0
    buffer_load_dwordx4 v26, s[56:59], s9 offen lds
    v_mfma_f32_16x16x32_bf16 v[124:127], a[184:187], a[12:15], v[124:127]
    s_waitcnt lgkmcnt(4)
    v_cvt_pk_bf16_f32 v136, v136, v137
    v_cvt_pk_bf16_f32 v137, v138, v139
    v_mfma_f32_16x16x32_bf16 v[124:127], a[180:183], a[4:7], v[124:127]
    ds_read_b128 a[156:159], v41 offset:31744
    v_cvt_pk_bf16_f32 v138, v140, v141
    v_mfma_f32_16x16x32_bf16 v[96:99], a[192:195], a[24:27], v[96:99]
    v_add_u32 v41, 0xfffe5000, v41
    v_mfma_f32_16x16x32_bf16 v[96:99], a[196:199], a[32:35], v[96:99]
    ds_read_b128 a[160:163], v42 offset:13312
    v_cvt_pk_bf16_f32 v139, v142, v143
    v_mfma_f32_16x16x32_bf16 v[96:99], a[200:203], a[40:43], v[96:99]
    v_mfma_f32_16x16x32_bf16 v[104:107], a[200:203], a[44:47], v[104:107]
    buffer_store_dwordx4 v[136:139], v13, s[60:63], s10 offen offset:1024 sc1
    ds_read_b128 a[164:167], v42 offset:31744
    v_add_u32 v87, s29, v3
    v_mfma_f32_16x16x32_bf16 v[104:107], a[196:199], a[36:39], v[104:107]
    s_add_u32 m0, s8, 0x13400
    ds_read_b128 a[168:171], v43 offset:0
    v_add_u32 v42, 0xfffe5000, v42
    v_mfma_f32_16x16x32_bf16 v[104:107], a[192:195], a[28:31], v[104:107]
    buffer_load_dwordx4 v27, s[56:59], s9 offen lds
    v_mfma_f32_16x16x32_bf16 v[100:103], a[204:207], a[24:27], v[100:103]
    s_waitcnt lgkmcnt(4)
    v_mfma_f32_16x16x32_bf16 v[100:103], a[208:211], a[32:35], v[100:103]
    ds_read_b128 a[172:175], v43 offset:18432
    v_add_u32 v91, s26, v2
    v_mfma_f32_16x16x32_bf16 v[100:103], a[212:215], a[40:43], v[100:103]
    v_add_u32 v88, s30, v3
    v_mfma_f32_16x16x32_bf16 v[108:111], a[212:215], a[44:47], v[108:111]
    ds_read_b128 a[176:179], v44 offset:0
    v_add_u32 v92, s27, v2
    v_mfma_f32_16x16x32_bf16 v[108:111], a[208:211], a[36:39], v[108:111]
    v_cvt_pk_bf16_f32 v144, v144, v145
    v_mfma_f32_16x16x32_bf16 v[108:111], a[204:207], a[28:31], v[108:111]
    ds_read_b128 a[180:183], v43 offset:4096
    v_cvt_pk_bf16_f32 v145, v146, v147
    v_mfma_f32_16x16x32_bf16 v[112:115], a[144:147], a[24:27], v[112:115]
    s_add_u32 m0, s8, 0x13800
    ds_read_b128 a[184:187], v43 offset:22528
    v_mfma_f32_16x16x32_bf16 v[112:115], a[148:151], a[32:35], v[112:115]
    buffer_load_dwordx4 v28, s[56:59], s9 offen lds
    v_mfma_f32_16x16x32_bf16 v[112:115], a[152:155], a[40:43], v[112:115]
    s_waitcnt lgkmcnt(4)
    v_cvt_pk_bf16_f32 v146, v148, v149
    v_mfma_f32_16x16x32_bf16 v[120:123], a[152:155], a[44:47], v[120:123]
    ds_read_b128 a[188:191], v44 offset:512
    v_cvt_pk_bf16_f32 v147, v150, v151
    v_mfma_f32_16x16x32_bf16 v[120:123], a[148:151], a[36:39], v[120:123]
    v_mfma_f32_16x16x32_bf16 v[120:123], a[144:147], a[28:31], v[120:123]
    buffer_store_dwordx4 v[144:147], v13, s[60:63], s10 offen offset:2048 sc1
    ds_read_b128 a[192:195], v43 offset:9216
    ds_read_b128 a[196:199], v43 offset:27648
    v_mfma_f32_16x16x32_bf16 v[116:119], a[156:159], a[24:27], v[116:119]
    v_mfma_f32_16x16x32_bf16 v[116:119], a[160:163], a[32:35], v[116:119]
    ds_write_b64 v16, v[10:11]
    v_mfma_f32_16x16x32_bf16 v[116:119], a[164:167], a[40:43], v[116:119]
    s_add_u32 m0, s8, 0x13c00
    ds_read_b128 a[200:203], v44 offset:9216
    v_mfma_f32_16x16x32_bf16 v[124:127], a[164:167], a[44:47], v[124:127]
    buffer_load_dwordx4 v29, s[56:59], s9 offen lds
    v_mfma_f32_16x16x32_bf16 v[124:127], a[160:163], a[36:39], v[124:127]
    s_waitcnt lgkmcnt(5)
    v_cvt_pk_bf16_f32 v152, v152, v153
    v_mfma_f32_16x16x32_bf16 v[124:127], a[156:159], a[28:31], v[124:127]
    ds_read_b128 a[204:207], v43 offset:13312
    v_cvt_pk_bf16_f32 v153, v154, v155
    v_mfma_f32_16x16x32_bf16 v[96:99], a[168:171], a[48:51], v[96:99]
    v_cvt_pk_bf16_f32 v154, v156, v157
    v_mfma_f32_16x16x32_bf16 v[96:99], a[172:175], a[56:59], v[96:99]
    ds_read_b128 a[208:211], v43 offset:31744
    v_cvt_pk_bf16_f32 v155, v158, v159
    v_mfma_f32_16x16x32_bf16 v[96:99], a[176:179], a[64:67], v[96:99]
    v_mfma_f32_16x16x32_bf16 v[104:107], a[176:179], a[68:71], v[104:107]
    buffer_store_dwordx4 v[152:155], v13, s[60:63], s10 offen offset:3072 sc1
    ds_read_b128 a[212:215], v44 offset:9728
    v_add_u32 v43, 0xfffe5000, v43
    v_mfma_f32_16x16x32_bf16 v[104:107], a[172:175], a[60:63], v[104:107]
    s_add_u32 m0, s8, 0x14000
    v_add_u32 v44, 0xfffe5000, v44
    v_mfma_f32_16x16x32_bf16 v[104:107], a[168:171], a[52:55], v[104:107]
    buffer_load_dwordx4 v30, s[56:59], s9 offen lds
    v_mfma_f32_16x16x32_bf16 v[100:103], a[180:183], a[48:51], v[100:103]
    s_waitcnt lgkmcnt(3)
    v_mfma_f32_16x16x32_bf16 v[100:103], a[184:187], a[56:59], v[100:103]
    ds_read_b64 v[220:221], v86 offset:0
    v_accvgpr_read_b32 v208, a216
    v_mfma_f32_16x16x32_bf16 v[100:103], a[188:191], a[64:67], v[100:103]
    v_mfma_f32_16x16x32_bf16 v[108:111], a[188:191], a[68:71], v[108:111]
    global_load_dwordx2 v[232:233], v90, s[32:33]
    v_mfma_f32_16x16x32_bf16 v[108:111], a[184:187], a[60:63], v[108:111]
    s_waitcnt vmcnt(26) lgkmcnt(1)
    s_barrier
    v_mfma_f32_16x16x32_bf16 v[108:111], a[180:183], a[52:55], v[108:111]
    ds_read_b128 a[144:147], v40 offset:0
    ds_read_b128 a[148:151], v40 offset:18432
    v_mfma_f32_16x16x32_bf16 v[112:115], a[192:195], a[48:51], v[112:115]
    s_mul_i32 s9, s97, 73728
    ds_read_b64 v[222:223], v86 offset:128
    ds_read_b128 a[152:155], v41 offset:0
    v_mfma_f32_16x16x32_bf16 v[112:115], a[196:199], a[56:59], v[112:115]
    s_add_u32 m0, s8, 0x1b000
    ds_read_b128 a[156:159], v40 offset:4096
    buffer_load_dwordx4 v22, s[56:59], s9 offen lds
    v_mfma_f32_16x16x32_bf16 v[112:115], a[200:203], a[64:67], v[112:115]
    s_waitcnt lgkmcnt(4)
    ds_read_b128 a[160:163], v40 offset:22528
    v_mfma_f32_16x16x32_bf16 v[120:123], a[200:203], a[68:71], v[120:123]
    ds_read_b128 a[164:167], v41 offset:4096
    v_mfma_f32_16x16x32_bf16 v[120:123], a[196:199], a[60:63], v[120:123]
    ds_read_b64 v[224:225], v87 offset:0
    ds_read_b128 a[168:171], v40 offset:9216
    v_mfma_f32_16x16x32_bf16 v[120:123], a[192:195], a[52:55], v[120:123]
    global_load_dwordx2 v[234:235], v91, s[32:33]
    v_mfma_f32_16x16x32_bf16 v[116:119], a[204:207], a[48:51], v[116:119]
    v_mfma_f32_16x16x32_bf16 v[116:119], a[208:211], a[56:59], v[116:119]
    ds_read_b128 a[172:175], v40 offset:27648
    v_accvgpr_read_b32 v209, a217
    v_mfma_f32_16x16x32_bf16 v[116:119], a[212:215], a[64:67], v[116:119]
    s_add_u32 m0, s8, 0x1b400
    ds_read_b64 v[226:227], v87 offset:128
    ds_read_b128 a[176:179], v41 offset:9216
    v_mfma_f32_16x16x32_bf16 v[124:127], a[212:215], a[68:71], v[124:127]
    buffer_load_dwordx4 v23, s[56:59], s9 offen lds
    v_mfma_f32_16x16x32_bf16 v[124:127], a[208:211], a[60:63], v[124:127]
    s_waitcnt lgkmcnt(6)
    v_mfma_f32_16x16x32_bf16 v[124:127], a[204:207], a[52:55], v[124:127]
    ds_read_b128 a[180:183], v40 offset:13312
    v_accvgpr_read_b32 v210, a218
    v_mfma_f32_16x16x32_bf16 v[128:131], a[144:147], a[0:3], 0
    v_mfma_f32_16x16x32_bf16 v[128:131], a[148:151], a[8:11], v[128:131]
    ds_read_b128 a[184:187], v40 offset:31744
    v_accvgpr_read_b32 v211, a219
    v_mfma_f32_16x16x32_bf16 v[128:131], a[152:155], a[16:19], v[128:131]
    v_mfma_f32_16x16x32_bf16 v[136:139], a[152:155], a[20:23], 0
    s_mov_b32 s10, 0x40000
    ds_read_b128 a[188:191], v41 offset:13312
    v_add_u32 v40, 0x9000, v40
    v_mfma_f32_16x16x32_bf16 v[136:139], a[148:151], a[12:15], v[136:139]
    s_add_u32 m0, s8, 0x1b800
    ds_read_b64 v[228:229], v88 offset:0
    ds_read_b128 a[192:195], v41 offset:18432
    v_mfma_f32_16x16x32_bf16 v[136:139], a[144:147], a[4:7], v[136:139]
    buffer_load_dwordx4 v24, s[56:59], s9 offen lds
    v_mfma_f32_16x16x32_bf16 v[132:135], a[156:159], a[0:3], 0
    s_waitcnt lgkmcnt(5)
    v_mfma_f32_16x16x32_bf16 v[132:135], a[160:163], a[8:11], v[132:135]
    ds_read_b128 a[196:199], v42 offset:0
    v_accvgpr_read_b32 v212, a220
    v_mfma_f32_16x16x32_bf16 v[132:135], a[164:167], a[16:19], v[132:135]
    ds_read_b64 v[230:231], v88 offset:128
    ds_read_b128 a[200:203], v42 offset:18432
    v_mfma_f32_16x16x32_bf16 v[140:143], a[164:167], a[20:23], 0
    global_load_dwordx2 v[236:237], v92, s[32:33]
    v_mfma_f32_16x16x32_bf16 v[140:143], a[160:163], a[12:15], v[140:143]
    v_cvt_pk_bf16_f32 v96, v96, v97
    v_mfma_f32_16x16x32_bf16 v[140:143], a[156:159], a[4:7], v[140:143]
    ds_read_b128 a[204:207], v41 offset:22528
    v_cvt_pk_bf16_f32 v97, v98, v99
    v_mfma_f32_16x16x32_bf16 v[144:147], a[168:171], a[0:3], 0
    s_add_u32 m0, s8, 0x1bc00
    ds_read_b128 a[208:211], v42 offset:4096
    v_mfma_f32_16x16x32_bf16 v[144:147], a[172:175], a[8:11], v[144:147]
    buffer_load_dwordx4 v25, s[56:59], s9 offen lds
    v_mfma_f32_16x16x32_bf16 v[144:147], a[176:179], a[16:19], v[144:147]
    s_waitcnt lgkmcnt(5)
    v_cvt_pk_bf16_f32 v98, v100, v101
    v_mfma_f32_16x16x32_bf16 v[152:155], a[176:179], a[20:23], 0
    ds_read_b128 a[212:215], v42 offset:22528
    v_cvt_pk_bf16_f32 v99, v102, v103
    v_mfma_f32_16x16x32_bf16 v[152:155], a[172:175], a[12:15], v[152:155]
    v_mfma_f32_16x16x32_bf16 v[152:155], a[168:171], a[4:7], v[152:155]
    buffer_store_dwordx4 v[96:99], v13, s[60:63], s10 offen offset:0 sc1
    ds_read_b128 a[144:147], v41 offset:27648
    v_mfma_f32_16x16x32_bf16 v[148:151], a[180:183], a[0:3], 0
    v_mfma_f32_16x16x32_bf16 v[148:151], a[184:187], a[8:11], v[148:151]
    ds_read_b128 a[148:151], v42 offset:9216
    v_mfma_f32_16x16x32_bf16 v[148:151], a[188:191], a[16:19], v[148:151]
    s_add_u32 m0, s8, 0x1c000
    ds_read_b128 a[152:155], v42 offset:27648
    v_mfma_f32_16x16x32_bf16 v[156:159], a[188:191], a[20:23], 0
    buffer_load_dwordx4 v26, s[56:59], s9 offen lds
    v_mfma_f32_16x16x32_bf16 v[156:159], a[184:187], a[12:15], v[156:159]
    s_waitcnt lgkmcnt(4)
    v_cvt_pk_bf16_f32 v104, v104, v105
    v_cvt_pk_bf16_f32 v105, v106, v107
    v_mfma_f32_16x16x32_bf16 v[156:159], a[180:183], a[4:7], v[156:159]
    ds_read_b128 a[156:159], v41 offset:31744
    v_cvt_pk_bf16_f32 v106, v108, v109
    v_mfma_f32_16x16x32_bf16 v[128:131], a[192:195], a[24:27], v[128:131]
    v_add_u32 v41, 0x9000, v41
    v_mfma_f32_16x16x32_bf16 v[128:131], a[196:199], a[32:35], v[128:131]
    ds_read_b128 a[160:163], v42 offset:13312
    v_cvt_pk_bf16_f32 v107, v110, v111
    v_mfma_f32_16x16x32_bf16 v[128:131], a[200:203], a[40:43], v[128:131]
    v_mfma_f32_16x16x32_bf16 v[136:139], a[200:203], a[44:47], v[136:139]
    buffer_store_dwordx4 v[104:107], v13, s[60:63], s10 offen offset:1024 sc1
    ds_read_b128 a[164:167], v42 offset:31744
    v_mfma_f32_16x16x32_bf16 v[136:139], a[196:199], a[36:39], v[136:139]
    s_add_u32 m0, s8, 0x1c400
    ds_read_b128 a[168:171], v43 offset:0
    v_add_u32 v42, 0x9000, v42
    v_mfma_f32_16x16x32_bf16 v[136:139], a[192:195], a[28:31], v[136:139]
    buffer_load_dwordx4 v27, s[56:59], s9 offen lds
    v_mfma_f32_16x16x32_bf16 v[132:135], a[204:207], a[24:27], v[132:135]
    s_waitcnt lgkmcnt(4)
    v_mfma_f32_16x16x32_bf16 v[132:135], a[208:211], a[32:35], v[132:135]
    ds_read_b128 a[172:175], v43 offset:18432
    v_accvgpr_read_b32 v213, a221
    v_mfma_f32_16x16x32_bf16 v[132:135], a[212:215], a[40:43], v[132:135]
    v_mfma_f32_16x16x32_bf16 v[140:143], a[212:215], a[44:47], v[140:143]
    ds_read_b128 a[176:179], v44 offset:0
    v_accvgpr_read_b32 v214, a222
    v_mfma_f32_16x16x32_bf16 v[140:143], a[208:211], a[36:39], v[140:143]
    v_cvt_pk_bf16_f32 v112, v112, v113
    v_mfma_f32_16x16x32_bf16 v[140:143], a[204:207], a[28:31], v[140:143]
    ds_read_b128 a[180:183], v43 offset:4096
    v_cvt_pk_bf16_f32 v113, v114, v115
    v_mfma_f32_16x16x32_bf16 v[144:147], a[144:147], a[24:27], v[144:147]
    s_add_u32 m0, s8, 0x1c800
    ds_read_b128 a[184:187], v43 offset:22528
    v_mfma_f32_16x16x32_bf16 v[144:147], a[148:151], a[32:35], v[144:147]
    buffer_load_dwordx4 v28, s[56:59], s9 offen lds
    v_mfma_f32_16x16x32_bf16 v[144:147], a[152:155], a[40:43], v[144:147]
    s_waitcnt lgkmcnt(4)
    v_cvt_pk_bf16_f32 v114, v116, v117
    v_mfma_f32_16x16x32_bf16 v[152:155], a[152:155], a[44:47], v[152:155]
    ds_read_b128 a[188:191], v44 offset:512
    v_cvt_pk_bf16_f32 v115, v118, v119
    v_mfma_f32_16x16x32_bf16 v[152:155], a[148:151], a[36:39], v[152:155]
    v_mfma_f32_16x16x32_bf16 v[152:155], a[144:147], a[28:31], v[152:155]
    buffer_store_dwordx4 v[112:115], v13, s[60:63], s10 offen offset:2048 sc1
    ds_read_b128 a[192:195], v43 offset:9216
    v_mfma_f32_16x16x32_bf16 v[148:151], a[156:159], a[24:27], v[148:151]
    v_mfma_f32_16x16x32_bf16 v[148:151], a[160:163], a[32:35], v[148:151]
    ds_read_b128 a[196:199], v43 offset:27648
    v_accvgpr_read_b32 v215, a223
    v_mfma_f32_16x16x32_bf16 v[148:151], a[164:167], a[40:43], v[148:151]
    s_add_u32 m0, s8, 0x1cc00
    ds_read_b128 a[200:203], v44 offset:9216
    v_mfma_f32_16x16x32_bf16 v[156:159], a[164:167], a[44:47], v[156:159]
    buffer_load_dwordx4 v29, s[56:59], s9 offen lds
    v_mfma_f32_16x16x32_bf16 v[156:159], a[160:163], a[36:39], v[156:159]
    s_waitcnt lgkmcnt(4)
    v_cvt_pk_bf16_f32 v120, v120, v121
    v_mfma_f32_16x16x32_bf16 v[156:159], a[156:159], a[28:31], v[156:159]
    ds_read_b128 a[204:207], v43 offset:13312
    v_cvt_pk_bf16_f32 v121, v122, v123
    v_mfma_f32_16x16x32_bf16 v[128:131], a[168:171], a[48:51], v[128:131]
    v_cvt_pk_bf16_f32 v122, v124, v125
    v_mfma_f32_16x16x32_bf16 v[128:131], a[172:175], a[56:59], v[128:131]
    ds_read_b128 a[208:211], v43 offset:31744
    v_cvt_pk_bf16_f32 v123, v126, v127
    v_mfma_f32_16x16x32_bf16 v[128:131], a[176:179], a[64:67], v[128:131]
    v_mfma_f32_16x16x32_bf16 v[136:139], a[176:179], a[68:71], v[136:139]
    buffer_store_dwordx4 v[120:123], v13, s[60:63], s10 offen offset:3072 sc1
    ds_read_b128 a[212:215], v44 offset:9728
    v_add_u32 v43, 0x9000, v43
    v_mfma_f32_16x16x32_bf16 v[136:139], a[172:175], a[60:63], v[136:139]
    s_add_u32 m0, s8, 0x1d000
    v_add_u32 v44, 0x9000, v44
    v_mfma_f32_16x16x32_bf16 v[136:139], a[168:171], a[52:55], v[136:139]
    buffer_load_dwordx4 v30, s[56:59], s9 offen lds
    v_mfma_f32_16x16x32_bf16 v[132:135], a[180:183], a[48:51], v[132:135]
    s_waitcnt lgkmcnt(3)
    v_mfma_f32_16x16x32_bf16 v[132:135], a[184:187], a[56:59], v[132:135]
    v_accvgpr_read_b32 v216, a224
    v_accvgpr_read_b32 v217, a225
    v_mfma_f32_16x16x32_bf16 v[132:135], a[188:191], a[64:67], v[132:135]
    v_mfma_f32_16x16x32_bf16 v[140:143], a[188:191], a[68:71], v[140:143]
    v_accvgpr_read_b32 v218, a226
    v_accvgpr_read_b32 v219, a227
    v_mfma_f32_16x16x32_bf16 v[140:143], a[184:187], a[60:63], v[140:143]
    s_waitcnt vmcnt(29) lgkmcnt(0)
    s_barrier
    v_mfma_f32_16x16x32_bf16 v[140:143], a[180:183], a[52:55], v[140:143]
    ds_read_b128 a[144:147], v40 offset:0
    ds_read_b128 a[148:151], v40 offset:18432
    v_mfma_f32_16x16x32_bf16 v[144:147], a[192:195], a[48:51], v[144:147]
    s_mul_i32 s9, s98, 73728
    ds_read_b128 a[152:155], v41 offset:0
    v_mfma_f32_16x16x32_bf16 v[144:147], a[196:199], a[56:59], v[144:147]
    s_add_u32 m0, s8, 0x0
    ds_read_b128 a[156:159], v40 offset:4096
    buffer_load_dwordx4 v22, s[56:59], s9 offen lds
    v_mfma_f32_16x16x32_bf16 v[144:147], a[200:203], a[64:67], v[144:147]
    s_waitcnt lgkmcnt(3)
    ds_read_b128 a[160:163], v40 offset:22528
    v_mfma_f32_16x16x32_bf16 v[152:155], a[200:203], a[68:71], v[152:155]
    ds_read_b128 a[164:167], v41 offset:4096
    v_mfma_f32_16x16x32_bf16 v[152:155], a[196:199], a[60:63], v[152:155]
    v_mfma_f32_16x16x32_bf16 v[152:155], a[192:195], a[52:55], v[152:155]
    ds_read_b128 a[168:171], v40 offset:9216
    v_mfma_f32_16x16x32_bf16 v[148:151], a[204:207], a[48:51], v[148:151]
    s_waitcnt vmcnt(11)
    v_lshlrev_b32 v238, 16, v232
    v_mfma_f32_16x16x32_bf16 v[148:151], a[208:211], a[56:59], v[148:151]
    ds_read_b128 a[172:175], v40 offset:27648
    v_and_b32 v239, s15, v232
    v_mfma_f32_16x16x32_bf16 v[148:151], a[212:215], a[64:67], v[148:151]
    s_add_u32 m0, s8, 0x400
    ds_read_b128 a[176:179], v41 offset:9216
    v_mfma_f32_16x16x32_bf16 v[156:159], a[212:215], a[68:71], v[156:159]
    buffer_load_dwordx4 v23, s[56:59], s9 offen lds
    v_mfma_f32_16x16x32_bf16 v[156:159], a[208:211], a[60:63], v[156:159]
    s_waitcnt lgkmcnt(4)
    v_mfma_f32_16x16x32_bf16 v[156:159], a[204:207], a[52:55], v[156:159]
    ds_read_b128 a[180:183], v40 offset:13312
    v_lshlrev_b32 v240, 16, v233
    v_mfma_f32_16x16x32_bf16 v[96:99], a[144:147], a[0:3], 0
    v_and_b32 v241, s15, v233
    v_mfma_f32_16x16x32_bf16 v[96:99], a[148:151], a[8:11], v[96:99]
    ds_read_b128 a[184:187], v40 offset:31744
    v_lshlrev_b32 v242, 16, v234
    v_mfma_f32_16x16x32_bf16 v[96:99], a[152:155], a[16:19], v[96:99]
    v_mfma_f32_16x16x32_bf16 v[104:107], a[152:155], a[20:23], 0
    s_mul_i32 s10, s94, 32768
    ds_read_b128 a[188:191], v41 offset:13312
    v_add_u32 v40, 0x9000, v40
    v_mfma_f32_16x16x32_bf16 v[104:107], a[148:151], a[12:15], v[104:107]
    s_add_u32 m0, s8, 0x800
    ds_read_b128 a[192:195], v41 offset:18432
    v_mfma_f32_16x16x32_bf16 v[104:107], a[144:147], a[4:7], v[104:107]
    buffer_load_dwordx4 v24, s[56:59], s9 offen lds
    v_mfma_f32_16x16x32_bf16 v[100:103], a[156:159], a[0:3], 0
    s_waitcnt lgkmcnt(4)
    v_and_b32 v243, s15, v234
    v_mfma_f32_16x16x32_bf16 v[100:103], a[160:163], a[8:11], v[100:103]
    ds_read_b128 a[196:199], v42 offset:0
    v_lshlrev_b32 v244, 16, v235
    v_mfma_f32_16x16x32_bf16 v[100:103], a[164:167], a[16:19], v[100:103]
    v_mfma_f32_16x16x32_bf16 v[108:111], a[164:167], a[20:23], 0
    ds_read_b128 a[200:203], v42 offset:18432
    v_and_b32 v245, s15, v235
    v_mfma_f32_16x16x32_bf16 v[108:111], a[160:163], a[12:15], v[108:111]
    v_cvt_pk_bf16_f32 v128, v128, v129
    v_mfma_f32_16x16x32_bf16 v[108:111], a[156:159], a[4:7], v[108:111]
    ds_read_b128 a[204:207], v41 offset:22528
    v_cvt_pk_bf16_f32 v129, v130, v131
    v_mfma_f32_16x16x32_bf16 v[112:115], a[168:171], a[0:3], 0
    s_add_u32 m0, s8, 0xc00
    ds_read_b128 a[208:211], v42 offset:4096
    v_mfma_f32_16x16x32_bf16 v[112:115], a[172:175], a[8:11], v[112:115]
    buffer_load_dwordx4 v25, s[56:59], s9 offen lds
    v_mfma_f32_16x16x32_bf16 v[112:115], a[176:179], a[16:19], v[112:115]
    s_waitcnt lgkmcnt(4)
    v_cvt_pk_bf16_f32 v130, v132, v133
    v_mfma_f32_16x16x32_bf16 v[120:123], a[176:179], a[20:23], 0
    ds_read_b128 a[212:215], v42 offset:22528
    v_cvt_pk_bf16_f32 v131, v134, v135
    v_mfma_f32_16x16x32_bf16 v[120:123], a[172:175], a[12:15], v[120:123]
    v_mfma_f32_16x16x32_bf16 v[120:123], a[168:171], a[4:7], v[120:123]
    buffer_store_dwordx4 v[128:131], v13, s[60:63], s10 offen offset:0 sc1
    ds_read_b128 a[144:147], v41 offset:27648
    v_lshlrev_b32 v246, 16, v236
    v_mfma_f32_16x16x32_bf16 v[116:119], a[180:183], a[0:3], 0
    v_mfma_f32_16x16x32_bf16 v[116:119], a[184:187], a[8:11], v[116:119]
    ds_read_b128 a[148:151], v42 offset:9216
    v_and_b32 v247, s15, v236
    v_mfma_f32_16x16x32_bf16 v[116:119], a[188:191], a[16:19], v[116:119]
    s_add_u32 m0, s8, 0x1000
    ds_read_b128 a[152:155], v42 offset:27648
    v_mfma_f32_16x16x32_bf16 v[124:127], a[188:191], a[20:23], 0
    buffer_load_dwordx4 v26, s[56:59], s9 offen lds
    v_mfma_f32_16x16x32_bf16 v[124:127], a[184:187], a[12:15], v[124:127]
    s_waitcnt lgkmcnt(4)
    v_cvt_pk_bf16_f32 v136, v136, v137
    v_cvt_pk_bf16_f32 v137, v138, v139
    v_mfma_f32_16x16x32_bf16 v[124:127], a[180:183], a[4:7], v[124:127]
    ds_read_b128 a[156:159], v41 offset:31744
    v_cvt_pk_bf16_f32 v138, v140, v141
    v_mfma_f32_16x16x32_bf16 v[96:99], a[192:195], a[24:27], v[96:99]
L_ps13:
    s_cbranch_execz L_rs13
    v_add_u32 v41, 0x9000, v41
    v_mfma_f32_16x16x32_bf16 v[96:99], a[196:199], a[32:35], v[96:99]
    ds_read_b128 a[160:163], v42 offset:13312
    v_cvt_pk_bf16_f32 v139, v142, v143
    v_mfma_f32_16x16x32_bf16 v[96:99], a[200:203], a[40:43], v[96:99]
    v_mfma_f32_16x16x32_bf16 v[104:107], a[200:203], a[44:47], v[104:107]
    buffer_store_dwordx4 v[136:139], v13, s[60:63], s10 offen offset:1024 sc1
    ds_read_b128 a[164:167], v42 offset:31744
    v_mfma_f32_16x16x32_bf16 v[104:107], a[196:199], a[36:39], v[104:107]
    s_add_u32 m0, s8, 0x1400
    ds_read_b128 a[168:171], v43 offset:0
    v_add_u32 v42, 0x9000, v42
    v_mfma_f32_16x16x32_bf16 v[104:107], a[192:195], a[28:31], v[104:107]
    buffer_load_dwordx4 v27, s[56:59], s9 offen lds
    v_mfma_f32_16x16x32_bf16 v[100:103], a[204:207], a[24:27], v[100:103]
    s_waitcnt lgkmcnt(4)
    v_lshlrev_b32 v248, 16, v237
    v_mfma_f32_16x16x32_bf16 v[100:103], a[208:211], a[32:35], v[100:103]
    ds_read_b128 a[172:175], v43 offset:18432
    v_and_b32 v249, s15, v237
    v_mfma_f32_16x16x32_bf16 v[100:103], a[212:215], a[40:43], v[100:103]
    v_lshlrev_b32 v184, 16, v208
    v_mfma_f32_16x16x32_bf16 v[108:111], a[212:215], a[44:47], v[108:111]
    ds_read_b128 a[176:179], v44 offset:0
    v_and_b32 v185, s15, v208
    v_mfma_f32_16x16x32_bf16 v[108:111], a[208:211], a[36:39], v[108:111]
    s_waitcnt vmcnt(9)
    v_mfma_f32_16x16x32_bf16 v[108:111], a[204:207], a[28:31], v[108:111]
    buffer_store_dword v7, v7, s[60:63], 0 offen offset:896 sc1
    ds_read_b128 a[180:183], v43 offset:4096
    v_cvt_pk_bf16_f32 v144, v144, v145
    v_mfma_f32_16x16x32_bf16 v[112:115], a[144:147], a[24:27], v[112:115]
    s_add_u32 m0, s8, 0x1800
    ds_read_b128 a[184:187], v43 offset:22528
    v_cvt_pk_bf16_f32 v145, v146, v147
    v_mfma_f32_16x16x32_bf16 v[112:115], a[148:151], a[32:35], v[112:115]
    buffer_load_dwordx4 v28, s[56:59], s9 offen lds
    v_mfma_f32_16x16x32_bf16 v[112:115], a[152:155], a[40:43], v[112:115]
    s_waitcnt lgkmcnt(4)
    v_cvt_pk_bf16_f32 v146, v148, v149
    v_mfma_f32_16x16x32_bf16 v[120:123], a[152:155], a[44:47], v[120:123]
    ds_read_b128 a[188:191], v44 offset:512
    v_cvt_pk_bf16_f32 v147, v150, v151
    v_mfma_f32_16x16x32_bf16 v[120:123], a[148:151], a[36:39], v[120:123]
    v_mfma_f32_16x16x32_bf16 v[120:123], a[144:147], a[28:31], v[120:123]
    buffer_store_dwordx4 v[144:147], v13, s[60:63], s10 offen offset:2048 sc1
    ds_read_b128 a[192:195], v43 offset:9216
    v_mfma_f32_16x16x32_bf16 v[116:119], a[156:159], a[24:27], v[116:119]
    v_mfma_f32_16x16x32_bf16 v[116:119], a[160:163], a[32:35], v[116:119]
    ds_read_b128 a[196:199], v43 offset:27648
    v_fma_f32 v52, v184, v221, v220
    v_mfma_f32_16x16x32_bf16 v[116:119], a[164:167], a[40:43], v[116:119]
    s_add_u32 m0, s8, 0x1c00
    ds_read_b128 a[200:203], v44 offset:9216
    v_mfma_f32_16x16x32_bf16 v[124:127], a[164:167], a[44:47], v[124:127]
    buffer_load_dwordx4 v29, s[56:59], s9 offen lds
    v_mfma_f32_16x16x32_bf16 v[124:127], a[160:163], a[36:39], v[124:127]
    s_waitcnt lgkmcnt(4)
    v_cvt_pk_bf16_f32 v152, v152, v153
    v_mfma_f32_16x16x32_bf16 v[124:127], a[156:159], a[28:31], v[124:127]
    ds_read_b128 a[204:207], v43 offset:13312
    v_cvt_pk_bf16_f32 v153, v154, v155
    v_mfma_f32_16x16x32_bf16 v[96:99], a[168:171], a[48:51], v[96:99]
    v_cvt_pk_bf16_f32 v154, v156, v157
    v_mfma_f32_16x16x32_bf16 v[96:99], a[172:175], a[56:59], v[96:99]
    ds_read_b128 a[208:211], v43 offset:31744
    v_cvt_pk_bf16_f32 v155, v158, v159
    v_mfma_f32_16x16x32_bf16 v[96:99], a[176:179], a[64:67], v[96:99]
    v_mfma_f32_16x16x32_bf16 v[104:107], a[176:179], a[68:71], v[104:107]
    buffer_store_dwordx4 v[152:155], v13, s[60:63], s10 offen offset:3072 sc1
    ds_read_b128 a[212:215], v44 offset:9728
    v_add_u32 v43, 0x9000, v43
    v_mfma_f32_16x16x32_bf16 v[104:107], a[172:175], a[60:63], v[104:107]
    s_add_u32 m0, s8, 0x2000
    v_add_u32 v44, 0x9000, v44
    v_mfma_f32_16x16x32_bf16 v[104:107], a[168:171], a[52:55], v[104:107]
    buffer_load_dwordx4 v30, s[56:59], s9 offen lds
    v_mfma_f32_16x16x32_bf16 v[100:103], a[180:183], a[48:51], v[100:103]
    s_waitcnt lgkmcnt(3)
    v_fma_f32 v53, v185, v221, v220
    v_mfma_f32_16x16x32_bf16 v[100:103], a[184:187], a[56:59], v[100:103]
    v_fmac_f32 v184, v52, v238
    v_fmac_f32 v185, v53, v239
    v_mfma_f32_16x16x32_bf16 v[100:103], a[188:191], a[64:67], v[100:103]
    v_lshlrev_b32 v186, 16, v209
    v_mfma_f32_16x16x32_bf16 v[108:111], a[188:191], a[68:71], v[108:111]
    v_and_b32 v187, s15, v209
    v_fma_f32 v54, v186, v221, v220
    v_mfma_f32_16x16x32_bf16 v[108:111], a[184:187], a[60:63], v[108:111]
    s_waitcnt lgkmcnt(0)
    s_barrier
    v_mfma_f32_16x16x32_bf16 v[108:111], a[180:183], a[52:55], v[108:111]
    ds_read_b128 a[144:147], v40 offset:0
    ds_read_b128 a[148:151], v40 offset:18432
    v_mfma_f32_16x16x32_bf16 v[112:115], a[192:195], a[48:51], v[112:115]
    s_mul_i32 s9, s99, 73728
    ds_read_b128 a[152:155], v41 offset:0
    v_mfma_f32_16x16x32_bf16 v[112:115], a[196:199], a[56:59], v[112:115]
    s_add_u32 m0, s8, 0x9000
    ds_read_b128 a[156:159], v40 offset:4096
    buffer_load_dwordx4 v22, s[56:59], s9 offen lds
    v_mfma_f32_16x16x32_bf16 v[112:115], a[200:203], a[64:67], v[112:115]
    s_waitcnt lgkmcnt(3)
    ds_read_b128 a[160:163], v40 offset:22528
    v_mfma_f32_16x16x32_bf16 v[120:123], a[200:203], a[68:71], v[120:123]
    ds_read_b128 a[164:167], v41 offset:4096
    v_mfma_f32_16x16x32_bf16 v[120:123], a[196:199], a[60:63], v[120:123]
    v_fma_f32 v55, v187, v221, v220
    v_mfma_f32_16x16x32_bf16 v[120:123], a[192:195], a[52:55], v[120:123]
    ds_read_b128 a[168:171], v40 offset:9216
    v_fmac_f32 v186, v54, v240
    v_mfma_f32_16x16x32_bf16 v[116:119], a[204:207], a[48:51], v[116:119]
    v_mfma_f32_16x16x32_bf16 v[116:119], a[208:211], a[56:59], v[116:119]
    ds_read_b128 a[172:175], v40 offset:27648
    v_fmac_f32 v187, v55, v241
    v_mfma_f32_16x16x32_bf16 v[116:119], a[212:215], a[64:67], v[116:119]
    s_add_u32 m0, s8, 0x9400
    ds_read_b128 a[176:179], v41 offset:9216
    v_mfma_f32_16x16x32_bf16 v[124:127], a[212:215], a[68:71], v[124:127]
    buffer_load_dwordx4 v23, s[56:59], s9 offen lds
    v_mfma_f32_16x16x32_bf16 v[124:127], a[208:211], a[60:63], v[124:127]
    s_waitcnt lgkmcnt(4)
    v_lshlrev_b32 v188, 16, v210
    v_mfma_f32_16x16x32_bf16 v[124:127], a[204:207], a[52:55], v[124:127]
    ds_read_b128 a[180:183], v40 offset:13312
    v_and_b32 v189, s15, v210
    v_mfma_f32_16x16x32_bf16 v[128:131], a[144:147], a[0:3], 0
    v_mfma_f32_16x16x32_bf16 v[128:131], a[148:151], a[8:11], v[128:131]
    ds_read_b128 a[184:187], v40 offset:31744
    v_fma_f32 v52, v188, v223, v222
    v_mfma_f32_16x16x32_bf16 v[128:131], a[152:155], a[16:19], v[128:131]
    v_add_u32 v40, 0x9000, v40
    v_mfma_f32_16x16x32_bf16 v[136:139], a[152:155], a[20:23], 0
    s_mul_i32 s10, s95, 32768
    ds_read_b128 a[188:191], v41 offset:13312
    v_fma_f32 v53, v189, v223, v222
    v_mfma_f32_16x16x32_bf16 v[136:139], a[148:151], a[12:15], v[136:139]
    s_add_u32 m0, s8, 0x9800
    ds_read_b128 a[192:195], v41 offset:18432
    v_mfma_f32_16x16x32_bf16 v[136:139], a[144:147], a[4:7], v[136:139]
    buffer_load_dwordx4 v24, s[56:59], s9 offen lds
    v_mfma_f32_16x16x32_bf16 v[132:135], a[156:159], a[0:3], 0
    s_waitcnt lgkmcnt(4)
    v_mfma_f32_16x16x32_bf16 v[132:135], a[160:163], a[8:11], v[132:135]
    ds_read_b128 a[196:199], v42 offset:0
    v_fmac_f32 v188, v52, v238
    v_mfma_f32_16x16x32_bf16 v[132:135], a[164:167], a[16:19], v[132:135]
    v_fmac_f32 v189, v53, v239
    v_mfma_f32_16x16x32_bf16 v[140:143], a[164:167], a[20:23], 0
    ds_read_b128 a[200:203], v42 offset:18432
    v_lshlrev_b32 v190, 16, v211
    v_mfma_f32_16x16x32_bf16 v[140:143], a[160:163], a[12:15], v[140:143]
    v_cvt_pk_bf16_f32 v96, v96, v97
    v_mfma_f32_16x16x32_bf16 v[140:143], a[156:159], a[4:7], v[140:143]
    ds_read_b128 a[204:207], v41 offset:22528
    v_cvt_pk_bf16_f32 v97, v98, v99
    v_mfma_f32_16x16x32_bf16 v[144:147], a[168:171], a[0:3], 0
    s_add_u32 m0, s8, 0x9c00
    ds_read_b128 a[208:211], v42 offset:4096
    v_mfma_f32_16x16x32_bf16 v[144:147], a[172:175], a[8:11], v[144:147]
    buffer_load_dwordx4 v25, s[56:59], s9 offen lds
    v_mfma_f32_16x16x32_bf16 v[144:147], a[176:179], a[16:19], v[144:147]
    s_waitcnt lgkmcnt(4)
    v_cvt_pk_bf16_f32 v98, v100, v101
    v_mfma_f32_16x16x32_bf16 v[152:155], a[176:179], a[20:23], 0
    ds_read_b128 a[212:215], v42 offset:22528
    v_cvt_pk_bf16_f32 v99, v102, v103
    v_mfma_f32_16x16x32_bf16 v[152:155], a[172:175], a[12:15], v[152:155]
    ds_read_b128 a[144:147], v41 offset:27648
    v_mfma_f32_16x16x32_bf16 v[152:155], a[168:171], a[4:7], v[152:155]
    buffer_store_dwordx4 v[96:99], v13, s[60:63], s10 offen offset:0 sc1
    buffer_load_dword v15, v31, s[60:63], 0 offen offset:896 sc1
    v_mfma_f32_16x16x32_bf16 v[148:151], a[180:183], a[0:3], 0
    v_mfma_f32_16x16x32_bf16 v[148:151], a[184:187], a[8:11], v[148:151]
    ds_read_b128 a[148:151], v42 offset:9216
    v_and_b32 v191, s15, v211
    v_mfma_f32_16x16x32_bf16 v[148:151], a[188:191], a[16:19], v[148:151]
    s_add_u32 m0, s8, 0xa000
    ds_read_b128 a[152:155], v42 offset:27648
    v_mfma_f32_16x16x32_bf16 v[156:159], a[188:191], a[20:23], 0
    buffer_load_dwordx4 v26, s[56:59], s9 offen lds
    v_mfma_f32_16x16x32_bf16 v[156:159], a[184:187], a[12:15], v[156:159]
    s_waitcnt lgkmcnt(4)
    v_cvt_pk_bf16_f32 v104, v104, v105
    v_cvt_pk_bf16_f32 v105, v106, v107
    v_mfma_f32_16x16x32_bf16 v[156:159], a[180:183], a[4:7], v[156:159]
    ds_read_b128 a[156:159], v41 offset:31744
    v_cvt_pk_bf16_f32 v106, v108, v109
    v_mfma_f32_16x16x32_bf16 v[128:131], a[192:195], a[24:27], v[128:131]
    v_add_u32 v41, 0x9000, v41
    v_mfma_f32_16x16x32_bf16 v[128:131], a[196:199], a[32:35], v[128:131]
    ds_read_b128 a[160:163], v42 offset:13312
    v_cvt_pk_bf16_f32 v107, v110, v111
    v_mfma_f32_16x16x32_bf16 v[128:131], a[200:203], a[40:43], v[128:131]
    v_mfma_f32_16x16x32_bf16 v[136:139], a[200:203], a[44:47], v[136:139]
    buffer_store_dwordx4 v[104:107], v13, s[60:63], s10 offen offset:1024 sc1
    ds_read_b128 a[164:167], v42 offset:31744
    v_fma_f32 v54, v190, v223, v222
    v_mfma_f32_16x16x32_bf16 v[136:139], a[196:199], a[36:39], v[136:139]
    s_add_u32 m0, s8, 0xa400
    ds_read_b128 a[168:171], v43 offset:0
    v_add_u32 v42, 0x9000, v42
    v_mfma_f32_16x16x32_bf16 v[136:139], a[192:195], a[28:31], v[136:139]
    buffer_load_dwordx4 v27, s[56:59], s9 offen lds
    v_mfma_f32_16x16x32_bf16 v[132:135], a[204:207], a[24:27], v[132:135]
    s_waitcnt lgkmcnt(4)
    v_mfma_f32_16x16x32_bf16 v[132:135], a[208:211], a[32:35], v[132:135]
    ds_read_b128 a[172:175], v43 offset:18432
    v_fma_f32 v55, v191, v223, v222
    v_mfma_f32_16x16x32_bf16 v[132:135], a[212:215], a[40:43], v[132:135]
    v_fmac_f32 v190, v54, v240
    v_mfma_f32_16x16x32_bf16 v[140:143], a[212:215], a[44:47], v[140:143]
    ds_read_b128 a[176:179], v44 offset:0
    v_fmac_f32 v191, v55, v241
    v_mfma_f32_16x16x32_bf16 v[140:143], a[208:211], a[36:39], v[140:143]
    s_waitcnt vmcnt(10)
    v_mfma_f32_16x16x32_bf16 v[140:143], a[204:207], a[28:31], v[140:143]
    buffer_store_dword v7, v7, s[60:63], 0 offen offset:128 sc1
    ds_read_b128 a[180:183], v43 offset:4096
    v_cvt_pk_bf16_f32 v112, v112, v113
    v_mfma_f32_16x16x32_bf16 v[144:147], a[144:147], a[24:27], v[144:147]
    s_add_u32 m0, s8, 0xa800
    ds_read_b128 a[184:187], v43 offset:22528
    v_cvt_pk_bf16_f32 v113, v114, v115
    v_mfma_f32_16x16x32_bf16 v[144:147], a[148:151], a[32:35], v[144:147]
    buffer_load_dwordx4 v28, s[56:59], s9 offen lds
    v_mfma_f32_16x16x32_bf16 v[144:147], a[152:155], a[40:43], v[144:147]
    s_waitcnt lgkmcnt(4)
    v_cvt_pk_bf16_f32 v114, v116, v117
    v_mfma_f32_16x16x32_bf16 v[152:155], a[152:155], a[44:47], v[152:155]
    ds_read_b128 a[188:191], v44 offset:512
    v_cvt_pk_bf16_f32 v115, v118, v119
    v_mfma_f32_16x16x32_bf16 v[152:155], a[148:151], a[36:39], v[152:155]
    v_mfma_f32_16x16x32_bf16 v[152:155], a[144:147], a[28:31], v[152:155]
    buffer_store_dwordx4 v[112:115], v13, s[60:63], s10 offen offset:2048 sc1
    ds_read_b128 a[192:195], v43 offset:9216
    v_mfma_f32_16x16x32_bf16 v[148:151], a[156:159], a[24:27], v[148:151]
    v_lshlrev_b32 v192, 16, v212
    v_mfma_f32_16x16x32_bf16 v[148:151], a[160:163], a[32:35], v[148:151]
    ds_read_b128 a[196:199], v43 offset:27648
    v_and_b32 v193, s15, v212
    v_mfma_f32_16x16x32_bf16 v[148:151], a[164:167], a[40:43], v[148:151]
    s_add_u32 m0, s8, 0xac00
    ds_read_b128 a[200:203], v44 offset:9216
    v_mfma_f32_16x16x32_bf16 v[156:159], a[164:167], a[44:47], v[156:159]
    buffer_load_dwordx4 v29, s[56:59], s9 offen lds
    v_mfma_f32_16x16x32_bf16 v[156:159], a[160:163], a[36:39], v[156:159]
    s_waitcnt lgkmcnt(4)
    v_cvt_pk_bf16_f32 v120, v120, v121
    v_mfma_f32_16x16x32_bf16 v[156:159], a[156:159], a[28:31], v[156:159]
    ds_read_b128 a[204:207], v43 offset:13312
    v_cvt_pk_bf16_f32 v121, v122, v123
    v_mfma_f32_16x16x32_bf16 v[128:131], a[168:171], a[48:51], v[128:131]
    v_cvt_pk_bf16_f32 v122, v124, v125
    v_mfma_f32_16x16x32_bf16 v[128:131], a[172:175], a[56:59], v[128:131]
    ds_read_b128 a[208:211], v43 offset:31744
    v_cvt_pk_bf16_f32 v123, v126, v127
    v_mfma_f32_16x16x32_bf16 v[128:131], a[176:179], a[64:67], v[128:131]
    v_mfma_f32_16x16x32_bf16 v[136:139], a[176:179], a[68:71], v[136:139]
    buffer_store_dwordx4 v[120:123], v13, s[60:63], s10 offen offset:3072 sc1
    ds_read_b128 a[212:215], v44 offset:9728
    v_add_u32 v43, 0x9000, v43
    v_mfma_f32_16x16x32_bf16 v[136:139], a[172:175], a[60:63], v[136:139]
    s_add_u32 m0, s8, 0xb000
    v_add_u32 v44, 0x9000, v44
    v_mfma_f32_16x16x32_bf16 v[136:139], a[168:171], a[52:55], v[136:139]
    buffer_load_dwordx4 v30, s[56:59], s9 offen lds
    v_mfma_f32_16x16x32_bf16 v[132:135], a[180:183], a[48:51], v[132:135]
    s_waitcnt lgkmcnt(3)
    v_mfma_f32_16x16x32_bf16 v[132:135], a[184:187], a[56:59], v[132:135]
    v_fma_f32 v52, v192, v225, v224
    v_fma_f32 v53, v193, v225, v224
    v_mfma_f32_16x16x32_bf16 v[132:135], a[188:191], a[64:67], v[132:135]
    v_fmac_f32 v192, v52, v242
    v_mfma_f32_16x16x32_bf16 v[140:143], a[188:191], a[68:71], v[140:143]
    v_fmac_f32 v193, v53, v243
    v_lshlrev_b32 v194, 16, v213
    v_mfma_f32_16x16x32_bf16 v[140:143], a[184:187], a[60:63], v[140:143]
    s_waitcnt lgkmcnt(0)
    s_barrier
    v_mfma_f32_16x16x32_bf16 v[140:143], a[180:183], a[52:55], v[140:143]
    ds_read_b128 a[144:147], v40 offset:0
    ds_read_b128 a[148:151], v40 offset:18432
    v_mfma_f32_16x16x32_bf16 v[144:147], a[192:195], a[48:51], v[144:147]
    ds_read_b128 a[152:155], v41 offset:0
    v_mfma_f32_16x16x32_bf16 v[144:147], a[196:199], a[56:59], v[144:147]
    ds_read_b128 a[156:159], v40 offset:4096
    v_mfma_f32_16x16x32_bf16 v[144:147], a[200:203], a[64:67], v[144:147]
    s_waitcnt lgkmcnt(3)
    ds_read_b128 a[160:163], v40 offset:22528
    v_mfma_f32_16x16x32_bf16 v[152:155], a[200:203], a[68:71], v[152:155]
    ds_read_b128 a[164:167], v41 offset:4096
    v_and_b32 v195, s15, v213
    v_mfma_f32_16x16x32_bf16 v[152:155], a[196:199], a[60:63], v[152:155]
    v_mfma_f32_16x16x32_bf16 v[152:155], a[192:195], a[52:55], v[152:155]
    ds_read_b128 a[168:171], v40 offset:9216
    v_fma_f32 v54, v194, v225, v224
    v_mfma_f32_16x16x32_bf16 v[148:151], a[204:207], a[48:51], v[148:151]
    v_fma_f32 v55, v195, v225, v224
    v_mfma_f32_16x16x32_bf16 v[148:151], a[208:211], a[56:59], v[148:151]
    ds_read_b128 a[172:175], v40 offset:27648
    v_fmac_f32 v194, v54, v244
    v_mfma_f32_16x16x32_bf16 v[148:151], a[212:215], a[64:67], v[148:151]
    v_fmac_f32 v195, v55, v245
    v_mfma_f32_16x16x32_bf16 v[156:159], a[212:215], a[68:71], v[156:159]
    ds_read_b128 a[176:179], v41 offset:9216
    v_lshlrev_b32 v196, 16, v214
    v_mfma_f32_16x16x32_bf16 v[156:159], a[208:211], a[60:63], v[156:159]
    s_waitcnt lgkmcnt(4)
    v_mfma_f32_16x16x32_bf16 v[156:159], a[204:207], a[52:55], v[156:159]
    ds_read_b128 a[180:183], v40 offset:13312
    v_and_b32 v197, s15, v214
    v_mfma_f32_16x16x32_bf16 v[96:99], a[144:147], a[0:3], 0
    s_waitcnt vmcnt(9)
    v_cmp_eq_u32 vcc, 0, v15
    v_mfma_f32_16x16x32_bf16 v[96:99], a[148:151], a[8:11], v[96:99]
    ds_read_b128 a[184:187], v40 offset:31744
    v_fma_f32 v52, v196, v227, v226
    v_mfma_f32_16x16x32_bf16 v[96:99], a[152:155], a[16:19], v[96:99]
    s_mul_i32 s10, s96, 32768
    s_cbranch_vccnz L_sb_spin
L_sb_ret:
    v_mfma_f32_16x16x32_bf16 v[104:107], a[152:155], a[20:23], 0
    ds_read_b128 a[188:191], v41 offset:13312
    v_add_u32 v40, 0xfffe5000, v40
    v_mfma_f32_16x16x32_bf16 v[104:107], a[148:151], a[12:15], v[104:107]
    v_fma_f32 v53, v197, v227, v226
    v_mfma_f32_16x16x32_bf16 v[104:107], a[144:147], a[4:7], v[104:107]
    ds_read_b128 a[192:195], v41 offset:18432
    v_fmac_f32 v196, v52, v242
    v_mfma_f32_16x16x32_bf16 v[100:103], a[156:159], a[0:3], 0
    s_mov_b32 s11, 16384
    s_waitcnt lgkmcnt(4)
    ds_read_b128 a[196:199], v42 offset:0
    v_mfma_f32_16x16x32_bf16 v[100:103], a[160:163], a[8:11], v[100:103]
    buffer_load_dwordx4 v[56:59], v17, s[60:63], s11 offen offset:0 sc1
    v_mfma_f32_16x16x32_bf16 v[100:103], a[164:167], a[16:19], v[100:103]
    v_mfma_f32_16x16x32_bf16 v[108:111], a[164:167], a[20:23], 0
    ds_read_b128 a[200:203], v42 offset:18432
    v_fmac_f32 v197, v53, v243
    v_mfma_f32_16x16x32_bf16 v[108:111], a[160:163], a[12:15], v[108:111]
    v_cvt_pk_bf16_f32 v128, v128, v129
    v_mfma_f32_16x16x32_bf16 v[108:111], a[156:159], a[4:7], v[108:111]
    ds_read_b128 a[204:207], v41 offset:22528
    v_cvt_pk_bf16_f32 v129, v130, v131
    v_mfma_f32_16x16x32_bf16 v[112:115], a[168:171], a[0:3], 0
    ds_read_b128 a[208:211], v42 offset:4096
    v_mfma_f32_16x16x32_bf16 v[112:115], a[172:175], a[8:11], v[112:115]
    buffer_load_dwordx4 v[60:63], v18, s[60:63], s11 offen offset:0 sc1
    v_mfma_f32_16x16x32_bf16 v[112:115], a[176:179], a[16:19], v[112:115]
    s_waitcnt lgkmcnt(4)
    v_cvt_pk_bf16_f32 v130, v132, v133
    v_mfma_f32_16x16x32_bf16 v[120:123], a[176:179], a[20:23], 0
    ds_read_b128 a[212:215], v42 offset:22528
    v_cvt_pk_bf16_f32 v131, v134, v135
    v_mfma_f32_16x16x32_bf16 v[120:123], a[172:175], a[12:15], v[120:123]
    v_mfma_f32_16x16x32_bf16 v[120:123], a[168:171], a[4:7], v[120:123]
    buffer_store_dwordx4 v[128:131], v13, s[60:63], s10 offen offset:0 sc1
    ds_read_b128 a[144:147], v41 offset:27648
    v_lshlrev_b32 v198, 16, v215
    v_mfma_f32_16x16x32_bf16 v[116:119], a[180:183], a[0:3], 0
    v_mfma_f32_16x16x32_bf16 v[116:119], a[184:187], a[8:11], v[116:119]
    ds_read_b128 a[148:151], v42 offset:9216
    v_and_b32 v199, s15, v215
    v_mfma_f32_16x16x32_bf16 v[116:119], a[188:191], a[16:19], v[116:119]
    ds_read_b128 a[152:155], v42 offset:27648
    v_mfma_f32_16x16x32_bf16 v[124:127], a[188:191], a[20:23], 0
    buffer_load_dwordx4 v[64:67], v19, s[60:63], s11 offen offset:0 sc1
    v_mfma_f32_16x16x32_bf16 v[124:127], a[184:187], a[12:15], v[124:127]
    s_waitcnt lgkmcnt(4)
    v_cvt_pk_bf16_f32 v136, v136, v137
    v_cvt_pk_bf16_f32 v137, v138, v139
    v_mfma_f32_16x16x32_bf16 v[124:127], a[180:183], a[4:7], v[124:127]
    ds_read_b128 a[156:159], v41 offset:31744
    v_cvt_pk_bf16_f32 v138, v140, v141
    v_mfma_f32_16x16x32_bf16 v[96:99], a[192:195], a[24:27], v[96:99]
    v_add_u32 v41, 0xfffe5000, v41
    v_mfma_f32_16x16x32_bf16 v[96:99], a[196:199], a[32:35], v[96:99]
    ds_read_b128 a[160:163], v42 offset:13312
    v_cvt_pk_bf16_f32 v139, v142, v143
    v_mfma_f32_16x16x32_bf16 v[96:99], a[200:203], a[40:43], v[96:99]
    v_mfma_f32_16x16x32_bf16 v[104:107], a[200:203], a[44:47], v[104:107]
    buffer_store_dwordx4 v[136:139], v13, s[60:63], s10 offen offset:1024 sc1
    ds_read_b128 a[164:167], v42 offset:31744
    v_mfma_f32_16x16x32_bf16 v[104:107], a[196:199], a[36:39], v[104:107]
    v_add_u32 v42, 0xfffe5000, v42
    v_mfma_f32_16x16x32_bf16 v[104:107], a[192:195], a[28:31], v[104:107]
    ds_read_b128 a[168:171], v43 offset:0
    v_fma_f32 v54, v198, v227, v226
    v_mfma_f32_16x16x32_bf16 v[100:103], a[204:207], a[24:27], v[100:103]
    s_mov_b32 s11, 20480
    s_waitcnt lgkmcnt(4)
    ds_read_b128 a[172:175], v43 offset:18432
    v_mfma_f32_16x16x32_bf16 v[100:103], a[208:211], a[32:35], v[100:103]
    buffer_load_dwordx4 v[68:71], v17, s[60:63], s11 offen offset:0 sc1
    v_mfma_f32_16x16x32_bf16 v[100:103], a[212:215], a[40:43], v[100:103]
    v_fma_f32 v55, v199, v227, v226
    v_mfma_f32_16x16x32_bf16 v[108:111], a[212:215], a[44:47], v[108:111]
    ds_read_b128 a[176:179], v44 offset:0
    v_fmac_f32 v198, v54, v244
    v_mfma_f32_16x16x32_bf16 v[108:111], a[208:211], a[36:39], v[108:111]
    s_waitcnt vmcnt(7)
    v_mfma_f32_16x16x32_bf16 v[108:111], a[204:207], a[28:31], v[108:111]
    buffer_store_dword v7, v7, s[60:63], 0 offen offset:256 sc1
    ds_read_b128 a[180:183], v43 offset:4096
    v_cvt_pk_bf16_f32 v144, v144, v145
    v_mfma_f32_16x16x32_bf16 v[112:115], a[144:147], a[24:27], v[112:115]
    ds_read_b128 a[184:187], v43 offset:22528
    v_cvt_pk_bf16_f32 v145, v146, v147
    v_mfma_f32_16x16x32_bf16 v[112:115], a[148:151], a[32:35], v[112:115]
    buffer_load_dwordx4 v[72:75], v18, s[60:63], s11 offen offset:0 sc1
    v_mfma_f32_16x16x32_bf16 v[112:115], a[152:155], a[40:43], v[112:115]
    s_waitcnt lgkmcnt(4)
    v_cvt_pk_bf16_f32 v146, v148, v149
    v_mfma_f32_16x16x32_bf16 v[120:123], a[152:155], a[44:47], v[120:123]
    ds_read_b128 a[188:191], v44 offset:512
    v_cvt_pk_bf16_f32 v147, v150, v151
    v_mfma_f32_16x16x32_bf16 v[120:123], a[148:151], a[36:39], v[120:123]
    v_mfma_f32_16x16x32_bf16 v[120:123], a[144:147], a[28:31], v[120:123]
    buffer_store_dwordx4 v[144:147], v13, s[60:63], s10 offen offset:2048 sc1
    ds_read_b128 a[192:195], v43 offset:9216
    v_mfma_f32_16x16x32_bf16 v[116:119], a[156:159], a[24:27], v[116:119]
    v_mfma_f32_16x16x32_bf16 v[116:119], a[160:163], a[32:35], v[116:119]
    ds_read_b128 a[196:199], v43 offset:27648
    v_fmac_f32 v199, v55, v245
    v_mfma_f32_16x16x32_bf16 v[116:119], a[164:167], a[40:43], v[116:119]
    ds_read_b128 a[200:203], v44 offset:9216
    v_mfma_f32_16x16x32_bf16 v[124:127], a[164:167], a[44:47], v[124:127]
    buffer_load_dwordx4 v[76:79], v19, s[60:63], s11 offen offset:0 sc1
    v_mfma_f32_16x16x32_bf16 v[124:127], a[160:163], a[36:39], v[124:127]
    s_waitcnt lgkmcnt(4)
    v_cvt_pk_bf16_f32 v152, v152, v153
    v_mfma_f32_16x16x32_bf16 v[124:127], a[156:159], a[28:31], v[124:127]
    ds_read_b128 a[204:207], v43 offset:13312
    v_cvt_pk_bf16_f32 v153, v154, v155
    v_mfma_f32_16x16x32_bf16 v[96:99], a[168:171], a[48:51], v[96:99]
    v_cvt_pk_bf16_f32 v154, v156, v157
    v_mfma_f32_16x16x32_bf16 v[96:99], a[172:175], a[56:59], v[96:99]
    ds_read_b128 a[208:211], v43 offset:31744
    v_cvt_pk_bf16_f32 v155, v158, v159
    v_mfma_f32_16x16x32_bf16 v[96:99], a[176:179], a[64:67], v[96:99]
    v_mfma_f32_16x16x32_bf16 v[104:107], a[176:179], a[68:71], v[104:107]
    buffer_store_dwordx4 v[152:155], v13, s[60:63], s10 offen offset:3072 sc1
    ds_read_b128 a[212:215], v44 offset:9728
    v_add_u32 v43, 0xfffe5000, v43
    v_mfma_f32_16x16x32_bf16 v[104:107], a[172:175], a[60:63], v[104:107]
    v_add_u32 v44, 0xfffe5000, v44
    v_mfma_f32_16x16x32_bf16 v[104:107], a[168:171], a[52:55], v[104:107]
    v_lshlrev_b32 v200, 16, v216
    v_and_b32 v201, s15, v216
    v_mfma_f32_16x16x32_bf16 v[100:103], a[180:183], a[48:51], v[100:103]
    s_waitcnt lgkmcnt(3)
    v_fma_f32 v52, v200, v229, v228
    v_mfma_f32_16x16x32_bf16 v[100:103], a[184:187], a[56:59], v[100:103]
    v_fma_f32 v53, v201, v229, v228
    v_fmac_f32 v200, v52, v246
    v_mfma_f32_16x16x32_bf16 v[100:103], a[188:191], a[64:67], v[100:103]
    v_mfma_f32_16x16x32_bf16 v[108:111], a[188:191], a[68:71], v[108:111]
    v_fmac_f32 v201, v53, v247
    v_lshlrev_b32 v202, 16, v217
    v_mfma_f32_16x16x32_bf16 v[108:111], a[184:187], a[60:63], v[108:111]
    s_waitcnt lgkmcnt(0)
    s_barrier
    v_mfma_f32_16x16x32_bf16 v[108:111], a[180:183], a[52:55], v[108:111]
    ds_read_b128 a[144:147], v40 offset:0
    ds_read_b128 a[148:151], v40 offset:18432
    v_mfma_f32_16x16x32_bf16 v[112:115], a[192:195], a[48:51], v[112:115]
    ds_read_b128 a[152:155], v41 offset:0
    v_mfma_f32_16x16x32_bf16 v[112:115], a[196:199], a[56:59], v[112:115]
    ds_read_b128 a[156:159], v40 offset:4096
    v_and_b32 v203, s15, v217
    v_mfma_f32_16x16x32_bf16 v[112:115], a[200:203], a[64:67], v[112:115]
    s_waitcnt lgkmcnt(3)
    ds_read_b128 a[160:163], v40 offset:22528
    v_mfma_f32_16x16x32_bf16 v[120:123], a[200:203], a[68:71], v[120:123]
    ds_read_b128 a[164:167], v41 offset:4096
    v_mfma_f32_16x16x32_bf16 v[120:123], a[196:199], a[60:63], v[120:123]
    v_fma_f32 v54, v202, v229, v228
    v_mfma_f32_16x16x32_bf16 v[120:123], a[192:195], a[52:55], v[120:123]
    ds_read_b128 a[168:171], v40 offset:9216
    v_fma_f32 v55, v203, v229, v228
    v_mfma_f32_16x16x32_bf16 v[116:119], a[204:207], a[48:51], v[116:119]
    v_mfma_f32_16x16x32_bf16 v[116:119], a[208:211], a[56:59], v[116:119]
    ds_read_b128 a[172:175], v40 offset:27648
    v_fmac_f32 v202, v54, v248
    v_mfma_f32_16x16x32_bf16 v[116:119], a[212:215], a[64:67], v[116:119]
    v_fmac_f32 v203, v55, v249
    v_mfma_f32_16x16x32_bf16 v[124:127], a[212:215], a[68:71], v[124:127]
    ds_read_b128 a[176:179], v41 offset:9216
    v_lshlrev_b32 v204, 16, v218
    v_mfma_f32_16x16x32_bf16 v[124:127], a[208:211], a[60:63], v[124:127]
    s_waitcnt lgkmcnt(4)
    v_mfma_f32_16x16x32_bf16 v[124:127], a[204:207], a[52:55], v[124:127]
    ds_read_b128 a[180:183], v40 offset:13312
    v_and_b32 v205, s15, v218
    v_mfma_f32_16x16x32_bf16 v[128:131], a[144:147], a[0:3], 0
    v_fma_f32 v52, v204, v231, v230
    v_mfma_f32_16x16x32_bf16 v[128:131], a[148:151], a[8:11], v[128:131]
    ds_read_b128 a[184:187], v40 offset:31744
    v_fma_f32 v53, v205, v231, v230
    v_mfma_f32_16x16x32_bf16 v[128:131], a[152:155], a[16:19], v[128:131]
    v_mfma_f32_16x16x32_bf16 v[136:139], a[152:155], a[20:23], 0
    s_mul_i32 s10, s97, 32768
    ds_read_b128 a[188:191], v41 offset:13312
    v_add_u32 v40, 0x9000, v40
    v_mfma_f32_16x16x32_bf16 v[136:139], a[148:151], a[12:15], v[136:139]
    v_fmac_f32 v204, v52, v246
    v_mfma_f32_16x16x32_bf16 v[136:139], a[144:147], a[4:7], v[136:139]
    ds_read_b128 a[192:195], v41 offset:18432
    v_fmac_f32 v205, v53, v247
    v_mfma_f32_16x16x32_bf16 v[132:135], a[156:159], a[0:3], 0
    s_waitcnt lgkmcnt(4)
    v_mfma_f32_16x16x32_bf16 v[132:135], a[160:163], a[8:11], v[132:135]
    ds_read_b128 a[196:199], v42 offset:0
    v_lshlrev_b32 v206, 16, v219
    v_mfma_f32_16x16x32_bf16 v[132:135], a[164:167], a[16:19], v[132:135]
    v_and_b32 v207, s15, v219
    v_mfma_f32_16x16x32_bf16 v[140:143], a[164:167], a[20:23], 0
    ds_read_b128 a[200:203], v42 offset:18432
    v_fma_f32 v54, v206, v231, v230
    v_mfma_f32_16x16x32_bf16 v[140:143], a[160:163], a[12:15], v[140:143]
    v_cvt_pk_bf16_f32 v96, v96, v97
    v_mfma_f32_16x16x32_bf16 v[140:143], a[156:159], a[4:7], v[140:143]
    ds_read_b128 a[204:207], v41 offset:22528
    v_fma_f32 v55, v207, v231, v230
    v_mfma_f32_16x16x32_bf16 v[144:147], a[168:171], a[0:3], 0
    v_cvt_pk_bf16_f32 v97, v98, v99
    v_mfma_f32_16x16x32_bf16 v[144:147], a[172:175], a[8:11], v[144:147]
    ds_read_b128 a[208:211], v42 offset:4096
    v_cvt_pk_bf16_f32 v98, v100, v101
    v_mfma_f32_16x16x32_bf16 v[144:147], a[176:179], a[16:19], v[144:147]
    s_waitcnt lgkmcnt(4)
    v_mfma_f32_16x16x32_bf16 v[152:155], a[176:179], a[20:23], 0
    ds_read_b128 a[212:215], v42 offset:22528
    v_cvt_pk_bf16_f32 v99, v102, v103
    v_mfma_f32_16x16x32_bf16 v[152:155], a[172:175], a[12:15], v[152:155]
    v_mfma_f32_16x16x32_bf16 v[152:155], a[168:171], a[4:7], v[152:155]
    buffer_store_dwordx4 v[96:99], v13, s[60:63], s10 offen offset:0 sc1
    ds_read_b128 a[144:147], v41 offset:27648
    v_mfma_f32_16x16x32_bf16 v[148:151], a[180:183], a[0:3], 0
    v_fmac_f32 v206, v54, v248
    v_mfma_f32_16x16x32_bf16 v[148:151], a[184:187], a[8:11], v[148:151]
    ds_read_b128 a[148:151], v42 offset:9216
    v_fmac_f32 v207, v55, v249
    v_mfma_f32_16x16x32_bf16 v[148:151], a[188:191], a[16:19], v[148:151]
    s_waitcnt vmcnt(8)
    v_cvt_pk_bf16_f32 v104, v104, v105
    v_cvt_pk_bf16_f32 v105, v106, v107
    v_mfma_f32_16x16x32_bf16 v[156:159], a[188:191], a[20:23], 0
    ds_read_b128 a[152:155], v42 offset:27648
    v_lshlrev_b32 v160, 16, v56
    v_mfma_f32_16x16x32_bf16 v[156:159], a[184:187], a[12:15], v[156:159]
    s_waitcnt lgkmcnt(4)
    v_cvt_pk_bf16_f32 v106, v108, v109
    v_and_b32 v161, s15, v56
    v_mfma_f32_16x16x32_bf16 v[156:159], a[180:183], a[4:7], v[156:159]
    ds_read_b128 a[156:159], v41 offset:31744
    v_lshlrev_b32 v162, 16, v57
    v_mfma_f32_16x16x32_bf16 v[128:131], a[192:195], a[24:27], v[128:131]
L_ps2:
    s_cbranch_execz L_rs2
    v_add_u32 v41, 0x9000, v41
    v_cvt_pk_bf16_f32 v107, v110, v111
    v_mfma_f32_16x16x32_bf16 v[128:131], a[196:199], a[32:35], v[128:131]
    ds_read_b128 a[160:163], v42 offset:13312
    v_and_b32 v163, s15, v57
    v_mfma_f32_16x16x32_bf16 v[128:131], a[200:203], a[40:43], v[128:131]
    v_mfma_f32_16x16x32_bf16 v[136:139], a[200:203], a[44:47], v[136:139]
    buffer_store_dwordx4 v[104:107], v13, s[60:63], s10 offen offset:1024 sc1
    ds_read_b128 a[164:167], v42 offset:31744
    v_lshlrev_b32 v164, 16, v58
    v_and_b32 v165, s15, v58
    v_mfma_f32_16x16x32_bf16 v[136:139], a[196:199], a[36:39], v[136:139]
    v_add_u32 v42, 0x9000, v42
    v_lshlrev_b32 v166, 16, v59
    v_mfma_f32_16x16x32_bf16 v[136:139], a[192:195], a[28:31], v[136:139]
    ds_read_b128 a[168:171], v43 offset:0
    v_and_b32 v167, s15, v59
    v_mfma_f32_16x16x32_bf16 v[132:135], a[204:207], a[24:27], v[132:135]
    s_waitcnt lgkmcnt(4)
    v_lshlrev_b32 v168, 16, v60
    v_and_b32 v169, s15, v60
    v_mfma_f32_16x16x32_bf16 v[132:135], a[208:211], a[32:35], v[132:135]
    ds_read_b128 a[172:175], v43 offset:18432
    v_lshlrev_b32 v170, 16, v61
    v_and_b32 v171, s15, v61
    v_mfma_f32_16x16x32_bf16 v[132:135], a[212:215], a[40:43], v[132:135]
    v_lshlrev_b32 v172, 16, v62
    v_and_b32 v173, s15, v62
    v_mfma_f32_16x16x32_bf16 v[140:143], a[212:215], a[44:47], v[140:143]
    ds_read_b128 a[176:179], v44 offset:0
    v_lshlrev_b32 v174, 16, v63
    v_mfma_f32_16x16x32_bf16 v[140:143], a[208:211], a[36:39], v[140:143]
    s_waitcnt vmcnt(2)
    v_mfma_f32_16x16x32_bf16 v[140:143], a[204:207], a[28:31], v[140:143]
    buffer_store_dword v7, v7, s[60:63], 0 offen offset:384 sc1
    ds_read_b128 a[180:183], v43 offset:4096
    v_cvt_pk_bf16_f32 v112, v112, v113
    v_and_b32 v175, s15, v63
    v_mfma_f32_16x16x32_bf16 v[144:147], a[144:147], a[24:27], v[144:147]
    v_cvt_pk_bf16_f32 v113, v114, v115
    v_lshlrev_b32 v176, 16, v64
    v_mfma_f32_16x16x32_bf16 v[144:147], a[148:151], a[32:35], v[144:147]
    ds_read_b128 a[184:187], v43 offset:22528
    v_and_b32 v177, s15, v64
    v_mfma_f32_16x16x32_bf16 v[144:147], a[152:155], a[40:43], v[144:147]
    s_waitcnt lgkmcnt(4)
    v_cvt_pk_bf16_f32 v114, v116, v117
    v_cvt_pk_bf16_f32 v115, v118, v119
    v_mfma_f32_16x16x32_bf16 v[152:155], a[152:155], a[44:47], v[152:155]
    ds_read_b128 a[188:191], v44 offset:512
    v_lshlrev_b32 v178, 16, v65
    v_mfma_f32_16x16x32_bf16 v[152:155], a[148:151], a[36:39], v[152:155]
    v_mfma_f32_16x16x32_bf16 v[152:155], a[144:147], a[28:31], v[152:155]
    buffer_store_dwordx4 v[112:115], v13, s[60:63], s10 offen offset:2048 sc1
    ds_read_b128 a[192:195], v43 offset:9216
    v_and_b32 v179, s15, v65
    v_lshlrev_b32 v180, 16, v66
    v_mfma_f32_16x16x32_bf16 v[148:151], a[156:159], a[24:27], v[148:151]
    v_and_b32 v181, s15, v66
    v_lshlrev_b32 v182, 16, v67
    v_mfma_f32_16x16x32_bf16 v[148:151], a[160:163], a[32:35], v[148:151]
    ds_read_b128 a[196:199], v43 offset:27648
    v_and_b32 v183, s15, v67
    v_mfma_f32_16x16x32_bf16 v[148:151], a[164:167], a[40:43], v[148:151]
    v_cvt_pk_bf16_f32 v120, v120, v121
    v_lshlrev_b32 v32, 16, v68
    v_mfma_f32_16x16x32_bf16 v[156:159], a[164:167], a[44:47], v[156:159]
    ds_read_b128 a[200:203], v44 offset:9216
    v_lshlrev_b32 v33, 16, v69
    v_mfma_f32_16x16x32_bf16 v[156:159], a[160:163], a[36:39], v[156:159]
    s_waitcnt lgkmcnt(4)
    v_cvt_pk_bf16_f32 v121, v122, v123
    v_mfma_f32_16x16x32_bf16 v[156:159], a[156:159], a[28:31], v[156:159]
    ds_read_b128 a[204:207], v43 offset:13312
    v_cvt_pk_bf16_f32 v122, v124, v125
    v_mfma_f32_16x16x32_bf16 v[128:131], a[168:171], a[48:51], v[128:131]
    v_cvt_pk_bf16_f32 v123, v126, v127
    v_and_b32 v68, s15, v68
    v_mfma_f32_16x16x32_bf16 v[128:131], a[172:175], a[56:59], v[128:131]
    ds_read_b128 a[208:211], v43 offset:31744
    v_and_b32 v69, s15, v69
    v_mfma_f32_16x16x32_bf16 v[128:131], a[176:179], a[64:67], v[128:131]
    v_mfma_f32_16x16x32_bf16 v[136:139], a[176:179], a[68:71], v[136:139]
    buffer_store_dwordx4 v[120:123], v13, s[60:63], s10 offen offset:3072 sc1
    ds_read_b128 a[212:215], v44 offset:9728
    v_add_u32 v43, 0x9000, v43
    v_mfma_f32_16x16x32_bf16 v[136:139], a[172:175], a[60:63], v[136:139]
    v_add_u32 v44, 0x9000, v44
    v_add_f32 v160, v160, v32
    v_mfma_f32_16x16x32_bf16 v[136:139], a[168:171], a[52:55], v[136:139]
    v_add_f32 v162, v162, v33
    v_add_f32 v161, v161, v68
    v_mfma_f32_16x16x32_bf16 v[132:135], a[180:183], a[48:51], v[132:135]
    s_waitcnt lgkmcnt(3)
    v_add_f32 v163, v163, v69
    v_lshlrev_b32 v32, 16, v70
    v_mfma_f32_16x16x32_bf16 v[132:135], a[184:187], a[56:59], v[132:135]
    v_lshlrev_b32 v33, 16, v71
    v_and_b32 v70, s15, v70
    v_mfma_f32_16x16x32_bf16 v[132:135], a[188:191], a[64:67], v[132:135]
    v_and_b32 v71, s15, v71
    v_mfma_f32_16x16x32_bf16 v[140:143], a[188:191], a[68:71], v[140:143]
    v_add_f32 v164, v164, v32
    v_add_f32 v166, v166, v33
    v_mfma_f32_16x16x32_bf16 v[140:143], a[184:187], a[60:63], v[140:143]
    s_waitcnt lgkmcnt(0)
    s_barrier
    v_mfma_f32_16x16x32_bf16 v[140:143], a[180:183], a[52:55], v[140:143]
    ds_read_b128 a[144:147], v40 offset:0
    ds_read_b128 a[148:151], v40 offset:18432
    v_mfma_f32_16x16x32_bf16 v[144:147], a[192:195], a[48:51], v[144:147]
    ds_read_b128 a[152:155], v41 offset:0
    ds_read_b128 a[156:159], v40 offset:4096
    v_mfma_f32_16x16x32_bf16 v[144:147], a[196:199], a[56:59], v[144:147]
    s_mov_b32 s11, 24576
    buffer_load_dwordx4 v[56:59], v17, s[60:63], s11 offen offset:0 sc1
    v_mfma_f32_16x16x32_bf16 v[144:147], a[200:203], a[64:67], v[144:147]
    s_waitcnt lgkmcnt(3)
    ds_read_b128 a[160:163], v40 offset:22528
    v_add_f32 v165, v165, v70
    v_mfma_f32_16x16x32_bf16 v[152:155], a[200:203], a[68:71], v[152:155]
    ds_read_b128 a[164:167], v41 offset:4096
    v_add_f32 v167, v167, v71
    v_mfma_f32_16x16x32_bf16 v[152:155], a[196:199], a[60:63], v[152:155]
    v_lshlrev_b32 v32, 16, v72
    v_lshlrev_b32 v33, 16, v73
    v_mfma_f32_16x16x32_bf16 v[152:155], a[192:195], a[52:55], v[152:155]
    ds_read_b128 a[168:171], v40 offset:9216
    v_and_b32 v72, s15, v72
    v_mfma_f32_16x16x32_bf16 v[148:151], a[204:207], a[48:51], v[148:151]
    ds_read_b128 a[172:175], v40 offset:27648
    v_mfma_f32_16x16x32_bf16 v[148:151], a[208:211], a[56:59], v[148:151]
    buffer_load_dwordx4 v[60:63], v18, s[60:63], s11 offen offset:0 sc1
    v_mfma_f32_16x16x32_bf16 v[148:151], a[212:215], a[64:67], v[148:151]
    v_and_b32 v73, s15, v73
    v_add_f32 v168, v168, v32
    v_mfma_f32_16x16x32_bf16 v[156:159], a[212:215], a[68:71], v[156:159]
    ds_read_b128 a[176:179], v41 offset:9216
    v_add_f32 v170, v170, v33
    v_mfma_f32_16x16x32_bf16 v[156:159], a[208:211], a[60:63], v[156:159]
    s_waitcnt lgkmcnt(4)
    ds_read_b128 a[180:183], v40 offset:13312
    v_mfma_f32_16x16x32_bf16 v[156:159], a[204:207], a[52:55], v[156:159]
    buffer_load_dwordx4 v[64:67], v19, s[60:63], s11 offen offset:0 sc1
    v_mfma_f32_16x16x32_bf16 v[96:99], a[144:147], a[0:3], 0
    v_add_f32 v169, v169, v72
    v_add_f32 v171, v171, v73
    v_mfma_f32_16x16x32_bf16 v[96:99], a[148:151], a[8:11], v[96:99]
    ds_read_b128 a[184:187], v40 offset:31744
    v_lshlrev_b32 v32, 16, v74
    v_mfma_f32_16x16x32_bf16 v[96:99], a[152:155], a[16:19], v[96:99]
    v_lshlrev_b32 v33, 16, v75
    v_and_b32 v74, s15, v74
    v_mfma_f32_16x16x32_bf16 v[104:107], a[152:155], a[20:23], 0
    s_mul_i32 s10, s98, 32768
    ds_read_b128 a[188:191], v41 offset:13312
    v_and_b32 v75, s15, v75
    v_mfma_f32_16x16x32_bf16 v[104:107], a[148:151], a[12:15], v[104:107]
    v_cvt_pk_bf16_f32 v128, v128, v129
    v_mfma_f32_16x16x32_bf16 v[104:107], a[144:147], a[4:7], v[104:107]
    ds_read_b128 a[192:195], v41 offset:18432
    v_add_f32 v172, v172, v32
    v_mfma_f32_16x16x32_bf16 v[100:103], a[156:159], a[0:3], 0
    s_waitcnt lgkmcnt(4)
    v_cvt_pk_bf16_f32 v129, v130, v131
    v_cvt_pk_bf16_f32 v130, v132, v133
    v_mfma_f32_16x16x32_bf16 v[100:103], a[160:163], a[8:11], v[100:103]
    ds_read_b128 a[196:199], v42 offset:0
    v_add_f32 v174, v174, v33
    v_mfma_f32_16x16x32_bf16 v[100:103], a[164:167], a[16:19], v[100:103]
    v_cvt_pk_bf16_f32 v131, v134, v135
    v_add_f32 v173, v173, v74
    v_mfma_f32_16x16x32_bf16 v[108:111], a[164:167], a[20:23], 0
    ds_read_b128 a[200:203], v42 offset:18432
    v_add_f32 v175, v175, v75
    v_mfma_f32_16x16x32_bf16 v[108:111], a[160:163], a[12:15], v[108:111]
    v_mfma_f32_16x16x32_bf16 v[108:111], a[156:159], a[4:7], v[108:111]
    buffer_store_dwordx4 v[128:131], v13, s[60:63], s10 offen offset:0 sc1
    ds_read_b128 a[204:207], v41 offset:22528
    v_cvt_pk_bf16_f32 v136, v136, v137
    v_mfma_f32_16x16x32_bf16 v[112:115], a[168:171], a[0:3], 0
    v_cvt_pk_bf16_f32 v137, v138, v139
    v_lshlrev_b32 v32, 16, v76
    v_mfma_f32_16x16x32_bf16 v[112:115], a[172:175], a[8:11], v[112:115]
    ds_read_b128 a[208:211], v42 offset:4096
    v_lshlrev_b32 v33, 16, v77
    v_mfma_f32_16x16x32_bf16 v[112:115], a[176:179], a[16:19], v[112:115]
    s_waitcnt lgkmcnt(4)
    v_cvt_pk_bf16_f32 v138, v140, v141
    v_mfma_f32_16x16x32_bf16 v[120:123], a[176:179], a[20:23], 0
    ds_read_b128 a[212:215], v42 offset:22528
    v_cvt_pk_bf16_f32 v139, v142, v143
    v_mfma_f32_16x16x32_bf16 v[120:123], a[172:175], a[12:15], v[120:123]
    v_mfma_f32_16x16x32_bf16 v[120:123], a[168:171], a[4:7], v[120:123]
    buffer_store_dwordx4 v[136:139], v13, s[60:63], s10 offen offset:1024 sc1
    ds_read_b128 a[144:147], v41 offset:27648
    v_cvt_pk_bf16_f32 v144, v144, v145
    v_and_b32 v76, s15, v76
    v_mfma_f32_16x16x32_bf16 v[116:119], a[180:183], a[0:3], 0
    v_cvt_pk_bf16_f32 v145, v146, v147
    v_mfma_f32_16x16x32_bf16 v[116:119], a[184:187], a[8:11], v[116:119]
    ds_read_b128 a[148:151], v42 offset:9216
    v_and_b32 v77, s15, v77
    v_mfma_f32_16x16x32_bf16 v[116:119], a[188:191], a[16:19], v[116:119]
    v_cvt_pk_bf16_f32 v146, v148, v149
    v_cvt_pk_bf16_f32 v147, v150, v151
    v_mfma_f32_16x16x32_bf16 v[124:127], a[188:191], a[20:23], 0
    ds_read_b128 a[152:155], v42 offset:27648
    v_add_f32 v176, v176, v32
    v_mfma_f32_16x16x32_bf16 v[124:127], a[184:187], a[12:15], v[124:127]
    s_waitcnt lgkmcnt(4)
    v_mfma_f32_16x16x32_bf16 v[124:127], a[180:183], a[4:7], v[124:127]
    buffer_store_dwordx4 v[144:147], v13, s[60:63], s10 offen offset:2048 sc1
    ds_read_b128 a[156:159], v41 offset:31744
    v_cvt_pk_bf16_f32 v152, v152, v153
    v_add_f32 v178, v178, v33
    v_mfma_f32_16x16x32_bf16 v[96:99], a[192:195], a[24:27], v[96:99]
    v_cvt_pk_bf16_f32 v153, v154, v155
    v_mfma_f32_16x16x32_bf16 v[96:99], a[196:199], a[32:35], v[96:99]
    ds_read_b128 a[160:163], v42 offset:13312
    v_add_f32 v177, v177, v76
    v_mfma_f32_16x16x32_bf16 v[96:99], a[200:203], a[40:43], v[96:99]
    v_cvt_pk_bf16_f32 v154, v156, v157
    v_cvt_pk_bf16_f32 v155, v158, v159
    v_mfma_f32_16x16x32_bf16 v[104:107], a[200:203], a[44:47], v[104:107]
    ds_read_b128 a[164:167], v42 offset:31744
    v_add_f32 v179, v179, v77
    v_mfma_f32_16x16x32_bf16 v[104:107], a[196:199], a[36:39], v[104:107]
    v_mfma_f32_16x16x32_bf16 v[104:107], a[192:195], a[28:31], v[104:107]
    buffer_store_dwordx4 v[152:155], v13, s[60:63], s10 offen offset:3072 sc1
    ds_read_b128 a[168:171], v43 offset:0
    v_lshlrev_b32 v32, 16, v78
    v_mfma_f32_16x16x32_bf16 v[100:103], a[204:207], a[24:27], v[100:103]
    s_waitcnt lgkmcnt(4)
    v_lshlrev_b32 v33, 16, v79
    v_and_b32 v78, s15, v78
    v_mfma_f32_16x16x32_bf16 v[100:103], a[208:211], a[32:35], v[100:103]
    ds_read_b128 a[172:175], v43 offset:18432
    v_and_b32 v79, s15, v79
    v_mfma_f32_16x16x32_bf16 v[100:103], a[212:215], a[40:43], v[100:103]
    v_add_f32 v180, v180, v32
    v_add_f32 v182, v182, v33
    v_mfma_f32_16x16x32_bf16 v[108:111], a[212:215], a[44:47], v[108:111]
    ds_read_b128 a[176:179], v44 offset:0
    v_add_f32 v181, v181, v78
    v_mfma_f32_16x16x32_bf16 v[108:111], a[208:211], a[36:39], v[108:111]
    s_waitcnt vmcnt(7)
    v_mfma_f32_16x16x32_bf16 v[108:111], a[204:207], a[28:31], v[108:111]
    buffer_store_dword v7, v7, s[60:63], 0 offen offset:512 sc1
    ds_read_b128 a[180:183], v43 offset:4096
    v_add_f32 v183, v183, v79
    v_mfma_f32_16x16x32_bf16 v[112:115], a[144:147], a[24:27], v[112:115]
    v_mfma_f32_16x16x32_bf16 v[112:115], a[148:151], a[32:35], v[112:115]
    ds_read_b128 a[184:187], v43 offset:22528
    v_mfma_f32_16x16x32_bf16 v[112:115], a[152:155], a[40:43], v[112:115]
    s_waitcnt lgkmcnt(4)
    v_mfma_f32_16x16x32_bf16 v[120:123], a[152:155], a[44:47], v[120:123]
    ds_read_b128 a[188:191], v44 offset:512
    v_mfma_f32_16x16x32_bf16 v[120:123], a[148:151], a[36:39], v[120:123]
    ds_read_b128 a[192:195], v43 offset:9216
    v_mfma_f32_16x16x32_bf16 v[120:123], a[144:147], a[28:31], v[120:123]
    s_mov_b32 s11, 28672
    buffer_load_dwordx4 v[68:71], v17, s[60:63], s11 offen offset:0 sc1
    v_mfma_f32_16x16x32_bf16 v[116:119], a[156:159], a[24:27], v[116:119]
    v_mfma_f32_16x16x32_bf16 v[116:119], a[160:163], a[32:35], v[116:119]
    ds_read_b128 a[196:199], v43 offset:27648
    v_mfma_f32_16x16x32_bf16 v[116:119], a[164:167], a[40:43], v[116:119]
    v_mfma_f32_16x16x32_bf16 v[124:127], a[164:167], a[44:47], v[124:127]
    ds_read_b128 a[200:203], v44 offset:9216
    v_mfma_f32_16x16x32_bf16 v[124:127], a[160:163], a[36:39], v[124:127]
    s_waitcnt lgkmcnt(4)
    ds_read_b128 a[204:207], v43 offset:13312
    v_mfma_f32_16x16x32_bf16 v[124:127], a[156:159], a[28:31], v[124:127]
    buffer_load_dwordx4 v[72:75], v18, s[60:63], s11 offen offset:0 sc1
    v_mfma_f32_16x16x32_bf16 v[96:99], a[168:171], a[48:51], v[96:99]
    v_mfma_f32_16x16x32_bf16 v[96:99], a[172:175], a[56:59], v[96:99]
    ds_read_b128 a[208:211], v43 offset:31744
    v_mfma_f32_16x16x32_bf16 v[96:99], a[176:179], a[64:67], v[96:99]
    v_mfma_f32_16x16x32_bf16 v[104:107], a[176:179], a[68:71], v[104:107]
    ds_read_b128 a[212:215], v44 offset:9728
    v_mfma_f32_16x16x32_bf16 v[104:107], a[172:175], a[60:63], v[104:107]
    v_mfma_f32_16x16x32_bf16 v[104:107], a[168:171], a[52:55], v[104:107]
    buffer_load_dwordx4 v[76:79], v19, s[60:63], s11 offen offset:0 sc1
    v_mfma_f32_16x16x32_bf16 v[100:103], a[180:183], a[48:51], v[100:103]
    s_waitcnt lgkmcnt(3)
    v_mfma_f32_16x16x32_bf16 v[100:103], a[184:187], a[56:59], v[100:103]
    v_mfma_f32_16x16x32_bf16 v[100:103], a[188:191], a[64:67], v[100:103]
    v_mfma_f32_16x16x32_bf16 v[108:111], a[188:191], a[68:71], v[108:111]
    v_mfma_f32_16x16x32_bf16 v[108:111], a[184:187], a[60:63], v[108:111]
    v_mfma_f32_16x16x32_bf16 v[108:111], a[180:183], a[52:55], v[108:111]
    v_mfma_f32_16x16x32_bf16 v[112:115], a[192:195], a[48:51], v[112:115]
    v_mfma_f32_16x16x32_bf16 v[112:115], a[196:199], a[56:59], v[112:115]
    v_mfma_f32_16x16x32_bf16 v[112:115], a[200:203], a[64:67], v[112:115]
    s_waitcnt lgkmcnt(0)
    v_mfma_f32_16x16x32_bf16 v[120:123], a[200:203], a[68:71], v[120:123]
    v_mfma_f32_16x16x32_bf16 v[120:123], a[196:199], a[60:63], v[120:123]
    v_mfma_f32_16x16x32_bf16 v[120:123], a[192:195], a[52:55], v[120:123]
    v_mfma_f32_16x16x32_bf16 v[116:119], a[204:207], a[48:51], v[116:119]
    v_mfma_f32_16x16x32_bf16 v[116:119], a[208:211], a[56:59], v[116:119]
    v_mfma_f32_16x16x32_bf16 v[116:119], a[212:215], a[64:67], v[116:119]
    v_mfma_f32_16x16x32_bf16 v[124:127], a[212:215], a[68:71], v[124:127]
    v_mfma_f32_16x16x32_bf16 v[124:127], a[208:211], a[60:63], v[124:127]
    v_mfma_f32_16x16x32_bf16 v[124:127], a[204:207], a[52:55], v[124:127]
    s_mul_i32 s10, s99, 32768
    s_waitcnt vmcnt(4)
    buffer_store_dword v7, v7, s[60:63], 0 offen offset:640 sc1
    v_cvt_pk_bf16_f32 v96, v96, v97
    v_cvt_pk_bf16_f32 v97, v98, v99
    v_cvt_pk_bf16_f32 v98, v100, v101
    v_cvt_pk_bf16_f32 v99, v102, v103
    buffer_store_dwordx4 v[96:99], v13, s[60:63], s10 offen offset:0 sc1
    v_cvt_pk_bf16_f32 v104, v104, v105
    v_cvt_pk_bf16_f32 v105, v106, v107
    v_cvt_pk_bf16_f32 v106, v108, v109
    v_cvt_pk_bf16_f32 v107, v110, v111
    buffer_store_dwordx4 v[104:107], v13, s[60:63], s10 offen offset:1024 sc1
    v_cvt_pk_bf16_f32 v112, v112, v113
    v_cvt_pk_bf16_f32 v113, v114, v115
    v_cvt_pk_bf16_f32 v114, v116, v117
    v_cvt_pk_bf16_f32 v115, v118, v119
    buffer_store_dwordx4 v[112:115], v13, s[60:63], s10 offen offset:2048 sc1
    v_cvt_pk_bf16_f32 v120, v120, v121
    v_cvt_pk_bf16_f32 v121, v122, v123
    v_cvt_pk_bf16_f32 v122, v124, v125
    v_cvt_pk_bf16_f32 v123, v126, v127
    buffer_store_dwordx4 v[120:123], v13, s[60:63], s10 offen offset:3072 sc1
    s_mov_b32 s64, s40
    s_mov_b32 s65, s41
    s_mov_b32 s66, 0x480000
    s_mov_b32 s67, 0x20000
    s_mov_b32 s12, 0x3f80
    s_mov_b32 s13, 0x3f800000
    v_mov_b32 v1, 0xbf317218
    buffer_load_dword v15, v14, s[60:63], 0 offen offset:768 sc1
    v_dot2c_f32_bf16 v160, s12, v56
    v_dot2c_f32_bf16 v161, s13, v56
    v_dot2c_f32_bf16 v162, s12, v57
    v_dot2c_f32_bf16 v163, s13, v57
    v_dot2c_f32_bf16 v164, s12, v58
    v_dot2c_f32_bf16 v165, s13, v58
    v_dot2c_f32_bf16 v166, s12, v59
    v_dot2c_f32_bf16 v167, s13, v59
    v_dot2c_f32_bf16 v168, s12, v60
    v_dot2c_f32_bf16 v169, s13, v60
    v_dot2c_f32_bf16 v170, s12, v61
    v_dot2c_f32_bf16 v171, s13, v61
    v_dot2c_f32_bf16 v172, s12, v62
    v_dot2c_f32_bf16 v173, s13, v62
    v_dot2c_f32_bf16 v174, s12, v63
    v_dot2c_f32_bf16 v175, s13, v63
    v_dot2c_f32_bf16 v176, s12, v64
    v_dot2c_f32_bf16 v177, s13, v64
    v_dot2c_f32_bf16 v178, s12, v65
    v_dot2c_f32_bf16 v179, s13, v65
    v_dot2c_f32_bf16 v180, s12, v66
    v_dot2c_f32_bf16 v181, s13, v66
    v_dot2c_f32_bf16 v182, s12, v67
    v_dot2c_f32_bf16 v183, s13, v67
    s_waitcnt vmcnt(8)
    v_dot2c_f32_bf16 v160, s12, v68
    v_dot2c_f32_bf16 v161, s13, v68
    v_dot2c_f32_bf16 v162, s12, v69
    v_dot2c_f32_bf16 v163, s13, v69
    v_dot2c_f32_bf16 v164, s12, v70
    v_dot2c_f32_bf16 v165, s13, v70
    v_dot2c_f32_bf16 v166, s12, v71
    v_dot2c_f32_bf16 v167, s13, v71
    s_waitcnt vmcnt(7)
    v_dot2c_f32_bf16 v168, s12, v72
    v_dot2c_f32_bf16 v169, s13, v72
    v_dot2c_f32_bf16 v170, s12, v73
    v_dot2c_f32_bf16 v171, s13, v73
    v_dot2c_f32_bf16 v172, s12, v74
    v_dot2c_f32_bf16 v173, s13, v74
    v_dot2c_f32_bf16 v174, s12, v75
    v_dot2c_f32_bf16 v175, s13, v75
    s_waitcnt vmcnt(6)
    v_dot2c_f32_bf16 v176, s12, v76
    v_dot2c_f32_bf16 v177, s13, v76
    v_dot2c_f32_bf16 v178, s12, v77
    v_dot2c_f32_bf16 v179, s13, v77
    v_dot2c_f32_bf16 v180, s12, v78
    v_dot2c_f32_bf16 v181, s13, v78
    v_dot2c_f32_bf16 v182, s12, v79
    v_dot2c_f32_bf16 v183, s13, v79
    s_waitcnt vmcnt(1)
    buffer_store_dword v7, v7, s[60:63], 0 offen offset:768 sc1
    s_waitcnt vmcnt(1)
    v_cmp_eq_u32 vcc, 0, v15
    s_nop 1
    s_cbranch_vccnz L_sa_spin
L_sa_ret:
    s_mov_b32 s11, 0
    buffer_load_dwordx4 v[136:139], v17, s[60:63], s11 offen offset:0 sc1
    buffer_load_dwordx4 v[140:143], v18, s[60:63], s11 offen offset:0 sc1
    buffer_load_dwordx4 v[144:147], v19, s[60:63], s11 offen offset:0 sc1
    s_mov_b32 s11, 4096
    buffer_load_dwordx4 v[148:151], v17, s[60:63], s11 offen offset:0 sc1
    buffer_load_dwordx4 v[152:155], v18, s[60:63], s11 offen offset:0 sc1
    buffer_load_dwordx4 v[156:159], v19, s[60:63], s11 offen offset:0 sc1
    s_mov_b32 s11, 8192
    buffer_load_dwordx4 v[112:115], v17, s[60:63], s11 offen offset:0 sc1
    buffer_load_dwordx4 v[116:119], v18, s[60:63], s11 offen offset:0 sc1
    buffer_load_dwordx4 v[120:123], v19, s[60:63], s11 offen offset:0 sc1
    s_mov_b32 s11, 12288
    buffer_load_dwordx4 v[124:127], v17, s[60:63], s11 offen offset:0 sc1
    buffer_load_dwordx4 v[128:131], v18, s[60:63], s11 offen offset:0 sc1
    buffer_load_dwordx4 v[132:135], v19, s[60:63], s11 offen offset:0 sc1
    s_waitcnt vmcnt(11)
    v_dot2c_f32_bf16 v160, s12, v136
    v_dot2c_f32_bf16 v161, s13, v136
    v_dot2c_f32_bf16 v162, s12, v137
    v_dot2c_f32_bf16 v163, s13, v137
    v_dot2c_f32_bf16 v164, s12, v138
    v_dot2c_f32_bf16 v165, s13, v138
    v_dot2c_f32_bf16 v166, s12, v139
    v_dot2c_f32_bf16 v167, s13, v139
    s_waitcnt vmcnt(10)
    v_dot2c_f32_bf16 v168, s12, v140
    v_dot2c_f32_bf16 v169, s13, v140
    v_dot2c_f32_bf16 v170, s12, v141
    v_dot2c_f32_bf16 v171, s13, v141
    v_dot2c_f32_bf16 v172, s12, v142
    v_dot2c_f32_bf16 v173, s13, v142
    v_dot2c_f32_bf16 v174, s12, v143
    v_dot2c_f32_bf16 v175, s13, v143
    s_waitcnt vmcnt(9)
    v_dot2c_f32_bf16 v176, s12, v144
    v_dot2c_f32_bf16 v177, s13, v144
    v_dot2c_f32_bf16 v178, s12, v145
    v_dot2c_f32_bf16 v179, s13, v145
    v_dot2c_f32_bf16 v180, s12, v146
    v_dot2c_f32_bf16 v181, s13, v146
    v_dot2c_f32_bf16 v182, s12, v147
    v_dot2c_f32_bf16 v183, s13, v147
    s_waitcnt vmcnt(8)
    v_dot2c_f32_bf16 v160, s12, v148
    v_dot2c_f32_bf16 v161, s13, v148
    v_dot2c_f32_bf16 v162, s12, v149
    v_dot2c_f32_bf16 v163, s13, v149
    v_dot2c_f32_bf16 v164, s12, v150
    v_dot2c_f32_bf16 v165, s13, v150
    v_dot2c_f32_bf16 v166, s12, v151
    v_dot2c_f32_bf16 v167, s13, v151
    s_waitcnt vmcnt(7)
    v_dot2c_f32_bf16 v168, s12, v152
    v_dot2c_f32_bf16 v169, s13, v152
    v_dot2c_f32_bf16 v170, s12, v153
    v_dot2c_f32_bf16 v171, s13, v153
    v_dot2c_f32_bf16 v172, s12, v154
    v_dot2c_f32_bf16 v173, s13, v154
    v_dot2c_f32_bf16 v174, s12, v155
    v_dot2c_f32_bf16 v175, s13, v155
    s_waitcnt vmcnt(6)
    v_dot2c_f32_bf16 v176, s12, v156
    v_dot2c_f32_bf16 v177, s13, v156
    v_dot2c_f32_bf16 v178, s12, v157
    v_dot2c_f32_bf16 v179, s13, v157
    v_dot2c_f32_bf16 v180, s12, v158
    v_dot2c_f32_bf16 v181, s13, v158
    v_dot2c_f32_bf16 v182, s12, v159
    v_dot2c_f32_bf16 v183, s13, v159
    s_waitcnt vmcnt(5)
    v_dot2c_f32_bf16 v160, s12, v112
    v_dot2c_f32_bf16 v161, s13, v112
    v_dot2c_f32_bf16 v162, s12, v113
    v_dot2c_f32_bf16 v163, s13, v113
    v_dot2c_f32_bf16 v164, s12, v114
    v_dot2c_f32_bf16 v165, s13, v114
    v_dot2c_f32_bf16 v166, s12, v115
    v_dot2c_f32_bf16 v167, s13, v115
    s_waitcnt vmcnt(4)
    v_dot2c_f32_bf16 v168, s12, v116
    v_dot2c_f32_bf16 v169, s13, v116
    v_dot2c_f32_bf16 v170, s12, v117
    v_dot2c_f32_bf16 v171, s13, v117
    v_dot2c_f32_bf16 v172, s12, v118
    v_dot2c_f32_bf16 v173, s13, v118
    v_dot2c_f32_bf16 v174, s12, v119
    v_dot2c_f32_bf16 v175, s13, v119
    s_waitcnt vmcnt(3)
    v_dot2c_f32_bf16 v176, s12, v120
    v_dot2c_f32_bf16 v177, s13, v120
    v_dot2c_f32_bf16 v178, s12, v121
    v_dot2c_f32_bf16 v179, s13, v121
    v_dot2c_f32_bf16 v180, s12, v122
    v_dot2c_f32_bf16 v181, s13, v122
    v_dot2c_f32_bf16 v182, s12, v123
    v_dot2c_f32_bf16 v183, s13, v123
    s_waitcnt vmcnt(2)
    v_dot2c_f32_bf16 v160, s12, v124
    v_dot2c_f32_bf16 v161, s13, v124
    v_dot2c_f32_bf16 v162, s12, v125
    v_dot2c_f32_bf16 v163, s13, v125
    v_dot2c_f32_bf16 v164, s12, v126
    v_dot2c_f32_bf16 v165, s13, v126
    v_dot2c_f32_bf16 v166, s12, v127
    v_dot2c_f32_bf16 v167, s13, v127
    s_waitcnt vmcnt(1)
    v_dot2c_f32_bf16 v168, s12, v128
    v_dot2c_f32_bf16 v169, s13, v128
    v_dot2c_f32_bf16 v170, s12, v129
    v_dot2c_f32_bf16 v171, s13, v129
    v_dot2c_f32_bf16 v172, s12, v130
    v_dot2c_f32_bf16 v173, s13, v130
    v_dot2c_f32_bf16 v174, s12, v131
    v_dot2c_f32_bf16 v175, s13, v131
    s_waitcnt vmcnt(0)
    v_dot2c_f32_bf16 v176, s12, v132
    v_dot2c_f32_bf16 v177, s13, v132
    v_dot2c_f32_bf16 v178, s12, v133
    v_dot2c_f32_bf16 v179, s13, v133
    v_dot2c_f32_bf16 v180, s12, v134
    v_dot2c_f32_bf16 v181, s13, v134
    v_dot2c_f32_bf16 v182, s12, v135
    v_dot2c_f32_bf16 v183, s13, v135
    ds_write_b128 v80, v[160:163] offset:0
    ds_write_b128 v81, v[164:167] offset:0
    ds_write_b128 v80, v[168:171] offset:2048
    ds_write_b128 v81, v[172:175] offset:2048
    ds_write_b128 v80, v[176:179] offset:4096
    ds_write_b128 v81, v[180:183] offset:4096
    ds_read_b128 v[208:211], v84 offset:0
    ds_read_b128 v[212:215], v84 offset:1024
    ds_read_b128 v[216:219], v84 offset:2048
    ds_read_b128 v[220:223], v84 offset:3072
    ds_read_b128 v[224:227], v84 offset:4096
    ds_read_b128 v[228:231], v84 offset:5120
    s_add_u32 s11, s18, 0
    s_waitcnt lgkmcnt(5)
    v_fma_f32 v208, v208, v1, v184
    v_fma_f32 v209, v209, v1, v185
    v_fma_f32 v210, v210, v1, v186
    v_fma_f32 v211, v211, v1, v187
    buffer_store_dwordx4 v[208:211], v85, s[64:67], s11 offen sc1
    s_add_u32 s11, s18, 36864
    s_waitcnt lgkmcnt(4)
    v_fma_f32 v212, v212, v1, v188
    v_fma_f32 v213, v213, v1, v189
    v_fma_f32 v214, v214, v1, v190
    v_fma_f32 v215, v215, v1, v191
    buffer_store_dwordx4 v[212:215], v85, s[64:67], s11 offen sc1
    s_add_u32 s11, s19, 0
    s_waitcnt lgkmcnt(3)
    v_fma_f32 v216, v216, v1, v192
    v_fma_f32 v217, v217, v1, v193
    v_fma_f32 v218, v218, v1, v194
    v_fma_f32 v219, v219, v1, v195
    buffer_store_dwordx4 v[216:219], v85, s[64:67], s11 offen sc1
    s_add_u32 s11, s19, 36864
    s_waitcnt lgkmcnt(2)
    v_fma_f32 v220, v220, v1, v196
    v_fma_f32 v221, v221, v1, v197
    v_fma_f32 v222, v222, v1, v198
    v_fma_f32 v223, v223, v1, v199
    buffer_store_dwordx4 v[220:223], v85, s[64:67], s11 offen sc1
    s_add_u32 s11, s20, 0
    s_waitcnt lgkmcnt(1)
    v_fma_f32 v224, v224, v1, v200
    v_fma_f32 v225, v225, v1, v201
    v_fma_f32 v226, v226, v1, v202
    v_fma_f32 v227, v227, v1, v203
    buffer_store_dwordx4 v[224:227], v85, s[64:67], s11 offen sc1
    s_add_u32 s11, s20, 36864
    s_waitcnt lgkmcnt(0)
    v_fma_f32 v228, v228, v1, v204
    v_fma_f32 v229, v229, v1, v205
    v_fma_f32 v230, v230, v1, v206
    v_fma_f32 v231, v231, v1, v207
    buffer_store_dwordx4 v[228:231], v85, s[64:67], s11 offen sc1
    s_endpgm
L_ps6:
    s_branch L_rs6
L_sc0_spin:
    global_load_dword v41, v40, s[42:43] sc1
    s_add_u32 s69, s69, 1
    s_cmp_lt_u32 s69, 0x800000
    s_cselect_b64 s[100:101], -1, 0
    s_waitcnt vmcnt(0)
    v_cmp_gt_u32 vcc, 16, v41
    s_nop 0
    s_and_b64 vcc, vcc, s[100:101]
    s_cbranch_scc1 L_sc0_spin
    s_branch L_sc0_ret
L_sa_spin:
    buffer_load_dword v15, v14, s[60:63], 0 offen offset:768 sc1
    s_add_u32 s69, s69, 1
    s_cmp_lt_u32 s69, 0x800000
    s_cselect_b64 s[100:101], -1, 0
    s_waitcnt vmcnt(0)
    v_cmp_eq_u32 vcc, 0, v15
    s_nop 0
    s_and_b64 vcc, vcc, s[100:101]
    s_cbranch_scc1 L_sa_spin
    s_branch L_sa_ret
L_sb_spin:
    buffer_load_dword v15, v31, s[60:63], 0 offen offset:896 sc1
    s_add_u32 s69, s69, 1
    s_cmp_lt_u32 s69, 0x800000
    s_cselect_b64 s[100:101], -1, 0
    s_waitcnt vmcnt(0)
    v_cmp_eq_u32 vcc, 0, v15
    s_nop 0
    s_and_b64 vcc, vcc, s[100:101]
    s_cbranch_scc1 L_sb_spin
    s_branch L_sb_ret
L_code_end:
    s_endpgm
.section .rodata,"a"
.p2align 6
.amdhsa_kernel parallel_sum__ssm_conv_s5__dense_activation_silu__prompt_kernel
  .amdhsa_next_free_vgpr 512
  .amdhsa_next_free_sgpr 102
  .amdhsa_accum_offset 256
  .amdhsa_group_segment_fixed_size 0
  .amdhsa_kernarg_size 120
  .amdhsa_user_sgpr_count 2
  .amdhsa_user_sgpr_kernarg_segment_ptr 1
  .amdhsa_system_sgpr_workgroup_id_x 1
  .amdhsa_float_denorm_mode_32 3
.end_amdhsa_kernel
```
